```python
import torch

def _softmax(x, axis=-1):
    return torch.softmax(x, dim=axis)
def _gelu(x):
    return torch.nn.functional.gelu(x, approximate="tanh")
def _silu(x):
    return torch.nn.functional.silu(x)
def _sigmoid(x):
    return torch.sigmoid(x)
def _layernorm(x, axis=-1, eps=1e-5):
    m = x.mean(dim=axis, keepdim=True)
    v = x.var(dim=axis, keepdim=True, unbiased=False)
    return (x - m) / torch.sqrt(v + eps)
def _scatter_add(tgt, idx, src, axis=0):
    return tgt.clone().index_add_(axis, idx, src)
def _segment_sum(src, seg, n):
    out = torch.zeros((n,) + src.shape[1:], dtype=src.dtype)
    return out.index_add_(0, seg, src)
def _pad(x, pw):
    flat = tuple(v for pair in reversed(pw) for v in pair)
    return torch.nn.functional.pad(x, flat)

kernel_name = 'parallel_sum__compressed_kv_cla__moe_arch_mod__prompt'

def setup_inputs():

    _w = (lambda a: (lambda t: t.to(torch.bfloat16) if t.is_floating_point() else t)(torch.as_tensor(a)))
    def _A_setup():
        B, H, Sq, Sk, D, M = 1, 32, 2048, 2048, 128, 576
        Dc = 4 * D
        return {
            "x": _w((lambda *s: torch.randn(*s, dtype=torch.bfloat16) * 0.05)(B, Sq, M)),
            "c_kv": _w((lambda *s: torch.randn(*s, dtype=torch.bfloat16) * 1.6)(B, Sk, Dc)),
            "w_q": _w((lambda *s: torch.randn(*s, dtype=torch.bfloat16) * 0.8)(M, H, D) * (M ** -0.5)),
            "w_uk": _w((lambda *s: torch.randn(*s, dtype=torch.bfloat16) * 0.8)(Dc, H, D) * (Dc ** -0.5)),
            "w_uv": _w((lambda *s: torch.randn(*s, dtype=torch.bfloat16) * 1.6)(Dc, H, D) * (Dc ** -0.5)),
            "w_o": _w((lambda *s: torch.randn(*s, dtype=torch.bfloat16) * 1.6)(H, D, M) * ((H * D) ** -0.5)),
        }
    _A_in = _A_setup()

    def _B_setup():
        B, S, D, F, C = 1, 2048, 576, 4608, 8
        return {
            "x": _w((lambda *s: torch.randn(*s, dtype=torch.bfloat16) * 0.05)(B, S, D)),
            "w_r": _w((lambda *s: torch.randn(*s, dtype=torch.bfloat16) * 0.05)(D)),
            "w_gate": _w((lambda *s: torch.randn(*s, dtype=torch.bfloat16) * 0.05)(D, F)),
            "w_up": _w((lambda *s: torch.randn(*s, dtype=torch.bfloat16) * 0.05)(D, F)),
            "w_down": _w((lambda *s: torch.randn(*s, dtype=torch.bfloat16) * 0.05)(F, D)),
        }
    _B_in = _B_setup()

    return {
        "A_x": _A_in["x"],
        "A_c_kv": _A_in["c_kv"],
        "A_w_q": _A_in["w_q"],
        "A_w_uk": _A_in["w_uk"],
        "A_w_uv": _A_in["w_uv"],
        "A_w_o": _A_in["w_o"],
        "B_x": _B_in["x"],
        "B_w_r": _B_in["w_r"],
        "B_w_gate": _B_in["w_gate"],
        "B_w_up": _B_in["w_up"],
        "B_w_down": _B_in["w_down"],
    }

def reference(A_x, A_c_kv, A_w_q, A_w_uk, A_w_uv, A_w_o, B_x, B_w_r, B_w_gate, B_w_up, B_w_down):
    def _A_ref(x, c_kv, w_q, w_uk, w_uv, w_o):
        B, Sq, M = x.shape[0], x.shape[1], x.shape[2]
        Sk = c_kv.shape[1]
        H, D = w_q.shape[1], w_q.shape[2]
        q = torch.einsum("bqm,mhd->bhqd", x, w_q)
        k = torch.einsum("bkc,chd->bhkd", c_kv, w_uk)
        v = torch.einsum("bkc,chd->bhkd", c_kv, w_uv)
        scores = torch.einsum("bhqd,bhkd->bhqk", q, k) * (D ** -0.5)
        off = Sk - Sq
        qi = torch.arange(Sq)[:, None]
        kj = torch.arange(Sk)[None, :]
        cmask = kj <= (qi + off)
        scores = torch.where(cmask[None, None], scores, -1e9)
        p = _softmax(scores, axis=-1)
        ctx = torch.einsum("bhqk,bhkd->bhqd", p, v)
        return torch.einsum("bhqd,hdm->bqm", ctx, w_o)

    def _B_ref(x, w_r, w_gate, w_up, w_down):
        B, S, D = x.shape
        C = 8
        r = x @ w_r
        idx = torch.argsort(-r, axis=-1)[:, :C]
        idx_e = (lambda x, n, axis: torch.repeat_interleave(x, n, dim=axis))(idx.reshape(B, C, 1), D, axis=2)
        x_sel = (lambda x, i, axis: torch.take_along_dim(x, i, dim=axis))(x, idx_e, axis=1)
        g = _silu(x_sel @ w_gate)
        u = x_sel @ w_up
        y = (g * u) @ w_down
        r_sel = _sigmoid((lambda x, i, axis: torch.take_along_dim(x, i, dim=axis))(r, idx, axis=1))
        y = y * r_sel.reshape(B, C, 1)
        b_off = (torch.arange(B) * S).reshape(B, 1)
        flat_idx = (idx + b_off).reshape(B * C)
        zero = (x * 0.0).reshape(B * S, D)
        upd = _scatter_add(zero, flat_idx, y.reshape(B * C, D), axis=0)
        return x + upd.reshape(B, S, D)

    x = A_x
    xn = _layernorm(x, axis=-1)
    return x + _A_ref(xn, A_c_kv, A_w_q, A_w_uk, A_w_uv, A_w_o) + _B_ref(xn, B_w_r, B_w_gate, B_w_up, B_w_down)
```

```asm
; @launch grid=(256,1,1) block=(256,1,1) lds=163840
.amdgcn_target "amdgcn-amd-amdhsa--gfx950"
.text
.globl parallel_sum__compressed_kv_cla__moe_arch_mod__prompt_kernel
.p2align 8
.type parallel_sum__compressed_kv_cla__moe_arch_mod__prompt_kernel,@function
parallel_sum__compressed_kv_cla__moe_arch_mod__prompt_kernel:
    s_cmp_ge_u32 s2, 256
    s_cbranch_scc1 L_ka_done
    s_load_dwordx4 s[20:23], s[0:1], 0
    s_load_dwordx4 s[60:63], s[0:1], 24
    s_load_dwordx2 s[24:25], s[0:1], 56
    s_load_dwordx4 s[64:67], s[0:1], 96
    s_load_dwordx2 s[28:29], s[0:1], 16
    s_getpc_b64 s[6:7]
    v_lshlrev_b32 v214, 7, v0
    v_mov_b32 v251, v0
    global_load_dword v252, v214, s[6:7]
    v_and_b32 v241, 63, v0
    v_lshrrev_b32 v215, 6, v0
    s_nop 0
    v_readfirstlane_b32 s44, v215
    s_and_b32 s45, s2, 7
    s_lshl_b32 s45, s45, 2
    s_lshr_b32 s47, s2, 3
    s_and_b32 s47, s47, 3
    s_add_u32 s45, s45, s47
    s_lshr_b32 s46, s2, 5
    v_lshrrev_b32 v214, 5, v241
    v_mul_u32_u24 v60, 1152, v214
    v_and_b32 v61, 31, v241
    v_lshlrev_b32 v61, 2, v61
    v_add_u32 v60, v60, v61
    s_lshl_b32 s52, s2, 2
    s_add_u32 s52, s52, s44
    s_mul_i32 s53, s52, 2304
    v_lshlrev_b32 v211, 7, v241
    s_lshl_b32 s58, s2, 13
    s_lshr_b32 s57, s2, 1
    s_lshl_b32 s57, s57, 13
    s_lshr_b32 s54, s44, 1
    s_xor_b32 s54, s54, s2
    s_and_b32 s54, s54, 1
    s_cselect_b32 s57, 0x40000000, s57
    s_mov_b32 s14, 0x200000
    s_mov_b32 s15, 0x00020000
    s_mov_b32 s18, 0x400000
    s_mov_b32 s19, 0x00020000
    s_mov_b32 s26, 1152
    s_mov_b32 s27, 0x00020000
    s_mov_b32 s30, 0x480000
    s_mov_b32 s31, 0x00020000
    s_cmp_lt_u32 s44, 2
    s_waitcnt lgkmcnt(0)
    s_cselect_b32 s16, s60, s62
    s_cselect_b32 s17, s61, s63
    s_mov_b32 s12, s22
    s_mov_b32 s13, s23
    s_mov_b32 s22, 0x240000
    s_mov_b32 s23, 0x00020000
    s_and_b32 s54, s44, 1
    s_cbranch_scc0 L_k1_t1
    buffer_load_dword v252, v211, s[16:19], s57 offen
L_k1_t1:
    s_cmp_eq_u32 s44, 0
    s_cbranch_scc0 L_k1_t2
    buffer_load_dword v252, v211, s[12:15], s58 offen
L_k1_t2:
    buffer_load_dword v0, v60, s[20:23], s53 offen offset:0
    buffer_load_dword v1, v60, s[20:23], s53 offen offset:128
    buffer_load_dword v2, v60, s[20:23], s53 offen offset:256
    buffer_load_dword v3, v60, s[20:23], s53 offen offset:384
    buffer_load_dword v4, v60, s[20:23], s53 offen offset:512
    buffer_load_dword v5, v60, s[20:23], s53 offen offset:640
    buffer_load_dword v6, v60, s[20:23], s53 offen offset:768
    buffer_load_dword v7, v60, s[20:23], s53 offen offset:896
    buffer_load_dword v8, v60, s[20:23], s53 offen offset:1024
    buffer_load_dword v9, v61, s[24:27], 0 offen offset:0
    buffer_load_dword v10, v61, s[24:27], 0 offen offset:128
    buffer_load_dword v11, v61, s[24:27], 0 offen offset:256
    buffer_load_dword v12, v61, s[24:27], 0 offen offset:384
    buffer_load_dword v13, v61, s[24:27], 0 offen offset:512
    buffer_load_dword v14, v61, s[24:27], 0 offen offset:640
    buffer_load_dword v15, v61, s[24:27], 0 offen offset:768
    buffer_load_dword v16, v61, s[24:27], 0 offen offset:896
    buffer_load_dword v17, v61, s[24:27], 0 offen offset:1024
    s_mov_b32 s8, s66
    s_mov_b32 s9, s67
    s_mov_b32 s10, 0x10000000
    s_mov_b32 s11, 0x00020000
    s_mov_b32 s40, s64
    s_mov_b32 s41, s65
    s_mov_b32 s42, 0x100
    s_mov_b32 s43, 0x00020000
    v_lshrrev_b32 v217, 4, v241
    v_lshlrev_b32 v215, 1, v217
    v_and_b32 v216, 15, v241
    v_xor_b32 v215, v215, v216
    s_and_b32 s54, s44, 1
    s_lshl_b32 s54, s54, 4
    v_add_u32 v214, s54, v217
    v_lshlrev_b32 v214, 13, v214
    v_xor_b32 v216, 0, v215
    v_lshl_add_u32 v216, v216, 4, v214
    v_add_u32 v206, 0, v216
    v_xor_b32 v216, 0, v215
    v_lshl_add_u32 v216, v216, 4, v214
    v_add_u32 v207, 31744, v216
    v_xor_b32 v216, 8, v215
    v_lshl_add_u32 v216, v216, 4, v214
    v_add_u32 v208, 63488, v216
    v_xor_b32 v216, 8, v215
    v_lshl_add_u32 v216, v216, 4, v214
    v_add_u32 v209, 95232, v216
    v_and_b32 v215, 1, v217
    v_lshlrev_b32 v215, 1, v215
    v_lshrrev_b32 v216, 1, v217
    v_mul_u32_u24 v216, 3, v216
    v_xor_b32 v215, v215, v216
    v_and_b32 v216, 3, v241
    v_xor_b32 v215, v215, v216
    v_lshrrev_b32 v214, 2, v241
    s_lshl_b32 s54, s44, 6
    v_add_u32 v214, s54, v214
    v_lshlrev_b32 v214, 10, v214
    v_lshl_add_u32 v202, v215, 4, v214
    v_add_u32 v203, 15360, v202
    v_add_u32 v204, 30720, v202
    v_add_u32 v205, 46080, v202
    s_lshl_b32 s48, s46, 18
    s_lshl_b32 s49, s45, 8
    s_lshl_b32 s50, s44, 13
    s_add_u32 m0, s50, 4096
    s_nop 0
    buffer_load_dwordx4 v206, s[16:19], s49 offen offset:0 lds
    buffer_load_dwordx4 v207, s[16:19], s49 offen offset:1024 lds
    buffer_load_dwordx4 v208, s[16:19], s49 offen offset:2048 lds
    buffer_load_dwordx4 v209, s[16:19], s49 offen offset:3072 lds
    s_add_u32 m0, s50, 0
    s_nop 0
    buffer_load_dwordx4 v202, s[12:15], s48 offen offset:0 lds
    buffer_load_dwordx4 v203, s[12:15], s48 offen offset:1024 lds
    buffer_load_dwordx4 v204, s[12:15], s48 offen offset:2048 lds
    buffer_load_dwordx4 v205, s[12:15], s48 offen offset:3072 lds
    s_add_u32 s48, s48, 64
    s_add_u32 s49, s49, 262144
    v_and_b32 v214, 15, v241
    v_lshrrev_b32 v215, 3, v214
    v_lshl_add_u32 v215, v215, 3, v214
    s_cmp_lt_u32 s44, 2
    s_cselect_b64 s[6:7], -1, 0
    v_cndmask_b32 v215, v215, v214, s[6:7]
    v_bfe_u32 v216, v215, 2, 1
    v_lshlrev_b32 v216, 1, v216
    v_bfe_u32 v218, v215, 3, 1
    v_mul_u32_u24 v218, 3, v218
    v_xor_b32 v216, v216, v218
    v_xor_b32 v216, v216, v217
    v_lshlrev_b32 v215, 6, v215
    v_lshl_add_u32 v215, v216, 4, v215
    s_and_b32 s54, s44, 1
    s_lshl_b32 s54, s54, 14
    v_add_u32 v192, s54, v215
    v_xor_b32 v193, 48, v192
    v_bfe_u32 v214, v241, 2, 2
    v_bfe_u32 v216, v241, 4, 1
    v_lshl_add_u32 v215, v216, 3, v214
    v_lshlrev_b32 v215, 8, v215
    v_lshl_or_b32 v214, v216, 2, v214
    v_lshrrev_b32 v216, 5, v241
    v_lshl_add_u32 v215, v216, 13, v215
    v_and_b32 v216, 3, v241
    v_lshl_add_u32 v215, v216, 3, v215
    s_and_b32 s54, s44, 2
    s_lshl_b32 s54, s54, 13
    s_add_u32 s54, s54, 4096
    v_add_u32 v215, s54, v215
    v_xor_b32 v216, 0, v214
    v_lshl_add_u32 v194, v216, 5, v215
    v_xor_b32 v216, 1, v214
    v_lshl_add_u32 v195, v216, 5, v215
    v_xor_b32 v216, 2, v214
    v_lshl_add_u32 v196, v216, 5, v215
    v_xor_b32 v216, 3, v214
    v_lshl_add_u32 v197, v216, 5, v215
    v_xor_b32 v216, 4, v214
    v_lshl_add_u32 v198, v216, 5, v215
    v_xor_b32 v216, 5, v214
    v_lshl_add_u32 v199, v216, 5, v215
    v_xor_b32 v216, 6, v214
    v_lshl_add_u32 v200, v216, 5, v215
    v_xor_b32 v216, 7, v214
    v_lshl_add_u32 v201, v216, 5, v215
    s_or_b32 s54, s2, s44
    s_cbranch_scc1 L_ka_non
    s_memrealtime s[4:5]
    s_waitcnt lgkmcnt(0)
    s_or_b32 s54, s4, 1
    v_mov_b32 v214, s54
    v_mov_b32 v215, 0
    s_mov_b64 exec, 1
    buffer_store_dword v214, v215, s[40:43], 0 offen sc1
    s_mov_b64 exec, -1
L_ka_non:
    s_add_u32 s56, s57, 0x100000
    s_and_b32 s54, s44, 1
    s_cselect_b32 s56, s56, 0x40000000
    s_load_dwordx2 s[36:37], s[0:1], 40
    s_load_dwordx4 s[60:63], s[0:1], 64
    s_load_dwordx2 s[64:65], s[0:1], 80
    v_mov_b32 v224, 0
    v_mov_b32 v225, 0
    v_mov_b32 v226, 0
    v_mov_b32 v227, 0
    v_mov_b32 v255, 0
    s_lshl_b32 s3, s44, 12
    s_lshl_b32 s73, s45, 8
    v_mfma_f32_32x32x16_bf16 v[96:111], v[224:227], v[224:227], 0
    v_mfma_f32_32x32x16_bf16 v[112:127], v[224:227], v[224:227], 0
    v_mfma_f32_32x32x16_bf16 v[128:143], v[224:227], v[224:227], 0
    v_mfma_f32_32x32x16_bf16 v[144:159], v[224:227], v[224:227], 0
    v_mfma_f32_32x32x16_bf16 v[160:175], v[224:227], v[224:227], 0
    v_mfma_f32_32x32x16_bf16 v[176:191], v[224:227], v[224:227], 0
    v_mfma_f32_32x32x16_bf16 a[0:15], v[224:227], v[224:227], 0
    v_mfma_f32_32x32x16_bf16 a[16:31], v[224:227], v[224:227], 0
    v_mfma_f32_32x32x16_bf16 a[32:47], v[224:227], v[224:227], 0
    v_mfma_f32_32x32x16_bf16 a[48:63], v[224:227], v[224:227], 0
    s_getpc_b64 s[6:7]
L_ka_pc0:
    s_sub_u32 s6, s6, L_ka_pc0-parallel_sum__compressed_kv_cla__moe_arch_mod__prompt_kernel
    s_subb_u32 s7, s7, 0
    v_lshlrev_b32 v220, 7, v251
    v_add_u32 v220, 32768, v220
    v_cmp_gt_u32 vcc, L_ka_codeend-parallel_sum__compressed_kv_cla__moe_arch_mod__prompt_kernel-64, v220
    s_and_saveexec_b64 s[4:5], vcc
    s_cbranch_execz L_ka_nocode1
    global_load_dword v252, v220, s[6:7]
L_ka_nocode1:
    s_mov_b64 exec, s[4:5]
    v_add_u32 v220, 32768, v220
    v_cmp_gt_u32 vcc, L_ka_codeend-parallel_sum__compressed_kv_cla__moe_arch_mod__prompt_kernel-64, v220
    s_and_saveexec_b64 s[4:5], vcc
    s_cbranch_execz L_ka_nocode2
    global_load_dword v252, v220, s[6:7]
L_ka_nocode2:
    s_mov_b64 exec, s[4:5]
    s_waitcnt lgkmcnt(0)
    s_mul_i32 s54, s46, 589824
    s_add_u32 s54, s54, s73
    s_add_u32 s76, s28, s54
    s_addc_u32 s77, s29, 0
    s_mov_b32 s78, 589824
    s_mov_b32 s70, 262144
    s_mov_b32 s79, 0x00020000
    s_cmp_eq_u32 s44, 0
    s_cselect_b32 s68, 2, 99
    s_mov_b32 s34, 20736
    s_cselect_b32 s34, 0, s34
    s_mov_b32 s32, s60
    s_mov_b32 s33, s61
    s_cmp_eq_u32 s44, 2
    s_cselect_b32 s32, s62, s32
    s_cselect_b32 s33, s63, s33
    s_cmp_eq_u32 s44, 3
    s_cselect_b32 s32, s64, s32
    s_cselect_b32 s33, s65, s33
    s_mul_i32 s54, s2, 20736
    s_add_u32 s32, s32, s54
    s_addc_u32 s33, s33, 0
    s_mov_b32 s35, 0x00020000
    s_mul_i32 s54, s2, 18432
    s_add_u32 s36, s36, s54
    s_addc_u32 s37, s37, 0
    s_mov_b32 s38, 18432
    s_mov_b32 s39, 0x00020000
    s_sub_u32 s62, 15, s46
    s_lshl_b32 s54, s62, 2
    s_add_u32 s54, s54, s44
    s_mul_i32 s71, s54, 36864
    s_lshl_b32 s54, s46, 2
    s_add_u32 s54, s54, s44
    s_mul_i32 s72, s54, 36864
    s_mov_b32 s66, 0x49800000
    s_mov_b32 s67, 0x35800000
    s_mov_b32 s57, 0x490000
    s_lshl_b32 s63, s45, 20
    s_add_u32 s63, s63, 0x1000000
    s_add_u32 s63, s63, s3
    s_add_u32 s54, s62, 1
    s_lshl_b32 s54, s54, 16
    s_add_u32 s64, s63, s54
    v_lshrrev_b32 v214, 1, v241
    v_lshlrev_b32 v214, 13, v214
    v_and_b32 v215, 1, v241
    v_lshl_add_u32 v250, v215, 7, v214
    v_lshlrev_b32 v240, 4, v241
    v_lshrrev_b32 v214, 4, v241
    v_lshlrev_b32 v215, 2, v214
    v_and_b32 v216, 15, v241
    v_xor_b32 v215, v215, v216
    v_lshlrev_b32 v215, 4, v215
    s_lshl_b32 s54, s44, 4
    v_add_u32 v214, s54, v214
    v_lshlrev_b32 v214, 13, v214
    v_add_u32 v214, v214, v215
    v_add_u32 v246, 0, v214
    v_add_u32 v247, 31744, v214
    v_add_u32 v248, 63488, v214
    v_add_u32 v249, 95232, v214
    v_lshrrev_b32 v214, 5, v241
    v_lshlrev_b32 v214, 3, v214
    v_bfe_u32 v215, v241, 2, 2
    v_add_u32 v214, v214, v215
    v_lshlrev_b32 v214, 8, v214
    v_bfe_u32 v216, v241, 4, 1
    v_lshl_add_u32 v214, v216, 3, v214
    v_and_b32 v216, 1, v241
    v_lshl_add_u32 v214, v216, 4, v214
    v_bfe_u32 v216, v241, 1, 1
    v_lshl_add_u32 v214, v216, 5, v214
    v_xor_b32 v216, 0, v215
    v_lshlrev_b32 v216, 6, v216
    v_add_u32 v242, v214, v216
    v_xor_b32 v216, 1, v215
    v_lshlrev_b32 v216, 6, v216
    v_add_u32 v243, v214, v216
    v_xor_b32 v216, 2, v215
    v_lshlrev_b32 v216, 6, v216
    v_add_u32 v244, v214, v216
    v_xor_b32 v216, 3, v215
    v_lshlrev_b32 v216, 6, v216
    v_add_u32 v245, v214, v216
    v_and_b32 v214, 15, v241
    v_bfe_u32 v215, v241, 4, 1
    v_mov_b32 v216, s62
    v_mov_b32 v217, s46
    v_cmp_eq_u32 vcc, 0, v215
    s_nop 0
    s_nop 0
    v_cndmask_b32 v216, v217, v216, vcc
    v_lshl_add_u32 v214, v216, 4, v214
    v_lshlrev_b32 v253, 7, v214
    s_waitcnt vmcnt(8)
    buffer_load_dword v254, v255, s[40:43], 0 offen sc1
    v_lshlrev_b32 v64, 16, v9
    v_and_b32 v65, 0xffff0000, v9
    v_lshlrev_b32 v66, 16, v10
    v_and_b32 v67, 0xffff0000, v10
    v_lshlrev_b32 v68, 16, v11
    v_and_b32 v69, 0xffff0000, v11
    v_lshlrev_b32 v70, 16, v12
    v_and_b32 v71, 0xffff0000, v12
    v_lshlrev_b32 v72, 16, v13
    v_and_b32 v73, 0xffff0000, v13
    v_lshlrev_b32 v74, 16, v14
    v_and_b32 v75, 0xffff0000, v14
    v_lshlrev_b32 v76, 16, v15
    v_and_b32 v77, 0xffff0000, v15
    v_lshlrev_b32 v78, 16, v16
    v_and_b32 v79, 0xffff0000, v16
    v_lshlrev_b32 v80, 16, v17
    v_and_b32 v81, 0xffff0000, v17
    v_lshlrev_b32 v18, 16, v0
    v_and_b32 v19, 0xffff0000, v0
    v_lshlrev_b32 v20, 16, v1
    v_and_b32 v21, 0xffff0000, v1
    v_lshlrev_b32 v22, 16, v2
    v_and_b32 v23, 0xffff0000, v2
    v_lshlrev_b32 v24, 16, v3
    v_and_b32 v25, 0xffff0000, v3
    v_lshlrev_b32 v26, 16, v4
    v_and_b32 v27, 0xffff0000, v4
    v_lshlrev_b32 v28, 16, v5
    v_and_b32 v29, 0xffff0000, v5
    v_lshlrev_b32 v30, 16, v6
    v_and_b32 v31, 0xffff0000, v6
    v_lshlrev_b32 v32, 16, v7
    v_and_b32 v33, 0xffff0000, v7
    v_lshlrev_b32 v34, 16, v8
    v_and_b32 v35, 0xffff0000, v8
    v_pk_add_f32 v[62:63], v[18:19], v[20:21]
    v_pk_add_f32 v[36:37], v[22:23], v[24:25]
    v_pk_add_f32 v[38:39], v[26:27], v[28:29]
    v_pk_add_f32 v[40:41], v[30:31], v[32:33]
    v_pk_add_f32 v[62:63], v[62:63], v[34:35]
    v_pk_add_f32 v[36:37], v[36:37], v[38:39]
    v_pk_add_f32 v[62:63], v[62:63], v[40:41]
    v_pk_add_f32 v[62:63], v[62:63], v[36:37]
    v_add_f32 v54, v62, v63
    s_nop 1
    v_add_f32_dpp v54, v54, v54 quad_perm:[1,0,3,2] row_mask:0xf bank_mask:0xf
    s_nop 1
    v_add_f32_dpp v54, v54, v54 quad_perm:[2,3,0,1] row_mask:0xf bank_mask:0xf
    s_nop 1
    v_add_f32_dpp v54, v54, v54 row_half_mirror row_mask:0xf bank_mask:0xf
    s_nop 1
    v_add_f32_dpp v54, v54, v54 row_mirror row_mask:0xf bank_mask:0xf
    v_mov_b32 v55, v54
    s_nop 1
    v_permlane16_swap_b32 v54, v55
    s_nop 0
    v_add_f32 v54, v54, v55
    v_mul_f32 v56, 0x3ae38e39, v54
    v_pk_add_f32 v[36:37], v[18:19], v[56:57] op_sel_hi:[1,0] neg_lo:[0,1] neg_hi:[0,1]
    v_pk_add_f32 v[38:39], v[20:21], v[56:57] op_sel_hi:[1,0] neg_lo:[0,1] neg_hi:[0,1]
    v_pk_add_f32 v[40:41], v[22:23], v[56:57] op_sel_hi:[1,0] neg_lo:[0,1] neg_hi:[0,1]
    v_pk_add_f32 v[42:43], v[24:25], v[56:57] op_sel_hi:[1,0] neg_lo:[0,1] neg_hi:[0,1]
    v_pk_add_f32 v[44:45], v[26:27], v[56:57] op_sel_hi:[1,0] neg_lo:[0,1] neg_hi:[0,1]
    v_pk_add_f32 v[46:47], v[28:29], v[56:57] op_sel_hi:[1,0] neg_lo:[0,1] neg_hi:[0,1]
    v_pk_add_f32 v[48:49], v[30:31], v[56:57] op_sel_hi:[1,0] neg_lo:[0,1] neg_hi:[0,1]
    v_pk_add_f32 v[50:51], v[32:33], v[56:57] op_sel_hi:[1,0] neg_lo:[0,1] neg_hi:[0,1]
    v_pk_add_f32 v[52:53], v[34:35], v[56:57] op_sel_hi:[1,0] neg_lo:[0,1] neg_hi:[0,1]
    v_pk_mul_f32 v[62:63], v[36:37], v[36:37]
    v_pk_mul_f32 v[58:59], v[38:39], v[38:39]
    v_pk_fma_f32 v[62:63], v[40:41], v[40:41], v[62:63]
    v_pk_fma_f32 v[58:59], v[42:43], v[42:43], v[58:59]
    v_pk_fma_f32 v[62:63], v[44:45], v[44:45], v[62:63]
    v_pk_fma_f32 v[58:59], v[46:47], v[46:47], v[58:59]
    v_pk_fma_f32 v[62:63], v[48:49], v[48:49], v[62:63]
    v_pk_fma_f32 v[58:59], v[50:51], v[50:51], v[58:59]
    v_pk_fma_f32 v[62:63], v[52:53], v[52:53], v[62:63]
    v_pk_add_f32 v[62:63], v[62:63], v[58:59]
    s_nop 0
    v_add_f32 v57, v62, v63
    s_nop 1
    v_add_f32_dpp v57, v57, v57 quad_perm:[1,0,3,2] row_mask:0xf bank_mask:0xf
    s_nop 1
    v_add_f32_dpp v57, v57, v57 quad_perm:[2,3,0,1] row_mask:0xf bank_mask:0xf
    s_nop 1
    v_add_f32_dpp v57, v57, v57 row_half_mirror row_mask:0xf bank_mask:0xf
    s_nop 1
    v_add_f32_dpp v57, v57, v57 row_mirror row_mask:0xf bank_mask:0xf
    v_mov_b32 v55, v57
    s_nop 1
    v_permlane16_swap_b32 v57, v55
    s_nop 0
    v_add_f32 v57, v57, v55
    s_add_u32 m0, s50, 36864
    s_nop 0
    buffer_load_dwordx4 v206, s[16:19], s49 offen offset:0 lds
    buffer_load_dwordx4 v207, s[16:19], s49 offen offset:1024 lds
    buffer_load_dwordx4 v208, s[16:19], s49 offen offset:2048 lds
    buffer_load_dwordx4 v209, s[16:19], s49 offen offset:3072 lds
    s_add_u32 m0, s50, 32768
    s_nop 0
    buffer_load_dwordx4 v202, s[12:15], s48 offen offset:0 lds
    buffer_load_dwordx4 v203, s[12:15], s48 offen offset:1024 lds
    buffer_load_dwordx4 v204, s[12:15], s48 offen offset:2048 lds
    buffer_load_dwordx4 v205, s[12:15], s48 offen offset:3072 lds
    s_add_u32 s48, s48, 64
    s_add_u32 s49, s49, 262144
    v_mul_f32 v57, 0x3ae38e39, v57
    v_cvt_pk_bf16_f32 v55, v56, v57
    v_lshlrev_b32 v56, 16, v55
    v_and_b32 v57, 0xffff0000, v55
    v_add_f32 v57, 0x3727c5ac, v57
    v_cvt_pk_bf16_f32 v55, v57, v57
    v_and_b32 v57, 0xffff0000, v55
    v_sqrt_f32 v59, v57
    v_pk_add_f32 v[36:37], v[18:19], v[56:57] op_sel_hi:[1,0] neg_lo:[0,1] neg_hi:[0,1]
    v_pk_add_f32 v[38:39], v[20:21], v[56:57] op_sel_hi:[1,0] neg_lo:[0,1] neg_hi:[0,1]
    v_pk_add_f32 v[40:41], v[22:23], v[56:57] op_sel_hi:[1,0] neg_lo:[0,1] neg_hi:[0,1]
    v_pk_add_f32 v[42:43], v[24:25], v[56:57] op_sel_hi:[1,0] neg_lo:[0,1] neg_hi:[0,1]
    v_pk_add_f32 v[44:45], v[26:27], v[56:57] op_sel_hi:[1,0] neg_lo:[0,1] neg_hi:[0,1]
    v_pk_add_f32 v[46:47], v[28:29], v[56:57] op_sel_hi:[1,0] neg_lo:[0,1] neg_hi:[0,1]
    v_pk_add_f32 v[48:49], v[30:31], v[56:57] op_sel_hi:[1,0] neg_lo:[0,1] neg_hi:[0,1]
    v_pk_add_f32 v[50:51], v[32:33], v[56:57] op_sel_hi:[1,0] neg_lo:[0,1] neg_hi:[0,1]
    v_pk_add_f32 v[52:53], v[34:35], v[56:57] op_sel_hi:[1,0] neg_lo:[0,1] neg_hi:[0,1]
    v_cvt_pk_bf16_f32 v55, v59, v59
    v_and_b32 v59, 0xffff0000, v55
    v_rcp_f32 v58, v59
    v_cvt_pk_bf16_f32 v0, v36, v37
    v_cvt_pk_bf16_f32 v1, v38, v39
    v_cvt_pk_bf16_f32 v2, v40, v41
    v_cvt_pk_bf16_f32 v3, v42, v43
    v_cvt_pk_bf16_f32 v4, v44, v45
    v_cvt_pk_bf16_f32 v5, v46, v47
    v_cvt_pk_bf16_f32 v6, v48, v49
    v_cvt_pk_bf16_f32 v7, v50, v51
    v_cvt_pk_bf16_f32 v8, v52, v53
    v_lshlrev_b32 v36, 16, v0
    v_and_b32 v37, 0xffff0000, v0
    v_lshlrev_b32 v38, 16, v1
    v_and_b32 v39, 0xffff0000, v1
    v_lshlrev_b32 v40, 16, v2
    v_and_b32 v41, 0xffff0000, v2
    v_lshlrev_b32 v42, 16, v3
    v_and_b32 v43, 0xffff0000, v3
    v_lshlrev_b32 v44, 16, v4
    v_and_b32 v45, 0xffff0000, v4
    v_lshlrev_b32 v46, 16, v5
    v_and_b32 v47, 0xffff0000, v5
    v_lshlrev_b32 v48, 16, v6
    v_and_b32 v49, 0xffff0000, v6
    v_lshlrev_b32 v50, 16, v7
    v_and_b32 v51, 0xffff0000, v7
    v_lshlrev_b32 v52, 16, v8
    v_and_b32 v53, 0xffff0000, v8
    v_pk_mul_f32 v[18:19], v[36:37], v[58:59] op_sel_hi:[1,0]
    v_pk_mul_f32 v[20:21], v[38:39], v[58:59] op_sel_hi:[1,0]
    v_pk_mul_f32 v[22:23], v[40:41], v[58:59] op_sel_hi:[1,0]
    v_pk_mul_f32 v[24:25], v[42:43], v[58:59] op_sel_hi:[1,0]
    v_pk_mul_f32 v[26:27], v[44:45], v[58:59] op_sel_hi:[1,0]
    v_pk_mul_f32 v[28:29], v[46:47], v[58:59] op_sel_hi:[1,0]
    v_pk_mul_f32 v[30:31], v[48:49], v[58:59] op_sel_hi:[1,0]
    v_pk_mul_f32 v[32:33], v[50:51], v[58:59] op_sel_hi:[1,0]
    v_pk_mul_f32 v[34:35], v[52:53], v[58:59] op_sel_hi:[1,0]
    v_pk_fma_f32 v[36:37], v[18:19], v[58:59], v[36:37] op_sel:[0,1,0] op_sel_hi:[1,1,1] neg_lo:[1,0,0] neg_hi:[1,0,0]
    v_pk_fma_f32 v[38:39], v[20:21], v[58:59], v[38:39] op_sel:[0,1,0] op_sel_hi:[1,1,1] neg_lo:[1,0,0] neg_hi:[1,0,0]
    v_pk_fma_f32 v[40:41], v[22:23], v[58:59], v[40:41] op_sel:[0,1,0] op_sel_hi:[1,1,1] neg_lo:[1,0,0] neg_hi:[1,0,0]
    v_pk_fma_f32 v[42:43], v[24:25], v[58:59], v[42:43] op_sel:[0,1,0] op_sel_hi:[1,1,1] neg_lo:[1,0,0] neg_hi:[1,0,0]
    v_pk_fma_f32 v[44:45], v[26:27], v[58:59], v[44:45] op_sel:[0,1,0] op_sel_hi:[1,1,1] neg_lo:[1,0,0] neg_hi:[1,0,0]
    v_pk_fma_f32 v[46:47], v[28:29], v[58:59], v[46:47] op_sel:[0,1,0] op_sel_hi:[1,1,1] neg_lo:[1,0,0] neg_hi:[1,0,0]
    v_pk_fma_f32 v[48:49], v[30:31], v[58:59], v[48:49] op_sel:[0,1,0] op_sel_hi:[1,1,1] neg_lo:[1,0,0] neg_hi:[1,0,0]
    v_pk_fma_f32 v[50:51], v[32:33], v[58:59], v[50:51] op_sel:[0,1,0] op_sel_hi:[1,1,1] neg_lo:[1,0,0] neg_hi:[1,0,0]
    v_pk_fma_f32 v[52:53], v[34:35], v[58:59], v[52:53] op_sel:[0,1,0] op_sel_hi:[1,1,1] neg_lo:[1,0,0] neg_hi:[1,0,0]
    v_pk_fma_f32 v[18:19], v[36:37], v[58:59], v[18:19] op_sel_hi:[1,0,1]
    v_pk_fma_f32 v[20:21], v[38:39], v[58:59], v[20:21] op_sel_hi:[1,0,1]
    v_pk_fma_f32 v[22:23], v[40:41], v[58:59], v[22:23] op_sel_hi:[1,0,1]
    v_pk_fma_f32 v[24:25], v[42:43], v[58:59], v[24:25] op_sel_hi:[1,0,1]
    v_pk_fma_f32 v[26:27], v[44:45], v[58:59], v[26:27] op_sel_hi:[1,0,1]
    v_pk_fma_f32 v[28:29], v[46:47], v[58:59], v[28:29] op_sel_hi:[1,0,1]
    v_pk_fma_f32 v[30:31], v[48:49], v[58:59], v[30:31] op_sel_hi:[1,0,1]
    v_pk_fma_f32 v[32:33], v[50:51], v[58:59], v[32:33] op_sel_hi:[1,0,1]
    v_pk_fma_f32 v[34:35], v[52:53], v[58:59], v[34:35] op_sel_hi:[1,0,1]
    v_cvt_pk_bf16_f32 v0, v18, v19
    v_cvt_pk_bf16_f32 v1, v20, v21
    v_cvt_pk_bf16_f32 v2, v22, v23
    v_cvt_pk_bf16_f32 v3, v24, v25
    v_cvt_pk_bf16_f32 v4, v26, v27
    v_cvt_pk_bf16_f32 v5, v28, v29
    v_cvt_pk_bf16_f32 v6, v30, v31
    v_cvt_pk_bf16_f32 v7, v32, v33
    v_cvt_pk_bf16_f32 v8, v34, v35
    s_mul_i32 s53, s44, 2304
    s_add_u32 s53, s53, 131072
    v_add_u32 v214, s53, v60
    ds_write_b32 v214, v0 offset:0
    ds_write_b32 v214, v1 offset:128
    ds_write_b32 v214, v2 offset:256
    ds_write_b32 v214, v3 offset:384
    ds_write_b32 v214, v4 offset:512
    ds_write_b32 v214, v5 offset:640
    ds_write_b32 v214, v6 offset:768
    ds_write_b32 v214, v7 offset:896
    ds_write_b32 v214, v8 offset:1024
    v_lshlrev_b32 v18, 16, v0
    v_and_b32 v19, 0xffff0000, v0
    v_lshlrev_b32 v20, 16, v1
    v_and_b32 v21, 0xffff0000, v1
    v_lshlrev_b32 v22, 16, v2
    v_and_b32 v23, 0xffff0000, v2
    v_lshlrev_b32 v24, 16, v3
    v_and_b32 v25, 0xffff0000, v3
    v_lshlrev_b32 v26, 16, v4
    v_and_b32 v27, 0xffff0000, v4
    v_lshlrev_b32 v28, 16, v5
    v_and_b32 v29, 0xffff0000, v5
    v_lshlrev_b32 v30, 16, v6
    v_and_b32 v31, 0xffff0000, v6
    v_lshlrev_b32 v32, 16, v7
    v_and_b32 v33, 0xffff0000, v7
    v_lshlrev_b32 v34, 16, v8
    v_and_b32 v35, 0xffff0000, v8
    v_pk_mul_f32 v[62:63], v[18:19], v[64:65]
    v_pk_mul_f32 v[58:59], v[20:21], v[66:67]
    v_pk_fma_f32 v[62:63], v[22:23], v[68:69], v[62:63]
    v_pk_fma_f32 v[58:59], v[24:25], v[70:71], v[58:59]
    v_pk_fma_f32 v[62:63], v[26:27], v[72:73], v[62:63]
    v_pk_fma_f32 v[58:59], v[28:29], v[74:75], v[58:59]
    v_pk_fma_f32 v[62:63], v[30:31], v[76:77], v[62:63]
    v_pk_fma_f32 v[58:59], v[32:33], v[78:79], v[58:59]
    v_pk_fma_f32 v[62:63], v[34:35], v[80:81], v[62:63]
    v_pk_add_f32 v[62:63], v[62:63], v[58:59]
    s_nop 0
    v_add_f32 v54, v62, v63
    s_nop 1
    v_add_f32_dpp v54, v54, v54 quad_perm:[1,0,3,2] row_mask:0xf bank_mask:0xf
    s_nop 1
    v_add_f32_dpp v54, v54, v54 quad_perm:[2,3,0,1] row_mask:0xf bank_mask:0xf
    s_nop 1
    v_add_f32_dpp v54, v54, v54 row_half_mirror row_mask:0xf bank_mask:0xf
    s_nop 1
    v_add_f32_dpp v54, v54, v54 row_mirror row_mask:0xf bank_mask:0xf
    v_mov_b32 v55, v54
    s_nop 1
    v_permlane16_swap_b32 v54, v55
    s_nop 0
    v_add_f32 v54, v54, v55
    v_cvt_pk_bf16_f32 v55, v54, v54
    v_and_b32 v219, 0xffff0000, v55
    s_add_u32 m0, s50, 69632
    s_nop 0
    buffer_load_dwordx4 v206, s[16:19], s49 offen offset:0 lds
    buffer_load_dwordx4 v207, s[16:19], s49 offen offset:1024 lds
    buffer_load_dwordx4 v208, s[16:19], s49 offen offset:2048 lds
    buffer_load_dwordx4 v209, s[16:19], s49 offen offset:3072 lds
    s_add_u32 m0, s50, 65536
    s_nop 0
    buffer_load_dwordx4 v202, s[12:15], s48 offen offset:0 lds
    buffer_load_dwordx4 v203, s[12:15], s48 offen offset:1024 lds
    buffer_load_dwordx4 v204, s[12:15], s48 offen offset:2048 lds
    buffer_load_dwordx4 v205, s[12:15], s48 offen offset:3072 lds
    s_add_u32 s48, s48, 64
    s_add_u32 s49, s49, 262144
    buffer_load_dword v252, v211, s[16:19], s56 offen
    s_add_u32 s56, s56, 0x100000
    v_lshrrev_b32 v214, 5, v241
    v_lshlrev_b32 v214, 2, v214
    s_lshl_b32 s52, s52, 3
    s_add_u32 s52, s52, 0x480000
    s_mov_b32 exec_lo, 1
    s_mov_b32 exec_hi, 1
    buffer_store_dword v219, v214, s[8:11], s52 offen sc1
    s_mov_b64 exec, -1
    v_mfma_f32_32x32x16_bf16 v[0:15], v[224:227], v[224:227], 0
    v_mfma_f32_32x32x16_bf16 v[16:31], v[224:227], v[224:227], 0
    v_mfma_f32_32x32x16_bf16 v[32:47], v[224:227], v[224:227], 0
    v_mfma_f32_32x32x16_bf16 v[48:63], v[224:227], v[224:227], 0
    v_mfma_f32_32x32x16_bf16 v[64:79], v[224:227], v[224:227], 0
    v_mfma_f32_32x32x16_bf16 v[80:95], v[224:227], v[224:227], 0
    s_lshl_b32 s52, s44, 3
    v_lshrrev_b32 v214, 3, v241
    v_add_u32 v214, s52, v214
    v_and_b32 v215, 7, v241
    v_mul_u32_u24 v216, 1152, v215
    v_lshl_add_u32 v216, v214, 4, v216
    v_add_u32 v216, 131072, v216
    v_lshlrev_b32 v214, 9, v214
    v_lshl_add_u32 v214, v215, 4, v214
    s_lshr_b32 s96, s2, 2
    s_mul_i32 s96, s96, 36864
    s_and_b32 s52, s2, 3
    s_lshl_b32 s52, s52, 7
    s_add_u32 s96, s96, s52
    s_add_u32 s97, s96, 16384
    s_add_u32 s98, s96, 32768
    s_cmp_eq_u32 s44, 0
    s_cselect_b32 s98, s98, 0x40000000
    s_waitcnt vmcnt(18) lgkmcnt(0)
    s_barrier
    ds_read_b128 v[224:227], v216 offset:0
    ds_read_b128 v[228:231], v216 offset:512
    ds_read_b128 v[232:235], v216 offset:1024
    s_mov_b32 s55, 0
L_ka_np:
    v_readfirstlane_b32 s58, v254
    s_nop 3
    s_cmp_lg_u32 s58, 0
    s_cbranch_scc1 L_ka_np_ok
    s_sleep 8
    buffer_load_dword v254, v255, s[40:43], 0 offen sc1
    s_add_u32 s55, s55, 1
    s_cmp_lt_u32 s55, 0x40000
    s_waitcnt vmcnt(0)
    s_cbranch_scc1 L_ka_np
L_ka_np_ok:
    s_mov_b32 s51, 0
    s_cmp_ge_u32 s44, 2
    s_cbranch_scc1 L_k1_v
    ds_read_b64_tr_b16 a[96:97], v194 offset:0
    ds_read_b64_tr_b16 a[98:99], v194 offset:1024
    ds_read_b64_tr_b16 a[100:101], v195 offset:0
    ds_read_b64_tr_b16 a[102:103], v195 offset:1024
    ds_read_b64_tr_b16 a[104:105], v196 offset:0
    ds_read_b64_tr_b16 a[106:107], v196 offset:1024
    ds_read_b64_tr_b16 a[108:109], v197 offset:0
    ds_read_b64_tr_b16 a[110:111], v197 offset:1024
    ds_read_b64_tr_b16 a[112:113], v198 offset:0
    ds_read_b64_tr_b16 a[114:115], v198 offset:1024
    ds_read_b64_tr_b16 a[116:117], v199 offset:0
    ds_read_b64_tr_b16 a[118:119], v199 offset:1024
    ds_read_b64_tr_b16 a[120:121], v200 offset:0
    ds_read_b64_tr_b16 a[122:123], v200 offset:1024
    ds_read_b64_tr_b16 a[124:125], v201 offset:0
    ds_read_b64_tr_b16 a[126:127], v201 offset:1024
    ds_read_b128 a[64:67], v192 offset:0
    ds_read_b128 a[68:71], v192 offset:1024
    ds_read_b128 a[72:75], v192 offset:2048
    ds_read_b128 a[76:79], v192 offset:3072
    ds_read_b128 a[80:83], v192 offset:8192
    ds_read_b128 a[84:87], v192 offset:9216
    ds_read_b128 a[88:91], v192 offset:10240
    s_waitcnt lgkmcnt(0)
    buffer_store_dwordx4 v[224:227], v214, s[8:11], s96 offen sc1
    buffer_store_dwordx4 v[228:231], v214, s[8:11], s97 offen sc1
    buffer_store_dwordx4 v[232:235], v214, s[8:11], s98 offen sc1
    .p2align 6
L_k1_loop_k:
    s_waitcnt lgkmcnt(2)
    v_mfma_f32_16x16x32_bf16 v[0:3], a[96:99], a[64:67], v[0:3]
    ds_read_b128 a[92:95], v192 offset:11264
    v_mfma_f32_16x16x32_bf16 v[4:7], a[100:103], a[64:67], v[4:7]
    v_mfma_f32_16x16x32_bf16 v[8:11], a[104:107], a[64:67], v[8:11]
    s_add_u32 m0, s50, 102400
    v_mfma_f32_16x16x32_bf16 v[12:15], a[108:111], a[64:67], v[12:15]
    buffer_load_dwordx4 v206, s[16:19], s49 offen offset:0 lds
    v_mfma_f32_16x16x32_bf16 v[16:19], a[112:115], a[64:67], v[16:19]
    v_mfma_f32_16x16x32_bf16 v[20:23], a[116:119], a[64:67], v[20:23]
    v_mfma_f32_16x16x32_bf16 v[24:27], a[120:123], a[64:67], v[24:27]
    v_mfma_f32_16x16x32_bf16 v[28:31], a[124:127], a[64:67], v[28:31]
    v_mfma_f32_16x16x32_bf16 v[32:35], a[96:99], a[68:71], v[32:35]
    v_mfma_f32_16x16x32_bf16 v[36:39], a[100:103], a[68:71], v[36:39]
    s_waitcnt vmcnt(9) lgkmcnt(0)
    s_barrier
    v_mfma_f32_16x16x32_bf16 v[40:43], a[104:107], a[68:71], v[40:43]
    ds_read_b128 a[64:67], v192 offset:32768
    v_mfma_f32_16x16x32_bf16 v[44:47], a[108:111], a[68:71], v[44:47]
    ds_read_b64_tr_b16 a[128:129], v194 offset:32768
    v_mfma_f32_16x16x32_bf16 v[48:51], a[112:115], a[68:71], v[48:51]
    buffer_load_dwordx4 v207, s[16:19], s49 offen offset:1024 lds
    v_mfma_f32_16x16x32_bf16 v[52:55], a[116:119], a[68:71], v[52:55]
    ds_read_b64_tr_b16 a[130:131], v194 offset:33792
    v_mfma_f32_16x16x32_bf16 v[56:59], a[120:123], a[68:71], v[56:59]
    v_mfma_f32_16x16x32_bf16 v[60:63], a[124:127], a[68:71], v[60:63]
    ds_read_b64_tr_b16 a[132:133], v195 offset:32768
    v_mfma_f32_16x16x32_bf16 v[64:67], a[96:99], a[72:75], v[64:67]
    ds_read_b128 a[68:71], v192 offset:33792
    v_mfma_f32_16x16x32_bf16 v[68:71], a[100:103], a[72:75], v[68:71]
    ds_read_b64_tr_b16 a[134:135], v195 offset:33792
    v_mfma_f32_16x16x32_bf16 v[72:75], a[104:107], a[72:75], v[72:75]
    buffer_load_dwordx4 v208, s[16:19], s49 offen offset:2048 lds
    v_mfma_f32_16x16x32_bf16 v[76:79], a[108:111], a[72:75], v[76:79]
    ds_read_b64_tr_b16 a[136:137], v196 offset:32768
    v_mfma_f32_16x16x32_bf16 v[80:83], a[112:115], a[72:75], v[80:83]
    v_mfma_f32_16x16x32_bf16 v[84:87], a[116:119], a[72:75], v[84:87]
    ds_read_b64_tr_b16 a[138:139], v196 offset:33792
    v_mfma_f32_16x16x32_bf16 v[88:91], a[120:123], a[72:75], v[88:91]
    v_mfma_f32_16x16x32_bf16 v[92:95], a[124:127], a[72:75], v[92:95]
    ds_read_b64_tr_b16 a[140:141], v197 offset:32768
    v_mfma_f32_16x16x32_bf16 v[96:99], a[96:99], a[76:79], v[96:99]
    ds_read_b128 a[72:75], v192 offset:34816
    v_mfma_f32_16x16x32_bf16 v[100:103], a[100:103], a[76:79], v[100:103]
    ds_read_b64_tr_b16 a[142:143], v197 offset:33792
    v_mfma_f32_16x16x32_bf16 v[104:107], a[104:107], a[76:79], v[104:107]
    buffer_load_dwordx4 v209, s[16:19], s49 offen offset:3072 lds
    v_mfma_f32_16x16x32_bf16 v[108:111], a[108:111], a[76:79], v[108:111]
    ds_read_b64_tr_b16 a[144:145], v198 offset:32768
    s_add_u32 m0, s50, 98304
    v_mfma_f32_16x16x32_bf16 v[112:115], a[112:115], a[76:79], v[112:115]
    v_mfma_f32_16x16x32_bf16 v[116:119], a[116:119], a[76:79], v[116:119]
    ds_read_b64_tr_b16 a[146:147], v198 offset:33792
    v_mfma_f32_16x16x32_bf16 v[120:123], a[120:123], a[76:79], v[120:123]
    v_mfma_f32_16x16x32_bf16 v[124:127], a[124:127], a[76:79], v[124:127]
    ds_read_b64_tr_b16 a[148:149], v199 offset:32768
    v_mfma_f32_16x16x32_bf16 v[128:131], a[96:99], a[80:83], v[128:131]
    ds_read_b128 a[76:79], v192 offset:35840
    v_mfma_f32_16x16x32_bf16 v[132:135], a[100:103], a[80:83], v[132:135]
    ds_read_b64_tr_b16 a[150:151], v199 offset:33792
    v_mfma_f32_16x16x32_bf16 v[136:139], a[104:107], a[80:83], v[136:139]
    buffer_load_dwordx4 v202, s[12:15], s48 offen offset:0 lds
    v_mfma_f32_16x16x32_bf16 v[140:143], a[108:111], a[80:83], v[140:143]
    ds_read_b64_tr_b16 a[152:153], v200 offset:32768
    v_mfma_f32_16x16x32_bf16 v[144:147], a[112:115], a[80:83], v[144:147]
    v_mfma_f32_16x16x32_bf16 v[148:151], a[116:119], a[80:83], v[148:151]
    ds_read_b64_tr_b16 a[154:155], v200 offset:33792
    v_mfma_f32_16x16x32_bf16 v[152:155], a[120:123], a[80:83], v[152:155]
    buffer_load_dwordx4 v203, s[12:15], s48 offen offset:1024 lds
    v_mfma_f32_16x16x32_bf16 v[156:159], a[124:127], a[80:83], v[156:159]
    ds_read_b64_tr_b16 a[156:157], v201 offset:32768
    v_mfma_f32_16x16x32_bf16 v[160:163], a[96:99], a[84:87], v[160:163]
    ds_read_b128 a[80:83], v192 offset:40960
    v_mfma_f32_16x16x32_bf16 v[164:167], a[100:103], a[84:87], v[164:167]
    ds_read_b64_tr_b16 a[158:159], v201 offset:33792
    v_mfma_f32_16x16x32_bf16 v[168:171], a[104:107], a[84:87], v[168:171]
    v_mfma_f32_16x16x32_bf16 v[172:175], a[108:111], a[84:87], v[172:175]
    v_mfma_f32_16x16x32_bf16 v[176:179], a[112:115], a[84:87], v[176:179]
    v_mfma_f32_16x16x32_bf16 v[180:183], a[116:119], a[84:87], v[180:183]
    buffer_load_dwordx4 v204, s[12:15], s48 offen offset:2048 lds
    v_mfma_f32_16x16x32_bf16 v[184:187], a[120:123], a[84:87], v[184:187]
    v_mfma_f32_16x16x32_bf16 v[188:191], a[124:127], a[84:87], v[188:191]
    v_mfma_f32_16x16x32_bf16 a[0:3], a[96:99], a[88:91], a[0:3]
    ds_read_b128 a[84:87], v192 offset:41984
    v_mfma_f32_16x16x32_bf16 a[4:7], a[100:103], a[88:91], a[4:7]
    v_mfma_f32_16x16x32_bf16 a[8:11], a[104:107], a[88:91], a[8:11]
    v_mfma_f32_16x16x32_bf16 a[12:15], a[108:111], a[88:91], a[12:15]
    v_mfma_f32_16x16x32_bf16 a[16:19], a[112:115], a[88:91], a[16:19]
    buffer_load_dwordx4 v205, s[12:15], s48 offen offset:3072 lds
    v_mfma_f32_16x16x32_bf16 a[20:23], a[116:119], a[88:91], a[20:23]
    v_mfma_f32_16x16x32_bf16 a[24:27], a[120:123], a[88:91], a[24:27]
    v_mfma_f32_16x16x32_bf16 a[28:31], a[124:127], a[88:91], a[28:31]
    v_mfma_f32_16x16x32_bf16 a[32:35], a[96:99], a[92:95], a[32:35]
    ds_read_b128 a[88:91], v192 offset:43008
    v_mfma_f32_16x16x32_bf16 a[36:39], a[100:103], a[92:95], a[36:39]
    v_mfma_f32_16x16x32_bf16 a[40:43], a[104:107], a[92:95], a[40:43]
    v_mfma_f32_16x16x32_bf16 a[44:47], a[108:111], a[92:95], a[44:47]
    v_mfma_f32_16x16x32_bf16 a[48:51], a[112:115], a[92:95], a[48:51]
    v_mfma_f32_16x16x32_bf16 a[52:55], a[116:119], a[92:95], a[52:55]
    v_mfma_f32_16x16x32_bf16 a[56:59], a[120:123], a[92:95], a[56:59]
    s_add_u32 s48, s48, 64
    v_mfma_f32_16x16x32_bf16 a[60:63], a[124:127], a[92:95], a[60:63]
    s_add_u32 s49, s49, 262144
    s_waitcnt lgkmcnt(2)
    v_mfma_f32_16x16x32_bf16 v[0:3], a[128:131], a[64:67], v[0:3]
    ds_read_b128 a[92:95], v192 offset:44032
    v_mfma_f32_16x16x32_bf16 v[4:7], a[132:135], a[64:67], v[4:7]
    v_mfma_f32_16x16x32_bf16 v[8:11], a[136:139], a[64:67], v[8:11]
    s_add_u32 m0, s50, 4096
    v_mfma_f32_16x16x32_bf16 v[12:15], a[140:143], a[64:67], v[12:15]
    buffer_load_dwordx4 v206, s[16:19], s49 offen offset:0 lds
    v_mfma_f32_16x16x32_bf16 v[16:19], a[144:147], a[64:67], v[16:19]
    v_mfma_f32_16x16x32_bf16 v[20:23], a[148:151], a[64:67], v[20:23]
    v_mfma_f32_16x16x32_bf16 v[24:27], a[152:155], a[64:67], v[24:27]
    v_mfma_f32_16x16x32_bf16 v[28:31], a[156:159], a[64:67], v[28:31]
    v_mfma_f32_16x16x32_bf16 v[32:35], a[128:131], a[68:71], v[32:35]
    v_mfma_f32_16x16x32_bf16 v[36:39], a[132:135], a[68:71], v[36:39]
    s_waitcnt vmcnt(9) lgkmcnt(0)
    s_barrier
    v_mfma_f32_16x16x32_bf16 v[40:43], a[136:139], a[68:71], v[40:43]
    buffer_load_dwordx4 v207, s[16:19], s49 offen offset:1024 lds
    v_xor_b32 v192, 0x10000, v192
    v_xor_b32 v194, 0x10000, v194
    v_mfma_f32_16x16x32_bf16 v[44:47], a[140:143], a[68:71], v[44:47]
    v_xor_b32 v195, 0x10000, v195
    v_xor_b32 v196, 0x10000, v196
    v_mfma_f32_16x16x32_bf16 v[48:51], a[144:147], a[68:71], v[48:51]
    v_xor_b32 v197, 0x10000, v197
    v_xor_b32 v198, 0x10000, v198
    v_mfma_f32_16x16x32_bf16 v[52:55], a[148:151], a[68:71], v[52:55]
    v_xor_b32 v199, 0x10000, v199
    v_xor_b32 v200, 0x10000, v200
    v_mfma_f32_16x16x32_bf16 v[56:59], a[152:155], a[68:71], v[56:59]
    v_xor_b32 v201, 0x10000, v201
    v_mfma_f32_16x16x32_bf16 v[60:63], a[156:159], a[68:71], v[60:63]
    ds_read_b128 a[64:67], v192 offset:0
    v_mfma_f32_16x16x32_bf16 v[64:67], a[128:131], a[72:75], v[64:67]
    ds_read_b64_tr_b16 a[96:97], v194 offset:0
    v_mfma_f32_16x16x32_bf16 v[68:71], a[132:135], a[72:75], v[68:71]
    buffer_load_dwordx4 v208, s[16:19], s49 offen offset:2048 lds
    v_mfma_f32_16x16x32_bf16 v[72:75], a[136:139], a[72:75], v[72:75]
    ds_read_b64_tr_b16 a[98:99], v194 offset:1024
    ds_read_b128 a[68:71], v192 offset:1024
    v_mfma_f32_16x16x32_bf16 v[76:79], a[140:143], a[72:75], v[76:79]
    v_mfma_f32_16x16x32_bf16 v[80:83], a[144:147], a[72:75], v[80:83]
    ds_read_b64_tr_b16 a[100:101], v195 offset:0
    v_mfma_f32_16x16x32_bf16 v[84:87], a[148:151], a[72:75], v[84:87]
    v_mfma_f32_16x16x32_bf16 v[88:91], a[152:155], a[72:75], v[88:91]
    ds_read_b64_tr_b16 a[102:103], v195 offset:1024
    v_mfma_f32_16x16x32_bf16 v[92:95], a[156:159], a[72:75], v[92:95]
    v_mfma_f32_16x16x32_bf16 v[96:99], a[128:131], a[76:79], v[96:99]
    ds_read_b64_tr_b16 a[104:105], v196 offset:0
    v_mfma_f32_16x16x32_bf16 v[100:103], a[132:135], a[76:79], v[100:103]
    ds_read_b128 a[72:75], v192 offset:2048
    v_mfma_f32_16x16x32_bf16 v[104:107], a[136:139], a[76:79], v[104:107]
    ds_read_b64_tr_b16 a[106:107], v196 offset:1024
    v_mfma_f32_16x16x32_bf16 v[108:111], a[140:143], a[76:79], v[108:111]
    buffer_load_dwordx4 v209, s[16:19], s49 offen offset:3072 lds
    v_mfma_f32_16x16x32_bf16 v[112:115], a[144:147], a[76:79], v[112:115]
    ds_read_b64_tr_b16 a[108:109], v197 offset:0
    s_add_u32 m0, s50, 0
    v_mfma_f32_16x16x32_bf16 v[116:119], a[148:151], a[76:79], v[116:119]
    v_mfma_f32_16x16x32_bf16 v[120:123], a[152:155], a[76:79], v[120:123]
    ds_read_b64_tr_b16 a[110:111], v197 offset:1024
    v_mfma_f32_16x16x32_bf16 v[124:127], a[156:159], a[76:79], v[124:127]
    buffer_load_dwordx4 v202, s[12:15], s48 offen offset:0 lds
    v_mfma_f32_16x16x32_bf16 v[128:131], a[128:131], a[80:83], v[128:131]
    ds_read_b64_tr_b16 a[112:113], v198 offset:0
    v_mfma_f32_16x16x32_bf16 v[132:135], a[132:135], a[80:83], v[132:135]
    ds_read_b128 a[76:79], v192 offset:3072
    v_mfma_f32_16x16x32_bf16 v[136:139], a[136:139], a[80:83], v[136:139]
    ds_read_b64_tr_b16 a[114:115], v198 offset:1024
    v_mfma_f32_16x16x32_bf16 v[140:143], a[140:143], a[80:83], v[140:143]
    v_mfma_f32_16x16x32_bf16 v[144:147], a[144:147], a[80:83], v[144:147]
    ds_read_b64_tr_b16 a[116:117], v199 offset:0
    v_mfma_f32_16x16x32_bf16 v[148:151], a[148:151], a[80:83], v[148:151]
    v_mfma_f32_16x16x32_bf16 v[152:155], a[152:155], a[80:83], v[152:155]
    ds_read_b64_tr_b16 a[118:119], v199 offset:1024
    v_mfma_f32_16x16x32_bf16 v[156:159], a[156:159], a[80:83], v[156:159]
    buffer_load_dwordx4 v203, s[12:15], s48 offen offset:1024 lds
    v_mfma_f32_16x16x32_bf16 v[160:163], a[128:131], a[84:87], v[160:163]
    ds_read_b64_tr_b16 a[120:121], v200 offset:0
    v_mfma_f32_16x16x32_bf16 v[164:167], a[132:135], a[84:87], v[164:167]
    ds_read_b128 a[80:83], v192 offset:8192
    v_mfma_f32_16x16x32_bf16 v[168:171], a[136:139], a[84:87], v[168:171]
    ds_read_b64_tr_b16 a[122:123], v200 offset:1024
    v_mfma_f32_16x16x32_bf16 v[172:175], a[140:143], a[84:87], v[172:175]
    v_mfma_f32_16x16x32_bf16 v[176:179], a[144:147], a[84:87], v[176:179]
    ds_read_b64_tr_b16 a[124:125], v201 offset:0
    v_mfma_f32_16x16x32_bf16 v[180:183], a[148:151], a[84:87], v[180:183]
    buffer_load_dwordx4 v204, s[12:15], s48 offen offset:2048 lds
    v_mfma_f32_16x16x32_bf16 v[184:187], a[152:155], a[84:87], v[184:187]
    ds_read_b64_tr_b16 a[126:127], v201 offset:1024
    v_mfma_f32_16x16x32_bf16 v[188:191], a[156:159], a[84:87], v[188:191]
    v_mfma_f32_16x16x32_bf16 a[0:3], a[128:131], a[88:91], a[0:3]
    v_mfma_f32_16x16x32_bf16 a[4:7], a[132:135], a[88:91], a[4:7]
    ds_read_b128 a[84:87], v192 offset:9216
    v_mfma_f32_16x16x32_bf16 a[8:11], a[136:139], a[88:91], a[8:11]
    v_mfma_f32_16x16x32_bf16 a[12:15], a[140:143], a[88:91], a[12:15]
    v_mfma_f32_16x16x32_bf16 a[16:19], a[144:147], a[88:91], a[16:19]
    buffer_load_dwordx4 v205, s[12:15], s48 offen offset:3072 lds
    v_mfma_f32_16x16x32_bf16 a[20:23], a[148:151], a[88:91], a[20:23]
    v_mfma_f32_16x16x32_bf16 a[24:27], a[152:155], a[88:91], a[24:27]
    v_mfma_f32_16x16x32_bf16 a[28:31], a[156:159], a[88:91], a[28:31]
    v_mfma_f32_16x16x32_bf16 a[32:35], a[128:131], a[92:95], a[32:35]
    v_mfma_f32_16x16x32_bf16 a[36:39], a[132:135], a[92:95], a[36:39]
    ds_read_b128 a[88:91], v192 offset:10240
    v_mfma_f32_16x16x32_bf16 a[40:43], a[136:139], a[92:95], a[40:43]
    v_mfma_f32_16x16x32_bf16 a[44:47], a[140:143], a[92:95], a[44:47]
    s_cmp_eq_u32 s68, s51
    s_cbranch_scc0 L_k1_zk1
    buffer_load_dword v252, v250, s[76:79], 0 offen
    v_add_u32 v250, s70, v250
L_k1_zk1:
    v_mfma_f32_16x16x32_bf16 a[48:51], a[144:147], a[92:95], a[48:51]
    v_mfma_f32_16x16x32_bf16 a[52:55], a[148:151], a[92:95], a[52:55]
    v_mfma_f32_16x16x32_bf16 a[56:59], a[152:155], a[92:95], a[56:59]
    s_add_u32 s48, s48, 64
    v_mfma_f32_16x16x32_bf16 a[60:63], a[156:159], a[92:95], a[60:63]
    s_add_u32 s49, s49, 262144
    s_waitcnt lgkmcnt(2)
    v_mfma_f32_16x16x32_bf16 v[0:3], a[96:99], a[64:67], v[0:3]
    ds_read_b128 a[92:95], v192 offset:11264
    v_mfma_f32_16x16x32_bf16 v[4:7], a[100:103], a[64:67], v[4:7]
    v_mfma_f32_16x16x32_bf16 v[8:11], a[104:107], a[64:67], v[8:11]
    s_add_u32 m0, s50, 36864
    v_mfma_f32_16x16x32_bf16 v[12:15], a[108:111], a[64:67], v[12:15]
    buffer_load_dwordx4 v206, s[16:19], s49 offen offset:0 lds
    v_mfma_f32_16x16x32_bf16 v[16:19], a[112:115], a[64:67], v[16:19]
    v_mfma_f32_16x16x32_bf16 v[20:23], a[116:119], a[64:67], v[20:23]
    v_mfma_f32_16x16x32_bf16 v[24:27], a[120:123], a[64:67], v[24:27]
    v_mfma_f32_16x16x32_bf16 v[28:31], a[124:127], a[64:67], v[28:31]
    v_mfma_f32_16x16x32_bf16 v[32:35], a[96:99], a[68:71], v[32:35]
    v_mfma_f32_16x16x32_bf16 v[36:39], a[100:103], a[68:71], v[36:39]
    s_waitcnt vmcnt(9) lgkmcnt(0)
    s_barrier
    v_mfma_f32_16x16x32_bf16 v[40:43], a[104:107], a[68:71], v[40:43]
    ds_read_b128 a[64:67], v192 offset:32768
    v_mfma_f32_16x16x32_bf16 v[44:47], a[108:111], a[68:71], v[44:47]
    ds_read_b64_tr_b16 a[128:129], v194 offset:32768
    v_mfma_f32_16x16x32_bf16 v[48:51], a[112:115], a[68:71], v[48:51]
    buffer_load_dwordx4 v207, s[16:19], s49 offen offset:1024 lds
    v_mfma_f32_16x16x32_bf16 v[52:55], a[116:119], a[68:71], v[52:55]
    ds_read_b64_tr_b16 a[130:131], v194 offset:33792
    v_mfma_f32_16x16x32_bf16 v[56:59], a[120:123], a[68:71], v[56:59]
    v_mfma_f32_16x16x32_bf16 v[60:63], a[124:127], a[68:71], v[60:63]
    ds_read_b64_tr_b16 a[132:133], v195 offset:32768
    v_mfma_f32_16x16x32_bf16 v[64:67], a[96:99], a[72:75], v[64:67]
    ds_read_b128 a[68:71], v192 offset:33792
    v_mfma_f32_16x16x32_bf16 v[68:71], a[100:103], a[72:75], v[68:71]
    ds_read_b64_tr_b16 a[134:135], v195 offset:33792
    v_mfma_f32_16x16x32_bf16 v[72:75], a[104:107], a[72:75], v[72:75]
    buffer_load_dwordx4 v208, s[16:19], s49 offen offset:2048 lds
    v_mfma_f32_16x16x32_bf16 v[76:79], a[108:111], a[72:75], v[76:79]
    ds_read_b64_tr_b16 a[136:137], v196 offset:32768
    v_mfma_f32_16x16x32_bf16 v[80:83], a[112:115], a[72:75], v[80:83]
    v_mfma_f32_16x16x32_bf16 v[84:87], a[116:119], a[72:75], v[84:87]
    ds_read_b64_tr_b16 a[138:139], v196 offset:33792
    v_mfma_f32_16x16x32_bf16 v[88:91], a[120:123], a[72:75], v[88:91]
    v_mfma_f32_16x16x32_bf16 v[92:95], a[124:127], a[72:75], v[92:95]
    ds_read_b64_tr_b16 a[140:141], v197 offset:32768
    v_mfma_f32_16x16x32_bf16 v[96:99], a[96:99], a[76:79], v[96:99]
    ds_read_b128 a[72:75], v192 offset:34816
    v_mfma_f32_16x16x32_bf16 v[100:103], a[100:103], a[76:79], v[100:103]
    ds_read_b64_tr_b16 a[142:143], v197 offset:33792
    v_mfma_f32_16x16x32_bf16 v[104:107], a[104:107], a[76:79], v[104:107]
    buffer_load_dwordx4 v209, s[16:19], s49 offen offset:3072 lds
    v_mfma_f32_16x16x32_bf16 v[108:111], a[108:111], a[76:79], v[108:111]
    ds_read_b64_tr_b16 a[144:145], v198 offset:32768
    s_add_u32 m0, s50, 32768
    v_mfma_f32_16x16x32_bf16 v[112:115], a[112:115], a[76:79], v[112:115]
    v_mfma_f32_16x16x32_bf16 v[116:119], a[116:119], a[76:79], v[116:119]
    ds_read_b64_tr_b16 a[146:147], v198 offset:33792
    v_mfma_f32_16x16x32_bf16 v[120:123], a[120:123], a[76:79], v[120:123]
    v_mfma_f32_16x16x32_bf16 v[124:127], a[124:127], a[76:79], v[124:127]
    ds_read_b64_tr_b16 a[148:149], v199 offset:32768
    v_mfma_f32_16x16x32_bf16 v[128:131], a[96:99], a[80:83], v[128:131]
    ds_read_b128 a[76:79], v192 offset:35840
    v_mfma_f32_16x16x32_bf16 v[132:135], a[100:103], a[80:83], v[132:135]
    ds_read_b64_tr_b16 a[150:151], v199 offset:33792
    v_mfma_f32_16x16x32_bf16 v[136:139], a[104:107], a[80:83], v[136:139]
    buffer_load_dwordx4 v202, s[12:15], s48 offen offset:0 lds
    v_mfma_f32_16x16x32_bf16 v[140:143], a[108:111], a[80:83], v[140:143]
    ds_read_b64_tr_b16 a[152:153], v200 offset:32768
    v_mfma_f32_16x16x32_bf16 v[144:147], a[112:115], a[80:83], v[144:147]
    v_mfma_f32_16x16x32_bf16 v[148:151], a[116:119], a[80:83], v[148:151]
    ds_read_b64_tr_b16 a[154:155], v200 offset:33792
    v_mfma_f32_16x16x32_bf16 v[152:155], a[120:123], a[80:83], v[152:155]
    buffer_load_dwordx4 v203, s[12:15], s48 offen offset:1024 lds
    v_mfma_f32_16x16x32_bf16 v[156:159], a[124:127], a[80:83], v[156:159]
    ds_read_b64_tr_b16 a[156:157], v201 offset:32768
    v_mfma_f32_16x16x32_bf16 v[160:163], a[96:99], a[84:87], v[160:163]
    ds_read_b128 a[80:83], v192 offset:40960
    v_mfma_f32_16x16x32_bf16 v[164:167], a[100:103], a[84:87], v[164:167]
    ds_read_b64_tr_b16 a[158:159], v201 offset:33792
    v_mfma_f32_16x16x32_bf16 v[168:171], a[104:107], a[84:87], v[168:171]
    v_mfma_f32_16x16x32_bf16 v[172:175], a[108:111], a[84:87], v[172:175]
    v_mfma_f32_16x16x32_bf16 v[176:179], a[112:115], a[84:87], v[176:179]
    v_mfma_f32_16x16x32_bf16 v[180:183], a[116:119], a[84:87], v[180:183]
    buffer_load_dwordx4 v204, s[12:15], s48 offen offset:2048 lds
    v_mfma_f32_16x16x32_bf16 v[184:187], a[120:123], a[84:87], v[184:187]
    v_mfma_f32_16x16x32_bf16 v[188:191], a[124:127], a[84:87], v[188:191]
    v_mfma_f32_16x16x32_bf16 a[0:3], a[96:99], a[88:91], a[0:3]
    ds_read_b128 a[84:87], v192 offset:41984
    v_mfma_f32_16x16x32_bf16 a[4:7], a[100:103], a[88:91], a[4:7]
    v_mfma_f32_16x16x32_bf16 a[8:11], a[104:107], a[88:91], a[8:11]
    v_mfma_f32_16x16x32_bf16 a[12:15], a[108:111], a[88:91], a[12:15]
    v_mfma_f32_16x16x32_bf16 a[16:19], a[112:115], a[88:91], a[16:19]
    buffer_load_dwordx4 v205, s[12:15], s48 offen offset:3072 lds
    v_mfma_f32_16x16x32_bf16 a[20:23], a[116:119], a[88:91], a[20:23]
    v_mfma_f32_16x16x32_bf16 a[24:27], a[120:123], a[88:91], a[24:27]
    v_mfma_f32_16x16x32_bf16 a[28:31], a[124:127], a[88:91], a[28:31]
    v_mfma_f32_16x16x32_bf16 a[32:35], a[96:99], a[92:95], a[32:35]
    ds_read_b128 a[88:91], v192 offset:43008
    v_mfma_f32_16x16x32_bf16 a[36:39], a[100:103], a[92:95], a[36:39]
    s_cmp_lt_u32 s56, 0x400000
    s_cbranch_scc0 L_k1_xk
    buffer_load_dword v252, v211, s[16:19], s56 offen
    s_add_u32 s56, s56, 0x100000
L_k1_xk:
    v_mfma_f32_16x16x32_bf16 a[40:43], a[104:107], a[92:95], a[40:43]
    v_mfma_f32_16x16x32_bf16 a[44:47], a[108:111], a[92:95], a[44:47]
    s_cmp_eq_u32 s68, s51
    s_cbranch_scc0 L_k1_zk2
    buffer_load_dword v252, v250, s[76:79], 0 offen
    v_add_u32 v250, s70, v250
L_k1_zk2:
    v_mfma_f32_16x16x32_bf16 a[48:51], a[112:115], a[92:95], a[48:51]
    v_mfma_f32_16x16x32_bf16 a[52:55], a[116:119], a[92:95], a[52:55]
    v_mfma_f32_16x16x32_bf16 a[56:59], a[120:123], a[92:95], a[56:59]
    s_add_u32 s48, s48, 64
    v_mfma_f32_16x16x32_bf16 a[60:63], a[124:127], a[92:95], a[60:63]
    s_add_u32 s49, s49, 262144
    s_waitcnt lgkmcnt(2)
    v_mfma_f32_16x16x32_bf16 v[0:3], a[128:131], a[64:67], v[0:3]
    ds_read_b128 a[92:95], v192 offset:44032
    v_mfma_f32_16x16x32_bf16 v[4:7], a[132:135], a[64:67], v[4:7]
    v_mfma_f32_16x16x32_bf16 v[8:11], a[136:139], a[64:67], v[8:11]
    s_add_u32 m0, s50, 69632
    v_mfma_f32_16x16x32_bf16 v[12:15], a[140:143], a[64:67], v[12:15]
    buffer_load_dwordx4 v206, s[16:19], s49 offen offset:0 lds
    v_mfma_f32_16x16x32_bf16 v[16:19], a[144:147], a[64:67], v[16:19]
    v_mfma_f32_16x16x32_bf16 v[20:23], a[148:151], a[64:67], v[20:23]
    v_mfma_f32_16x16x32_bf16 v[24:27], a[152:155], a[64:67], v[24:27]
    v_mfma_f32_16x16x32_bf16 v[28:31], a[156:159], a[64:67], v[28:31]
    v_mfma_f32_16x16x32_bf16 v[32:35], a[128:131], a[68:71], v[32:35]
    v_mfma_f32_16x16x32_bf16 v[36:39], a[132:135], a[68:71], v[36:39]
    s_waitcnt vmcnt(9) lgkmcnt(0)
    s_barrier
    v_mfma_f32_16x16x32_bf16 v[40:43], a[136:139], a[68:71], v[40:43]
    buffer_load_dwordx4 v207, s[16:19], s49 offen offset:1024 lds
    v_xor_b32 v192, 0x10000, v192
    v_xor_b32 v194, 0x10000, v194
    v_mfma_f32_16x16x32_bf16 v[44:47], a[140:143], a[68:71], v[44:47]
    v_xor_b32 v195, 0x10000, v195
    v_xor_b32 v196, 0x10000, v196
    v_mfma_f32_16x16x32_bf16 v[48:51], a[144:147], a[68:71], v[48:51]
    v_xor_b32 v197, 0x10000, v197
    v_xor_b32 v198, 0x10000, v198
    v_mfma_f32_16x16x32_bf16 v[52:55], a[148:151], a[68:71], v[52:55]
    v_xor_b32 v199, 0x10000, v199
    v_xor_b32 v200, 0x10000, v200
    v_mfma_f32_16x16x32_bf16 v[56:59], a[152:155], a[68:71], v[56:59]
    v_xor_b32 v201, 0x10000, v201
    v_mfma_f32_16x16x32_bf16 v[60:63], a[156:159], a[68:71], v[60:63]
    ds_read_b128 a[64:67], v192 offset:0
    v_mfma_f32_16x16x32_bf16 v[64:67], a[128:131], a[72:75], v[64:67]
    ds_read_b64_tr_b16 a[96:97], v194 offset:0
    s_or_b32 s55, s51, s44
    s_cbranch_scc1 L_k1_yka
    s_lshl_b32 s55, s2, 7
    s_add_u32 s55, s55, 0x490000
    v_mov_b32 v254, s58
    s_mov_b64 exec, 1
    buffer_store_dword v254, v255, s[8:11], s55 offen offset:0 sc1
    s_mov_b64 exec, -1
L_k1_yka:
    v_mfma_f32_16x16x32_bf16 v[68:71], a[132:135], a[72:75], v[68:71]
    buffer_load_dwordx4 v208, s[16:19], s49 offen offset:2048 lds
    v_mfma_f32_16x16x32_bf16 v[72:75], a[136:139], a[72:75], v[72:75]
    ds_read_b64_tr_b16 a[98:99], v194 offset:1024
    ds_read_b128 a[68:71], v192 offset:1024
    v_mfma_f32_16x16x32_bf16 v[76:79], a[140:143], a[72:75], v[76:79]
    v_mfma_f32_16x16x32_bf16 v[80:83], a[144:147], a[72:75], v[80:83]
    ds_read_b64_tr_b16 a[100:101], v195 offset:0
    v_mfma_f32_16x16x32_bf16 v[84:87], a[148:151], a[72:75], v[84:87]
    v_mfma_f32_16x16x32_bf16 v[88:91], a[152:155], a[72:75], v[88:91]
    ds_read_b64_tr_b16 a[102:103], v195 offset:1024
    v_mfma_f32_16x16x32_bf16 v[92:95], a[156:159], a[72:75], v[92:95]
    v_mfma_f32_16x16x32_bf16 v[96:99], a[128:131], a[76:79], v[96:99]
    ds_read_b64_tr_b16 a[104:105], v196 offset:0
    v_mfma_f32_16x16x32_bf16 v[100:103], a[132:135], a[76:79], v[100:103]
    ds_read_b128 a[72:75], v192 offset:2048
    v_mfma_f32_16x16x32_bf16 v[104:107], a[136:139], a[76:79], v[104:107]
    ds_read_b64_tr_b16 a[106:107], v196 offset:1024
    v_mfma_f32_16x16x32_bf16 v[108:111], a[140:143], a[76:79], v[108:111]
    buffer_load_dwordx4 v209, s[16:19], s49 offen offset:3072 lds
    v_mfma_f32_16x16x32_bf16 v[112:115], a[144:147], a[76:79], v[112:115]
    ds_read_b64_tr_b16 a[108:109], v197 offset:0
    s_add_u32 m0, s50, 65536
    v_mfma_f32_16x16x32_bf16 v[116:119], a[148:151], a[76:79], v[116:119]
    v_mfma_f32_16x16x32_bf16 v[120:123], a[152:155], a[76:79], v[120:123]
    ds_read_b64_tr_b16 a[110:111], v197 offset:1024
    v_mfma_f32_16x16x32_bf16 v[124:127], a[156:159], a[76:79], v[124:127]
    buffer_load_dwordx4 v202, s[12:15], s48 offen offset:0 lds
    v_mfma_f32_16x16x32_bf16 v[128:131], a[128:131], a[80:83], v[128:131]
    ds_read_b64_tr_b16 a[112:113], v198 offset:0
    v_mfma_f32_16x16x32_bf16 v[132:135], a[132:135], a[80:83], v[132:135]
    ds_read_b128 a[76:79], v192 offset:3072
    v_mfma_f32_16x16x32_bf16 v[136:139], a[136:139], a[80:83], v[136:139]
    ds_read_b64_tr_b16 a[114:115], v198 offset:1024
    v_mfma_f32_16x16x32_bf16 v[140:143], a[140:143], a[80:83], v[140:143]
    v_mfma_f32_16x16x32_bf16 v[144:147], a[144:147], a[80:83], v[144:147]
    ds_read_b64_tr_b16 a[116:117], v199 offset:0
    v_mfma_f32_16x16x32_bf16 v[148:151], a[148:151], a[80:83], v[148:151]
    v_mfma_f32_16x16x32_bf16 v[152:155], a[152:155], a[80:83], v[152:155]
    ds_read_b64_tr_b16 a[118:119], v199 offset:1024
    v_mfma_f32_16x16x32_bf16 v[156:159], a[156:159], a[80:83], v[156:159]
    buffer_load_dwordx4 v203, s[12:15], s48 offen offset:1024 lds
    v_mfma_f32_16x16x32_bf16 v[160:163], a[128:131], a[84:87], v[160:163]
    ds_read_b64_tr_b16 a[120:121], v200 offset:0
    v_mfma_f32_16x16x32_bf16 v[164:167], a[132:135], a[84:87], v[164:167]
    ds_read_b128 a[80:83], v192 offset:8192
    v_mfma_f32_16x16x32_bf16 v[168:171], a[136:139], a[84:87], v[168:171]
    ds_read_b64_tr_b16 a[122:123], v200 offset:1024
    v_mfma_f32_16x16x32_bf16 v[172:175], a[140:143], a[84:87], v[172:175]
    v_mfma_f32_16x16x32_bf16 v[176:179], a[144:147], a[84:87], v[176:179]
    ds_read_b64_tr_b16 a[124:125], v201 offset:0
    v_mfma_f32_16x16x32_bf16 v[180:183], a[148:151], a[84:87], v[180:183]
    buffer_load_dwordx4 v204, s[12:15], s48 offen offset:2048 lds
    v_mfma_f32_16x16x32_bf16 v[184:187], a[152:155], a[84:87], v[184:187]
    ds_read_b64_tr_b16 a[126:127], v201 offset:1024
    v_mfma_f32_16x16x32_bf16 v[188:191], a[156:159], a[84:87], v[188:191]
    v_mfma_f32_16x16x32_bf16 a[0:3], a[128:131], a[88:91], a[0:3]
    v_mfma_f32_16x16x32_bf16 a[4:7], a[132:135], a[88:91], a[4:7]
    ds_read_b128 a[84:87], v192 offset:9216
    v_mfma_f32_16x16x32_bf16 a[8:11], a[136:139], a[88:91], a[8:11]
    v_mfma_f32_16x16x32_bf16 a[12:15], a[140:143], a[88:91], a[12:15]
    v_mfma_f32_16x16x32_bf16 a[16:19], a[144:147], a[88:91], a[16:19]
    buffer_load_dwordx4 v205, s[12:15], s48 offen offset:3072 lds
    v_mfma_f32_16x16x32_bf16 a[20:23], a[148:151], a[88:91], a[20:23]
    v_mfma_f32_16x16x32_bf16 a[24:27], a[152:155], a[88:91], a[24:27]
    v_mfma_f32_16x16x32_bf16 a[28:31], a[156:159], a[88:91], a[28:31]
    v_mfma_f32_16x16x32_bf16 a[32:35], a[128:131], a[92:95], a[32:35]
    v_mfma_f32_16x16x32_bf16 a[36:39], a[132:135], a[92:95], a[36:39]
    ds_read_b128 a[88:91], v192 offset:10240
    v_mfma_f32_16x16x32_bf16 a[40:43], a[136:139], a[92:95], a[40:43]
    v_mfma_f32_16x16x32_bf16 a[44:47], a[140:143], a[92:95], a[44:47]
    s_cmp_eq_u32 s68, s51
    s_cbranch_scc0 L_k1_zk3
    buffer_load_dword v252, v250, s[76:79], 0 offen
    v_add_u32 v250, s70, v250
L_k1_zk3:
    v_mfma_f32_16x16x32_bf16 a[48:51], a[144:147], a[92:95], a[48:51]
    s_add_u32 s51, s51, 1
    v_mfma_f32_16x16x32_bf16 a[52:55], a[148:151], a[92:95], a[52:55]
    v_mfma_f32_16x16x32_bf16 a[56:59], a[152:155], a[92:95], a[56:59]
    s_add_u32 s48, s48, 64
    v_mfma_f32_16x16x32_bf16 a[60:63], a[156:159], a[92:95], a[60:63]
    s_add_u32 s49, s49, 262144
    s_cmp_lt_u32 s51, 3
    s_cbranch_scc1 L_k1_loop_k
    s_waitcnt lgkmcnt(2)
    v_mfma_f32_16x16x32_bf16 v[0:3], a[96:99], a[64:67], v[0:3]
    ds_read_b128 a[92:95], v192 offset:11264
    v_mfma_f32_16x16x32_bf16 v[4:7], a[100:103], a[64:67], v[4:7]
    v_mfma_f32_16x16x32_bf16 v[8:11], a[104:107], a[64:67], v[8:11]
    s_add_u32 m0, s50, 102400
    v_mfma_f32_16x16x32_bf16 v[12:15], a[108:111], a[64:67], v[12:15]
    buffer_load_dwordx4 v206, s[16:19], s49 offen offset:0 lds
    v_mfma_f32_16x16x32_bf16 v[16:19], a[112:115], a[64:67], v[16:19]
    v_mfma_f32_16x16x32_bf16 v[20:23], a[116:119], a[64:67], v[20:23]
    v_mfma_f32_16x16x32_bf16 v[24:27], a[120:123], a[64:67], v[24:27]
    v_mfma_f32_16x16x32_bf16 v[28:31], a[124:127], a[64:67], v[28:31]
    v_mfma_f32_16x16x32_bf16 v[32:35], a[96:99], a[68:71], v[32:35]
    v_mfma_f32_16x16x32_bf16 v[36:39], a[100:103], a[68:71], v[36:39]
    s_waitcnt vmcnt(9)
    s_waitcnt lgkmcnt(0)
    s_barrier
    v_mfma_f32_16x16x32_bf16 v[40:43], a[104:107], a[68:71], v[40:43]
    ds_read_b128 a[64:67], v192 offset:32768
    v_mfma_f32_16x16x32_bf16 v[44:47], a[108:111], a[68:71], v[44:47]
    ds_read_b64_tr_b16 a[128:129], v194 offset:32768
    v_mfma_f32_16x16x32_bf16 v[48:51], a[112:115], a[68:71], v[48:51]
    buffer_load_dwordx4 v207, s[16:19], s49 offen offset:1024 lds
    v_mfma_f32_16x16x32_bf16 v[52:55], a[116:119], a[68:71], v[52:55]
    ds_read_b64_tr_b16 a[130:131], v194 offset:33792
    v_mfma_f32_16x16x32_bf16 v[56:59], a[120:123], a[68:71], v[56:59]
    v_mfma_f32_16x16x32_bf16 v[60:63], a[124:127], a[68:71], v[60:63]
    ds_read_b64_tr_b16 a[132:133], v195 offset:32768
    v_mfma_f32_16x16x32_bf16 v[64:67], a[96:99], a[72:75], v[64:67]
    ds_read_b128 a[68:71], v192 offset:33792
    v_mfma_f32_16x16x32_bf16 v[68:71], a[100:103], a[72:75], v[68:71]
    ds_read_b64_tr_b16 a[134:135], v195 offset:33792
    v_mfma_f32_16x16x32_bf16 v[72:75], a[104:107], a[72:75], v[72:75]
    buffer_load_dwordx4 v208, s[16:19], s49 offen offset:2048 lds
    v_mfma_f32_16x16x32_bf16 v[76:79], a[108:111], a[72:75], v[76:79]
    ds_read_b64_tr_b16 a[136:137], v196 offset:32768
    v_mfma_f32_16x16x32_bf16 v[80:83], a[112:115], a[72:75], v[80:83]
    v_mfma_f32_16x16x32_bf16 v[84:87], a[116:119], a[72:75], v[84:87]
    ds_read_b64_tr_b16 a[138:139], v196 offset:33792
    v_mfma_f32_16x16x32_bf16 v[88:91], a[120:123], a[72:75], v[88:91]
    v_mfma_f32_16x16x32_bf16 v[92:95], a[124:127], a[72:75], v[92:95]
    ds_read_b64_tr_b16 a[140:141], v197 offset:32768
    v_mfma_f32_16x16x32_bf16 v[96:99], a[96:99], a[76:79], v[96:99]
    ds_read_b128 a[72:75], v192 offset:34816
    v_mfma_f32_16x16x32_bf16 v[100:103], a[100:103], a[76:79], v[100:103]
    ds_read_b64_tr_b16 a[142:143], v197 offset:33792
    v_mfma_f32_16x16x32_bf16 v[104:107], a[104:107], a[76:79], v[104:107]
    buffer_load_dwordx4 v209, s[16:19], s49 offen offset:3072 lds
    v_mfma_f32_16x16x32_bf16 v[108:111], a[108:111], a[76:79], v[108:111]
    ds_read_b64_tr_b16 a[144:145], v198 offset:32768
    s_add_u32 m0, s50, 98304
    v_mfma_f32_16x16x32_bf16 v[112:115], a[112:115], a[76:79], v[112:115]
    v_mfma_f32_16x16x32_bf16 v[116:119], a[116:119], a[76:79], v[116:119]
    ds_read_b64_tr_b16 a[146:147], v198 offset:33792
    v_mfma_f32_16x16x32_bf16 v[120:123], a[120:123], a[76:79], v[120:123]
    v_mfma_f32_16x16x32_bf16 v[124:127], a[124:127], a[76:79], v[124:127]
    ds_read_b64_tr_b16 a[148:149], v199 offset:32768
    v_mfma_f32_16x16x32_bf16 v[128:131], a[96:99], a[80:83], v[128:131]
    ds_read_b128 a[76:79], v192 offset:35840
    v_mfma_f32_16x16x32_bf16 v[132:135], a[100:103], a[80:83], v[132:135]
    ds_read_b64_tr_b16 a[150:151], v199 offset:33792
    v_mfma_f32_16x16x32_bf16 v[136:139], a[104:107], a[80:83], v[136:139]
    buffer_load_dwordx4 v202, s[12:15], s48 offen offset:0 lds
    v_mfma_f32_16x16x32_bf16 v[140:143], a[108:111], a[80:83], v[140:143]
    ds_read_b64_tr_b16 a[152:153], v200 offset:32768
    v_mfma_f32_16x16x32_bf16 v[144:147], a[112:115], a[80:83], v[144:147]
    v_mfma_f32_16x16x32_bf16 v[148:151], a[116:119], a[80:83], v[148:151]
    ds_read_b64_tr_b16 a[154:155], v200 offset:33792
    v_mfma_f32_16x16x32_bf16 v[152:155], a[120:123], a[80:83], v[152:155]
    buffer_load_dwordx4 v203, s[12:15], s48 offen offset:1024 lds
    v_mfma_f32_16x16x32_bf16 v[156:159], a[124:127], a[80:83], v[156:159]
    ds_read_b64_tr_b16 a[156:157], v201 offset:32768
    v_mfma_f32_16x16x32_bf16 v[160:163], a[96:99], a[84:87], v[160:163]
    ds_read_b128 a[80:83], v192 offset:40960
    v_mfma_f32_16x16x32_bf16 v[164:167], a[100:103], a[84:87], v[164:167]
    ds_read_b64_tr_b16 a[158:159], v201 offset:33792
    v_mfma_f32_16x16x32_bf16 v[168:171], a[104:107], a[84:87], v[168:171]
    v_mfma_f32_16x16x32_bf16 v[172:175], a[108:111], a[84:87], v[172:175]
    v_mfma_f32_16x16x32_bf16 v[176:179], a[112:115], a[84:87], v[176:179]
    v_mfma_f32_16x16x32_bf16 v[180:183], a[116:119], a[84:87], v[180:183]
    buffer_load_dwordx4 v204, s[12:15], s48 offen offset:2048 lds
    v_mfma_f32_16x16x32_bf16 v[184:187], a[120:123], a[84:87], v[184:187]
    v_mfma_f32_16x16x32_bf16 v[188:191], a[124:127], a[84:87], v[188:191]
    v_mfma_f32_16x16x32_bf16 a[0:3], a[96:99], a[88:91], a[0:3]
    ds_read_b128 a[84:87], v192 offset:41984
    v_mfma_f32_16x16x32_bf16 a[4:7], a[100:103], a[88:91], a[4:7]
    v_mfma_f32_16x16x32_bf16 a[8:11], a[104:107], a[88:91], a[8:11]
    v_mfma_f32_16x16x32_bf16 a[12:15], a[108:111], a[88:91], a[12:15]
    v_mfma_f32_16x16x32_bf16 a[16:19], a[112:115], a[88:91], a[16:19]
    buffer_load_dwordx4 v205, s[12:15], s48 offen offset:3072 lds
    v_mfma_f32_16x16x32_bf16 a[20:23], a[116:119], a[88:91], a[20:23]
    v_mfma_f32_16x16x32_bf16 a[24:27], a[120:123], a[88:91], a[24:27]
    v_mfma_f32_16x16x32_bf16 a[28:31], a[124:127], a[88:91], a[28:31]
    v_mfma_f32_16x16x32_bf16 a[32:35], a[96:99], a[92:95], a[32:35]
    ds_read_b128 a[88:91], v192 offset:43008
    v_mfma_f32_16x16x32_bf16 a[36:39], a[100:103], a[92:95], a[36:39]
    v_mfma_f32_16x16x32_bf16 a[40:43], a[104:107], a[92:95], a[40:43]
    buffer_load_dword v254, v253, s[8:11], s57 offen sc1
    v_mfma_f32_16x16x32_bf16 a[44:47], a[108:111], a[92:95], a[44:47]
    v_mfma_f32_16x16x32_bf16 a[48:51], a[112:115], a[92:95], a[48:51]
    v_mfma_f32_16x16x32_bf16 a[52:55], a[116:119], a[92:95], a[52:55]
    v_mfma_f32_16x16x32_bf16 a[56:59], a[120:123], a[92:95], a[56:59]
    s_add_u32 s48, s48, 64
    v_mfma_f32_16x16x32_bf16 a[60:63], a[124:127], a[92:95], a[60:63]
    s_add_u32 s49, s49, 262144
    s_waitcnt lgkmcnt(2)
    v_mfma_f32_16x16x32_bf16 v[0:3], a[128:131], a[64:67], v[0:3]
    ds_read_b128 a[92:95], v192 offset:44032
    v_mfma_f32_16x16x32_bf16 v[4:7], a[132:135], a[64:67], v[4:7]
    v_mfma_f32_16x16x32_bf16 v[8:11], a[136:139], a[64:67], v[8:11]
    v_mfma_f32_16x16x32_bf16 v[12:15], a[140:143], a[64:67], v[12:15]
    v_mfma_f32_16x16x32_bf16 v[16:19], a[144:147], a[64:67], v[16:19]
    v_mfma_f32_16x16x32_bf16 v[20:23], a[148:151], a[64:67], v[20:23]
    v_mfma_f32_16x16x32_bf16 v[24:27], a[152:155], a[64:67], v[24:27]
    v_mfma_f32_16x16x32_bf16 v[28:31], a[156:159], a[64:67], v[28:31]
    v_mfma_f32_16x16x32_bf16 v[32:35], a[128:131], a[68:71], v[32:35]
    v_mfma_f32_16x16x32_bf16 v[36:39], a[132:135], a[68:71], v[36:39]
    s_waitcnt vmcnt(9)
    s_waitcnt lgkmcnt(0)
    s_barrier
    s_waitcnt vmcnt(0)
    s_mov_b32 s55, 0
L_ka_fl_lnk:
    v_cmp_ne_u32 vcc, s58, v254
    s_cbranch_vccz L_ka_fl_lnk_ok
    s_sleep 8
    buffer_load_dword v254, v253, s[8:11], s57 offen sc1
    s_add_u32 s55, s55, 1
    s_cmp_lt_u32 s55, 0x40000
    s_waitcnt vmcnt(0)
    s_cbranch_scc1 L_ka_fl_lnk
L_ka_fl_lnk_ok:
    v_mfma_f32_16x16x32_bf16 v[40:43], a[136:139], a[68:71], v[40:43]
    v_xor_b32 v192, 0x10000, v192
    v_xor_b32 v194, 0x10000, v194
    v_mfma_f32_16x16x32_bf16 v[44:47], a[140:143], a[68:71], v[44:47]
    v_xor_b32 v195, 0x10000, v195
    v_xor_b32 v196, 0x10000, v196
    v_mfma_f32_16x16x32_bf16 v[48:51], a[144:147], a[68:71], v[48:51]
    v_xor_b32 v197, 0x10000, v197
    v_xor_b32 v198, 0x10000, v198
    v_mfma_f32_16x16x32_bf16 v[52:55], a[148:151], a[68:71], v[52:55]
    v_xor_b32 v199, 0x10000, v199
    v_xor_b32 v200, 0x10000, v200
    v_mfma_f32_16x16x32_bf16 v[56:59], a[152:155], a[68:71], v[56:59]
    v_xor_b32 v201, 0x10000, v201
    v_mfma_f32_16x16x32_bf16 v[60:63], a[156:159], a[68:71], v[60:63]
    ds_read_b128 a[64:67], v192 offset:0
    s_add_u32 s52, s71, 0
    s_add_u32 s53, s72, 0
    v_mfma_f32_16x16x32_bf16 v[64:67], a[128:131], a[72:75], v[64:67]
    ds_read_b64_tr_b16 a[96:97], v194 offset:0
    v_mfma_f32_16x16x32_bf16 v[68:71], a[132:135], a[72:75], v[68:71]
    buffer_load_dwordx4 a[192:195], v240, s[8:11], s52 offen offset:0 sc1
    v_mfma_f32_16x16x32_bf16 v[72:75], a[136:139], a[72:75], v[72:75]
    ds_read_b64_tr_b16 a[98:99], v194 offset:1024
    ds_read_b128 a[68:71], v192 offset:1024
    v_mfma_f32_16x16x32_bf16 v[76:79], a[140:143], a[72:75], v[76:79]
    v_mfma_f32_16x16x32_bf16 v[80:83], a[144:147], a[72:75], v[80:83]
    ds_read_b64_tr_b16 a[100:101], v195 offset:0
    v_mfma_f32_16x16x32_bf16 v[84:87], a[148:151], a[72:75], v[84:87]
    buffer_load_dwordx4 a[196:199], v240, s[8:11], s53 offen offset:0 sc1
    v_mfma_f32_16x16x32_bf16 v[88:91], a[152:155], a[72:75], v[88:91]
    ds_read_b64_tr_b16 a[102:103], v195 offset:1024
    v_mfma_f32_16x16x32_bf16 v[92:95], a[156:159], a[72:75], v[92:95]
    v_mfma_f32_16x16x32_bf16 v[96:99], a[128:131], a[76:79], v[96:99]
    ds_read_b64_tr_b16 a[104:105], v196 offset:0
    v_mfma_f32_16x16x32_bf16 v[100:103], a[132:135], a[76:79], v[100:103]
    ds_read_b128 a[72:75], v192 offset:2048
    v_mfma_f32_16x16x32_bf16 v[104:107], a[136:139], a[76:79], v[104:107]
    ds_read_b64_tr_b16 a[106:107], v196 offset:1024
    v_mfma_f32_16x16x32_bf16 v[108:111], a[140:143], a[76:79], v[108:111]
    buffer_load_dwordx4 a[200:203], v240, s[8:11], s52 offen offset:1024 sc1
    v_mfma_f32_16x16x32_bf16 v[112:115], a[144:147], a[76:79], v[112:115]
    ds_read_b64_tr_b16 a[108:109], v197 offset:0
    v_mfma_f32_16x16x32_bf16 v[116:119], a[148:151], a[76:79], v[116:119]
    v_mfma_f32_16x16x32_bf16 v[120:123], a[152:155], a[76:79], v[120:123]
    ds_read_b64_tr_b16 a[110:111], v197 offset:1024
    v_mfma_f32_16x16x32_bf16 v[124:127], a[156:159], a[76:79], v[124:127]
    buffer_load_dwordx4 a[204:207], v240, s[8:11], s53 offen offset:1024 sc1
    v_mfma_f32_16x16x32_bf16 v[128:131], a[128:131], a[80:83], v[128:131]
    ds_read_b64_tr_b16 a[112:113], v198 offset:0
    v_mfma_f32_16x16x32_bf16 v[132:135], a[132:135], a[80:83], v[132:135]
    ds_read_b128 a[76:79], v192 offset:3072
    v_mfma_f32_16x16x32_bf16 v[136:139], a[136:139], a[80:83], v[136:139]
    ds_read_b64_tr_b16 a[114:115], v198 offset:1024
    v_mfma_f32_16x16x32_bf16 v[140:143], a[140:143], a[80:83], v[140:143]
    buffer_load_dwordx4 a[208:211], v240, s[8:11], s52 offen offset:2048 sc1
    v_mfma_f32_16x16x32_bf16 v[144:147], a[144:147], a[80:83], v[144:147]
    ds_read_b64_tr_b16 a[116:117], v199 offset:0
    v_mfma_f32_16x16x32_bf16 v[148:151], a[148:151], a[80:83], v[148:151]
    v_mfma_f32_16x16x32_bf16 v[152:155], a[152:155], a[80:83], v[152:155]
    ds_read_b64_tr_b16 a[118:119], v199 offset:1024
    v_mfma_f32_16x16x32_bf16 v[156:159], a[156:159], a[80:83], v[156:159]
    buffer_load_dwordx4 a[212:215], v240, s[8:11], s53 offen offset:2048 sc1
    v_mfma_f32_16x16x32_bf16 v[160:163], a[128:131], a[84:87], v[160:163]
    ds_read_b64_tr_b16 a[120:121], v200 offset:0
    v_mfma_f32_16x16x32_bf16 v[164:167], a[132:135], a[84:87], v[164:167]
    ds_read_b128 a[80:83], v192 offset:8192
    v_mfma_f32_16x16x32_bf16 v[168:171], a[136:139], a[84:87], v[168:171]
    ds_read_b64_tr_b16 a[122:123], v200 offset:1024
    v_mfma_f32_16x16x32_bf16 v[172:175], a[140:143], a[84:87], v[172:175]
    buffer_load_dwordx4 a[216:219], v240, s[8:11], s52 offen offset:3072 sc1
    v_mfma_f32_16x16x32_bf16 v[176:179], a[144:147], a[84:87], v[176:179]
    ds_read_b64_tr_b16 a[124:125], v201 offset:0
    v_mfma_f32_16x16x32_bf16 v[180:183], a[148:151], a[84:87], v[180:183]
    v_mfma_f32_16x16x32_bf16 v[184:187], a[152:155], a[84:87], v[184:187]
    ds_read_b64_tr_b16 a[126:127], v201 offset:1024
    v_mfma_f32_16x16x32_bf16 v[188:191], a[156:159], a[84:87], v[188:191]
    buffer_load_dwordx4 a[220:223], v240, s[8:11], s53 offen offset:3072 sc1
    v_mfma_f32_16x16x32_bf16 a[0:3], a[128:131], a[88:91], a[0:3]
    v_mfma_f32_16x16x32_bf16 a[4:7], a[132:135], a[88:91], a[4:7]
    ds_read_b128 a[84:87], v192 offset:9216
    s_add_u32 m0, s3, 0
    s_add_u32 s54, s73, 0
    v_mfma_f32_16x16x32_bf16 a[8:11], a[136:139], a[88:91], a[8:11]
    buffer_load_dwordx4 v246, s[28:31], s54 offen offset:0 lds
    v_mfma_f32_16x16x32_bf16 a[12:15], a[140:143], a[88:91], a[12:15]
    v_mfma_f32_16x16x32_bf16 a[16:19], a[144:147], a[88:91], a[16:19]
    v_mfma_f32_16x16x32_bf16 a[20:23], a[148:151], a[88:91], a[20:23]
    buffer_load_dwordx4 v247, s[28:31], s54 offen offset:1024 lds
    v_mfma_f32_16x16x32_bf16 a[24:27], a[152:155], a[88:91], a[24:27]
    v_mfma_f32_16x16x32_bf16 a[28:31], a[156:159], a[88:91], a[28:31]
    v_mfma_f32_16x16x32_bf16 a[32:35], a[128:131], a[92:95], a[32:35]
    buffer_load_dwordx4 v248, s[28:31], s54 offen offset:2048 lds
    v_mfma_f32_16x16x32_bf16 a[36:39], a[132:135], a[92:95], a[36:39]
    ds_read_b128 a[88:91], v192 offset:10240
    v_mfma_f32_16x16x32_bf16 a[40:43], a[136:139], a[92:95], a[40:43]
    v_mfma_f32_16x16x32_bf16 a[44:47], a[140:143], a[92:95], a[44:47]
    buffer_load_dwordx4 v249, s[28:31], s54 offen offset:3072 lds
    v_mfma_f32_16x16x32_bf16 a[48:51], a[144:147], a[92:95], a[48:51]
    v_mfma_f32_16x16x32_bf16 a[52:55], a[148:151], a[92:95], a[52:55]
    v_mfma_f32_16x16x32_bf16 a[56:59], a[152:155], a[92:95], a[56:59]
    v_mfma_f32_16x16x32_bf16 a[60:63], a[156:159], a[92:95], a[60:63]
    s_waitcnt lgkmcnt(2)
    v_mfma_f32_16x16x32_bf16 v[0:3], a[96:99], a[64:67], v[0:3]
    ds_read_b128 a[92:95], v192 offset:11264
    v_mfma_f32_16x16x32_bf16 v[4:7], a[100:103], a[64:67], v[4:7]
    v_mfma_f32_16x16x32_bf16 v[8:11], a[104:107], a[64:67], v[8:11]
    v_mfma_f32_16x16x32_bf16 v[12:15], a[108:111], a[64:67], v[12:15]
    v_mfma_f32_16x16x32_bf16 v[16:19], a[112:115], a[64:67], v[16:19]
    v_mfma_f32_16x16x32_bf16 v[20:23], a[116:119], a[64:67], v[20:23]
    v_mfma_f32_16x16x32_bf16 v[24:27], a[120:123], a[64:67], v[24:27]
    v_mfma_f32_16x16x32_bf16 v[28:31], a[124:127], a[64:67], v[28:31]
    v_mfma_f32_16x16x32_bf16 v[32:35], a[96:99], a[68:71], v[32:35]
    v_mfma_f32_16x16x32_bf16 v[36:39], a[100:103], a[68:71], v[36:39]
    s_waitcnt vmcnt(13)
    s_waitcnt lgkmcnt(0)
    s_barrier
    v_mfma_f32_16x16x32_bf16 v[40:43], a[104:107], a[68:71], v[40:43]
    ds_read_b128 a[64:67], v192 offset:32768
    v_mfma_f32_16x16x32_bf16 v[44:47], a[108:111], a[68:71], v[44:47]
    ds_read_b64_tr_b16 a[128:129], v194 offset:32768
    v_mfma_f32_16x16x32_bf16 v[48:51], a[112:115], a[68:71], v[48:51]
    v_mfma_f32_16x16x32_bf16 v[52:55], a[116:119], a[68:71], v[52:55]
    ds_read_b64_tr_b16 a[130:131], v194 offset:33792
    v_mfma_f32_16x16x32_bf16 v[56:59], a[120:123], a[68:71], v[56:59]
    v_mfma_f32_16x16x32_bf16 v[60:63], a[124:127], a[68:71], v[60:63]
    ds_read_b64_tr_b16 a[132:133], v195 offset:32768
    s_add_u32 s52, s71, 4096
    s_add_u32 s53, s72, 4096
    v_mfma_f32_16x16x32_bf16 v[64:67], a[96:99], a[72:75], v[64:67]
    ds_read_b128 a[68:71], v192 offset:33792
    v_mfma_f32_16x16x32_bf16 v[68:71], a[100:103], a[72:75], v[68:71]
    ds_read_b64_tr_b16 a[134:135], v195 offset:33792
    v_mfma_f32_16x16x32_bf16 v[72:75], a[104:107], a[72:75], v[72:75]
    buffer_load_dwordx4 a[224:227], v240, s[8:11], s52 offen offset:0 sc1
    v_mfma_f32_16x16x32_bf16 v[76:79], a[108:111], a[72:75], v[76:79]
    ds_read_b64_tr_b16 a[136:137], v196 offset:32768
    v_mfma_f32_16x16x32_bf16 v[80:83], a[112:115], a[72:75], v[80:83]
    v_mfma_f32_16x16x32_bf16 v[84:87], a[116:119], a[72:75], v[84:87]
    ds_read_b64_tr_b16 a[138:139], v196 offset:33792
    v_mfma_f32_16x16x32_bf16 v[88:91], a[120:123], a[72:75], v[88:91]
    buffer_load_dwordx4 a[228:231], v240, s[8:11], s53 offen offset:0 sc1
    v_mfma_f32_16x16x32_bf16 v[92:95], a[124:127], a[72:75], v[92:95]
    ds_read_b64_tr_b16 a[140:141], v197 offset:32768
    v_mfma_f32_16x16x32_bf16 v[96:99], a[96:99], a[76:79], v[96:99]
    ds_read_b128 a[72:75], v192 offset:34816
    v_mfma_f32_16x16x32_bf16 v[100:103], a[100:103], a[76:79], v[100:103]
    ds_read_b64_tr_b16 a[142:143], v197 offset:33792
    v_mfma_f32_16x16x32_bf16 v[104:107], a[104:107], a[76:79], v[104:107]
    buffer_load_dwordx4 a[232:235], v240, s[8:11], s52 offen offset:1024 sc1
    v_mfma_f32_16x16x32_bf16 v[108:111], a[108:111], a[76:79], v[108:111]
    ds_read_b64_tr_b16 a[144:145], v198 offset:32768
    v_mfma_f32_16x16x32_bf16 v[112:115], a[112:115], a[76:79], v[112:115]
    v_mfma_f32_16x16x32_bf16 v[116:119], a[116:119], a[76:79], v[116:119]
    ds_read_b64_tr_b16 a[146:147], v198 offset:33792
    v_mfma_f32_16x16x32_bf16 v[120:123], a[120:123], a[76:79], v[120:123]
    buffer_load_dwordx4 a[236:239], v240, s[8:11], s53 offen offset:1024 sc1
    v_mfma_f32_16x16x32_bf16 v[124:127], a[124:127], a[76:79], v[124:127]
    ds_read_b64_tr_b16 a[148:149], v199 offset:32768
    v_mfma_f32_16x16x32_bf16 v[128:131], a[96:99], a[80:83], v[128:131]
    ds_read_b128 a[76:79], v192 offset:35840
    v_mfma_f32_16x16x32_bf16 v[132:135], a[100:103], a[80:83], v[132:135]
    ds_read_b64_tr_b16 a[150:151], v199 offset:33792
    v_mfma_f32_16x16x32_bf16 v[136:139], a[104:107], a[80:83], v[136:139]
    buffer_load_dwordx4 a[240:243], v240, s[8:11], s52 offen offset:2048 sc1
    v_mfma_f32_16x16x32_bf16 v[140:143], a[108:111], a[80:83], v[140:143]
    ds_read_b64_tr_b16 a[152:153], v200 offset:32768
    v_mfma_f32_16x16x32_bf16 v[144:147], a[112:115], a[80:83], v[144:147]
    v_mfma_f32_16x16x32_bf16 v[148:151], a[116:119], a[80:83], v[148:151]
    ds_read_b64_tr_b16 a[154:155], v200 offset:33792
    v_mfma_f32_16x16x32_bf16 v[152:155], a[120:123], a[80:83], v[152:155]
    buffer_load_dwordx4 a[244:247], v240, s[8:11], s53 offen offset:2048 sc1
    v_mfma_f32_16x16x32_bf16 v[156:159], a[124:127], a[80:83], v[156:159]
    ds_read_b64_tr_b16 a[156:157], v201 offset:32768
    v_mfma_f32_16x16x32_bf16 v[160:163], a[96:99], a[84:87], v[160:163]
    ds_read_b128 a[80:83], v192 offset:40960
    v_mfma_f32_16x16x32_bf16 v[164:167], a[100:103], a[84:87], v[164:167]
    ds_read_b64_tr_b16 a[158:159], v201 offset:33792
    v_mfma_f32_16x16x32_bf16 v[168:171], a[104:107], a[84:87], v[168:171]
    buffer_load_dwordx4 a[248:251], v240, s[8:11], s52 offen offset:3072 sc1
    v_mfma_f32_16x16x32_bf16 v[172:175], a[108:111], a[84:87], v[172:175]
    v_mfma_f32_16x16x32_bf16 v[176:179], a[112:115], a[84:87], v[176:179]
    v_mfma_f32_16x16x32_bf16 v[180:183], a[116:119], a[84:87], v[180:183]
    buffer_load_dwordx4 a[252:255], v240, s[8:11], s53 offen offset:3072 sc1
    v_mfma_f32_16x16x32_bf16 v[184:187], a[120:123], a[84:87], v[184:187]
    v_mfma_f32_16x16x32_bf16 v[188:191], a[124:127], a[84:87], v[188:191]
    s_add_u32 m0, s3, 16384
    s_add_u32 s54, s73, 524288
    v_mfma_f32_16x16x32_bf16 a[0:3], a[96:99], a[88:91], a[0:3]
    ds_read_b128 a[84:87], v192 offset:41984
    v_mfma_f32_16x16x32_bf16 a[4:7], a[100:103], a[88:91], a[4:7]
    buffer_load_dwordx4 v246, s[28:31], s54 offen offset:0 lds
    v_mfma_f32_16x16x32_bf16 a[8:11], a[104:107], a[88:91], a[8:11]
    v_mfma_f32_16x16x32_bf16 a[12:15], a[108:111], a[88:91], a[12:15]
    v_mfma_f32_16x16x32_bf16 a[16:19], a[112:115], a[88:91], a[16:19]
    buffer_load_dwordx4 v247, s[28:31], s54 offen offset:1024 lds
    v_mfma_f32_16x16x32_bf16 a[20:23], a[116:119], a[88:91], a[20:23]
    v_mfma_f32_16x16x32_bf16 a[24:27], a[120:123], a[88:91], a[24:27]
    v_mfma_f32_16x16x32_bf16 a[28:31], a[124:127], a[88:91], a[28:31]
    buffer_load_dwordx4 v248, s[28:31], s54 offen offset:2048 lds
    v_mfma_f32_16x16x32_bf16 a[32:35], a[96:99], a[92:95], a[32:35]
    ds_read_b128 a[88:91], v192 offset:43008
    v_mfma_f32_16x16x32_bf16 a[36:39], a[100:103], a[92:95], a[36:39]
    v_mfma_f32_16x16x32_bf16 a[40:43], a[104:107], a[92:95], a[40:43]
    buffer_load_dwordx4 v249, s[28:31], s54 offen offset:3072 lds
    v_mfma_f32_16x16x32_bf16 a[44:47], a[108:111], a[92:95], a[44:47]
    v_mfma_f32_16x16x32_bf16 a[48:51], a[112:115], a[92:95], a[48:51]
    v_mfma_f32_16x16x32_bf16 a[52:55], a[116:119], a[92:95], a[52:55]
    v_mfma_f32_16x16x32_bf16 a[56:59], a[120:123], a[92:95], a[56:59]
    v_mfma_f32_16x16x32_bf16 a[60:63], a[124:127], a[92:95], a[60:63]
    s_waitcnt lgkmcnt(2)
    v_mfma_f32_16x16x32_bf16 v[128:131], a[128:131], a[80:83], v[128:131]
    ds_read_b128 a[92:95], v192 offset:44032
    v_mfma_f32_16x16x32_bf16 v[132:135], a[132:135], a[80:83], v[132:135]
    s_add_u32 m0, s3, 32768
    s_add_u32 s54, s73, 1048576
    s_lshl_b32 s48, s45, 20
    s_add_u32 s48, s48, 0x1000000
    v_mfma_f32_16x16x32_bf16 v[136:139], a[136:139], a[80:83], v[136:139]
    s_lshl_b32 s49, s46, 17
    s_add_u32 s48, s48, s49
    v_mfma_f32_16x16x32_bf16 v[140:143], a[140:143], a[80:83], v[140:143]
    buffer_load_dwordx4 v246, s[28:31], s54 offen offset:0 lds
    v_mfma_f32_16x16x32_bf16 v[144:147], a[144:147], a[80:83], v[144:147]
    s_and_b32 s49, s44, 1
    s_lshl_b32 s49, s49, 16
    v_mfma_f32_16x16x32_bf16 v[148:151], a[148:151], a[80:83], v[148:151]
    s_add_u32 s48, s48, s49
    s_mov_b32 s49, 2048
    v_mfma_f32_16x16x32_bf16 v[152:155], a[152:155], a[80:83], v[152:155]
    v_and_b32 v250, 15, v241
    v_lshlrev_b32 v250, 4, v250
    v_mfma_f32_16x16x32_bf16 v[156:159], a[156:159], a[80:83], v[156:159]
    buffer_load_dwordx4 v247, s[28:31], s54 offen offset:1024 lds
    v_bfe_u32 v252, v241, 4, 1
    v_lshl_add_u32 v250, v252, 10, v250
    s_waitcnt lgkmcnt(2)
    v_mfma_f32_16x16x32_bf16 v[160:163], a[128:131], a[84:87], v[160:163]
    v_lshrrev_b32 v252, 5, v241
    v_lshl_add_u32 v250, v252, 9, v250
    v_mfma_f32_16x16x32_bf16 v[164:167], a[132:135], a[84:87], v[164:167]
    v_cvt_pk_bf16_f32 v192, v128, v129
    v_cvt_pk_bf16_f32 v193, v130, v131
    v_cvt_pk_bf16_f32 v194, v132, v133
    v_mfma_f32_16x16x32_bf16 v[168:171], a[136:139], a[84:87], v[168:171]
    v_cvt_pk_bf16_f32 v195, v134, v135
    v_cvt_pk_bf16_f32 v200, v136, v137
    v_cvt_pk_bf16_f32 v201, v138, v139
    v_mfma_f32_16x16x32_bf16 v[172:175], a[140:143], a[84:87], v[172:175]
    buffer_load_dwordx4 v248, s[28:31], s54 offen offset:2048 lds
    v_cvt_pk_bf16_f32 v202, v140, v141
    v_cvt_pk_bf16_f32 v203, v142, v143
    v_mfma_f32_16x16x32_bf16 v[176:179], a[144:147], a[84:87], v[176:179]
    v_cvt_pk_bf16_f32 v208, v144, v145
    v_cvt_pk_bf16_f32 v209, v146, v147
    v_cvt_pk_bf16_f32 v210, v148, v149
    v_mfma_f32_16x16x32_bf16 v[180:183], a[148:151], a[84:87], v[180:183]
    v_cvt_pk_bf16_f32 v211, v150, v151
    v_cvt_pk_bf16_f32 v216, v152, v153
    v_cvt_pk_bf16_f32 v217, v154, v155
    v_mfma_f32_16x16x32_bf16 v[184:187], a[152:155], a[84:87], v[184:187]
    v_cvt_pk_bf16_f32 v218, v156, v157
    v_cvt_pk_bf16_f32 v219, v158, v159
    v_cvt_pk_bf16_f32 v196, v160, v161
    v_mfma_f32_16x16x32_bf16 v[188:191], a[156:159], a[84:87], v[188:191]
    buffer_load_dwordx4 v249, s[28:31], s54 offen offset:3072 lds
    v_cvt_pk_bf16_f32 v197, v162, v163
    v_cvt_pk_bf16_f32 v198, v164, v165
    s_waitcnt lgkmcnt(1)
    v_mfma_f32_16x16x32_bf16 a[0:3], a[128:131], a[88:91], a[0:3]
    v_cvt_pk_bf16_f32 v199, v166, v167
    v_cvt_pk_bf16_f32 v204, v168, v169
    v_cvt_pk_bf16_f32 v205, v170, v171
    v_mfma_f32_16x16x32_bf16 a[4:7], a[132:135], a[88:91], a[4:7]
    v_cvt_pk_bf16_f32 v206, v172, v173
    v_cvt_pk_bf16_f32 v207, v174, v175
    v_cvt_pk_bf16_f32 v212, v176, v177
    v_mfma_f32_16x16x32_bf16 a[8:11], a[136:139], a[88:91], a[8:11]
    v_cvt_pk_bf16_f32 v213, v178, v179
    v_cvt_pk_bf16_f32 v214, v180, v181
    v_cvt_pk_bf16_f32 v215, v182, v183
    v_mfma_f32_16x16x32_bf16 a[12:15], a[140:143], a[88:91], a[12:15]
    v_cvt_pk_bf16_f32 v220, v184, v185
    v_cvt_pk_bf16_f32 v221, v186, v187
    v_cvt_pk_bf16_f32 v222, v188, v189
    v_mfma_f32_16x16x32_bf16 a[16:19], a[144:147], a[88:91], a[16:19]
    v_cvt_pk_bf16_f32 v223, v190, v191
    v_mfma_f32_16x16x32_bf16 a[20:23], a[148:151], a[88:91], a[20:23]
    v_accvgpr_read_b32 v128, a0
    v_accvgpr_read_b32 v129, a1
    v_accvgpr_read_b32 v130, a2
    v_mfma_f32_16x16x32_bf16 a[24:27], a[152:155], a[88:91], a[24:27]
    v_accvgpr_read_b32 v131, a3
    v_accvgpr_read_b32 v132, a4
    v_accvgpr_read_b32 v133, a5
    v_mfma_f32_16x16x32_bf16 a[28:31], a[156:159], a[88:91], a[28:31]
    v_accvgpr_read_b32 v134, a6
    v_accvgpr_read_b32 v135, a7
    v_cvt_pk_bf16_f32 v224, v128, v129
    s_waitcnt lgkmcnt(0)
    v_mfma_f32_16x16x32_bf16 a[32:35], a[128:131], a[92:95], a[32:35]
    v_cvt_pk_bf16_f32 v225, v130, v131
    v_cvt_pk_bf16_f32 v226, v132, v133
    v_cvt_pk_bf16_f32 v227, v134, v135
    v_mfma_f32_16x16x32_bf16 a[36:39], a[132:135], a[92:95], a[36:39]
    v_accvgpr_read_b32 v144, a8
    v_accvgpr_read_b32 v145, a9
    v_accvgpr_read_b32 v146, a10
    v_mfma_f32_16x16x32_bf16 a[40:43], a[136:139], a[92:95], a[40:43]
    v_accvgpr_read_b32 v147, a11
    v_accvgpr_read_b32 v148, a12
    v_accvgpr_read_b32 v149, a13
    v_mfma_f32_16x16x32_bf16 a[44:47], a[140:143], a[92:95], a[44:47]
    v_accvgpr_read_b32 v150, a14
    v_accvgpr_read_b32 v151, a15
    v_cvt_pk_bf16_f32 v232, v144, v145
    v_mfma_f32_16x16x32_bf16 a[48:51], a[144:147], a[92:95], a[48:51]
    v_cvt_pk_bf16_f32 v233, v146, v147
    v_cvt_pk_bf16_f32 v234, v148, v149
    v_cvt_pk_bf16_f32 v235, v150, v151
    v_mfma_f32_16x16x32_bf16 a[52:55], a[148:151], a[92:95], a[52:55]
    v_accvgpr_read_b32 v128, a16
    v_accvgpr_read_b32 v129, a17
    v_accvgpr_read_b32 v130, a18
    v_mfma_f32_16x16x32_bf16 a[56:59], a[152:155], a[92:95], a[56:59]
    v_accvgpr_read_b32 v131, a19
    v_accvgpr_read_b32 v132, a20
    v_accvgpr_read_b32 v133, a21
    v_mfma_f32_16x16x32_bf16 a[60:63], a[156:159], a[92:95], a[60:63]
    v_accvgpr_read_b32 v134, a22
    v_accvgpr_read_b32 v135, a23
    v_cvt_pk_bf16_f32 v176, v128, v129
    v_mfma_f32_16x16x32_bf16 v[0:3], a[128:131], a[64:67], v[0:3]
    v_cvt_pk_bf16_f32 v177, v130, v131
    v_cvt_pk_bf16_f32 v178, v132, v133
    v_cvt_pk_bf16_f32 v179, v134, v135
    s_add_u32 s55, s48, 49152
    s_mul_i32 s54, s49, 2
    s_add_u32 s55, s55, s54
    v_mfma_f32_16x16x32_bf16 v[4:7], a[132:135], a[64:67], v[4:7]
    buffer_store_dwordx4 v[176:179], v250, s[8:11], s55 offen offset:0 sc1
    v_accvgpr_read_b32 v144, a24
    v_accvgpr_read_b32 v145, a25
    v_mfma_f32_16x16x32_bf16 v[8:11], a[136:139], a[64:67], v[8:11]
    v_accvgpr_read_b32 v146, a26
    v_accvgpr_read_b32 v147, a27
    v_accvgpr_read_b32 v148, a28
    v_mfma_f32_16x16x32_bf16 v[12:15], a[140:143], a[64:67], v[12:15]
    v_accvgpr_read_b32 v149, a29
    v_accvgpr_read_b32 v150, a30
    v_accvgpr_read_b32 v151, a31
    v_mfma_f32_16x16x32_bf16 v[16:19], a[144:147], a[64:67], v[16:19]
    v_cvt_pk_bf16_f32 v184, v144, v145
    v_cvt_pk_bf16_f32 v185, v146, v147
    v_cvt_pk_bf16_f32 v186, v148, v149
    v_mfma_f32_16x16x32_bf16 v[20:23], a[148:151], a[64:67], v[20:23]
    v_cvt_pk_bf16_f32 v187, v150, v151
    s_add_u32 s55, s48, 49152
    s_mul_i32 s54, s49, 3
    s_add_u32 s55, s55, s54
    v_mfma_f32_16x16x32_bf16 v[24:27], a[152:155], a[64:67], v[24:27]
    buffer_store_dwordx4 v[184:187], v250, s[8:11], s55 offen offset:0 sc1
    v_accvgpr_read_b32 v136, a32
    v_accvgpr_read_b32 v137, a33
    v_mfma_f32_16x16x32_bf16 v[28:31], a[156:159], a[64:67], v[28:31]
    v_accvgpr_read_b32 v138, a34
    v_accvgpr_read_b32 v139, a35
    v_accvgpr_read_b32 v140, a36
    v_mfma_f32_16x16x32_bf16 v[32:35], a[128:131], a[68:71], v[32:35]
    v_accvgpr_read_b32 v141, a37
    v_accvgpr_read_b32 v142, a38
    v_accvgpr_read_b32 v143, a39
    v_mfma_f32_16x16x32_bf16 v[36:39], a[132:135], a[68:71], v[36:39]
    v_cvt_pk_bf16_f32 v228, v136, v137
    v_cvt_pk_bf16_f32 v229, v138, v139
    v_cvt_pk_bf16_f32 v230, v140, v141
    v_mfma_f32_16x16x32_bf16 v[40:43], a[136:139], a[68:71], v[40:43]
    v_cvt_pk_bf16_f32 v231, v142, v143
    v_accvgpr_read_b32 v152, a40
    v_accvgpr_read_b32 v153, a41
    v_mfma_f32_16x16x32_bf16 v[44:47], a[140:143], a[68:71], v[44:47]
    v_accvgpr_read_b32 v154, a42
    v_accvgpr_read_b32 v155, a43
    v_accvgpr_read_b32 v156, a44
    v_mfma_f32_16x16x32_bf16 v[48:51], a[144:147], a[68:71], v[48:51]
    v_accvgpr_read_b32 v157, a45
    v_accvgpr_read_b32 v158, a46
    v_accvgpr_read_b32 v159, a47
    v_mfma_f32_16x16x32_bf16 v[52:55], a[148:151], a[68:71], v[52:55]
    v_cvt_pk_bf16_f32 v236, v152, v153
    v_cvt_pk_bf16_f32 v237, v154, v155
    v_cvt_pk_bf16_f32 v238, v156, v157
    v_mfma_f32_16x16x32_bf16 v[56:59], a[152:155], a[68:71], v[56:59]
    v_cvt_pk_bf16_f32 v239, v158, v159
    v_accvgpr_read_b32 v136, a48
    v_accvgpr_read_b32 v137, a49
    v_mfma_f32_16x16x32_bf16 v[60:63], a[156:159], a[68:71], v[60:63]
    v_accvgpr_read_b32 v138, a50
    v_accvgpr_read_b32 v139, a51
    v_accvgpr_read_b32 v140, a52
    v_mfma_f32_16x16x32_bf16 v[64:67], a[128:131], a[72:75], v[64:67]
    v_accvgpr_read_b32 v141, a53
    v_accvgpr_read_b32 v142, a54
    v_accvgpr_read_b32 v143, a55
    v_mfma_f32_16x16x32_bf16 v[68:71], a[132:135], a[72:75], v[68:71]
    v_cvt_pk_bf16_f32 v180, v136, v137
    v_cvt_pk_bf16_f32 v181, v138, v139
    v_cvt_pk_bf16_f32 v182, v140, v141
    v_mfma_f32_16x16x32_bf16 v[72:75], a[136:139], a[72:75], v[72:75]
    v_cvt_pk_bf16_f32 v183, v142, v143
    s_add_u32 s55, s48, 49152
    s_mul_i32 s54, s49, 2
    s_add_u32 s55, s55, s54
    v_mfma_f32_16x16x32_bf16 v[76:79], a[140:143], a[72:75], v[76:79]
    buffer_store_dwordx4 v[180:183], v250, s[8:11], s55 offen offset:256 sc1
    v_accvgpr_read_b32 v152, a56
    v_accvgpr_read_b32 v153, a57
    v_mfma_f32_16x16x32_bf16 v[80:83], a[144:147], a[72:75], v[80:83]
    v_accvgpr_read_b32 v154, a58
    v_accvgpr_read_b32 v155, a59
    v_accvgpr_read_b32 v156, a60
    v_mfma_f32_16x16x32_bf16 v[84:87], a[148:151], a[72:75], v[84:87]
    v_accvgpr_read_b32 v157, a61
    v_accvgpr_read_b32 v158, a62
    v_accvgpr_read_b32 v159, a63
    v_mfma_f32_16x16x32_bf16 v[88:91], a[152:155], a[72:75], v[88:91]
    v_cvt_pk_bf16_f32 v188, v152, v153
    v_cvt_pk_bf16_f32 v189, v154, v155
    v_cvt_pk_bf16_f32 v190, v156, v157
    v_mfma_f32_16x16x32_bf16 v[92:95], a[156:159], a[72:75], v[92:95]
    v_cvt_pk_bf16_f32 v191, v158, v159
    s_add_u32 s55, s48, 49152
    s_mul_i32 s54, s49, 3
    s_add_u32 s55, s55, s54
    v_mfma_f32_16x16x32_bf16 v[96:99], a[128:131], a[76:79], v[96:99]
    buffer_store_dwordx4 v[188:191], v250, s[8:11], s55 offen offset:256 sc1
    v_cvt_pk_bf16_f32 v128, v0, v1
    v_cvt_pk_bf16_f32 v129, v2, v3
    v_mfma_f32_16x16x32_bf16 v[100:103], a[132:135], a[76:79], v[100:103]
    v_cvt_pk_bf16_f32 v130, v4, v5
    v_cvt_pk_bf16_f32 v131, v6, v7
    v_cvt_pk_bf16_f32 v136, v8, v9
    v_mfma_f32_16x16x32_bf16 v[104:107], a[136:139], a[76:79], v[104:107]
    v_cvt_pk_bf16_f32 v137, v10, v11
    v_cvt_pk_bf16_f32 v138, v12, v13
    v_cvt_pk_bf16_f32 v139, v14, v15
    v_mfma_f32_16x16x32_bf16 v[108:111], a[140:143], a[76:79], v[108:111]
    v_cvt_pk_bf16_f32 v144, v16, v17
    v_cvt_pk_bf16_f32 v145, v18, v19
    v_cvt_pk_bf16_f32 v146, v20, v21
    v_mfma_f32_16x16x32_bf16 v[112:115], a[144:147], a[76:79], v[112:115]
    v_cvt_pk_bf16_f32 v147, v22, v23
    v_cvt_pk_bf16_f32 v152, v24, v25
    v_cvt_pk_bf16_f32 v153, v26, v27
    v_mfma_f32_16x16x32_bf16 v[116:119], a[148:151], a[76:79], v[116:119]
    v_cvt_pk_bf16_f32 v154, v28, v29
    v_cvt_pk_bf16_f32 v155, v30, v31
    v_cvt_pk_bf16_f32 v132, v32, v33
    v_mfma_f32_16x16x32_bf16 v[120:123], a[152:155], a[76:79], v[120:123]
    v_cvt_pk_bf16_f32 v133, v34, v35
    v_cvt_pk_bf16_f32 v134, v36, v37
    v_cvt_pk_bf16_f32 v135, v38, v39
    v_mfma_f32_16x16x32_bf16 v[124:127], a[156:159], a[76:79], v[124:127]
    v_cvt_pk_bf16_f32 v140, v40, v41
    v_cvt_pk_bf16_f32 v141, v42, v43
    v_cvt_pk_bf16_f32 v142, v44, v45
    v_cvt_pk_bf16_f32 v143, v46, v47
    v_cvt_pk_bf16_f32 v148, v48, v49
    v_cvt_pk_bf16_f32 v149, v50, v51
    v_cvt_pk_bf16_f32 v150, v52, v53
    v_cvt_pk_bf16_f32 v151, v54, v55
    v_cvt_pk_bf16_f32 v156, v56, v57
    v_cvt_pk_bf16_f32 v157, v58, v59
    v_cvt_pk_bf16_f32 v158, v60, v61
    v_cvt_pk_bf16_f32 v159, v62, v63
    v_cvt_pk_bf16_f32 v160, v64, v65
    v_cvt_pk_bf16_f32 v161, v66, v67
    v_cvt_pk_bf16_f32 v162, v68, v69
    v_cvt_pk_bf16_f32 v163, v70, v71
    v_cvt_pk_bf16_f32 v168, v72, v73
    v_cvt_pk_bf16_f32 v169, v74, v75
    v_cvt_pk_bf16_f32 v170, v76, v77
    v_cvt_pk_bf16_f32 v171, v78, v79
    v_cvt_pk_bf16_f32 v176, v80, v81
    v_cvt_pk_bf16_f32 v177, v82, v83
    v_cvt_pk_bf16_f32 v178, v84, v85
    v_cvt_pk_bf16_f32 v179, v86, v87
    v_cvt_pk_bf16_f32 v184, v88, v89
    v_cvt_pk_bf16_f32 v185, v90, v91
    v_cvt_pk_bf16_f32 v186, v92, v93
    v_cvt_pk_bf16_f32 v187, v94, v95
    v_cvt_pk_bf16_f32 v164, v96, v97
    v_cvt_pk_bf16_f32 v165, v98, v99
    v_cvt_pk_bf16_f32 v166, v100, v101
    v_cvt_pk_bf16_f32 v167, v102, v103
    v_cvt_pk_bf16_f32 v172, v104, v105
    v_cvt_pk_bf16_f32 v173, v106, v107
    v_cvt_pk_bf16_f32 v174, v108, v109
    v_cvt_pk_bf16_f32 v175, v110, v111
    v_cvt_pk_bf16_f32 v180, v112, v113
    v_cvt_pk_bf16_f32 v181, v114, v115
    v_cvt_pk_bf16_f32 v182, v116, v117
    v_cvt_pk_bf16_f32 v183, v118, v119
    v_cvt_pk_bf16_f32 v188, v120, v121
    v_cvt_pk_bf16_f32 v189, v122, v123
    v_cvt_pk_bf16_f32 v190, v124, v125
    v_cvt_pk_bf16_f32 v191, v126, v127
    s_branch L_ka_q
L_k1_v:
    ds_read_b64_tr_b16 a[96:97], v194 offset:0
    ds_read_b64_tr_b16 a[98:99], v194 offset:1024
    ds_read_b64_tr_b16 a[100:101], v195 offset:0
    ds_read_b64_tr_b16 a[102:103], v195 offset:1024
    ds_read_b64_tr_b16 a[104:105], v196 offset:0
    ds_read_b64_tr_b16 a[106:107], v196 offset:1024
    ds_read_b64_tr_b16 a[108:109], v197 offset:0
    ds_read_b64_tr_b16 a[110:111], v197 offset:1024
    ds_read_b64_tr_b16 a[112:113], v198 offset:0
    ds_read_b64_tr_b16 a[114:115], v198 offset:1024
    ds_read_b64_tr_b16 a[116:117], v199 offset:0
    ds_read_b64_tr_b16 a[118:119], v199 offset:1024
    ds_read_b64_tr_b16 a[120:121], v200 offset:0
    ds_read_b64_tr_b16 a[122:123], v200 offset:1024
    ds_read_b64_tr_b16 a[124:125], v201 offset:0
    ds_read_b64_tr_b16 a[126:127], v201 offset:1024
    ds_read_b128 a[64:67], v192 offset:0
    ds_read_b128 a[68:71], v193 offset:512
    ds_read_b128 a[72:75], v192 offset:2048
    ds_read_b128 a[76:79], v193 offset:2560
    ds_read_b128 a[80:83], v192 offset:8192
    ds_read_b128 a[84:87], v193 offset:8704
    ds_read_b128 a[88:91], v192 offset:10240
    s_waitcnt lgkmcnt(0)
    buffer_store_dwordx4 v[224:227], v214, s[8:11], s96 offen sc1
    buffer_store_dwordx4 v[228:231], v214, s[8:11], s97 offen sc1
    buffer_store_dwordx4 v[232:235], v214, s[8:11], s98 offen sc1
    .p2align 6
L_k1_loop_v:
    s_waitcnt lgkmcnt(2)
    v_mfma_f32_16x16x32_bf16 v[0:3], a[64:67], a[96:99], v[0:3]
    ds_read_b128 a[92:95], v193 offset:10752
    v_mfma_f32_16x16x32_bf16 v[4:7], a[64:67], a[100:103], v[4:7]
    v_mfma_f32_16x16x32_bf16 v[8:11], a[64:67], a[104:107], v[8:11]
    s_add_u32 m0, s50, 102400
    v_mfma_f32_16x16x32_bf16 v[12:15], a[64:67], a[108:111], v[12:15]
    buffer_load_dwordx4 v206, s[16:19], s49 offen offset:0 lds
    v_mfma_f32_16x16x32_bf16 v[16:19], a[64:67], a[112:115], v[16:19]
    v_mfma_f32_16x16x32_bf16 v[20:23], a[64:67], a[116:119], v[20:23]
    v_mfma_f32_16x16x32_bf16 v[24:27], a[64:67], a[120:123], v[24:27]
    v_mfma_f32_16x16x32_bf16 v[28:31], a[64:67], a[124:127], v[28:31]
    v_mfma_f32_16x16x32_bf16 v[32:35], a[68:71], a[96:99], v[32:35]
    v_mfma_f32_16x16x32_bf16 v[36:39], a[68:71], a[100:103], v[36:39]
    s_waitcnt vmcnt(9) lgkmcnt(0)
    s_barrier
    v_mfma_f32_16x16x32_bf16 v[40:43], a[68:71], a[104:107], v[40:43]
    ds_read_b128 a[64:67], v192 offset:32768
    v_mfma_f32_16x16x32_bf16 v[44:47], a[68:71], a[108:111], v[44:47]
    ds_read_b64_tr_b16 a[128:129], v194 offset:32768
    v_mfma_f32_16x16x32_bf16 v[48:51], a[68:71], a[112:115], v[48:51]
    buffer_load_dwordx4 v207, s[16:19], s49 offen offset:1024 lds
    v_mfma_f32_16x16x32_bf16 v[52:55], a[68:71], a[116:119], v[52:55]
    ds_read_b64_tr_b16 a[130:131], v194 offset:33792
    v_mfma_f32_16x16x32_bf16 v[56:59], a[68:71], a[120:123], v[56:59]
    v_mfma_f32_16x16x32_bf16 v[60:63], a[68:71], a[124:127], v[60:63]
    ds_read_b64_tr_b16 a[132:133], v195 offset:32768
    v_mfma_f32_16x16x32_bf16 v[64:67], a[72:75], a[96:99], v[64:67]
    ds_read_b128 a[68:71], v193 offset:33280
    v_mfma_f32_16x16x32_bf16 v[68:71], a[72:75], a[100:103], v[68:71]
    ds_read_b64_tr_b16 a[134:135], v195 offset:33792
    v_mfma_f32_16x16x32_bf16 v[72:75], a[72:75], a[104:107], v[72:75]
    buffer_load_dwordx4 v208, s[16:19], s49 offen offset:2048 lds
    v_mfma_f32_16x16x32_bf16 v[76:79], a[72:75], a[108:111], v[76:79]
    ds_read_b64_tr_b16 a[136:137], v196 offset:32768
    v_mfma_f32_16x16x32_bf16 v[80:83], a[72:75], a[112:115], v[80:83]
    v_mfma_f32_16x16x32_bf16 v[84:87], a[72:75], a[116:119], v[84:87]
    ds_read_b64_tr_b16 a[138:139], v196 offset:33792
    v_mfma_f32_16x16x32_bf16 v[88:91], a[72:75], a[120:123], v[88:91]
    v_mfma_f32_16x16x32_bf16 v[92:95], a[72:75], a[124:127], v[92:95]
    ds_read_b64_tr_b16 a[140:141], v197 offset:32768
    v_mfma_f32_16x16x32_bf16 v[96:99], a[76:79], a[96:99], v[96:99]
    ds_read_b128 a[72:75], v192 offset:34816
    v_mfma_f32_16x16x32_bf16 v[100:103], a[76:79], a[100:103], v[100:103]
    ds_read_b64_tr_b16 a[142:143], v197 offset:33792
    v_mfma_f32_16x16x32_bf16 v[104:107], a[76:79], a[104:107], v[104:107]
    buffer_load_dwordx4 v209, s[16:19], s49 offen offset:3072 lds
    v_mfma_f32_16x16x32_bf16 v[108:111], a[76:79], a[108:111], v[108:111]
    ds_read_b64_tr_b16 a[144:145], v198 offset:32768
    s_add_u32 m0, s50, 98304
    v_mfma_f32_16x16x32_bf16 v[112:115], a[76:79], a[112:115], v[112:115]
    v_mfma_f32_16x16x32_bf16 v[116:119], a[76:79], a[116:119], v[116:119]
    ds_read_b64_tr_b16 a[146:147], v198 offset:33792
    v_mfma_f32_16x16x32_bf16 v[120:123], a[76:79], a[120:123], v[120:123]
    v_mfma_f32_16x16x32_bf16 v[124:127], a[76:79], a[124:127], v[124:127]
    ds_read_b64_tr_b16 a[148:149], v199 offset:32768
    v_mfma_f32_16x16x32_bf16 v[128:131], a[80:83], a[96:99], v[128:131]
    ds_read_b128 a[76:79], v193 offset:35328
    v_mfma_f32_16x16x32_bf16 v[132:135], a[80:83], a[100:103], v[132:135]
    ds_read_b64_tr_b16 a[150:151], v199 offset:33792
    v_mfma_f32_16x16x32_bf16 v[136:139], a[80:83], a[104:107], v[136:139]
    buffer_load_dwordx4 v202, s[12:15], s48 offen offset:0 lds
    v_mfma_f32_16x16x32_bf16 v[140:143], a[80:83], a[108:111], v[140:143]
    ds_read_b64_tr_b16 a[152:153], v200 offset:32768
    v_mfma_f32_16x16x32_bf16 v[144:147], a[80:83], a[112:115], v[144:147]
    v_mfma_f32_16x16x32_bf16 v[148:151], a[80:83], a[116:119], v[148:151]
    ds_read_b64_tr_b16 a[154:155], v200 offset:33792
    v_mfma_f32_16x16x32_bf16 v[152:155], a[80:83], a[120:123], v[152:155]
    buffer_load_dwordx4 v203, s[12:15], s48 offen offset:1024 lds
    v_mfma_f32_16x16x32_bf16 v[156:159], a[80:83], a[124:127], v[156:159]
    ds_read_b64_tr_b16 a[156:157], v201 offset:32768
    v_mfma_f32_16x16x32_bf16 v[160:163], a[84:87], a[96:99], v[160:163]
    ds_read_b128 a[80:83], v192 offset:40960
    v_mfma_f32_16x16x32_bf16 v[164:167], a[84:87], a[100:103], v[164:167]
    ds_read_b64_tr_b16 a[158:159], v201 offset:33792
    v_mfma_f32_16x16x32_bf16 v[168:171], a[84:87], a[104:107], v[168:171]
    v_mfma_f32_16x16x32_bf16 v[172:175], a[84:87], a[108:111], v[172:175]
    v_mfma_f32_16x16x32_bf16 v[176:179], a[84:87], a[112:115], v[176:179]
    v_mfma_f32_16x16x32_bf16 v[180:183], a[84:87], a[116:119], v[180:183]
    buffer_load_dwordx4 v204, s[12:15], s48 offen offset:2048 lds
    v_mfma_f32_16x16x32_bf16 v[184:187], a[84:87], a[120:123], v[184:187]
    v_mfma_f32_16x16x32_bf16 v[188:191], a[84:87], a[124:127], v[188:191]
    v_mfma_f32_16x16x32_bf16 a[0:3], a[88:91], a[96:99], a[0:3]
    ds_read_b128 a[84:87], v193 offset:41472
    v_mfma_f32_16x16x32_bf16 a[4:7], a[88:91], a[100:103], a[4:7]
    v_mfma_f32_16x16x32_bf16 a[8:11], a[88:91], a[104:107], a[8:11]
    v_mfma_f32_16x16x32_bf16 a[12:15], a[88:91], a[108:111], a[12:15]
    v_mfma_f32_16x16x32_bf16 a[16:19], a[88:91], a[112:115], a[16:19]
    buffer_load_dwordx4 v205, s[12:15], s48 offen offset:3072 lds
    v_mfma_f32_16x16x32_bf16 a[20:23], a[88:91], a[116:119], a[20:23]
    v_mfma_f32_16x16x32_bf16 a[24:27], a[88:91], a[120:123], a[24:27]
    v_mfma_f32_16x16x32_bf16 a[28:31], a[88:91], a[124:127], a[28:31]
    v_mfma_f32_16x16x32_bf16 a[32:35], a[92:95], a[96:99], a[32:35]
    ds_read_b128 a[88:91], v192 offset:43008
    v_mfma_f32_16x16x32_bf16 a[36:39], a[92:95], a[100:103], a[36:39]
    v_mfma_f32_16x16x32_bf16 a[40:43], a[92:95], a[104:107], a[40:43]
    v_mfma_f32_16x16x32_bf16 a[44:47], a[92:95], a[108:111], a[44:47]
    v_mfma_f32_16x16x32_bf16 a[48:51], a[92:95], a[112:115], a[48:51]
    v_mfma_f32_16x16x32_bf16 a[52:55], a[92:95], a[116:119], a[52:55]
    v_mfma_f32_16x16x32_bf16 a[56:59], a[92:95], a[120:123], a[56:59]
    s_add_u32 s48, s48, 64
    v_mfma_f32_16x16x32_bf16 a[60:63], a[92:95], a[124:127], a[60:63]
    s_add_u32 s49, s49, 262144
    s_waitcnt lgkmcnt(2)
    v_mfma_f32_16x16x32_bf16 v[0:3], a[64:67], a[128:131], v[0:3]
    ds_read_b128 a[92:95], v193 offset:43520
    v_mfma_f32_16x16x32_bf16 v[4:7], a[64:67], a[132:135], v[4:7]
    v_mfma_f32_16x16x32_bf16 v[8:11], a[64:67], a[136:139], v[8:11]
    s_add_u32 m0, s50, 4096
    v_mfma_f32_16x16x32_bf16 v[12:15], a[64:67], a[140:143], v[12:15]
    buffer_load_dwordx4 v206, s[16:19], s49 offen offset:0 lds
    v_mfma_f32_16x16x32_bf16 v[16:19], a[64:67], a[144:147], v[16:19]
    v_mfma_f32_16x16x32_bf16 v[20:23], a[64:67], a[148:151], v[20:23]
    v_mfma_f32_16x16x32_bf16 v[24:27], a[64:67], a[152:155], v[24:27]
    v_mfma_f32_16x16x32_bf16 v[28:31], a[64:67], a[156:159], v[28:31]
    v_mfma_f32_16x16x32_bf16 v[32:35], a[68:71], a[128:131], v[32:35]
    v_mfma_f32_16x16x32_bf16 v[36:39], a[68:71], a[132:135], v[36:39]
    s_waitcnt vmcnt(9) lgkmcnt(0)
    s_barrier
    v_mfma_f32_16x16x32_bf16 v[40:43], a[68:71], a[136:139], v[40:43]
    buffer_load_dwordx4 v207, s[16:19], s49 offen offset:1024 lds
    v_xor_b32 v192, 0x10000, v192
    v_xor_b32 v193, 0x10000, v193
    v_mfma_f32_16x16x32_bf16 v[44:47], a[68:71], a[140:143], v[44:47]
    v_xor_b32 v194, 0x10000, v194
    v_xor_b32 v195, 0x10000, v195
    v_mfma_f32_16x16x32_bf16 v[48:51], a[68:71], a[144:147], v[48:51]
    v_xor_b32 v196, 0x10000, v196
    v_xor_b32 v197, 0x10000, v197
    v_mfma_f32_16x16x32_bf16 v[52:55], a[68:71], a[148:151], v[52:55]
    v_xor_b32 v198, 0x10000, v198
    v_xor_b32 v199, 0x10000, v199
    v_mfma_f32_16x16x32_bf16 v[56:59], a[68:71], a[152:155], v[56:59]
    v_xor_b32 v200, 0x10000, v200
    v_xor_b32 v201, 0x10000, v201
    v_mfma_f32_16x16x32_bf16 v[60:63], a[68:71], a[156:159], v[60:63]
    ds_read_b128 a[64:67], v192 offset:0
    v_mfma_f32_16x16x32_bf16 v[64:67], a[72:75], a[128:131], v[64:67]
    ds_read_b64_tr_b16 a[96:97], v194 offset:0
    v_mfma_f32_16x16x32_bf16 v[68:71], a[72:75], a[132:135], v[68:71]
    buffer_load_dwordx4 v208, s[16:19], s49 offen offset:2048 lds
    v_mfma_f32_16x16x32_bf16 v[72:75], a[72:75], a[136:139], v[72:75]
    ds_read_b64_tr_b16 a[98:99], v194 offset:1024
    ds_read_b128 a[68:71], v193 offset:512
    v_mfma_f32_16x16x32_bf16 v[76:79], a[72:75], a[140:143], v[76:79]
    v_mfma_f32_16x16x32_bf16 v[80:83], a[72:75], a[144:147], v[80:83]
    ds_read_b64_tr_b16 a[100:101], v195 offset:0
    v_mfma_f32_16x16x32_bf16 v[84:87], a[72:75], a[148:151], v[84:87]
    v_mfma_f32_16x16x32_bf16 v[88:91], a[72:75], a[152:155], v[88:91]
    ds_read_b64_tr_b16 a[102:103], v195 offset:1024
    v_mfma_f32_16x16x32_bf16 v[92:95], a[72:75], a[156:159], v[92:95]
    v_mfma_f32_16x16x32_bf16 v[96:99], a[76:79], a[128:131], v[96:99]
    ds_read_b64_tr_b16 a[104:105], v196 offset:0
    v_mfma_f32_16x16x32_bf16 v[100:103], a[76:79], a[132:135], v[100:103]
    ds_read_b128 a[72:75], v192 offset:2048
    v_mfma_f32_16x16x32_bf16 v[104:107], a[76:79], a[136:139], v[104:107]
    ds_read_b64_tr_b16 a[106:107], v196 offset:1024
    v_mfma_f32_16x16x32_bf16 v[108:111], a[76:79], a[140:143], v[108:111]
    buffer_load_dwordx4 v209, s[16:19], s49 offen offset:3072 lds
    v_mfma_f32_16x16x32_bf16 v[112:115], a[76:79], a[144:147], v[112:115]
    ds_read_b64_tr_b16 a[108:109], v197 offset:0
    s_add_u32 m0, s50, 0
    v_mfma_f32_16x16x32_bf16 v[116:119], a[76:79], a[148:151], v[116:119]
    v_mfma_f32_16x16x32_bf16 v[120:123], a[76:79], a[152:155], v[120:123]
    ds_read_b64_tr_b16 a[110:111], v197 offset:1024
    v_mfma_f32_16x16x32_bf16 v[124:127], a[76:79], a[156:159], v[124:127]
    buffer_load_dwordx4 v202, s[12:15], s48 offen offset:0 lds
    v_mfma_f32_16x16x32_bf16 v[128:131], a[80:83], a[128:131], v[128:131]
    ds_read_b64_tr_b16 a[112:113], v198 offset:0
    v_mfma_f32_16x16x32_bf16 v[132:135], a[80:83], a[132:135], v[132:135]
    ds_read_b128 a[76:79], v193 offset:2560
    v_mfma_f32_16x16x32_bf16 v[136:139], a[80:83], a[136:139], v[136:139]
    ds_read_b64_tr_b16 a[114:115], v198 offset:1024
    v_mfma_f32_16x16x32_bf16 v[140:143], a[80:83], a[140:143], v[140:143]
    v_mfma_f32_16x16x32_bf16 v[144:147], a[80:83], a[144:147], v[144:147]
    ds_read_b64_tr_b16 a[116:117], v199 offset:0
    v_mfma_f32_16x16x32_bf16 v[148:151], a[80:83], a[148:151], v[148:151]
    v_mfma_f32_16x16x32_bf16 v[152:155], a[80:83], a[152:155], v[152:155]
    ds_read_b64_tr_b16 a[118:119], v199 offset:1024
    v_mfma_f32_16x16x32_bf16 v[156:159], a[80:83], a[156:159], v[156:159]
    buffer_load_dwordx4 v203, s[12:15], s48 offen offset:1024 lds
    v_mfma_f32_16x16x32_bf16 v[160:163], a[84:87], a[128:131], v[160:163]
    ds_read_b64_tr_b16 a[120:121], v200 offset:0
    v_mfma_f32_16x16x32_bf16 v[164:167], a[84:87], a[132:135], v[164:167]
    ds_read_b128 a[80:83], v192 offset:8192
    v_mfma_f32_16x16x32_bf16 v[168:171], a[84:87], a[136:139], v[168:171]
    ds_read_b64_tr_b16 a[122:123], v200 offset:1024
    v_mfma_f32_16x16x32_bf16 v[172:175], a[84:87], a[140:143], v[172:175]
    v_mfma_f32_16x16x32_bf16 v[176:179], a[84:87], a[144:147], v[176:179]
    ds_read_b64_tr_b16 a[124:125], v201 offset:0
    v_mfma_f32_16x16x32_bf16 v[180:183], a[84:87], a[148:151], v[180:183]
    buffer_load_dwordx4 v204, s[12:15], s48 offen offset:2048 lds
    v_mfma_f32_16x16x32_bf16 v[184:187], a[84:87], a[152:155], v[184:187]
    ds_read_b64_tr_b16 a[126:127], v201 offset:1024
    v_mfma_f32_16x16x32_bf16 v[188:191], a[84:87], a[156:159], v[188:191]
    v_mfma_f32_16x16x32_bf16 a[0:3], a[88:91], a[128:131], a[0:3]
    v_mfma_f32_16x16x32_bf16 a[4:7], a[88:91], a[132:135], a[4:7]
    ds_read_b128 a[84:87], v193 offset:8704
    v_mfma_f32_16x16x32_bf16 a[8:11], a[88:91], a[136:139], a[8:11]
    v_mfma_f32_16x16x32_bf16 a[12:15], a[88:91], a[140:143], a[12:15]
    v_mfma_f32_16x16x32_bf16 a[16:19], a[88:91], a[144:147], a[16:19]
    buffer_load_dwordx4 v205, s[12:15], s48 offen offset:3072 lds
    v_mfma_f32_16x16x32_bf16 a[20:23], a[88:91], a[148:151], a[20:23]
    v_mfma_f32_16x16x32_bf16 a[24:27], a[88:91], a[152:155], a[24:27]
    v_mfma_f32_16x16x32_bf16 a[28:31], a[88:91], a[156:159], a[28:31]
    v_mfma_f32_16x16x32_bf16 a[32:35], a[92:95], a[128:131], a[32:35]
    v_mfma_f32_16x16x32_bf16 a[36:39], a[92:95], a[132:135], a[36:39]
    ds_read_b128 a[88:91], v192 offset:10240
    v_mfma_f32_16x16x32_bf16 a[40:43], a[92:95], a[136:139], a[40:43]
    v_mfma_f32_16x16x32_bf16 a[44:47], a[92:95], a[140:143], a[44:47]
    s_cmp_eq_u32 s68, s51
    s_cbranch_scc0 L_k1_zv1
    buffer_load_dword v252, v250, s[76:79], 0 offen
    v_add_u32 v250, s70, v250
L_k1_zv1:
    v_mfma_f32_16x16x32_bf16 a[48:51], a[92:95], a[144:147], a[48:51]
    v_mfma_f32_16x16x32_bf16 a[52:55], a[92:95], a[148:151], a[52:55]
    v_mfma_f32_16x16x32_bf16 a[56:59], a[92:95], a[152:155], a[56:59]
    s_add_u32 s48, s48, 64
    v_mfma_f32_16x16x32_bf16 a[60:63], a[92:95], a[156:159], a[60:63]
    s_add_u32 s49, s49, 262144
    s_waitcnt lgkmcnt(2)
    v_mfma_f32_16x16x32_bf16 v[0:3], a[64:67], a[96:99], v[0:3]
    ds_read_b128 a[92:95], v193 offset:10752
    v_mfma_f32_16x16x32_bf16 v[4:7], a[64:67], a[100:103], v[4:7]
    v_mfma_f32_16x16x32_bf16 v[8:11], a[64:67], a[104:107], v[8:11]
    s_add_u32 m0, s50, 36864
    v_mfma_f32_16x16x32_bf16 v[12:15], a[64:67], a[108:111], v[12:15]
    buffer_load_dwordx4 v206, s[16:19], s49 offen offset:0 lds
    v_mfma_f32_16x16x32_bf16 v[16:19], a[64:67], a[112:115], v[16:19]
    v_mfma_f32_16x16x32_bf16 v[20:23], a[64:67], a[116:119], v[20:23]
    v_mfma_f32_16x16x32_bf16 v[24:27], a[64:67], a[120:123], v[24:27]
    v_mfma_f32_16x16x32_bf16 v[28:31], a[64:67], a[124:127], v[28:31]
    v_mfma_f32_16x16x32_bf16 v[32:35], a[68:71], a[96:99], v[32:35]
    v_mfma_f32_16x16x32_bf16 v[36:39], a[68:71], a[100:103], v[36:39]
    s_waitcnt vmcnt(9) lgkmcnt(0)
    s_barrier
    v_mfma_f32_16x16x32_bf16 v[40:43], a[68:71], a[104:107], v[40:43]
    ds_read_b128 a[64:67], v192 offset:32768
    v_mfma_f32_16x16x32_bf16 v[44:47], a[68:71], a[108:111], v[44:47]
    ds_read_b64_tr_b16 a[128:129], v194 offset:32768
    v_mfma_f32_16x16x32_bf16 v[48:51], a[68:71], a[112:115], v[48:51]
    buffer_load_dwordx4 v207, s[16:19], s49 offen offset:1024 lds
    v_mfma_f32_16x16x32_bf16 v[52:55], a[68:71], a[116:119], v[52:55]
    ds_read_b64_tr_b16 a[130:131], v194 offset:33792
    v_mfma_f32_16x16x32_bf16 v[56:59], a[68:71], a[120:123], v[56:59]
    v_mfma_f32_16x16x32_bf16 v[60:63], a[68:71], a[124:127], v[60:63]
    ds_read_b64_tr_b16 a[132:133], v195 offset:32768
    v_mfma_f32_16x16x32_bf16 v[64:67], a[72:75], a[96:99], v[64:67]
    ds_read_b128 a[68:71], v193 offset:33280
    v_mfma_f32_16x16x32_bf16 v[68:71], a[72:75], a[100:103], v[68:71]
    ds_read_b64_tr_b16 a[134:135], v195 offset:33792
    v_mfma_f32_16x16x32_bf16 v[72:75], a[72:75], a[104:107], v[72:75]
    buffer_load_dwordx4 v208, s[16:19], s49 offen offset:2048 lds
    v_mfma_f32_16x16x32_bf16 v[76:79], a[72:75], a[108:111], v[76:79]
    ds_read_b64_tr_b16 a[136:137], v196 offset:32768
    v_mfma_f32_16x16x32_bf16 v[80:83], a[72:75], a[112:115], v[80:83]
    v_mfma_f32_16x16x32_bf16 v[84:87], a[72:75], a[116:119], v[84:87]
    ds_read_b64_tr_b16 a[138:139], v196 offset:33792
    v_mfma_f32_16x16x32_bf16 v[88:91], a[72:75], a[120:123], v[88:91]
    v_mfma_f32_16x16x32_bf16 v[92:95], a[72:75], a[124:127], v[92:95]
    ds_read_b64_tr_b16 a[140:141], v197 offset:32768
    v_mfma_f32_16x16x32_bf16 v[96:99], a[76:79], a[96:99], v[96:99]
    ds_read_b128 a[72:75], v192 offset:34816
    v_mfma_f32_16x16x32_bf16 v[100:103], a[76:79], a[100:103], v[100:103]
    ds_read_b64_tr_b16 a[142:143], v197 offset:33792
    v_mfma_f32_16x16x32_bf16 v[104:107], a[76:79], a[104:107], v[104:107]
    buffer_load_dwordx4 v209, s[16:19], s49 offen offset:3072 lds
    v_mfma_f32_16x16x32_bf16 v[108:111], a[76:79], a[108:111], v[108:111]
    ds_read_b64_tr_b16 a[144:145], v198 offset:32768
    s_add_u32 m0, s50, 32768
    v_mfma_f32_16x16x32_bf16 v[112:115], a[76:79], a[112:115], v[112:115]
    v_mfma_f32_16x16x32_bf16 v[116:119], a[76:79], a[116:119], v[116:119]
    ds_read_b64_tr_b16 a[146:147], v198 offset:33792
    v_mfma_f32_16x16x32_bf16 v[120:123], a[76:79], a[120:123], v[120:123]
    v_mfma_f32_16x16x32_bf16 v[124:127], a[76:79], a[124:127], v[124:127]
    ds_read_b64_tr_b16 a[148:149], v199 offset:32768
    v_mfma_f32_16x16x32_bf16 v[128:131], a[80:83], a[96:99], v[128:131]
    ds_read_b128 a[76:79], v193 offset:35328
    v_mfma_f32_16x16x32_bf16 v[132:135], a[80:83], a[100:103], v[132:135]
    ds_read_b64_tr_b16 a[150:151], v199 offset:33792
    v_mfma_f32_16x16x32_bf16 v[136:139], a[80:83], a[104:107], v[136:139]
    buffer_load_dwordx4 v202, s[12:15], s48 offen offset:0 lds
    v_mfma_f32_16x16x32_bf16 v[140:143], a[80:83], a[108:111], v[140:143]
    ds_read_b64_tr_b16 a[152:153], v200 offset:32768
    v_mfma_f32_16x16x32_bf16 v[144:147], a[80:83], a[112:115], v[144:147]
    v_mfma_f32_16x16x32_bf16 v[148:151], a[80:83], a[116:119], v[148:151]
    ds_read_b64_tr_b16 a[154:155], v200 offset:33792
    v_mfma_f32_16x16x32_bf16 v[152:155], a[80:83], a[120:123], v[152:155]
    buffer_load_dwordx4 v203, s[12:15], s48 offen offset:1024 lds
    v_mfma_f32_16x16x32_bf16 v[156:159], a[80:83], a[124:127], v[156:159]
    ds_read_b64_tr_b16 a[156:157], v201 offset:32768
    v_mfma_f32_16x16x32_bf16 v[160:163], a[84:87], a[96:99], v[160:163]
    ds_read_b128 a[80:83], v192 offset:40960
    v_mfma_f32_16x16x32_bf16 v[164:167], a[84:87], a[100:103], v[164:167]
    ds_read_b64_tr_b16 a[158:159], v201 offset:33792
    v_mfma_f32_16x16x32_bf16 v[168:171], a[84:87], a[104:107], v[168:171]
    v_mfma_f32_16x16x32_bf16 v[172:175], a[84:87], a[108:111], v[172:175]
    v_mfma_f32_16x16x32_bf16 v[176:179], a[84:87], a[112:115], v[176:179]
    v_mfma_f32_16x16x32_bf16 v[180:183], a[84:87], a[116:119], v[180:183]
    buffer_load_dwordx4 v204, s[12:15], s48 offen offset:2048 lds
    v_mfma_f32_16x16x32_bf16 v[184:187], a[84:87], a[120:123], v[184:187]
    v_mfma_f32_16x16x32_bf16 v[188:191], a[84:87], a[124:127], v[188:191]
    v_mfma_f32_16x16x32_bf16 a[0:3], a[88:91], a[96:99], a[0:3]
    ds_read_b128 a[84:87], v193 offset:41472
    v_mfma_f32_16x16x32_bf16 a[4:7], a[88:91], a[100:103], a[4:7]
    v_mfma_f32_16x16x32_bf16 a[8:11], a[88:91], a[104:107], a[8:11]
    v_mfma_f32_16x16x32_bf16 a[12:15], a[88:91], a[108:111], a[12:15]
    v_mfma_f32_16x16x32_bf16 a[16:19], a[88:91], a[112:115], a[16:19]
    buffer_load_dwordx4 v205, s[12:15], s48 offen offset:3072 lds
    v_mfma_f32_16x16x32_bf16 a[20:23], a[88:91], a[116:119], a[20:23]
    v_mfma_f32_16x16x32_bf16 a[24:27], a[88:91], a[120:123], a[24:27]
    v_mfma_f32_16x16x32_bf16 a[28:31], a[88:91], a[124:127], a[28:31]
    v_mfma_f32_16x16x32_bf16 a[32:35], a[92:95], a[96:99], a[32:35]
    ds_read_b128 a[88:91], v192 offset:43008
    v_mfma_f32_16x16x32_bf16 a[36:39], a[92:95], a[100:103], a[36:39]
    s_cmp_lt_u32 s56, 0x400000
    s_cbranch_scc0 L_k1_xv
    buffer_load_dword v252, v211, s[16:19], s56 offen
    s_add_u32 s56, s56, 0x100000
L_k1_xv:
    v_mfma_f32_16x16x32_bf16 a[40:43], a[92:95], a[104:107], a[40:43]
    v_mfma_f32_16x16x32_bf16 a[44:47], a[92:95], a[108:111], a[44:47]
    s_cmp_eq_u32 s68, s51
    s_cbranch_scc0 L_k1_zv2
    buffer_load_dword v252, v250, s[76:79], 0 offen
    v_add_u32 v250, s70, v250
L_k1_zv2:
    v_mfma_f32_16x16x32_bf16 a[48:51], a[92:95], a[112:115], a[48:51]
    v_mfma_f32_16x16x32_bf16 a[52:55], a[92:95], a[116:119], a[52:55]
    v_mfma_f32_16x16x32_bf16 a[56:59], a[92:95], a[120:123], a[56:59]
    s_add_u32 s48, s48, 64
    v_mfma_f32_16x16x32_bf16 a[60:63], a[92:95], a[124:127], a[60:63]
    s_add_u32 s49, s49, 262144
    s_waitcnt lgkmcnt(2)
    v_mfma_f32_16x16x32_bf16 v[0:3], a[64:67], a[128:131], v[0:3]
    ds_read_b128 a[92:95], v193 offset:43520
    v_mfma_f32_16x16x32_bf16 v[4:7], a[64:67], a[132:135], v[4:7]
    v_mfma_f32_16x16x32_bf16 v[8:11], a[64:67], a[136:139], v[8:11]
    s_add_u32 m0, s50, 69632
    v_mfma_f32_16x16x32_bf16 v[12:15], a[64:67], a[140:143], v[12:15]
    buffer_load_dwordx4 v206, s[16:19], s49 offen offset:0 lds
    v_mfma_f32_16x16x32_bf16 v[16:19], a[64:67], a[144:147], v[16:19]
    v_mfma_f32_16x16x32_bf16 v[20:23], a[64:67], a[148:151], v[20:23]
    v_mfma_f32_16x16x32_bf16 v[24:27], a[64:67], a[152:155], v[24:27]
    v_mfma_f32_16x16x32_bf16 v[28:31], a[64:67], a[156:159], v[28:31]
    v_mfma_f32_16x16x32_bf16 v[32:35], a[68:71], a[128:131], v[32:35]
    v_mfma_f32_16x16x32_bf16 v[36:39], a[68:71], a[132:135], v[36:39]
    s_waitcnt vmcnt(9) lgkmcnt(0)
    s_barrier
    v_mfma_f32_16x16x32_bf16 v[40:43], a[68:71], a[136:139], v[40:43]
    buffer_load_dwordx4 v207, s[16:19], s49 offen offset:1024 lds
    v_xor_b32 v192, 0x10000, v192
    v_xor_b32 v193, 0x10000, v193
    v_mfma_f32_16x16x32_bf16 v[44:47], a[68:71], a[140:143], v[44:47]
    v_xor_b32 v194, 0x10000, v194
    v_xor_b32 v195, 0x10000, v195
    v_mfma_f32_16x16x32_bf16 v[48:51], a[68:71], a[144:147], v[48:51]
    v_xor_b32 v196, 0x10000, v196
    v_xor_b32 v197, 0x10000, v197
    v_mfma_f32_16x16x32_bf16 v[52:55], a[68:71], a[148:151], v[52:55]
    v_xor_b32 v198, 0x10000, v198
    v_xor_b32 v199, 0x10000, v199
    v_mfma_f32_16x16x32_bf16 v[56:59], a[68:71], a[152:155], v[56:59]
    v_xor_b32 v200, 0x10000, v200
    v_xor_b32 v201, 0x10000, v201
    v_mfma_f32_16x16x32_bf16 v[60:63], a[68:71], a[156:159], v[60:63]
    ds_read_b128 a[64:67], v192 offset:0
    v_mfma_f32_16x16x32_bf16 v[64:67], a[72:75], a[128:131], v[64:67]
    ds_read_b64_tr_b16 a[96:97], v194 offset:0
    v_mfma_f32_16x16x32_bf16 v[68:71], a[72:75], a[132:135], v[68:71]
    buffer_load_dwordx4 v208, s[16:19], s49 offen offset:2048 lds
    v_mfma_f32_16x16x32_bf16 v[72:75], a[72:75], a[136:139], v[72:75]
    ds_read_b64_tr_b16 a[98:99], v194 offset:1024
    ds_read_b128 a[68:71], v193 offset:512
    v_mfma_f32_16x16x32_bf16 v[76:79], a[72:75], a[140:143], v[76:79]
    v_mfma_f32_16x16x32_bf16 v[80:83], a[72:75], a[144:147], v[80:83]
    ds_read_b64_tr_b16 a[100:101], v195 offset:0
    v_mfma_f32_16x16x32_bf16 v[84:87], a[72:75], a[148:151], v[84:87]
    v_mfma_f32_16x16x32_bf16 v[88:91], a[72:75], a[152:155], v[88:91]
    ds_read_b64_tr_b16 a[102:103], v195 offset:1024
    v_mfma_f32_16x16x32_bf16 v[92:95], a[72:75], a[156:159], v[92:95]
    v_mfma_f32_16x16x32_bf16 v[96:99], a[76:79], a[128:131], v[96:99]
    ds_read_b64_tr_b16 a[104:105], v196 offset:0
    v_mfma_f32_16x16x32_bf16 v[100:103], a[76:79], a[132:135], v[100:103]
    ds_read_b128 a[72:75], v192 offset:2048
    v_mfma_f32_16x16x32_bf16 v[104:107], a[76:79], a[136:139], v[104:107]
    ds_read_b64_tr_b16 a[106:107], v196 offset:1024
    v_mfma_f32_16x16x32_bf16 v[108:111], a[76:79], a[140:143], v[108:111]
    buffer_load_dwordx4 v209, s[16:19], s49 offen offset:3072 lds
    v_mfma_f32_16x16x32_bf16 v[112:115], a[76:79], a[144:147], v[112:115]
    ds_read_b64_tr_b16 a[108:109], v197 offset:0
    s_add_u32 m0, s50, 65536
    v_mfma_f32_16x16x32_bf16 v[116:119], a[76:79], a[148:151], v[116:119]
    v_mfma_f32_16x16x32_bf16 v[120:123], a[76:79], a[152:155], v[120:123]
    ds_read_b64_tr_b16 a[110:111], v197 offset:1024
    v_mfma_f32_16x16x32_bf16 v[124:127], a[76:79], a[156:159], v[124:127]
    buffer_load_dwordx4 v202, s[12:15], s48 offen offset:0 lds
    v_mfma_f32_16x16x32_bf16 v[128:131], a[80:83], a[128:131], v[128:131]
    ds_read_b64_tr_b16 a[112:113], v198 offset:0
    v_mfma_f32_16x16x32_bf16 v[132:135], a[80:83], a[132:135], v[132:135]
    ds_read_b128 a[76:79], v193 offset:2560
    v_mfma_f32_16x16x32_bf16 v[136:139], a[80:83], a[136:139], v[136:139]
    ds_read_b64_tr_b16 a[114:115], v198 offset:1024
    v_mfma_f32_16x16x32_bf16 v[140:143], a[80:83], a[140:143], v[140:143]
    v_mfma_f32_16x16x32_bf16 v[144:147], a[80:83], a[144:147], v[144:147]
    ds_read_b64_tr_b16 a[116:117], v199 offset:0
    v_mfma_f32_16x16x32_bf16 v[148:151], a[80:83], a[148:151], v[148:151]
    v_mfma_f32_16x16x32_bf16 v[152:155], a[80:83], a[152:155], v[152:155]
    ds_read_b64_tr_b16 a[118:119], v199 offset:1024
    v_mfma_f32_16x16x32_bf16 v[156:159], a[80:83], a[156:159], v[156:159]
    buffer_load_dwordx4 v203, s[12:15], s48 offen offset:1024 lds
    v_mfma_f32_16x16x32_bf16 v[160:163], a[84:87], a[128:131], v[160:163]
    ds_read_b64_tr_b16 a[120:121], v200 offset:0
    v_mfma_f32_16x16x32_bf16 v[164:167], a[84:87], a[132:135], v[164:167]
    ds_read_b128 a[80:83], v192 offset:8192
    v_mfma_f32_16x16x32_bf16 v[168:171], a[84:87], a[136:139], v[168:171]
    ds_read_b64_tr_b16 a[122:123], v200 offset:1024
    v_mfma_f32_16x16x32_bf16 v[172:175], a[84:87], a[140:143], v[172:175]
    v_mfma_f32_16x16x32_bf16 v[176:179], a[84:87], a[144:147], v[176:179]
    ds_read_b64_tr_b16 a[124:125], v201 offset:0
    v_mfma_f32_16x16x32_bf16 v[180:183], a[84:87], a[148:151], v[180:183]
    buffer_load_dwordx4 v204, s[12:15], s48 offen offset:2048 lds
    v_mfma_f32_16x16x32_bf16 v[184:187], a[84:87], a[152:155], v[184:187]
    ds_read_b64_tr_b16 a[126:127], v201 offset:1024
    v_mfma_f32_16x16x32_bf16 v[188:191], a[84:87], a[156:159], v[188:191]
    v_mfma_f32_16x16x32_bf16 a[0:3], a[88:91], a[128:131], a[0:3]
    v_mfma_f32_16x16x32_bf16 a[4:7], a[88:91], a[132:135], a[4:7]
    ds_read_b128 a[84:87], v193 offset:8704
    v_mfma_f32_16x16x32_bf16 a[8:11], a[88:91], a[136:139], a[8:11]
    v_mfma_f32_16x16x32_bf16 a[12:15], a[88:91], a[140:143], a[12:15]
    v_mfma_f32_16x16x32_bf16 a[16:19], a[88:91], a[144:147], a[16:19]
    buffer_load_dwordx4 v205, s[12:15], s48 offen offset:3072 lds
    v_mfma_f32_16x16x32_bf16 a[20:23], a[88:91], a[148:151], a[20:23]
    v_mfma_f32_16x16x32_bf16 a[24:27], a[88:91], a[152:155], a[24:27]
    v_mfma_f32_16x16x32_bf16 a[28:31], a[88:91], a[156:159], a[28:31]
    v_mfma_f32_16x16x32_bf16 a[32:35], a[92:95], a[128:131], a[32:35]
    v_mfma_f32_16x16x32_bf16 a[36:39], a[92:95], a[132:135], a[36:39]
    ds_read_b128 a[88:91], v192 offset:10240
    v_mfma_f32_16x16x32_bf16 a[40:43], a[92:95], a[136:139], a[40:43]
    v_mfma_f32_16x16x32_bf16 a[44:47], a[92:95], a[140:143], a[44:47]
    s_cmp_eq_u32 s68, s51
    s_cbranch_scc0 L_k1_zv3
    buffer_load_dword v252, v250, s[76:79], 0 offen
    v_add_u32 v250, s70, v250
L_k1_zv3:
    v_mfma_f32_16x16x32_bf16 a[48:51], a[92:95], a[144:147], a[48:51]
    s_add_u32 s51, s51, 1
    v_mfma_f32_16x16x32_bf16 a[52:55], a[92:95], a[148:151], a[52:55]
    v_mfma_f32_16x16x32_bf16 a[56:59], a[92:95], a[152:155], a[56:59]
    s_add_u32 s48, s48, 64
    v_mfma_f32_16x16x32_bf16 a[60:63], a[92:95], a[156:159], a[60:63]
    s_add_u32 s49, s49, 262144
    s_cmp_lt_u32 s51, 3
    s_cbranch_scc1 L_k1_loop_v
    s_waitcnt lgkmcnt(2)
    v_mfma_f32_16x16x32_bf16 v[0:3], a[64:67], a[96:99], v[0:3]
    ds_read_b128 a[92:95], v193 offset:10752
    v_mfma_f32_16x16x32_bf16 v[4:7], a[64:67], a[100:103], v[4:7]
    v_mfma_f32_16x16x32_bf16 v[8:11], a[64:67], a[104:107], v[8:11]
    s_add_u32 m0, s50, 102400
    v_mfma_f32_16x16x32_bf16 v[12:15], a[64:67], a[108:111], v[12:15]
    buffer_load_dwordx4 v206, s[16:19], s49 offen offset:0 lds
    v_mfma_f32_16x16x32_bf16 v[16:19], a[64:67], a[112:115], v[16:19]
    v_mfma_f32_16x16x32_bf16 v[20:23], a[64:67], a[116:119], v[20:23]
    v_mfma_f32_16x16x32_bf16 v[24:27], a[64:67], a[120:123], v[24:27]
    v_mfma_f32_16x16x32_bf16 v[28:31], a[64:67], a[124:127], v[28:31]
    v_mfma_f32_16x16x32_bf16 v[32:35], a[68:71], a[96:99], v[32:35]
    v_mfma_f32_16x16x32_bf16 v[36:39], a[68:71], a[100:103], v[36:39]
    s_waitcnt vmcnt(9)
    s_waitcnt lgkmcnt(0)
    s_barrier
    v_mfma_f32_16x16x32_bf16 v[40:43], a[68:71], a[104:107], v[40:43]
    ds_read_b128 a[64:67], v192 offset:32768
    v_mfma_f32_16x16x32_bf16 v[44:47], a[68:71], a[108:111], v[44:47]
    ds_read_b64_tr_b16 a[128:129], v194 offset:32768
    v_mfma_f32_16x16x32_bf16 v[48:51], a[68:71], a[112:115], v[48:51]
    buffer_load_dwordx4 v207, s[16:19], s49 offen offset:1024 lds
    v_mfma_f32_16x16x32_bf16 v[52:55], a[68:71], a[116:119], v[52:55]
    ds_read_b64_tr_b16 a[130:131], v194 offset:33792
    v_mfma_f32_16x16x32_bf16 v[56:59], a[68:71], a[120:123], v[56:59]
    v_mfma_f32_16x16x32_bf16 v[60:63], a[68:71], a[124:127], v[60:63]
    ds_read_b64_tr_b16 a[132:133], v195 offset:32768
    v_mfma_f32_16x16x32_bf16 v[64:67], a[72:75], a[96:99], v[64:67]
    ds_read_b128 a[68:71], v193 offset:33280
    v_mfma_f32_16x16x32_bf16 v[68:71], a[72:75], a[100:103], v[68:71]
    ds_read_b64_tr_b16 a[134:135], v195 offset:33792
    v_mfma_f32_16x16x32_bf16 v[72:75], a[72:75], a[104:107], v[72:75]
    buffer_load_dwordx4 v208, s[16:19], s49 offen offset:2048 lds
    v_mfma_f32_16x16x32_bf16 v[76:79], a[72:75], a[108:111], v[76:79]
    ds_read_b64_tr_b16 a[136:137], v196 offset:32768
    v_mfma_f32_16x16x32_bf16 v[80:83], a[72:75], a[112:115], v[80:83]
    v_mfma_f32_16x16x32_bf16 v[84:87], a[72:75], a[116:119], v[84:87]
    ds_read_b64_tr_b16 a[138:139], v196 offset:33792
    v_mfma_f32_16x16x32_bf16 v[88:91], a[72:75], a[120:123], v[88:91]
    v_mfma_f32_16x16x32_bf16 v[92:95], a[72:75], a[124:127], v[92:95]
    ds_read_b64_tr_b16 a[140:141], v197 offset:32768
    v_mfma_f32_16x16x32_bf16 v[96:99], a[76:79], a[96:99], v[96:99]
    ds_read_b128 a[72:75], v192 offset:34816
    v_mfma_f32_16x16x32_bf16 v[100:103], a[76:79], a[100:103], v[100:103]
    ds_read_b64_tr_b16 a[142:143], v197 offset:33792
    v_mfma_f32_16x16x32_bf16 v[104:107], a[76:79], a[104:107], v[104:107]
    buffer_load_dwordx4 v209, s[16:19], s49 offen offset:3072 lds
    v_mfma_f32_16x16x32_bf16 v[108:111], a[76:79], a[108:111], v[108:111]
    ds_read_b64_tr_b16 a[144:145], v198 offset:32768
    s_add_u32 m0, s50, 98304
    v_mfma_f32_16x16x32_bf16 v[112:115], a[76:79], a[112:115], v[112:115]
    v_mfma_f32_16x16x32_bf16 v[116:119], a[76:79], a[116:119], v[116:119]
    ds_read_b64_tr_b16 a[146:147], v198 offset:33792
    v_mfma_f32_16x16x32_bf16 v[120:123], a[76:79], a[120:123], v[120:123]
    v_mfma_f32_16x16x32_bf16 v[124:127], a[76:79], a[124:127], v[124:127]
    ds_read_b64_tr_b16 a[148:149], v199 offset:32768
    v_mfma_f32_16x16x32_bf16 v[128:131], a[80:83], a[96:99], v[128:131]
    ds_read_b128 a[76:79], v193 offset:35328
    v_mfma_f32_16x16x32_bf16 v[132:135], a[80:83], a[100:103], v[132:135]
    ds_read_b64_tr_b16 a[150:151], v199 offset:33792
    v_mfma_f32_16x16x32_bf16 v[136:139], a[80:83], a[104:107], v[136:139]
    buffer_load_dwordx4 v202, s[12:15], s48 offen offset:0 lds
    v_mfma_f32_16x16x32_bf16 v[140:143], a[80:83], a[108:111], v[140:143]
    ds_read_b64_tr_b16 a[152:153], v200 offset:32768
    v_mfma_f32_16x16x32_bf16 v[144:147], a[80:83], a[112:115], v[144:147]
    v_mfma_f32_16x16x32_bf16 v[148:151], a[80:83], a[116:119], v[148:151]
    ds_read_b64_tr_b16 a[154:155], v200 offset:33792
    v_mfma_f32_16x16x32_bf16 v[152:155], a[80:83], a[120:123], v[152:155]
    buffer_load_dwordx4 v203, s[12:15], s48 offen offset:1024 lds
    v_mfma_f32_16x16x32_bf16 v[156:159], a[80:83], a[124:127], v[156:159]
    ds_read_b64_tr_b16 a[156:157], v201 offset:32768
    v_mfma_f32_16x16x32_bf16 v[160:163], a[84:87], a[96:99], v[160:163]
    ds_read_b128 a[80:83], v192 offset:40960
    v_mfma_f32_16x16x32_bf16 v[164:167], a[84:87], a[100:103], v[164:167]
    ds_read_b64_tr_b16 a[158:159], v201 offset:33792
    v_mfma_f32_16x16x32_bf16 v[168:171], a[84:87], a[104:107], v[168:171]
    v_mfma_f32_16x16x32_bf16 v[172:175], a[84:87], a[108:111], v[172:175]
    v_mfma_f32_16x16x32_bf16 v[176:179], a[84:87], a[112:115], v[176:179]
    v_mfma_f32_16x16x32_bf16 v[180:183], a[84:87], a[116:119], v[180:183]
    buffer_load_dwordx4 v204, s[12:15], s48 offen offset:2048 lds
    v_mfma_f32_16x16x32_bf16 v[184:187], a[84:87], a[120:123], v[184:187]
    v_mfma_f32_16x16x32_bf16 v[188:191], a[84:87], a[124:127], v[188:191]
    v_mfma_f32_16x16x32_bf16 a[0:3], a[88:91], a[96:99], a[0:3]
    ds_read_b128 a[84:87], v193 offset:41472
    v_mfma_f32_16x16x32_bf16 a[4:7], a[88:91], a[100:103], a[4:7]
    v_mfma_f32_16x16x32_bf16 a[8:11], a[88:91], a[104:107], a[8:11]
    v_mfma_f32_16x16x32_bf16 a[12:15], a[88:91], a[108:111], a[12:15]
    v_mfma_f32_16x16x32_bf16 a[16:19], a[88:91], a[112:115], a[16:19]
    buffer_load_dwordx4 v205, s[12:15], s48 offen offset:3072 lds
    v_mfma_f32_16x16x32_bf16 a[20:23], a[88:91], a[116:119], a[20:23]
    v_mfma_f32_16x16x32_bf16 a[24:27], a[88:91], a[120:123], a[24:27]
    v_mfma_f32_16x16x32_bf16 a[28:31], a[88:91], a[124:127], a[28:31]
    v_mfma_f32_16x16x32_bf16 a[32:35], a[92:95], a[96:99], a[32:35]
    ds_read_b128 a[88:91], v192 offset:43008
    v_mfma_f32_16x16x32_bf16 a[36:39], a[92:95], a[100:103], a[36:39]
    v_mfma_f32_16x16x32_bf16 a[40:43], a[92:95], a[104:107], a[40:43]
    buffer_load_dword v254, v253, s[8:11], s57 offen sc1
    v_mfma_f32_16x16x32_bf16 a[44:47], a[92:95], a[108:111], a[44:47]
    v_mfma_f32_16x16x32_bf16 a[48:51], a[92:95], a[112:115], a[48:51]
    v_mfma_f32_16x16x32_bf16 a[52:55], a[92:95], a[116:119], a[52:55]
    v_mfma_f32_16x16x32_bf16 a[56:59], a[92:95], a[120:123], a[56:59]
    s_add_u32 s48, s48, 64
    v_mfma_f32_16x16x32_bf16 a[60:63], a[92:95], a[124:127], a[60:63]
    s_add_u32 s49, s49, 262144
    s_waitcnt lgkmcnt(2)
    v_mfma_f32_16x16x32_bf16 v[0:3], a[64:67], a[128:131], v[0:3]
    ds_read_b128 a[92:95], v193 offset:43520
    v_mfma_f32_16x16x32_bf16 v[4:7], a[64:67], a[132:135], v[4:7]
    v_mfma_f32_16x16x32_bf16 v[8:11], a[64:67], a[136:139], v[8:11]
    v_mfma_f32_16x16x32_bf16 v[12:15], a[64:67], a[140:143], v[12:15]
    v_mfma_f32_16x16x32_bf16 v[16:19], a[64:67], a[144:147], v[16:19]
    v_mfma_f32_16x16x32_bf16 v[20:23], a[64:67], a[148:151], v[20:23]
    v_mfma_f32_16x16x32_bf16 v[24:27], a[64:67], a[152:155], v[24:27]
    v_mfma_f32_16x16x32_bf16 v[28:31], a[64:67], a[156:159], v[28:31]
    v_mfma_f32_16x16x32_bf16 v[32:35], a[68:71], a[128:131], v[32:35]
    v_mfma_f32_16x16x32_bf16 v[36:39], a[68:71], a[132:135], v[36:39]
    s_waitcnt vmcnt(9)
    s_waitcnt lgkmcnt(0)
    s_barrier
    s_waitcnt vmcnt(0)
    s_mov_b32 s55, 0
L_ka_fl_lnv:
    v_cmp_ne_u32 vcc, s58, v254
    s_cbranch_vccz L_ka_fl_lnv_ok
    s_sleep 8
    buffer_load_dword v254, v253, s[8:11], s57 offen sc1
    s_add_u32 s55, s55, 1
    s_cmp_lt_u32 s55, 0x40000
    s_waitcnt vmcnt(0)
    s_cbranch_scc1 L_ka_fl_lnv
L_ka_fl_lnv_ok:
    v_mfma_f32_16x16x32_bf16 v[40:43], a[68:71], a[136:139], v[40:43]
    v_xor_b32 v192, 0x10000, v192
    v_xor_b32 v193, 0x10000, v193
    v_mfma_f32_16x16x32_bf16 v[44:47], a[68:71], a[140:143], v[44:47]
    v_xor_b32 v194, 0x10000, v194
    v_xor_b32 v195, 0x10000, v195
    v_mfma_f32_16x16x32_bf16 v[48:51], a[68:71], a[144:147], v[48:51]
    v_xor_b32 v196, 0x10000, v196
    v_xor_b32 v197, 0x10000, v197
    v_mfma_f32_16x16x32_bf16 v[52:55], a[68:71], a[148:151], v[52:55]
    v_xor_b32 v198, 0x10000, v198
    v_xor_b32 v199, 0x10000, v199
    v_mfma_f32_16x16x32_bf16 v[56:59], a[68:71], a[152:155], v[56:59]
    v_xor_b32 v200, 0x10000, v200
    v_xor_b32 v201, 0x10000, v201
    v_mfma_f32_16x16x32_bf16 v[60:63], a[68:71], a[156:159], v[60:63]
    ds_read_b128 a[64:67], v192 offset:0
    s_add_u32 s52, s71, 0
    s_add_u32 s53, s72, 0
    v_mfma_f32_16x16x32_bf16 v[64:67], a[72:75], a[128:131], v[64:67]
    ds_read_b64_tr_b16 a[96:97], v194 offset:0
    v_mfma_f32_16x16x32_bf16 v[68:71], a[72:75], a[132:135], v[68:71]
    buffer_load_dwordx4 a[192:195], v240, s[8:11], s52 offen offset:0 sc1
    v_mfma_f32_16x16x32_bf16 v[72:75], a[72:75], a[136:139], v[72:75]
    ds_read_b64_tr_b16 a[98:99], v194 offset:1024
    ds_read_b128 a[68:71], v193 offset:512
    v_mfma_f32_16x16x32_bf16 v[76:79], a[72:75], a[140:143], v[76:79]
    v_mfma_f32_16x16x32_bf16 v[80:83], a[72:75], a[144:147], v[80:83]
    ds_read_b64_tr_b16 a[100:101], v195 offset:0
    v_mfma_f32_16x16x32_bf16 v[84:87], a[72:75], a[148:151], v[84:87]
    buffer_load_dwordx4 a[196:199], v240, s[8:11], s53 offen offset:0 sc1
    v_mfma_f32_16x16x32_bf16 v[88:91], a[72:75], a[152:155], v[88:91]
    ds_read_b64_tr_b16 a[102:103], v195 offset:1024
    v_mfma_f32_16x16x32_bf16 v[92:95], a[72:75], a[156:159], v[92:95]
    v_mfma_f32_16x16x32_bf16 v[96:99], a[76:79], a[128:131], v[96:99]
    ds_read_b64_tr_b16 a[104:105], v196 offset:0
    v_mfma_f32_16x16x32_bf16 v[100:103], a[76:79], a[132:135], v[100:103]
    ds_read_b128 a[72:75], v192 offset:2048
    v_mfma_f32_16x16x32_bf16 v[104:107], a[76:79], a[136:139], v[104:107]
    ds_read_b64_tr_b16 a[106:107], v196 offset:1024
    v_mfma_f32_16x16x32_bf16 v[108:111], a[76:79], a[140:143], v[108:111]
    buffer_load_dwordx4 a[200:203], v240, s[8:11], s52 offen offset:1024 sc1
    v_mfma_f32_16x16x32_bf16 v[112:115], a[76:79], a[144:147], v[112:115]
    ds_read_b64_tr_b16 a[108:109], v197 offset:0
    v_mfma_f32_16x16x32_bf16 v[116:119], a[76:79], a[148:151], v[116:119]
    v_mfma_f32_16x16x32_bf16 v[120:123], a[76:79], a[152:155], v[120:123]
    ds_read_b64_tr_b16 a[110:111], v197 offset:1024
    v_mfma_f32_16x16x32_bf16 v[124:127], a[76:79], a[156:159], v[124:127]
    buffer_load_dwordx4 a[204:207], v240, s[8:11], s53 offen offset:1024 sc1
    v_mfma_f32_16x16x32_bf16 v[128:131], a[80:83], a[128:131], v[128:131]
    ds_read_b64_tr_b16 a[112:113], v198 offset:0
    v_mfma_f32_16x16x32_bf16 v[132:135], a[80:83], a[132:135], v[132:135]
    ds_read_b128 a[76:79], v193 offset:2560
    v_mfma_f32_16x16x32_bf16 v[136:139], a[80:83], a[136:139], v[136:139]
    ds_read_b64_tr_b16 a[114:115], v198 offset:1024
    v_mfma_f32_16x16x32_bf16 v[140:143], a[80:83], a[140:143], v[140:143]
    buffer_load_dwordx4 a[208:211], v240, s[8:11], s52 offen offset:2048 sc1
    v_mfma_f32_16x16x32_bf16 v[144:147], a[80:83], a[144:147], v[144:147]
    ds_read_b64_tr_b16 a[116:117], v199 offset:0
    v_mfma_f32_16x16x32_bf16 v[148:151], a[80:83], a[148:151], v[148:151]
    v_mfma_f32_16x16x32_bf16 v[152:155], a[80:83], a[152:155], v[152:155]
    ds_read_b64_tr_b16 a[118:119], v199 offset:1024
    v_mfma_f32_16x16x32_bf16 v[156:159], a[80:83], a[156:159], v[156:159]
    buffer_load_dwordx4 a[212:215], v240, s[8:11], s53 offen offset:2048 sc1
    v_mfma_f32_16x16x32_bf16 v[160:163], a[84:87], a[128:131], v[160:163]
    ds_read_b64_tr_b16 a[120:121], v200 offset:0
    v_mfma_f32_16x16x32_bf16 v[164:167], a[84:87], a[132:135], v[164:167]
    ds_read_b128 a[80:83], v192 offset:8192
    v_mfma_f32_16x16x32_bf16 v[168:171], a[84:87], a[136:139], v[168:171]
    ds_read_b64_tr_b16 a[122:123], v200 offset:1024
    v_mfma_f32_16x16x32_bf16 v[172:175], a[84:87], a[140:143], v[172:175]
    buffer_load_dwordx4 a[216:219], v240, s[8:11], s52 offen offset:3072 sc1
    v_mfma_f32_16x16x32_bf16 v[176:179], a[84:87], a[144:147], v[176:179]
    ds_read_b64_tr_b16 a[124:125], v201 offset:0
    v_mfma_f32_16x16x32_bf16 v[180:183], a[84:87], a[148:151], v[180:183]
    v_mfma_f32_16x16x32_bf16 v[184:187], a[84:87], a[152:155], v[184:187]
    ds_read_b64_tr_b16 a[126:127], v201 offset:1024
    v_mfma_f32_16x16x32_bf16 v[188:191], a[84:87], a[156:159], v[188:191]
    buffer_load_dwordx4 a[220:223], v240, s[8:11], s53 offen offset:3072 sc1
    v_mfma_f32_16x16x32_bf16 a[0:3], a[88:91], a[128:131], a[0:3]
    v_mfma_f32_16x16x32_bf16 a[4:7], a[88:91], a[132:135], a[4:7]
    ds_read_b128 a[84:87], v193 offset:8704
    s_add_u32 m0, s3, 0
    s_add_u32 s54, s73, 0
    v_mfma_f32_16x16x32_bf16 a[8:11], a[88:91], a[136:139], a[8:11]
    buffer_load_dwordx4 v246, s[28:31], s54 offen offset:0 lds
    v_mfma_f32_16x16x32_bf16 a[12:15], a[88:91], a[140:143], a[12:15]
    v_mfma_f32_16x16x32_bf16 a[16:19], a[88:91], a[144:147], a[16:19]
    v_mfma_f32_16x16x32_bf16 a[20:23], a[88:91], a[148:151], a[20:23]
    buffer_load_dwordx4 v247, s[28:31], s54 offen offset:1024 lds
    v_mfma_f32_16x16x32_bf16 a[24:27], a[88:91], a[152:155], a[24:27]
    v_mfma_f32_16x16x32_bf16 a[28:31], a[88:91], a[156:159], a[28:31]
    v_mfma_f32_16x16x32_bf16 a[32:35], a[92:95], a[128:131], a[32:35]
    buffer_load_dwordx4 v248, s[28:31], s54 offen offset:2048 lds
    v_mfma_f32_16x16x32_bf16 a[36:39], a[92:95], a[132:135], a[36:39]
    ds_read_b128 a[88:91], v192 offset:10240
    v_mfma_f32_16x16x32_bf16 a[40:43], a[92:95], a[136:139], a[40:43]
    v_mfma_f32_16x16x32_bf16 a[44:47], a[92:95], a[140:143], a[44:47]
    buffer_load_dwordx4 v249, s[28:31], s54 offen offset:3072 lds
    v_mfma_f32_16x16x32_bf16 a[48:51], a[92:95], a[144:147], a[48:51]
    v_mfma_f32_16x16x32_bf16 a[52:55], a[92:95], a[148:151], a[52:55]
    v_mfma_f32_16x16x32_bf16 a[56:59], a[92:95], a[152:155], a[56:59]
    v_mfma_f32_16x16x32_bf16 a[60:63], a[92:95], a[156:159], a[60:63]
    s_waitcnt lgkmcnt(2)
    v_mfma_f32_16x16x32_bf16 v[0:3], a[64:67], a[96:99], v[0:3]
    ds_read_b128 a[92:95], v193 offset:10752
    v_mfma_f32_16x16x32_bf16 v[4:7], a[64:67], a[100:103], v[4:7]
    v_mfma_f32_16x16x32_bf16 v[8:11], a[64:67], a[104:107], v[8:11]
    v_mfma_f32_16x16x32_bf16 v[12:15], a[64:67], a[108:111], v[12:15]
    v_mfma_f32_16x16x32_bf16 v[16:19], a[64:67], a[112:115], v[16:19]
    v_mfma_f32_16x16x32_bf16 v[20:23], a[64:67], a[116:119], v[20:23]
    v_mfma_f32_16x16x32_bf16 v[24:27], a[64:67], a[120:123], v[24:27]
    v_mfma_f32_16x16x32_bf16 v[28:31], a[64:67], a[124:127], v[28:31]
    v_mfma_f32_16x16x32_bf16 v[32:35], a[68:71], a[96:99], v[32:35]
    v_mfma_f32_16x16x32_bf16 v[36:39], a[68:71], a[100:103], v[36:39]
    s_waitcnt vmcnt(13)
    s_waitcnt lgkmcnt(0)
    s_barrier
    v_mfma_f32_16x16x32_bf16 v[40:43], a[68:71], a[104:107], v[40:43]
    ds_read_b128 a[64:67], v192 offset:32768
    v_mfma_f32_16x16x32_bf16 v[44:47], a[68:71], a[108:111], v[44:47]
    ds_read_b64_tr_b16 a[128:129], v194 offset:32768
    v_mfma_f32_16x16x32_bf16 v[48:51], a[68:71], a[112:115], v[48:51]
    v_mfma_f32_16x16x32_bf16 v[52:55], a[68:71], a[116:119], v[52:55]
    ds_read_b64_tr_b16 a[130:131], v194 offset:33792
    v_mfma_f32_16x16x32_bf16 v[56:59], a[68:71], a[120:123], v[56:59]
    v_mfma_f32_16x16x32_bf16 v[60:63], a[68:71], a[124:127], v[60:63]
    ds_read_b64_tr_b16 a[132:133], v195 offset:32768
    s_add_u32 s52, s71, 4096
    s_add_u32 s53, s72, 4096
    v_mfma_f32_16x16x32_bf16 v[64:67], a[72:75], a[96:99], v[64:67]
    ds_read_b128 a[68:71], v193 offset:33280
    v_mfma_f32_16x16x32_bf16 v[68:71], a[72:75], a[100:103], v[68:71]
    ds_read_b64_tr_b16 a[134:135], v195 offset:33792
    v_mfma_f32_16x16x32_bf16 v[72:75], a[72:75], a[104:107], v[72:75]
    buffer_load_dwordx4 a[224:227], v240, s[8:11], s52 offen offset:0 sc1
    v_mfma_f32_16x16x32_bf16 v[76:79], a[72:75], a[108:111], v[76:79]
    ds_read_b64_tr_b16 a[136:137], v196 offset:32768
    v_mfma_f32_16x16x32_bf16 v[80:83], a[72:75], a[112:115], v[80:83]
    v_mfma_f32_16x16x32_bf16 v[84:87], a[72:75], a[116:119], v[84:87]
    ds_read_b64_tr_b16 a[138:139], v196 offset:33792
    v_mfma_f32_16x16x32_bf16 v[88:91], a[72:75], a[120:123], v[88:91]
    buffer_load_dwordx4 a[228:231], v240, s[8:11], s53 offen offset:0 sc1
    v_mfma_f32_16x16x32_bf16 v[92:95], a[72:75], a[124:127], v[92:95]
    ds_read_b64_tr_b16 a[140:141], v197 offset:32768
    v_mfma_f32_16x16x32_bf16 v[96:99], a[76:79], a[96:99], v[96:99]
    ds_read_b128 a[72:75], v192 offset:34816
    v_mfma_f32_16x16x32_bf16 v[100:103], a[76:79], a[100:103], v[100:103]
    ds_read_b64_tr_b16 a[142:143], v197 offset:33792
    v_mfma_f32_16x16x32_bf16 v[104:107], a[76:79], a[104:107], v[104:107]
    buffer_load_dwordx4 a[232:235], v240, s[8:11], s52 offen offset:1024 sc1
    v_mfma_f32_16x16x32_bf16 v[108:111], a[76:79], a[108:111], v[108:111]
    ds_read_b64_tr_b16 a[144:145], v198 offset:32768
    v_mfma_f32_16x16x32_bf16 v[112:115], a[76:79], a[112:115], v[112:115]
    v_mfma_f32_16x16x32_bf16 v[116:119], a[76:79], a[116:119], v[116:119]
    ds_read_b64_tr_b16 a[146:147], v198 offset:33792
    v_mfma_f32_16x16x32_bf16 v[120:123], a[76:79], a[120:123], v[120:123]
    buffer_load_dwordx4 a[236:239], v240, s[8:11], s53 offen offset:1024 sc1
    v_mfma_f32_16x16x32_bf16 v[124:127], a[76:79], a[124:127], v[124:127]
    ds_read_b64_tr_b16 a[148:149], v199 offset:32768
    v_mfma_f32_16x16x32_bf16 v[128:131], a[80:83], a[96:99], v[128:131]
    ds_read_b128 a[76:79], v193 offset:35328
    v_mfma_f32_16x16x32_bf16 v[132:135], a[80:83], a[100:103], v[132:135]
    ds_read_b64_tr_b16 a[150:151], v199 offset:33792
    v_mfma_f32_16x16x32_bf16 v[136:139], a[80:83], a[104:107], v[136:139]
    buffer_load_dwordx4 a[240:243], v240, s[8:11], s52 offen offset:2048 sc1
    v_mfma_f32_16x16x32_bf16 v[140:143], a[80:83], a[108:111], v[140:143]
    ds_read_b64_tr_b16 a[152:153], v200 offset:32768
    v_mfma_f32_16x16x32_bf16 v[144:147], a[80:83], a[112:115], v[144:147]
    v_mfma_f32_16x16x32_bf16 v[148:151], a[80:83], a[116:119], v[148:151]
    ds_read_b64_tr_b16 a[154:155], v200 offset:33792
    v_mfma_f32_16x16x32_bf16 v[152:155], a[80:83], a[120:123], v[152:155]
    buffer_load_dwordx4 a[244:247], v240, s[8:11], s53 offen offset:2048 sc1
    v_mfma_f32_16x16x32_bf16 v[156:159], a[80:83], a[124:127], v[156:159]
    ds_read_b64_tr_b16 a[156:157], v201 offset:32768
    v_mfma_f32_16x16x32_bf16 v[160:163], a[84:87], a[96:99], v[160:163]
    ds_read_b128 a[80:83], v192 offset:40960
    v_mfma_f32_16x16x32_bf16 v[164:167], a[84:87], a[100:103], v[164:167]
    ds_read_b64_tr_b16 a[158:159], v201 offset:33792
    v_mfma_f32_16x16x32_bf16 v[168:171], a[84:87], a[104:107], v[168:171]
    buffer_load_dwordx4 a[248:251], v240, s[8:11], s52 offen offset:3072 sc1
    v_mfma_f32_16x16x32_bf16 v[172:175], a[84:87], a[108:111], v[172:175]
    v_mfma_f32_16x16x32_bf16 v[176:179], a[84:87], a[112:115], v[176:179]
    v_mfma_f32_16x16x32_bf16 v[180:183], a[84:87], a[116:119], v[180:183]
    buffer_load_dwordx4 a[252:255], v240, s[8:11], s53 offen offset:3072 sc1
    v_mfma_f32_16x16x32_bf16 v[184:187], a[84:87], a[120:123], v[184:187]
    v_mfma_f32_16x16x32_bf16 v[188:191], a[84:87], a[124:127], v[188:191]
    s_add_u32 m0, s3, 16384
    s_add_u32 s54, s73, 524288
    v_mfma_f32_16x16x32_bf16 a[0:3], a[88:91], a[96:99], a[0:3]
    ds_read_b128 a[84:87], v193 offset:41472
    v_mfma_f32_16x16x32_bf16 a[4:7], a[88:91], a[100:103], a[4:7]
    buffer_load_dwordx4 v246, s[28:31], s54 offen offset:0 lds
    v_mfma_f32_16x16x32_bf16 a[8:11], a[88:91], a[104:107], a[8:11]
    v_mfma_f32_16x16x32_bf16 a[12:15], a[88:91], a[108:111], a[12:15]
    v_mfma_f32_16x16x32_bf16 a[16:19], a[88:91], a[112:115], a[16:19]
    buffer_load_dwordx4 v247, s[28:31], s54 offen offset:1024 lds
    v_mfma_f32_16x16x32_bf16 a[20:23], a[88:91], a[116:119], a[20:23]
    v_mfma_f32_16x16x32_bf16 a[24:27], a[88:91], a[120:123], a[24:27]
    v_mfma_f32_16x16x32_bf16 a[28:31], a[88:91], a[124:127], a[28:31]
    buffer_load_dwordx4 v248, s[28:31], s54 offen offset:2048 lds
    v_mfma_f32_16x16x32_bf16 a[32:35], a[92:95], a[96:99], a[32:35]
    ds_read_b128 a[88:91], v192 offset:43008
    v_mfma_f32_16x16x32_bf16 a[36:39], a[92:95], a[100:103], a[36:39]
    v_mfma_f32_16x16x32_bf16 a[40:43], a[92:95], a[104:107], a[40:43]
    buffer_load_dwordx4 v249, s[28:31], s54 offen offset:3072 lds
    v_mfma_f32_16x16x32_bf16 a[44:47], a[92:95], a[108:111], a[44:47]
    v_mfma_f32_16x16x32_bf16 a[48:51], a[92:95], a[112:115], a[48:51]
    v_mfma_f32_16x16x32_bf16 a[52:55], a[92:95], a[116:119], a[52:55]
    v_mfma_f32_16x16x32_bf16 a[56:59], a[92:95], a[120:123], a[56:59]
    v_mfma_f32_16x16x32_bf16 a[60:63], a[92:95], a[124:127], a[60:63]
    s_waitcnt lgkmcnt(2)
    v_mfma_f32_16x16x32_bf16 v[128:131], a[80:83], a[128:131], v[128:131]
    ds_read_b128 a[92:95], v193 offset:43520
    v_mfma_f32_16x16x32_bf16 v[132:135], a[80:83], a[132:135], v[132:135]
    s_add_u32 m0, s3, 32768
    s_add_u32 s54, s73, 1048576
    s_lshl_b32 s48, s45, 20
    s_add_u32 s48, s48, 0x1002000
    v_mfma_f32_16x16x32_bf16 v[136:139], a[80:83], a[136:139], v[136:139]
    s_lshl_b32 s49, s46, 17
    s_add_u32 s48, s48, s49
    v_mfma_f32_16x16x32_bf16 v[140:143], a[80:83], a[140:143], v[140:143]
    buffer_load_dwordx4 v246, s[28:31], s54 offen offset:0 lds
    v_mfma_f32_16x16x32_bf16 v[144:147], a[80:83], a[144:147], v[144:147]
    s_and_b32 s49, s44, 1
    s_lshl_b32 s49, s49, 16
    v_mfma_f32_16x16x32_bf16 v[148:151], a[80:83], a[148:151], v[148:151]
    s_add_u32 s48, s48, s49
    s_mov_b32 s49, 1024
    v_mfma_f32_16x16x32_bf16 v[152:155], a[80:83], a[152:155], v[152:155]
    v_and_b32 v250, 15, v241
    v_lshlrev_b32 v250, 4, v250
    v_mfma_f32_16x16x32_bf16 v[156:159], a[80:83], a[156:159], v[156:159]
    buffer_load_dwordx4 v247, s[28:31], s54 offen offset:1024 lds
    v_bfe_u32 v252, v241, 4, 1
    v_lshl_add_u32 v250, v252, 9, v250
    s_waitcnt lgkmcnt(2)
    v_mfma_f32_16x16x32_bf16 v[160:163], a[84:87], a[128:131], v[160:163]
    v_lshrrev_b32 v252, 5, v241
    v_lshl_add_u32 v250, v252, 12, v250
    v_mfma_f32_16x16x32_bf16 v[164:167], a[84:87], a[132:135], v[164:167]
    v_mfma_f32_16x16x32_bf16 v[168:171], a[84:87], a[136:139], v[168:171]
    v_mfma_f32_16x16x32_bf16 v[172:175], a[84:87], a[140:143], v[172:175]
    buffer_load_dwordx4 v248, s[28:31], s54 offen offset:2048 lds
    v_mfma_f32_16x16x32_bf16 v[176:179], a[84:87], a[144:147], v[176:179]
    v_cvt_pk_bf16_f32 v192, v128, v129
    v_cvt_pk_bf16_f32 v193, v130, v131
    v_cvt_pk_bf16_f32 v194, v160, v161
    v_mfma_f32_16x16x32_bf16 v[180:183], a[84:87], a[148:151], v[180:183]
    v_cvt_pk_bf16_f32 v195, v162, v163
    v_cvt_pk_bf16_f32 v196, v132, v133
    v_cvt_pk_bf16_f32 v197, v134, v135
    v_mfma_f32_16x16x32_bf16 v[184:187], a[84:87], a[152:155], v[184:187]
    v_cvt_pk_bf16_f32 v198, v164, v165
    v_cvt_pk_bf16_f32 v199, v166, v167
    v_cvt_pk_bf16_f32 v200, v136, v137
    v_mfma_f32_16x16x32_bf16 v[188:191], a[84:87], a[156:159], v[188:191]
    buffer_load_dwordx4 v249, s[28:31], s54 offen offset:3072 lds
    v_cvt_pk_bf16_f32 v201, v138, v139
    v_cvt_pk_bf16_f32 v202, v168, v169
    s_waitcnt lgkmcnt(1)
    v_mfma_f32_16x16x32_bf16 a[0:3], a[88:91], a[128:131], a[0:3]
    v_cvt_pk_bf16_f32 v203, v170, v171
    v_cvt_pk_bf16_f32 v204, v140, v141
    v_cvt_pk_bf16_f32 v205, v142, v143
    v_mfma_f32_16x16x32_bf16 a[4:7], a[88:91], a[132:135], a[4:7]
    v_cvt_pk_bf16_f32 v206, v172, v173
    v_cvt_pk_bf16_f32 v207, v174, v175
    v_cvt_pk_bf16_f32 v208, v144, v145
    v_mfma_f32_16x16x32_bf16 a[8:11], a[88:91], a[136:139], a[8:11]
    v_cvt_pk_bf16_f32 v209, v146, v147
    v_cvt_pk_bf16_f32 v210, v176, v177
    v_cvt_pk_bf16_f32 v211, v178, v179
    v_mfma_f32_16x16x32_bf16 a[12:15], a[88:91], a[140:143], a[12:15]
    v_cvt_pk_bf16_f32 v212, v148, v149
    v_cvt_pk_bf16_f32 v213, v150, v151
    v_cvt_pk_bf16_f32 v214, v180, v181
    v_mfma_f32_16x16x32_bf16 a[16:19], a[88:91], a[144:147], a[16:19]
    v_cvt_pk_bf16_f32 v215, v182, v183
    v_cvt_pk_bf16_f32 v216, v152, v153
    v_cvt_pk_bf16_f32 v217, v154, v155
    v_mfma_f32_16x16x32_bf16 a[20:23], a[88:91], a[148:151], a[20:23]
    v_cvt_pk_bf16_f32 v218, v184, v185
    v_cvt_pk_bf16_f32 v219, v186, v187
    v_cvt_pk_bf16_f32 v220, v156, v157
    v_mfma_f32_16x16x32_bf16 a[24:27], a[88:91], a[152:155], a[24:27]
    v_cvt_pk_bf16_f32 v221, v158, v159
    v_cvt_pk_bf16_f32 v222, v188, v189
    v_cvt_pk_bf16_f32 v223, v190, v191
    v_mfma_f32_16x16x32_bf16 a[28:31], a[88:91], a[156:159], a[28:31]
    s_waitcnt lgkmcnt(0)
    v_mfma_f32_16x16x32_bf16 a[32:35], a[92:95], a[128:131], a[32:35]
    v_mfma_f32_16x16x32_bf16 a[36:39], a[92:95], a[132:135], a[36:39]
    v_mfma_f32_16x16x32_bf16 a[40:43], a[92:95], a[136:139], a[40:43]
    v_mfma_f32_16x16x32_bf16 a[44:47], a[92:95], a[140:143], a[44:47]
    v_mfma_f32_16x16x32_bf16 a[48:51], a[92:95], a[144:147], a[48:51]
    v_accvgpr_read_b32 v128, a0
    v_accvgpr_read_b32 v129, a1
    v_accvgpr_read_b32 v130, a2
    v_mfma_f32_16x16x32_bf16 a[52:55], a[92:95], a[148:151], a[52:55]
    v_accvgpr_read_b32 v131, a3
    v_accvgpr_read_b32 v132, a32
    v_accvgpr_read_b32 v133, a33
    v_mfma_f32_16x16x32_bf16 a[56:59], a[92:95], a[152:155], a[56:59]
    v_accvgpr_read_b32 v134, a34
    v_accvgpr_read_b32 v135, a35
    v_cvt_pk_bf16_f32 v224, v128, v129
    v_mfma_f32_16x16x32_bf16 a[60:63], a[92:95], a[156:159], a[60:63]
    v_cvt_pk_bf16_f32 v225, v130, v131
    v_cvt_pk_bf16_f32 v226, v132, v133
    v_cvt_pk_bf16_f32 v227, v134, v135
    v_mfma_f32_16x16x32_bf16 v[0:3], a[64:67], a[128:131], v[0:3]
    v_accvgpr_read_b32 v136, a4
    v_accvgpr_read_b32 v137, a5
    v_accvgpr_read_b32 v138, a6
    v_mfma_f32_16x16x32_bf16 v[4:7], a[64:67], a[132:135], v[4:7]
    v_accvgpr_read_b32 v139, a7
    v_accvgpr_read_b32 v140, a36
    v_accvgpr_read_b32 v141, a37
    v_mfma_f32_16x16x32_bf16 v[8:11], a[64:67], a[136:139], v[8:11]
    v_accvgpr_read_b32 v142, a38
    v_accvgpr_read_b32 v143, a39
    v_cvt_pk_bf16_f32 v228, v136, v137
    v_mfma_f32_16x16x32_bf16 v[12:15], a[64:67], a[140:143], v[12:15]
    v_cvt_pk_bf16_f32 v229, v138, v139
    v_cvt_pk_bf16_f32 v230, v140, v141
    v_cvt_pk_bf16_f32 v231, v142, v143
    v_mfma_f32_16x16x32_bf16 v[16:19], a[64:67], a[144:147], v[16:19]
    v_accvgpr_read_b32 v144, a8
    v_accvgpr_read_b32 v145, a9
    v_accvgpr_read_b32 v146, a10
    v_mfma_f32_16x16x32_bf16 v[20:23], a[64:67], a[148:151], v[20:23]
    v_accvgpr_read_b32 v147, a11
    v_accvgpr_read_b32 v148, a40
    v_accvgpr_read_b32 v149, a41
    v_mfma_f32_16x16x32_bf16 v[24:27], a[64:67], a[152:155], v[24:27]
    v_accvgpr_read_b32 v150, a42
    v_accvgpr_read_b32 v151, a43
    v_cvt_pk_bf16_f32 v232, v144, v145
    v_mfma_f32_16x16x32_bf16 v[28:31], a[64:67], a[156:159], v[28:31]
    v_cvt_pk_bf16_f32 v233, v146, v147
    v_cvt_pk_bf16_f32 v234, v148, v149
    v_cvt_pk_bf16_f32 v235, v150, v151
    v_mfma_f32_16x16x32_bf16 v[32:35], a[68:71], a[128:131], v[32:35]
    v_accvgpr_read_b32 v152, a12
    v_accvgpr_read_b32 v153, a13
    v_accvgpr_read_b32 v154, a14
    v_mfma_f32_16x16x32_bf16 v[36:39], a[68:71], a[132:135], v[36:39]
    v_accvgpr_read_b32 v155, a15
    v_accvgpr_read_b32 v156, a44
    v_accvgpr_read_b32 v157, a45
    v_mfma_f32_16x16x32_bf16 v[40:43], a[68:71], a[136:139], v[40:43]
    v_accvgpr_read_b32 v158, a46
    v_accvgpr_read_b32 v159, a47
    v_cvt_pk_bf16_f32 v236, v152, v153
    v_mfma_f32_16x16x32_bf16 v[44:47], a[68:71], a[140:143], v[44:47]
    v_cvt_pk_bf16_f32 v237, v154, v155
    v_cvt_pk_bf16_f32 v238, v156, v157
    v_cvt_pk_bf16_f32 v239, v158, v159
    v_mfma_f32_16x16x32_bf16 v[48:51], a[68:71], a[144:147], v[48:51]
    v_accvgpr_read_b32 v128, a16
    v_accvgpr_read_b32 v129, a17
    v_accvgpr_read_b32 v130, a18
    v_mfma_f32_16x16x32_bf16 v[52:55], a[68:71], a[148:151], v[52:55]
    v_accvgpr_read_b32 v131, a19
    v_accvgpr_read_b32 v132, a48
    v_accvgpr_read_b32 v133, a49
    v_mfma_f32_16x16x32_bf16 v[56:59], a[68:71], a[152:155], v[56:59]
    v_accvgpr_read_b32 v134, a50
    v_accvgpr_read_b32 v135, a51
    v_cvt_pk_bf16_f32 v176, v128, v129
    v_mfma_f32_16x16x32_bf16 v[60:63], a[68:71], a[156:159], v[60:63]
    v_cvt_pk_bf16_f32 v177, v130, v131
    v_cvt_pk_bf16_f32 v178, v132, v133
    v_cvt_pk_bf16_f32 v179, v134, v135
    s_add_u32 s55, s48, 49152
    s_mul_i32 s54, s49, 2
    s_add_u32 s55, s55, s54
    v_mfma_f32_16x16x32_bf16 v[64:67], a[72:75], a[128:131], v[64:67]
    buffer_store_dwordx4 v[176:179], v250, s[8:11], s55 offen offset:0 sc1
    v_accvgpr_read_b32 v136, a20
    v_accvgpr_read_b32 v137, a21
    v_mfma_f32_16x16x32_bf16 v[68:71], a[72:75], a[132:135], v[68:71]
    v_accvgpr_read_b32 v138, a22
    v_accvgpr_read_b32 v139, a23
    v_accvgpr_read_b32 v140, a52
    v_mfma_f32_16x16x32_bf16 v[72:75], a[72:75], a[136:139], v[72:75]
    v_accvgpr_read_b32 v141, a53
    v_accvgpr_read_b32 v142, a54
    v_accvgpr_read_b32 v143, a55
    v_mfma_f32_16x16x32_bf16 v[76:79], a[72:75], a[140:143], v[76:79]
    v_cvt_pk_bf16_f32 v180, v136, v137
    v_cvt_pk_bf16_f32 v181, v138, v139
    v_cvt_pk_bf16_f32 v182, v140, v141
    v_mfma_f32_16x16x32_bf16 v[80:83], a[72:75], a[144:147], v[80:83]
    v_cvt_pk_bf16_f32 v183, v142, v143
    s_add_u32 s55, s48, 49152
    s_mul_i32 s54, s49, 2
    s_add_u32 s55, s55, s54
    v_mfma_f32_16x16x32_bf16 v[84:87], a[72:75], a[148:151], v[84:87]
    buffer_store_dwordx4 v[180:183], v250, s[8:11], s55 offen offset:256 sc1
    v_accvgpr_read_b32 v144, a24
    v_accvgpr_read_b32 v145, a25
    v_mfma_f32_16x16x32_bf16 v[88:91], a[72:75], a[152:155], v[88:91]
    v_accvgpr_read_b32 v146, a26
    v_accvgpr_read_b32 v147, a27
    v_accvgpr_read_b32 v148, a56
    v_mfma_f32_16x16x32_bf16 v[92:95], a[72:75], a[156:159], v[92:95]
    v_accvgpr_read_b32 v149, a57
    v_accvgpr_read_b32 v150, a58
    v_accvgpr_read_b32 v151, a59
    v_mfma_f32_16x16x32_bf16 v[96:99], a[76:79], a[128:131], v[96:99]
    v_cvt_pk_bf16_f32 v184, v144, v145
    v_cvt_pk_bf16_f32 v185, v146, v147
    v_cvt_pk_bf16_f32 v186, v148, v149
    v_mfma_f32_16x16x32_bf16 v[100:103], a[76:79], a[132:135], v[100:103]
    v_cvt_pk_bf16_f32 v187, v150, v151
    s_add_u32 s55, s48, 49152
    s_mul_i32 s54, s49, 3
    s_add_u32 s55, s55, s54
    v_mfma_f32_16x16x32_bf16 v[104:107], a[76:79], a[136:139], v[104:107]
    buffer_store_dwordx4 v[184:187], v250, s[8:11], s55 offen offset:0 sc1
    v_accvgpr_read_b32 v152, a28
    v_accvgpr_read_b32 v153, a29
    v_mfma_f32_16x16x32_bf16 v[108:111], a[76:79], a[140:143], v[108:111]
    v_accvgpr_read_b32 v154, a30
    v_accvgpr_read_b32 v155, a31
    v_accvgpr_read_b32 v156, a60
    v_mfma_f32_16x16x32_bf16 v[112:115], a[76:79], a[144:147], v[112:115]
    v_accvgpr_read_b32 v157, a61
    v_accvgpr_read_b32 v158, a62
    v_accvgpr_read_b32 v159, a63
    v_mfma_f32_16x16x32_bf16 v[116:119], a[76:79], a[148:151], v[116:119]
    v_cvt_pk_bf16_f32 v188, v152, v153
    v_cvt_pk_bf16_f32 v189, v154, v155
    v_cvt_pk_bf16_f32 v190, v156, v157
    v_mfma_f32_16x16x32_bf16 v[120:123], a[76:79], a[152:155], v[120:123]
    v_cvt_pk_bf16_f32 v191, v158, v159
    s_add_u32 s55, s48, 49152
    s_mul_i32 s54, s49, 3
    s_add_u32 s55, s55, s54
    v_mfma_f32_16x16x32_bf16 v[124:127], a[76:79], a[156:159], v[124:127]
    buffer_store_dwordx4 v[188:191], v250, s[8:11], s55 offen offset:256 sc1
    v_cvt_pk_bf16_f32 v128, v0, v1
    v_cvt_pk_bf16_f32 v129, v2, v3
    v_cvt_pk_bf16_f32 v130, v32, v33
    v_cvt_pk_bf16_f32 v131, v34, v35
    v_cvt_pk_bf16_f32 v132, v4, v5
    v_cvt_pk_bf16_f32 v133, v6, v7
    v_cvt_pk_bf16_f32 v134, v36, v37
    v_cvt_pk_bf16_f32 v135, v38, v39
    v_cvt_pk_bf16_f32 v136, v8, v9
    v_cvt_pk_bf16_f32 v137, v10, v11
    v_cvt_pk_bf16_f32 v138, v40, v41
    v_cvt_pk_bf16_f32 v139, v42, v43
    v_cvt_pk_bf16_f32 v140, v12, v13
    v_cvt_pk_bf16_f32 v141, v14, v15
    v_cvt_pk_bf16_f32 v142, v44, v45
    v_cvt_pk_bf16_f32 v143, v46, v47
    v_cvt_pk_bf16_f32 v144, v16, v17
    v_cvt_pk_bf16_f32 v145, v18, v19
    v_cvt_pk_bf16_f32 v146, v48, v49
    v_cvt_pk_bf16_f32 v147, v50, v51
    v_cvt_pk_bf16_f32 v148, v20, v21
    v_cvt_pk_bf16_f32 v149, v22, v23
    v_cvt_pk_bf16_f32 v150, v52, v53
    v_cvt_pk_bf16_f32 v151, v54, v55
    v_cvt_pk_bf16_f32 v152, v24, v25
    v_cvt_pk_bf16_f32 v153, v26, v27
    v_cvt_pk_bf16_f32 v154, v56, v57
    v_cvt_pk_bf16_f32 v155, v58, v59
    v_cvt_pk_bf16_f32 v156, v28, v29
    v_cvt_pk_bf16_f32 v157, v30, v31
    v_cvt_pk_bf16_f32 v158, v60, v61
    v_cvt_pk_bf16_f32 v159, v62, v63
    v_cvt_pk_bf16_f32 v160, v64, v65
    v_cvt_pk_bf16_f32 v161, v66, v67
    v_cvt_pk_bf16_f32 v162, v96, v97
    v_cvt_pk_bf16_f32 v163, v98, v99
    v_cvt_pk_bf16_f32 v164, v68, v69
    v_cvt_pk_bf16_f32 v165, v70, v71
    v_cvt_pk_bf16_f32 v166, v100, v101
    v_cvt_pk_bf16_f32 v167, v102, v103
    v_cvt_pk_bf16_f32 v168, v72, v73
    v_cvt_pk_bf16_f32 v169, v74, v75
    v_cvt_pk_bf16_f32 v170, v104, v105
    v_cvt_pk_bf16_f32 v171, v106, v107
    v_cvt_pk_bf16_f32 v172, v76, v77
    v_cvt_pk_bf16_f32 v173, v78, v79
    v_cvt_pk_bf16_f32 v174, v108, v109
    v_cvt_pk_bf16_f32 v175, v110, v111
    v_cvt_pk_bf16_f32 v176, v80, v81
    v_cvt_pk_bf16_f32 v177, v82, v83
    v_cvt_pk_bf16_f32 v178, v112, v113
    v_cvt_pk_bf16_f32 v179, v114, v115
    v_cvt_pk_bf16_f32 v180, v84, v85
    v_cvt_pk_bf16_f32 v181, v86, v87
    v_cvt_pk_bf16_f32 v182, v116, v117
    v_cvt_pk_bf16_f32 v183, v118, v119
    v_cvt_pk_bf16_f32 v184, v88, v89
    v_cvt_pk_bf16_f32 v185, v90, v91
    v_cvt_pk_bf16_f32 v186, v120, v121
    v_cvt_pk_bf16_f32 v187, v122, v123
    v_cvt_pk_bf16_f32 v188, v92, v93
    v_cvt_pk_bf16_f32 v189, v94, v95
    v_cvt_pk_bf16_f32 v190, v124, v125
    v_cvt_pk_bf16_f32 v191, v126, v127
L_ka_q:
    s_and_b32 s52, s2, 31
    v_and_b32 v253, 7, v241
    v_lshl_add_u32 v253, v253, 5, s52
    v_lshlrev_b32 v253, 7, v253
    v_add_u32 v253, 4, v253
    s_waitcnt vmcnt(20)
    s_barrier
    ds_read_b64_tr_b16 a[160:161], v242 offset:0
    ds_read_b64_tr_b16 a[162:163], v242 offset:1024
    ds_read_b64_tr_b16 a[164:165], v243 offset:0
    ds_read_b64_tr_b16 a[166:167], v243 offset:1024
    ds_read_b64_tr_b16 a[168:169], v244 offset:0
    ds_read_b64_tr_b16 a[170:171], v244 offset:1024
    ds_read_b64_tr_b16 a[172:173], v245 offset:0
    ds_read_b64_tr_b16 a[174:175], v245 offset:1024
    s_waitcnt vmcnt(30)
    s_waitcnt lgkmcnt(0)
    v_mfma_f32_32x32x16_bf16 v[0:15], a[160:163], a[192:195], 0
    ds_read_b64_tr_b16 a[176:177], v242 offset:4096
    ds_read_b64_tr_b16 a[178:179], v242 offset:5120
    v_mfma_f32_32x32x16_bf16 v[64:79], a[160:163], a[196:199], 0
    ds_read_b64_tr_b16 a[180:181], v243 offset:4096
    ds_read_b64_tr_b16 a[182:183], v243 offset:5120
    v_mfma_f32_32x32x16_bf16 v[16:31], a[164:167], a[192:195], 0
    ds_read_b64_tr_b16 a[184:185], v244 offset:4096
    ds_read_b64_tr_b16 a[186:187], v244 offset:5120
    v_mfma_f32_32x32x16_bf16 v[80:95], a[164:167], a[196:199], 0
    ds_read_b64_tr_b16 a[188:189], v245 offset:4096
    ds_read_b64_tr_b16 a[190:191], v245 offset:5120
    v_mfma_f32_32x32x16_bf16 v[32:47], a[168:171], a[192:195], 0
    s_mov_b32 s6, s48
    buffer_store_dwordx4 v[128:131], v250, s[8:11], s48 offen offset:0 sc1
    v_mfma_f32_32x32x16_bf16 v[96:111], a[168:171], a[196:199], 0
    v_mfma_f32_32x32x16_bf16 v[48:63], a[172:175], a[192:195], 0
    v_mfma_f32_32x32x16_bf16 v[112:127], a[172:175], a[196:199], 0
    s_add_u32 s52, s71, 8192
    s_add_u32 s53, s72, 8192
    buffer_load_dwordx4 a[192:195], v240, s[8:11], s52 offen offset:0 sc1
    buffer_load_dwordx4 a[196:199], v240, s[8:11], s53 offen offset:0 sc1
    s_waitcnt vmcnt(31)
    s_waitcnt lgkmcnt(0)
    v_mfma_f32_32x32x16_bf16 v[0:15], a[176:179], a[200:203], v[0:15]
    ds_read_b64_tr_b16 a[160:161], v242 offset:8192
    ds_read_b64_tr_b16 a[162:163], v242 offset:9216
    v_mfma_f32_32x32x16_bf16 v[64:79], a[176:179], a[204:207], v[64:79]
    ds_read_b64_tr_b16 a[164:165], v243 offset:8192
    ds_read_b64_tr_b16 a[166:167], v243 offset:9216
    v_mfma_f32_32x32x16_bf16 v[16:31], a[180:183], a[200:203], v[16:31]
    ds_read_b64_tr_b16 a[168:169], v244 offset:8192
    ds_read_b64_tr_b16 a[170:171], v244 offset:9216
    v_mfma_f32_32x32x16_bf16 v[80:95], a[180:183], a[204:207], v[80:95]
    ds_read_b64_tr_b16 a[172:173], v245 offset:8192
    ds_read_b64_tr_b16 a[174:175], v245 offset:9216
    v_mfma_f32_32x32x16_bf16 v[32:47], a[184:187], a[200:203], v[32:47]
    buffer_store_dwordx4 v[132:135], v250, s[8:11], s48 offen offset:256 sc1
    v_mfma_f32_32x32x16_bf16 v[96:111], a[184:187], a[204:207], v[96:111]
    v_mfma_f32_32x32x16_bf16 v[48:63], a[188:191], a[200:203], v[48:63]
    v_mfma_f32_32x32x16_bf16 v[112:127], a[188:191], a[204:207], v[112:127]
    s_add_u32 s52, s71, 8192
    s_add_u32 s53, s72, 8192
    buffer_load_dwordx4 a[200:203], v240, s[8:11], s52 offen offset:1024 sc1
    buffer_load_dwordx4 a[204:207], v240, s[8:11], s53 offen offset:1024 sc1
    s_waitcnt vmcnt(32)
    s_waitcnt lgkmcnt(0)
    v_mfma_f32_32x32x16_bf16 v[0:15], a[160:163], a[208:211], v[0:15]
    ds_read_b64_tr_b16 a[176:177], v242 offset:12288
    ds_read_b64_tr_b16 a[178:179], v242 offset:13312
    v_mfma_f32_32x32x16_bf16 v[64:79], a[160:163], a[212:215], v[64:79]
    ds_read_b64_tr_b16 a[180:181], v243 offset:12288
    ds_read_b64_tr_b16 a[182:183], v243 offset:13312
    v_mfma_f32_32x32x16_bf16 v[16:31], a[164:167], a[208:211], v[16:31]
    ds_read_b64_tr_b16 a[184:185], v244 offset:12288
    ds_read_b64_tr_b16 a[186:187], v244 offset:13312
    v_mfma_f32_32x32x16_bf16 v[80:95], a[164:167], a[212:215], v[80:95]
    ds_read_b64_tr_b16 a[188:189], v245 offset:12288
    ds_read_b64_tr_b16 a[190:191], v245 offset:13312
    v_mfma_f32_32x32x16_bf16 v[32:47], a[168:171], a[208:211], v[32:47]
    s_add_u32 s48, s48, s49
    buffer_store_dwordx4 v[136:139], v250, s[8:11], s48 offen offset:0 sc1
    v_mfma_f32_32x32x16_bf16 v[96:111], a[168:171], a[212:215], v[96:111]
    v_mfma_f32_32x32x16_bf16 v[48:63], a[172:175], a[208:211], v[48:63]
    v_mfma_f32_32x32x16_bf16 v[112:127], a[172:175], a[212:215], v[112:127]
    s_add_u32 s52, s71, 8192
    s_add_u32 s53, s72, 8192
    buffer_load_dwordx4 a[208:211], v240, s[8:11], s52 offen offset:2048 sc1
    buffer_load_dwordx4 a[212:215], v240, s[8:11], s53 offen offset:2048 sc1
    s_waitcnt vmcnt(33)
    s_waitcnt lgkmcnt(0)
    s_waitcnt vmcnt(17)
    s_barrier
    v_mfma_f32_32x32x16_bf16 v[0:15], a[176:179], a[216:219], v[0:15]
    ds_read_b64_tr_b16 a[160:161], v242 offset:16384
    ds_read_b64_tr_b16 a[162:163], v242 offset:17408
    v_mfma_f32_32x32x16_bf16 v[64:79], a[176:179], a[220:223], v[64:79]
    ds_read_b64_tr_b16 a[164:165], v243 offset:16384
    ds_read_b64_tr_b16 a[166:167], v243 offset:17408
    v_mfma_f32_32x32x16_bf16 v[16:31], a[180:183], a[216:219], v[16:31]
    ds_read_b64_tr_b16 a[168:169], v244 offset:16384
    ds_read_b64_tr_b16 a[170:171], v244 offset:17408
    v_mfma_f32_32x32x16_bf16 v[80:95], a[180:183], a[220:223], v[80:95]
    ds_read_b64_tr_b16 a[172:173], v245 offset:16384
    ds_read_b64_tr_b16 a[174:175], v245 offset:17408
    v_mfma_f32_32x32x16_bf16 v[32:47], a[184:187], a[216:219], v[32:47]
    buffer_store_dwordx4 v[140:143], v250, s[8:11], s48 offen offset:256 sc1
    v_mfma_f32_32x32x16_bf16 v[96:111], a[184:187], a[220:223], v[96:111]
    s_add_u32 m0, s3, 0
    s_add_u32 s54, s73, 1572864
    buffer_load_dwordx4 v246, s[28:31], s54 offen offset:0 lds
    buffer_load_dwordx4 v247, s[28:31], s54 offen offset:1024 lds
    buffer_load_dwordx4 v248, s[28:31], s54 offen offset:2048 lds
    buffer_load_dwordx4 v249, s[28:31], s54 offen offset:3072 lds
    v_mfma_f32_32x32x16_bf16 v[48:63], a[188:191], a[216:219], v[48:63]
    v_mfma_f32_32x32x16_bf16 v[112:127], a[188:191], a[220:223], v[112:127]
    s_add_u32 s52, s71, 8192
    s_add_u32 s53, s72, 8192
    buffer_load_dwordx4 a[216:219], v240, s[8:11], s52 offen offset:3072 sc1
    buffer_load_dwordx4 a[220:223], v240, s[8:11], s53 offen offset:3072 sc1
    s_waitcnt vmcnt(34)
    s_waitcnt lgkmcnt(0)
    v_mfma_f32_32x32x16_bf16 v[0:15], a[160:163], a[224:227], v[0:15]
    ds_read_b64_tr_b16 a[176:177], v242 offset:20480
    ds_read_b64_tr_b16 a[178:179], v242 offset:21504
    v_mfma_f32_32x32x16_bf16 v[64:79], a[160:163], a[228:231], v[64:79]
    ds_read_b64_tr_b16 a[180:181], v243 offset:20480
    ds_read_b64_tr_b16 a[182:183], v243 offset:21504
    v_mfma_f32_32x32x16_bf16 v[16:31], a[164:167], a[224:227], v[16:31]
    ds_read_b64_tr_b16 a[184:185], v244 offset:20480
    ds_read_b64_tr_b16 a[186:187], v244 offset:21504
    v_mfma_f32_32x32x16_bf16 v[80:95], a[164:167], a[228:231], v[80:95]
    ds_read_b64_tr_b16 a[188:189], v245 offset:20480
    ds_read_b64_tr_b16 a[190:191], v245 offset:21504
    v_mfma_f32_32x32x16_bf16 v[32:47], a[168:171], a[224:227], v[32:47]
    s_add_u32 s48, s48, s49
    buffer_store_dwordx4 v[144:147], v250, s[8:11], s48 offen offset:0 sc1
    v_mfma_f32_32x32x16_bf16 v[96:111], a[168:171], a[228:231], v[96:111]
    v_mfma_f32_32x32x16_bf16 v[48:63], a[172:175], a[224:227], v[48:63]
    v_mfma_f32_32x32x16_bf16 v[112:127], a[172:175], a[228:231], v[112:127]
    s_add_u32 s52, s71, 12288
    s_add_u32 s53, s72, 12288
    buffer_load_dwordx4 a[224:227], v240, s[8:11], s52 offen offset:0 sc1
    buffer_load_dwordx4 a[228:231], v240, s[8:11], s53 offen offset:0 sc1
    s_waitcnt vmcnt(35)
    s_waitcnt lgkmcnt(0)
    v_mfma_f32_32x32x16_bf16 v[0:15], a[176:179], a[232:235], v[0:15]
    ds_read_b64_tr_b16 a[160:161], v242 offset:24576
    ds_read_b64_tr_b16 a[162:163], v242 offset:25600
    v_mfma_f32_32x32x16_bf16 v[64:79], a[176:179], a[236:239], v[64:79]
    ds_read_b64_tr_b16 a[164:165], v243 offset:24576
    ds_read_b64_tr_b16 a[166:167], v243 offset:25600
    v_mfma_f32_32x32x16_bf16 v[16:31], a[180:183], a[232:235], v[16:31]
    ds_read_b64_tr_b16 a[168:169], v244 offset:24576
    ds_read_b64_tr_b16 a[170:171], v244 offset:25600
    v_mfma_f32_32x32x16_bf16 v[80:95], a[180:183], a[236:239], v[80:95]
    ds_read_b64_tr_b16 a[172:173], v245 offset:24576
    ds_read_b64_tr_b16 a[174:175], v245 offset:25600
    v_mfma_f32_32x32x16_bf16 v[32:47], a[184:187], a[232:235], v[32:47]
    buffer_store_dwordx4 v[148:151], v250, s[8:11], s48 offen offset:256 sc1
    v_mfma_f32_32x32x16_bf16 v[96:111], a[184:187], a[236:239], v[96:111]
    v_mfma_f32_32x32x16_bf16 v[48:63], a[188:191], a[232:235], v[48:63]
    v_mfma_f32_32x32x16_bf16 v[112:127], a[188:191], a[236:239], v[112:127]
    s_add_u32 s52, s71, 12288
    s_add_u32 s53, s72, 12288
    buffer_load_dwordx4 a[232:235], v240, s[8:11], s52 offen offset:1024 sc1
    buffer_load_dwordx4 a[236:239], v240, s[8:11], s53 offen offset:1024 sc1
    s_waitcnt vmcnt(36)
    s_waitcnt lgkmcnt(0)
    v_mfma_f32_32x32x16_bf16 v[0:15], a[160:163], a[240:243], v[0:15]
    ds_read_b64_tr_b16 a[176:177], v242 offset:28672
    ds_read_b64_tr_b16 a[178:179], v242 offset:29696
    v_mfma_f32_32x32x16_bf16 v[64:79], a[160:163], a[244:247], v[64:79]
    ds_read_b64_tr_b16 a[180:181], v243 offset:28672
    ds_read_b64_tr_b16 a[182:183], v243 offset:29696
    v_mfma_f32_32x32x16_bf16 v[16:31], a[164:167], a[240:243], v[16:31]
    ds_read_b64_tr_b16 a[184:185], v244 offset:28672
    ds_read_b64_tr_b16 a[186:187], v244 offset:29696
    v_mfma_f32_32x32x16_bf16 v[80:95], a[164:167], a[244:247], v[80:95]
    ds_read_b64_tr_b16 a[188:189], v245 offset:28672
    ds_read_b64_tr_b16 a[190:191], v245 offset:29696
    v_mfma_f32_32x32x16_bf16 v[32:47], a[168:171], a[240:243], v[32:47]
    s_add_u32 s48, s48, s49
    buffer_store_dwordx4 v[152:155], v250, s[8:11], s48 offen offset:0 sc1
    v_mfma_f32_32x32x16_bf16 v[96:111], a[168:171], a[244:247], v[96:111]
    v_mfma_f32_32x32x16_bf16 v[48:63], a[172:175], a[240:243], v[48:63]
    v_mfma_f32_32x32x16_bf16 v[112:127], a[172:175], a[244:247], v[112:127]
    s_add_u32 s52, s71, 12288
    s_add_u32 s53, s72, 12288
    buffer_load_dwordx4 a[240:243], v240, s[8:11], s52 offen offset:2048 sc1
    buffer_load_dwordx4 a[244:247], v240, s[8:11], s53 offen offset:2048 sc1
    s_waitcnt vmcnt(37)
    s_waitcnt lgkmcnt(0)
    s_waitcnt vmcnt(29)
    s_barrier
    v_mfma_f32_32x32x16_bf16 v[0:15], a[176:179], a[248:251], v[0:15]
    ds_read_b64_tr_b16 a[160:161], v242 offset:32768
    ds_read_b64_tr_b16 a[162:163], v242 offset:33792
    v_mfma_f32_32x32x16_bf16 v[64:79], a[176:179], a[252:255], v[64:79]
    ds_read_b64_tr_b16 a[164:165], v243 offset:32768
    ds_read_b64_tr_b16 a[166:167], v243 offset:33792
    v_mfma_f32_32x32x16_bf16 v[16:31], a[180:183], a[248:251], v[16:31]
    ds_read_b64_tr_b16 a[168:169], v244 offset:32768
    ds_read_b64_tr_b16 a[170:171], v244 offset:33792
    v_mfma_f32_32x32x16_bf16 v[80:95], a[180:183], a[252:255], v[80:95]
    ds_read_b64_tr_b16 a[172:173], v245 offset:32768
    ds_read_b64_tr_b16 a[174:175], v245 offset:33792
    v_mfma_f32_32x32x16_bf16 v[32:47], a[184:187], a[248:251], v[32:47]
    buffer_store_dwordx4 v[156:159], v250, s[8:11], s48 offen offset:256 sc1
    v_mfma_f32_32x32x16_bf16 v[96:111], a[184:187], a[252:255], v[96:111]
    s_add_u32 m0, s3, 16384
    s_add_u32 s54, s73, 2097152
    buffer_load_dwordx4 v246, s[28:31], s54 offen offset:0 lds
    buffer_load_dwordx4 v247, s[28:31], s54 offen offset:1024 lds
    buffer_load_dwordx4 v248, s[28:31], s54 offen offset:2048 lds
    buffer_load_dwordx4 v249, s[28:31], s54 offen offset:3072 lds
    v_mfma_f32_32x32x16_bf16 v[48:63], a[188:191], a[248:251], v[48:63]
    v_mfma_f32_32x32x16_bf16 v[112:127], a[188:191], a[252:255], v[112:127]
    s_add_u32 s52, s71, 12288
    s_add_u32 s53, s72, 12288
    buffer_load_dwordx4 a[248:251], v240, s[8:11], s52 offen offset:3072 sc1
    buffer_load_dwordx4 a[252:255], v240, s[8:11], s53 offen offset:3072 sc1
    s_waitcnt vmcnt(29)
    s_waitcnt lgkmcnt(0)
    v_mfma_f32_32x32x16_bf16 v[0:15], a[160:163], a[192:195], v[0:15]
    ds_read_b64_tr_b16 a[176:177], v242 offset:36864
    ds_read_b64_tr_b16 a[178:179], v242 offset:37888
    v_mfma_f32_32x32x16_bf16 v[64:79], a[160:163], a[196:199], v[64:79]
    ds_read_b64_tr_b16 a[180:181], v243 offset:36864
    ds_read_b64_tr_b16 a[182:183], v243 offset:37888
    v_mfma_f32_32x32x16_bf16 v[16:31], a[164:167], a[192:195], v[16:31]
    ds_read_b64_tr_b16 a[184:185], v244 offset:36864
    ds_read_b64_tr_b16 a[186:187], v244 offset:37888
    v_mfma_f32_32x32x16_bf16 v[80:95], a[164:167], a[196:199], v[80:95]
    ds_read_b64_tr_b16 a[188:189], v245 offset:36864
    ds_read_b64_tr_b16 a[190:191], v245 offset:37888
    v_mfma_f32_32x32x16_bf16 v[32:47], a[168:171], a[192:195], v[32:47]
    s_add_u32 s48, s6, 16384
    s_mov_b32 s6, s48
    buffer_store_dwordx4 v[160:163], v250, s[8:11], s48 offen offset:0 sc1
    v_mfma_f32_32x32x16_bf16 v[96:111], a[168:171], a[196:199], v[96:111]
    v_mfma_f32_32x32x16_bf16 v[48:63], a[172:175], a[192:195], v[48:63]
    v_mfma_f32_32x32x16_bf16 v[112:127], a[172:175], a[196:199], v[112:127]
    s_add_u32 s52, s71, 16384
    s_add_u32 s53, s72, 16384
    buffer_load_dwordx4 a[192:195], v240, s[8:11], s52 offen offset:0 sc1
    buffer_load_dwordx4 a[196:199], v240, s[8:11], s53 offen offset:0 sc1
    s_waitcnt vmcnt(29)
    s_waitcnt lgkmcnt(0)
    v_mfma_f32_32x32x16_bf16 v[0:15], a[176:179], a[200:203], v[0:15]
    ds_read_b64_tr_b16 a[160:161], v242 offset:40960
    ds_read_b64_tr_b16 a[162:163], v242 offset:41984
    v_mfma_f32_32x32x16_bf16 v[64:79], a[176:179], a[204:207], v[64:79]
    ds_read_b64_tr_b16 a[164:165], v243 offset:40960
    ds_read_b64_tr_b16 a[166:167], v243 offset:41984
    v_mfma_f32_32x32x16_bf16 v[16:31], a[180:183], a[200:203], v[16:31]
    ds_read_b64_tr_b16 a[168:169], v244 offset:40960
    ds_read_b64_tr_b16 a[170:171], v244 offset:41984
    v_mfma_f32_32x32x16_bf16 v[80:95], a[180:183], a[204:207], v[80:95]
    ds_read_b64_tr_b16 a[172:173], v245 offset:40960
    ds_read_b64_tr_b16 a[174:175], v245 offset:41984
    v_mfma_f32_32x32x16_bf16 v[32:47], a[184:187], a[200:203], v[32:47]
    buffer_store_dwordx4 v[164:167], v250, s[8:11], s48 offen offset:256 sc1
    v_mfma_f32_32x32x16_bf16 v[96:111], a[184:187], a[204:207], v[96:111]
    v_mfma_f32_32x32x16_bf16 v[48:63], a[188:191], a[200:203], v[48:63]
    v_mfma_f32_32x32x16_bf16 v[112:127], a[188:191], a[204:207], v[112:127]
    s_add_u32 s52, s71, 16384
    s_add_u32 s53, s72, 16384
    buffer_load_dwordx4 a[200:203], v240, s[8:11], s52 offen offset:1024 sc1
    buffer_load_dwordx4 a[204:207], v240, s[8:11], s53 offen offset:1024 sc1
    s_waitcnt vmcnt(29)
    s_waitcnt lgkmcnt(0)
    v_mfma_f32_32x32x16_bf16 v[0:15], a[160:163], a[208:211], v[0:15]
    ds_read_b64_tr_b16 a[176:177], v242 offset:45056
    ds_read_b64_tr_b16 a[178:179], v242 offset:46080
    v_mfma_f32_32x32x16_bf16 v[64:79], a[160:163], a[212:215], v[64:79]
    ds_read_b64_tr_b16 a[180:181], v243 offset:45056
    ds_read_b64_tr_b16 a[182:183], v243 offset:46080
    v_mfma_f32_32x32x16_bf16 v[16:31], a[164:167], a[208:211], v[16:31]
    ds_read_b64_tr_b16 a[184:185], v244 offset:45056
    ds_read_b64_tr_b16 a[186:187], v244 offset:46080
    v_mfma_f32_32x32x16_bf16 v[80:95], a[164:167], a[212:215], v[80:95]
    ds_read_b64_tr_b16 a[188:189], v245 offset:45056
    ds_read_b64_tr_b16 a[190:191], v245 offset:46080
    v_mfma_f32_32x32x16_bf16 v[32:47], a[168:171], a[208:211], v[32:47]
    s_add_u32 s48, s48, s49
    buffer_store_dwordx4 v[168:171], v250, s[8:11], s48 offen offset:0 sc1
    v_mfma_f32_32x32x16_bf16 v[96:111], a[168:171], a[212:215], v[96:111]
    v_mfma_f32_32x32x16_bf16 v[48:63], a[172:175], a[208:211], v[48:63]
    v_mfma_f32_32x32x16_bf16 v[112:127], a[172:175], a[212:215], v[112:127]
    s_add_u32 s52, s71, 16384
    s_add_u32 s53, s72, 16384
    buffer_load_dwordx4 a[208:211], v240, s[8:11], s52 offen offset:2048 sc1
    buffer_load_dwordx4 a[212:215], v240, s[8:11], s53 offen offset:2048 sc1
    s_waitcnt vmcnt(25)
    s_waitcnt lgkmcnt(0)
    s_waitcnt vmcnt(27)
    s_barrier
    v_mfma_f32_32x32x16_bf16 v[0:15], a[176:179], a[216:219], v[0:15]
    ds_read_b64_tr_b16 a[160:161], v242 offset:0
    ds_read_b64_tr_b16 a[162:163], v242 offset:1024
    v_mfma_f32_32x32x16_bf16 v[64:79], a[176:179], a[220:223], v[64:79]
    ds_read_b64_tr_b16 a[164:165], v243 offset:0
    ds_read_b64_tr_b16 a[166:167], v243 offset:1024
    v_mfma_f32_32x32x16_bf16 v[16:31], a[180:183], a[216:219], v[16:31]
    ds_read_b64_tr_b16 a[168:169], v244 offset:0
    ds_read_b64_tr_b16 a[170:171], v244 offset:1024
    v_mfma_f32_32x32x16_bf16 v[80:95], a[180:183], a[220:223], v[80:95]
    ds_read_b64_tr_b16 a[172:173], v245 offset:0
    ds_read_b64_tr_b16 a[174:175], v245 offset:1024
    v_mfma_f32_32x32x16_bf16 v[32:47], a[184:187], a[216:219], v[32:47]
    buffer_store_dwordx4 v[172:175], v250, s[8:11], s48 offen offset:256 sc1
    v_mfma_f32_32x32x16_bf16 v[96:111], a[184:187], a[220:223], v[96:111]
    s_add_u32 m0, s3, 32768
    s_add_u32 s54, s73, 2621440
    buffer_load_dwordx4 v246, s[28:31], s54 offen offset:0 lds
    buffer_load_dwordx4 v247, s[28:31], s54 offen offset:1024 lds
    buffer_load_dwordx4 v248, s[28:31], s54 offen offset:2048 lds
    buffer_load_dwordx4 v249, s[28:31], s54 offen offset:3072 lds
    v_mfma_f32_32x32x16_bf16 v[48:63], a[188:191], a[216:219], v[48:63]
    v_mfma_f32_32x32x16_bf16 v[112:127], a[188:191], a[220:223], v[112:127]
    s_add_u32 s52, s71, 16384
    s_add_u32 s53, s72, 16384
    buffer_load_dwordx4 a[216:219], v240, s[8:11], s52 offen offset:3072 sc1
    buffer_load_dwordx4 a[220:223], v240, s[8:11], s53 offen offset:3072 sc1
    s_waitcnt vmcnt(29)
    s_waitcnt lgkmcnt(0)
    v_mfma_f32_32x32x16_bf16 v[0:15], a[160:163], a[224:227], v[0:15]
    ds_read_b64_tr_b16 a[176:177], v242 offset:4096
    ds_read_b64_tr_b16 a[178:179], v242 offset:5120
    v_mfma_f32_32x32x16_bf16 v[64:79], a[160:163], a[228:231], v[64:79]
    ds_read_b64_tr_b16 a[180:181], v243 offset:4096
    ds_read_b64_tr_b16 a[182:183], v243 offset:5120
    v_mfma_f32_32x32x16_bf16 v[16:31], a[164:167], a[224:227], v[16:31]
    ds_read_b64_tr_b16 a[184:185], v244 offset:4096
    ds_read_b64_tr_b16 a[186:187], v244 offset:5120
    v_mfma_f32_32x32x16_bf16 v[80:95], a[164:167], a[228:231], v[80:95]
    ds_read_b64_tr_b16 a[188:189], v245 offset:4096
    ds_read_b64_tr_b16 a[190:191], v245 offset:5120
    v_mfma_f32_32x32x16_bf16 v[32:47], a[168:171], a[224:227], v[32:47]
    s_add_u32 s48, s48, s49
    buffer_store_dwordx4 v[176:179], v250, s[8:11], s48 offen offset:0 sc1
    v_mfma_f32_32x32x16_bf16 v[96:111], a[168:171], a[228:231], v[96:111]
    v_mfma_f32_32x32x16_bf16 v[48:63], a[172:175], a[224:227], v[48:63]
    v_mfma_f32_32x32x16_bf16 v[112:127], a[172:175], a[228:231], v[112:127]
    s_add_u32 s52, s71, 20480
    s_add_u32 s53, s72, 20480
    buffer_load_dwordx4 a[224:227], v240, s[8:11], s52 offen offset:0 sc1
    buffer_load_dwordx4 a[228:231], v240, s[8:11], s53 offen offset:0 sc1
    s_waitcnt vmcnt(29)
    s_waitcnt lgkmcnt(0)
    v_mfma_f32_32x32x16_bf16 v[0:15], a[176:179], a[232:235], v[0:15]
    ds_read_b64_tr_b16 a[160:161], v242 offset:8192
    ds_read_b64_tr_b16 a[162:163], v242 offset:9216
    v_mfma_f32_32x32x16_bf16 v[64:79], a[176:179], a[236:239], v[64:79]
    ds_read_b64_tr_b16 a[164:165], v243 offset:8192
    ds_read_b64_tr_b16 a[166:167], v243 offset:9216
    v_mfma_f32_32x32x16_bf16 v[16:31], a[180:183], a[232:235], v[16:31]
    ds_read_b64_tr_b16 a[168:169], v244 offset:8192
    ds_read_b64_tr_b16 a[170:171], v244 offset:9216
    v_mfma_f32_32x32x16_bf16 v[80:95], a[180:183], a[236:239], v[80:95]
    ds_read_b64_tr_b16 a[172:173], v245 offset:8192
    ds_read_b64_tr_b16 a[174:175], v245 offset:9216
    v_mfma_f32_32x32x16_bf16 v[32:47], a[184:187], a[232:235], v[32:47]
    buffer_store_dwordx4 v[180:183], v250, s[8:11], s48 offen offset:256 sc1
    v_mfma_f32_32x32x16_bf16 v[96:111], a[184:187], a[236:239], v[96:111]
    v_mfma_f32_32x32x16_bf16 v[48:63], a[188:191], a[232:235], v[48:63]
    v_mfma_f32_32x32x16_bf16 v[112:127], a[188:191], a[236:239], v[112:127]
    s_add_u32 s52, s71, 20480
    s_add_u32 s53, s72, 20480
    buffer_load_dwordx4 a[232:235], v240, s[8:11], s52 offen offset:1024 sc1
    buffer_load_dwordx4 a[236:239], v240, s[8:11], s53 offen offset:1024 sc1
    s_waitcnt vmcnt(29)
    s_waitcnt lgkmcnt(0)
    v_mfma_f32_32x32x16_bf16 v[0:15], a[160:163], a[240:243], v[0:15]
    ds_read_b64_tr_b16 a[176:177], v242 offset:12288
    ds_read_b64_tr_b16 a[178:179], v242 offset:13312
    v_mfma_f32_32x32x16_bf16 v[64:79], a[160:163], a[244:247], v[64:79]
    ds_read_b64_tr_b16 a[180:181], v243 offset:12288
    ds_read_b64_tr_b16 a[182:183], v243 offset:13312
    v_mfma_f32_32x32x16_bf16 v[16:31], a[164:167], a[240:243], v[16:31]
    ds_read_b64_tr_b16 a[184:185], v244 offset:12288
    ds_read_b64_tr_b16 a[186:187], v244 offset:13312
    v_mfma_f32_32x32x16_bf16 v[80:95], a[164:167], a[244:247], v[80:95]
    ds_read_b64_tr_b16 a[188:189], v245 offset:12288
    ds_read_b64_tr_b16 a[190:191], v245 offset:13312
    v_mfma_f32_32x32x16_bf16 v[32:47], a[168:171], a[240:243], v[32:47]
    s_add_u32 s48, s48, s49
    buffer_store_dwordx4 v[184:187], v250, s[8:11], s48 offen offset:0 sc1
    v_mfma_f32_32x32x16_bf16 v[96:111], a[168:171], a[244:247], v[96:111]
    v_mfma_f32_32x32x16_bf16 v[48:63], a[172:175], a[240:243], v[48:63]
    v_mfma_f32_32x32x16_bf16 v[112:127], a[172:175], a[244:247], v[112:127]
    s_add_u32 s52, s71, 20480
    s_add_u32 s53, s72, 20480
    buffer_load_dwordx4 a[240:243], v240, s[8:11], s52 offen offset:2048 sc1
    buffer_load_dwordx4 a[244:247], v240, s[8:11], s53 offen offset:2048 sc1
    s_waitcnt vmcnt(25)
    s_waitcnt lgkmcnt(0)
    s_waitcnt vmcnt(27)
    s_barrier
    v_mfma_f32_32x32x16_bf16 v[0:15], a[176:179], a[248:251], v[0:15]
    ds_read_b64_tr_b16 a[160:161], v242 offset:16384
    ds_read_b64_tr_b16 a[162:163], v242 offset:17408
    v_mfma_f32_32x32x16_bf16 v[64:79], a[176:179], a[252:255], v[64:79]
    ds_read_b64_tr_b16 a[164:165], v243 offset:16384
    ds_read_b64_tr_b16 a[166:167], v243 offset:17408
    v_mfma_f32_32x32x16_bf16 v[16:31], a[180:183], a[248:251], v[16:31]
    ds_read_b64_tr_b16 a[168:169], v244 offset:16384
    ds_read_b64_tr_b16 a[170:171], v244 offset:17408
    v_mfma_f32_32x32x16_bf16 v[80:95], a[180:183], a[252:255], v[80:95]
    ds_read_b64_tr_b16 a[172:173], v245 offset:16384
    ds_read_b64_tr_b16 a[174:175], v245 offset:17408
    v_mfma_f32_32x32x16_bf16 v[32:47], a[184:187], a[248:251], v[32:47]
    buffer_store_dwordx4 v[188:191], v250, s[8:11], s48 offen offset:256 sc1
    v_mfma_f32_32x32x16_bf16 v[96:111], a[184:187], a[252:255], v[96:111]
    s_add_u32 m0, s3, 0
    s_add_u32 s54, s73, 3145728
    buffer_load_dwordx4 v246, s[28:31], s54 offen offset:0 lds
    buffer_load_dwordx4 v247, s[28:31], s54 offen offset:1024 lds
    buffer_load_dwordx4 v248, s[28:31], s54 offen offset:2048 lds
    buffer_load_dwordx4 v249, s[28:31], s54 offen offset:3072 lds
    v_mfma_f32_32x32x16_bf16 v[48:63], a[188:191], a[248:251], v[48:63]
    v_mfma_f32_32x32x16_bf16 v[112:127], a[188:191], a[252:255], v[112:127]
    s_add_u32 s52, s71, 20480
    s_add_u32 s53, s72, 20480
    buffer_load_dwordx4 a[248:251], v240, s[8:11], s52 offen offset:3072 sc1
    buffer_load_dwordx4 a[252:255], v240, s[8:11], s53 offen offset:3072 sc1
    s_waitcnt vmcnt(29)
    s_waitcnt lgkmcnt(0)
    v_mfma_f32_32x32x16_bf16 v[0:15], a[160:163], a[192:195], v[0:15]
    ds_read_b64_tr_b16 a[176:177], v242 offset:20480
    ds_read_b64_tr_b16 a[178:179], v242 offset:21504
    v_mfma_f32_32x32x16_bf16 v[64:79], a[160:163], a[196:199], v[64:79]
    ds_read_b64_tr_b16 a[180:181], v243 offset:20480
    ds_read_b64_tr_b16 a[182:183], v243 offset:21504
    v_mfma_f32_32x32x16_bf16 v[16:31], a[164:167], a[192:195], v[16:31]
    ds_read_b64_tr_b16 a[184:185], v244 offset:20480
    ds_read_b64_tr_b16 a[186:187], v244 offset:21504
    v_mfma_f32_32x32x16_bf16 v[80:95], a[164:167], a[196:199], v[80:95]
    ds_read_b64_tr_b16 a[188:189], v245 offset:20480
    ds_read_b64_tr_b16 a[190:191], v245 offset:21504
    v_mfma_f32_32x32x16_bf16 v[32:47], a[168:171], a[192:195], v[32:47]
    s_add_u32 s48, s6, 16384
    s_mov_b32 s6, s48
    buffer_store_dwordx4 v[192:195], v250, s[8:11], s48 offen offset:0 sc1
    v_mfma_f32_32x32x16_bf16 v[96:111], a[168:171], a[196:199], v[96:111]
    v_mfma_f32_32x32x16_bf16 v[48:63], a[172:175], a[192:195], v[48:63]
    v_mfma_f32_32x32x16_bf16 v[112:127], a[172:175], a[196:199], v[112:127]
    s_add_u32 s52, s71, 24576
    s_add_u32 s53, s72, 24576
    buffer_load_dwordx4 a[192:195], v240, s[8:11], s52 offen offset:0 sc1
    buffer_load_dwordx4 a[196:199], v240, s[8:11], s53 offen offset:0 sc1
    s_waitcnt vmcnt(29)
    s_waitcnt lgkmcnt(0)
    v_mfma_f32_32x32x16_bf16 v[0:15], a[176:179], a[200:203], v[0:15]
    ds_read_b64_tr_b16 a[160:161], v242 offset:24576
    ds_read_b64_tr_b16 a[162:163], v242 offset:25600
    v_mfma_f32_32x32x16_bf16 v[64:79], a[176:179], a[204:207], v[64:79]
    ds_read_b64_tr_b16 a[164:165], v243 offset:24576
    ds_read_b64_tr_b16 a[166:167], v243 offset:25600
    v_mfma_f32_32x32x16_bf16 v[16:31], a[180:183], a[200:203], v[16:31]
    ds_read_b64_tr_b16 a[168:169], v244 offset:24576
    ds_read_b64_tr_b16 a[170:171], v244 offset:25600
    v_mfma_f32_32x32x16_bf16 v[80:95], a[180:183], a[204:207], v[80:95]
    ds_read_b64_tr_b16 a[172:173], v245 offset:24576
    ds_read_b64_tr_b16 a[174:175], v245 offset:25600
    v_mfma_f32_32x32x16_bf16 v[32:47], a[184:187], a[200:203], v[32:47]
    buffer_store_dwordx4 v[196:199], v250, s[8:11], s48 offen offset:256 sc1
    v_mfma_f32_32x32x16_bf16 v[96:111], a[184:187], a[204:207], v[96:111]
    v_mfma_f32_32x32x16_bf16 v[48:63], a[188:191], a[200:203], v[48:63]
    v_mfma_f32_32x32x16_bf16 v[112:127], a[188:191], a[204:207], v[112:127]
    s_add_u32 s52, s71, 24576
    s_add_u32 s53, s72, 24576
    buffer_load_dwordx4 a[200:203], v240, s[8:11], s52 offen offset:1024 sc1
    buffer_load_dwordx4 a[204:207], v240, s[8:11], s53 offen offset:1024 sc1
    s_waitcnt vmcnt(29)
    s_waitcnt lgkmcnt(0)
    v_mfma_f32_32x32x16_bf16 v[0:15], a[160:163], a[208:211], v[0:15]
    ds_read_b64_tr_b16 a[176:177], v242 offset:28672
    ds_read_b64_tr_b16 a[178:179], v242 offset:29696
    v_mfma_f32_32x32x16_bf16 v[64:79], a[160:163], a[212:215], v[64:79]
    ds_read_b64_tr_b16 a[180:181], v243 offset:28672
    ds_read_b64_tr_b16 a[182:183], v243 offset:29696
    v_mfma_f32_32x32x16_bf16 v[16:31], a[164:167], a[208:211], v[16:31]
    ds_read_b64_tr_b16 a[184:185], v244 offset:28672
    ds_read_b64_tr_b16 a[186:187], v244 offset:29696
    v_mfma_f32_32x32x16_bf16 v[80:95], a[164:167], a[212:215], v[80:95]
    ds_read_b64_tr_b16 a[188:189], v245 offset:28672
    ds_read_b64_tr_b16 a[190:191], v245 offset:29696
    v_mfma_f32_32x32x16_bf16 v[32:47], a[168:171], a[208:211], v[32:47]
    s_add_u32 s48, s48, s49
    buffer_store_dwordx4 v[200:203], v250, s[8:11], s48 offen offset:0 sc1
    v_mfma_f32_32x32x16_bf16 v[96:111], a[168:171], a[212:215], v[96:111]
    v_mfma_f32_32x32x16_bf16 v[48:63], a[172:175], a[208:211], v[48:63]
    v_mfma_f32_32x32x16_bf16 v[112:127], a[172:175], a[212:215], v[112:127]
    s_add_u32 s52, s71, 24576
    s_add_u32 s53, s72, 24576
    buffer_load_dwordx4 a[208:211], v240, s[8:11], s52 offen offset:2048 sc1
    buffer_load_dwordx4 a[212:215], v240, s[8:11], s53 offen offset:2048 sc1
    s_waitcnt vmcnt(25)
    s_waitcnt lgkmcnt(0)
    s_waitcnt vmcnt(27)
    s_barrier
    v_mfma_f32_32x32x16_bf16 v[0:15], a[176:179], a[216:219], v[0:15]
    ds_read_b64_tr_b16 a[160:161], v242 offset:32768
    ds_read_b64_tr_b16 a[162:163], v242 offset:33792
    v_mfma_f32_32x32x16_bf16 v[64:79], a[176:179], a[220:223], v[64:79]
    ds_read_b64_tr_b16 a[164:165], v243 offset:32768
    ds_read_b64_tr_b16 a[166:167], v243 offset:33792
    v_mfma_f32_32x32x16_bf16 v[16:31], a[180:183], a[216:219], v[16:31]
    ds_read_b64_tr_b16 a[168:169], v244 offset:32768
    ds_read_b64_tr_b16 a[170:171], v244 offset:33792
    v_mfma_f32_32x32x16_bf16 v[80:95], a[180:183], a[220:223], v[80:95]
    ds_read_b64_tr_b16 a[172:173], v245 offset:32768
    ds_read_b64_tr_b16 a[174:175], v245 offset:33792
    v_mfma_f32_32x32x16_bf16 v[32:47], a[184:187], a[216:219], v[32:47]
    buffer_store_dwordx4 v[204:207], v250, s[8:11], s48 offen offset:256 sc1
    v_mfma_f32_32x32x16_bf16 v[96:111], a[184:187], a[220:223], v[96:111]
    s_add_u32 m0, s3, 16384
    s_add_u32 s54, s73, 3670016
    buffer_load_dwordx4 v246, s[28:31], s54 offen offset:0 lds
    buffer_load_dwordx4 v247, s[28:31], s54 offen offset:1024 lds
    buffer_load_dwordx4 v248, s[28:31], s54 offen offset:2048 lds
    buffer_load_dwordx4 v249, s[28:31], s54 offen offset:3072 lds
    v_mfma_f32_32x32x16_bf16 v[48:63], a[188:191], a[216:219], v[48:63]
    v_mfma_f32_32x32x16_bf16 v[112:127], a[188:191], a[220:223], v[112:127]
    s_add_u32 s52, s71, 24576
    s_add_u32 s53, s72, 24576
    buffer_load_dwordx4 a[216:219], v240, s[8:11], s52 offen offset:3072 sc1
    buffer_load_dwordx4 a[220:223], v240, s[8:11], s53 offen offset:3072 sc1
    s_waitcnt vmcnt(29)
    s_waitcnt lgkmcnt(0)
    v_mfma_f32_32x32x16_bf16 v[0:15], a[160:163], a[224:227], v[0:15]
    ds_read_b64_tr_b16 a[176:177], v242 offset:36864
    ds_read_b64_tr_b16 a[178:179], v242 offset:37888
    v_mfma_f32_32x32x16_bf16 v[64:79], a[160:163], a[228:231], v[64:79]
    ds_read_b64_tr_b16 a[180:181], v243 offset:36864
    ds_read_b64_tr_b16 a[182:183], v243 offset:37888
    v_mfma_f32_32x32x16_bf16 v[16:31], a[164:167], a[224:227], v[16:31]
    ds_read_b64_tr_b16 a[184:185], v244 offset:36864
    ds_read_b64_tr_b16 a[186:187], v244 offset:37888
    v_mfma_f32_32x32x16_bf16 v[80:95], a[164:167], a[228:231], v[80:95]
    ds_read_b64_tr_b16 a[188:189], v245 offset:36864
    ds_read_b64_tr_b16 a[190:191], v245 offset:37888
    v_mfma_f32_32x32x16_bf16 v[32:47], a[168:171], a[224:227], v[32:47]
    s_add_u32 s48, s48, s49
    buffer_store_dwordx4 v[208:211], v250, s[8:11], s48 offen offset:0 sc1
    v_mfma_f32_32x32x16_bf16 v[96:111], a[168:171], a[228:231], v[96:111]
    v_mfma_f32_32x32x16_bf16 v[48:63], a[172:175], a[224:227], v[48:63]
    v_mfma_f32_32x32x16_bf16 v[112:127], a[172:175], a[228:231], v[112:127]
    s_add_u32 s52, s71, 28672
    s_add_u32 s53, s72, 28672
    buffer_load_dwordx4 a[224:227], v240, s[8:11], s52 offen offset:0 sc1
    buffer_load_dwordx4 a[228:231], v240, s[8:11], s53 offen offset:0 sc1
    s_waitcnt vmcnt(29)
    s_waitcnt lgkmcnt(0)
    v_mfma_f32_32x32x16_bf16 v[0:15], a[176:179], a[232:235], v[0:15]
    ds_read_b64_tr_b16 a[160:161], v242 offset:40960
    ds_read_b64_tr_b16 a[162:163], v242 offset:41984
    v_mfma_f32_32x32x16_bf16 v[64:79], a[176:179], a[236:239], v[64:79]
    ds_read_b64_tr_b16 a[164:165], v243 offset:40960
    ds_read_b64_tr_b16 a[166:167], v243 offset:41984
    v_mfma_f32_32x32x16_bf16 v[16:31], a[180:183], a[232:235], v[16:31]
    ds_read_b64_tr_b16 a[168:169], v244 offset:40960
    ds_read_b64_tr_b16 a[170:171], v244 offset:41984
    v_mfma_f32_32x32x16_bf16 v[80:95], a[180:183], a[236:239], v[80:95]
    ds_read_b64_tr_b16 a[172:173], v245 offset:40960
    ds_read_b64_tr_b16 a[174:175], v245 offset:41984
    v_mfma_f32_32x32x16_bf16 v[32:47], a[184:187], a[232:235], v[32:47]
    buffer_store_dwordx4 v[212:215], v250, s[8:11], s48 offen offset:256 sc1
    v_mfma_f32_32x32x16_bf16 v[96:111], a[184:187], a[236:239], v[96:111]
    v_mfma_f32_32x32x16_bf16 v[48:63], a[188:191], a[232:235], v[48:63]
    v_mfma_f32_32x32x16_bf16 v[112:127], a[188:191], a[236:239], v[112:127]
    s_add_u32 s52, s71, 28672
    s_add_u32 s53, s72, 28672
    buffer_load_dwordx4 a[232:235], v240, s[8:11], s52 offen offset:1024 sc1
    buffer_load_dwordx4 a[236:239], v240, s[8:11], s53 offen offset:1024 sc1
    s_waitcnt vmcnt(29)
    s_waitcnt lgkmcnt(0)
    v_mfma_f32_32x32x16_bf16 v[0:15], a[160:163], a[240:243], v[0:15]
    ds_read_b64_tr_b16 a[176:177], v242 offset:45056
    ds_read_b64_tr_b16 a[178:179], v242 offset:46080
    v_mfma_f32_32x32x16_bf16 v[64:79], a[160:163], a[244:247], v[64:79]
    ds_read_b64_tr_b16 a[180:181], v243 offset:45056
    ds_read_b64_tr_b16 a[182:183], v243 offset:46080
    v_mfma_f32_32x32x16_bf16 v[16:31], a[164:167], a[240:243], v[16:31]
    ds_read_b64_tr_b16 a[184:185], v244 offset:45056
    ds_read_b64_tr_b16 a[186:187], v244 offset:46080
    v_mfma_f32_32x32x16_bf16 v[80:95], a[164:167], a[244:247], v[80:95]
    ds_read_b64_tr_b16 a[188:189], v245 offset:45056
    ds_read_b64_tr_b16 a[190:191], v245 offset:46080
    v_mfma_f32_32x32x16_bf16 v[32:47], a[168:171], a[240:243], v[32:47]
    s_add_u32 s48, s48, s49
    buffer_store_dwordx4 v[216:219], v250, s[8:11], s48 offen offset:0 sc1
    v_mfma_f32_32x32x16_bf16 v[96:111], a[168:171], a[244:247], v[96:111]
    v_mfma_f32_32x32x16_bf16 v[48:63], a[172:175], a[240:243], v[48:63]
    v_mfma_f32_32x32x16_bf16 v[112:127], a[172:175], a[244:247], v[112:127]
    s_add_u32 s52, s71, 28672
    s_add_u32 s53, s72, 28672
    buffer_load_dwordx4 a[240:243], v240, s[8:11], s52 offen offset:2048 sc1
    buffer_load_dwordx4 a[244:247], v240, s[8:11], s53 offen offset:2048 sc1
    s_waitcnt vmcnt(25)
    s_waitcnt lgkmcnt(0)
    s_waitcnt vmcnt(27)
    s_barrier
    v_mfma_f32_32x32x16_bf16 v[0:15], a[176:179], a[248:251], v[0:15]
    ds_read_b64_tr_b16 a[160:161], v242 offset:0
    ds_read_b64_tr_b16 a[162:163], v242 offset:1024
    v_mfma_f32_32x32x16_bf16 v[64:79], a[176:179], a[252:255], v[64:79]
    ds_read_b64_tr_b16 a[164:165], v243 offset:0
    ds_read_b64_tr_b16 a[166:167], v243 offset:1024
    v_mfma_f32_32x32x16_bf16 v[16:31], a[180:183], a[248:251], v[16:31]
    ds_read_b64_tr_b16 a[168:169], v244 offset:0
    ds_read_b64_tr_b16 a[170:171], v244 offset:1024
    v_mfma_f32_32x32x16_bf16 v[80:95], a[180:183], a[252:255], v[80:95]
    ds_read_b64_tr_b16 a[172:173], v245 offset:0
    ds_read_b64_tr_b16 a[174:175], v245 offset:1024
    v_mfma_f32_32x32x16_bf16 v[32:47], a[184:187], a[248:251], v[32:47]
    buffer_store_dwordx4 v[220:223], v250, s[8:11], s48 offen offset:256 sc1
    v_mfma_f32_32x32x16_bf16 v[96:111], a[184:187], a[252:255], v[96:111]
    s_add_u32 m0, s3, 32768
    s_add_u32 s54, s73, 4194304
    buffer_load_dwordx4 v246, s[28:31], s54 offen offset:0 lds
    buffer_load_dwordx4 v247, s[28:31], s54 offen offset:1024 lds
    buffer_load_dwordx4 v248, s[28:31], s54 offen offset:2048 lds
    buffer_load_dwordx4 v249, s[28:31], s54 offen offset:3072 lds
    v_mfma_f32_32x32x16_bf16 v[48:63], a[188:191], a[248:251], v[48:63]
    v_mfma_f32_32x32x16_bf16 v[112:127], a[188:191], a[252:255], v[112:127]
    s_add_u32 s52, s71, 28672
    s_add_u32 s53, s72, 28672
    buffer_load_dwordx4 a[248:251], v240, s[8:11], s52 offen offset:3072 sc1
    buffer_load_dwordx4 a[252:255], v240, s[8:11], s53 offen offset:3072 sc1
    s_waitcnt vmcnt(29)
    s_waitcnt lgkmcnt(0)
    v_mfma_f32_32x32x16_bf16 v[0:15], a[160:163], a[192:195], v[0:15]
    ds_read_b64_tr_b16 a[176:177], v242 offset:4096
    ds_read_b64_tr_b16 a[178:179], v242 offset:5120
    v_mfma_f32_32x32x16_bf16 v[64:79], a[160:163], a[196:199], v[64:79]
    ds_read_b64_tr_b16 a[180:181], v243 offset:4096
    ds_read_b64_tr_b16 a[182:183], v243 offset:5120
    v_mfma_f32_32x32x16_bf16 v[16:31], a[164:167], a[192:195], v[16:31]
    ds_read_b64_tr_b16 a[184:185], v244 offset:4096
    ds_read_b64_tr_b16 a[186:187], v244 offset:5120
    v_mfma_f32_32x32x16_bf16 v[80:95], a[164:167], a[196:199], v[80:95]
    ds_read_b64_tr_b16 a[188:189], v245 offset:4096
    ds_read_b64_tr_b16 a[190:191], v245 offset:5120
    v_mfma_f32_32x32x16_bf16 v[32:47], a[168:171], a[192:195], v[32:47]
    s_add_u32 s48, s6, 16384
    s_mov_b32 s6, s48
    buffer_store_dwordx4 v[224:227], v250, s[8:11], s48 offen offset:0 sc1
    v_mfma_f32_32x32x16_bf16 v[96:111], a[168:171], a[196:199], v[96:111]
    v_mfma_f32_32x32x16_bf16 v[48:63], a[172:175], a[192:195], v[48:63]
    v_mfma_f32_32x32x16_bf16 v[112:127], a[172:175], a[196:199], v[112:127]
    s_add_u32 s52, s71, 32768
    s_add_u32 s53, s72, 32768
    buffer_load_dwordx4 a[192:195], v240, s[8:11], s52 offen offset:0 sc1
    buffer_load_dwordx4 a[196:199], v240, s[8:11], s53 offen offset:0 sc1
    s_waitcnt vmcnt(29)
    s_waitcnt lgkmcnt(0)
    v_mfma_f32_32x32x16_bf16 v[0:15], a[176:179], a[200:203], v[0:15]
    ds_read_b64_tr_b16 a[160:161], v242 offset:8192
    ds_read_b64_tr_b16 a[162:163], v242 offset:9216
    v_mfma_f32_32x32x16_bf16 v[64:79], a[176:179], a[204:207], v[64:79]
    ds_read_b64_tr_b16 a[164:165], v243 offset:8192
    ds_read_b64_tr_b16 a[166:167], v243 offset:9216
    v_mfma_f32_32x32x16_bf16 v[16:31], a[180:183], a[200:203], v[16:31]
    ds_read_b64_tr_b16 a[168:169], v244 offset:8192
    ds_read_b64_tr_b16 a[170:171], v244 offset:9216
    v_mfma_f32_32x32x16_bf16 v[80:95], a[180:183], a[204:207], v[80:95]
    ds_read_b64_tr_b16 a[172:173], v245 offset:8192
    ds_read_b64_tr_b16 a[174:175], v245 offset:9216
    v_mfma_f32_32x32x16_bf16 v[32:47], a[184:187], a[200:203], v[32:47]
    buffer_store_dwordx4 v[228:231], v250, s[8:11], s48 offen offset:256 sc1
    v_mfma_f32_32x32x16_bf16 v[96:111], a[184:187], a[204:207], v[96:111]
    v_mfma_f32_32x32x16_bf16 v[48:63], a[188:191], a[200:203], v[48:63]
    v_mfma_f32_32x32x16_bf16 v[112:127], a[188:191], a[204:207], v[112:127]
    s_add_u32 s52, s71, 32768
    s_add_u32 s53, s72, 32768
    buffer_load_dwordx4 a[200:203], v240, s[8:11], s52 offen offset:1024 sc1
    buffer_load_dwordx4 a[204:207], v240, s[8:11], s53 offen offset:1024 sc1
    s_waitcnt vmcnt(29)
    s_waitcnt lgkmcnt(0)
    v_mfma_f32_32x32x16_bf16 v[0:15], a[160:163], a[208:211], v[0:15]
    ds_read_b64_tr_b16 a[176:177], v242 offset:12288
    ds_read_b64_tr_b16 a[178:179], v242 offset:13312
    v_mfma_f32_32x32x16_bf16 v[64:79], a[160:163], a[212:215], v[64:79]
    ds_read_b64_tr_b16 a[180:181], v243 offset:12288
    ds_read_b64_tr_b16 a[182:183], v243 offset:13312
    v_mfma_f32_32x32x16_bf16 v[16:31], a[164:167], a[208:211], v[16:31]
    ds_read_b64_tr_b16 a[184:185], v244 offset:12288
    ds_read_b64_tr_b16 a[186:187], v244 offset:13312
    v_mfma_f32_32x32x16_bf16 v[80:95], a[164:167], a[212:215], v[80:95]
    ds_read_b64_tr_b16 a[188:189], v245 offset:12288
    ds_read_b64_tr_b16 a[190:191], v245 offset:13312
    v_mfma_f32_32x32x16_bf16 v[32:47], a[168:171], a[208:211], v[32:47]
    s_add_u32 s48, s48, s49
    buffer_store_dwordx4 v[232:235], v250, s[8:11], s48 offen offset:0 sc1
    v_mfma_f32_32x32x16_bf16 v[96:111], a[168:171], a[212:215], v[96:111]
    v_mfma_f32_32x32x16_bf16 v[48:63], a[172:175], a[208:211], v[48:63]
    v_mfma_f32_32x32x16_bf16 v[112:127], a[172:175], a[212:215], v[112:127]
    s_add_u32 s52, s71, 32768
    s_add_u32 s53, s72, 32768
    buffer_load_dwordx4 a[208:211], v240, s[8:11], s52 offen offset:2048 sc1
    buffer_load_dwordx4 a[212:215], v240, s[8:11], s53 offen offset:2048 sc1
    s_waitcnt vmcnt(25)
    s_waitcnt lgkmcnt(0)
    s_waitcnt vmcnt(27)
    s_barrier
    v_mfma_f32_32x32x16_bf16 v[0:15], a[176:179], a[216:219], v[0:15]
    ds_read_b64_tr_b16 a[160:161], v242 offset:16384
    ds_read_b64_tr_b16 a[162:163], v242 offset:17408
    v_mfma_f32_32x32x16_bf16 v[64:79], a[176:179], a[220:223], v[64:79]
    ds_read_b64_tr_b16 a[164:165], v243 offset:16384
    ds_read_b64_tr_b16 a[166:167], v243 offset:17408
    v_mfma_f32_32x32x16_bf16 v[16:31], a[180:183], a[216:219], v[16:31]
    ds_read_b64_tr_b16 a[168:169], v244 offset:16384
    ds_read_b64_tr_b16 a[170:171], v244 offset:17408
    v_mfma_f32_32x32x16_bf16 v[80:95], a[180:183], a[220:223], v[80:95]
    ds_read_b64_tr_b16 a[172:173], v245 offset:16384
    ds_read_b64_tr_b16 a[174:175], v245 offset:17408
    v_mfma_f32_32x32x16_bf16 v[32:47], a[184:187], a[216:219], v[32:47]
    buffer_store_dwordx4 v[236:239], v250, s[8:11], s48 offen offset:256 sc1
    v_mfma_f32_32x32x16_bf16 v[96:111], a[184:187], a[220:223], v[96:111]
    v_mfma_f32_32x32x16_bf16 v[48:63], a[188:191], a[216:219], v[48:63]
    v_mfma_f32_32x32x16_bf16 v[112:127], a[188:191], a[220:223], v[112:127]
    s_add_u32 s52, s71, 32768
    s_add_u32 s53, s72, 32768
    buffer_load_dwordx4 a[216:219], v240, s[8:11], s52 offen offset:3072 sc1
    buffer_load_dwordx4 a[220:223], v240, s[8:11], s53 offen offset:3072 sc1
    s_waitcnt vmcnt(25)
    s_waitcnt lgkmcnt(0)
    v_mfma_f32_32x32x16_bf16 v[0:15], a[160:163], a[224:227], v[0:15]
    ds_read_b64_tr_b16 a[176:177], v242 offset:20480
    ds_read_b64_tr_b16 a[178:179], v242 offset:21504
    v_mfma_f32_32x32x16_bf16 v[64:79], a[160:163], a[228:231], v[64:79]
    ds_read_b64_tr_b16 a[180:181], v243 offset:20480
    ds_read_b64_tr_b16 a[182:183], v243 offset:21504
    v_mfma_f32_32x32x16_bf16 v[16:31], a[164:167], a[224:227], v[16:31]
    ds_read_b64_tr_b16 a[184:185], v244 offset:20480
    ds_read_b64_tr_b16 a[186:187], v244 offset:21504
    v_mfma_f32_32x32x16_bf16 v[80:95], a[164:167], a[228:231], v[80:95]
    ds_read_b64_tr_b16 a[188:189], v245 offset:20480
    ds_read_b64_tr_b16 a[190:191], v245 offset:21504
    v_mfma_f32_32x32x16_bf16 v[32:47], a[168:171], a[224:227], v[32:47]
    v_mfma_f32_32x32x16_bf16 v[96:111], a[168:171], a[228:231], v[96:111]
    s_xor_b32 s69, s2, 162
    s_or_b32 s69, s69, s44
    s_cbranch_scc1 L_k2_notk0
    v_lshlrev_b32 v252, 7, v241
    s_mov_b32 s54, 0x490000
    buffer_load_dword v148, v252, s[8:11], s54 offen sc1
    s_add_u32 s54, s54, 8192
    buffer_load_dword v149, v252, s[8:11], s54 offen sc1
    s_add_u32 s54, s54, 8192
    buffer_load_dword v150, v252, s[8:11], s54 offen sc1
    s_add_u32 s54, s54, 8192
    buffer_load_dword v151, v252, s[8:11], s54 offen sc1
    s_add_u32 s54, s54, 8192
L_k2_notk0:
    v_mfma_f32_32x32x16_bf16 v[48:63], a[172:175], a[224:227], v[48:63]
    v_mfma_f32_32x32x16_bf16 v[112:127], a[172:175], a[228:231], v[112:127]
    s_waitcnt vmcnt(22)
    s_waitcnt lgkmcnt(0)
    v_mfma_f32_32x32x16_bf16 v[0:15], a[176:179], a[232:235], v[0:15]
    ds_read_b64_tr_b16 a[160:161], v242 offset:24576
    ds_read_b64_tr_b16 a[162:163], v242 offset:25600
    v_mfma_f32_32x32x16_bf16 v[64:79], a[176:179], a[236:239], v[64:79]
    ds_read_b64_tr_b16 a[164:165], v243 offset:24576
    ds_read_b64_tr_b16 a[166:167], v243 offset:25600
    v_mfma_f32_32x32x16_bf16 v[16:31], a[180:183], a[232:235], v[16:31]
    ds_read_b64_tr_b16 a[168:169], v244 offset:24576
    ds_read_b64_tr_b16 a[170:171], v244 offset:25600
    v_mfma_f32_32x32x16_bf16 v[80:95], a[180:183], a[236:239], v[80:95]
    ds_read_b64_tr_b16 a[172:173], v245 offset:24576
    ds_read_b64_tr_b16 a[174:175], v245 offset:25600
    v_mfma_f32_32x32x16_bf16 v[32:47], a[184:187], a[232:235], v[32:47]
    v_mfma_f32_32x32x16_bf16 v[96:111], a[184:187], a[236:239], v[96:111]
    s_lshl_b32 s54, s44, 10
    s_add_u32 m0, s54, 131072
    s_nop 0
    buffer_load_dwordx4 v240, s[36:39], s54 offen lds
    s_add_u32 s54, s54, 4096
    s_add_u32 m0, m0, 4096
    s_nop 0
    buffer_load_dwordx4 v240, s[36:39], s54 offen lds
    s_add_u32 s54, s54, 4096
    s_add_u32 m0, m0, 4096
    s_nop 0
    buffer_load_dwordx4 v240, s[36:39], s54 offen lds
    s_add_u32 s54, s54, 4096
    s_add_u32 m0, m0, 4096
    s_nop 0
    buffer_load_dwordx4 v240, s[36:39], s54 offen lds
    s_add_u32 s54, s54, 4096
    s_add_u32 m0, m0, 4096
    s_nop 0
    buffer_load_dwordx4 v240, s[36:39], s54 offen lds
    v_mfma_f32_32x32x16_bf16 v[48:63], a[188:191], a[232:235], v[48:63]
    v_mfma_f32_32x32x16_bf16 v[112:127], a[188:191], a[236:239], v[112:127]
    s_waitcnt vmcnt(24)
    s_waitcnt lgkmcnt(0)
    v_mfma_f32_32x32x16_bf16 v[0:15], a[160:163], a[240:243], v[0:15]
    ds_read_b64_tr_b16 a[176:177], v242 offset:28672
    ds_read_b64_tr_b16 a[178:179], v242 offset:29696
    v_mfma_f32_32x32x16_bf16 v[64:79], a[160:163], a[244:247], v[64:79]
    ds_read_b64_tr_b16 a[180:181], v243 offset:28672
    ds_read_b64_tr_b16 a[182:183], v243 offset:29696
    v_mfma_f32_32x32x16_bf16 v[16:31], a[164:167], a[240:243], v[16:31]
    ds_read_b64_tr_b16 a[184:185], v244 offset:28672
    ds_read_b64_tr_b16 a[186:187], v244 offset:29696
    v_mfma_f32_32x32x16_bf16 v[80:95], a[164:167], a[244:247], v[80:95]
    ds_read_b64_tr_b16 a[188:189], v245 offset:28672
    ds_read_b64_tr_b16 a[190:191], v245 offset:29696
    v_mfma_f32_32x32x16_bf16 v[32:47], a[168:171], a[240:243], v[32:47]
    v_mfma_f32_32x32x16_bf16 v[96:111], a[168:171], a[244:247], v[96:111]
    v_mfma_f32_32x32x16_bf16 v[48:63], a[172:175], a[240:243], v[48:63]
    v_mfma_f32_32x32x16_bf16 v[112:127], a[172:175], a[244:247], v[112:127]
    s_waitcnt vmcnt(17)
    s_waitcnt lgkmcnt(0)
    s_waitcnt vmcnt(19)
    s_waitcnt vmcnt(7)
    s_barrier
    s_cmp_lg_u32 s44, 0
    s_cbranch_scc1 L_ka_sf_kv
    s_lshl_b32 s55, s2, 7
    s_add_u32 s55, s55, 0x490000
    v_mov_b32 v254, s58
    s_mov_b64 exec, 1
    buffer_store_dword v254, v255, s[8:11], s55 offen offset:4 sc1
    s_mov_b64 exec, -1
L_ka_sf_kv:
    v_mfma_f32_32x32x16_bf16 v[0:15], a[176:179], a[248:251], v[0:15]
    ds_read_b64_tr_b16 a[160:161], v242 offset:32768
    ds_read_b64_tr_b16 a[162:163], v242 offset:33792
    v_mfma_f32_32x32x16_bf16 v[64:79], a[176:179], a[252:255], v[64:79]
    ds_read_b64_tr_b16 a[164:165], v243 offset:32768
    ds_read_b64_tr_b16 a[166:167], v243 offset:33792
    v_mfma_f32_32x32x16_bf16 v[16:31], a[180:183], a[248:251], v[16:31]
    ds_read_b64_tr_b16 a[168:169], v244 offset:32768
    ds_read_b64_tr_b16 a[170:171], v244 offset:33792
    v_mfma_f32_32x32x16_bf16 v[80:95], a[180:183], a[252:255], v[80:95]
    ds_read_b64_tr_b16 a[172:173], v245 offset:32768
    ds_read_b64_tr_b16 a[174:175], v245 offset:33792
    v_mfma_f32_32x32x16_bf16 v[32:47], a[184:187], a[248:251], v[32:47]
    v_mfma_f32_32x32x16_bf16 v[96:111], a[184:187], a[252:255], v[96:111]
    v_mfma_f32_32x32x16_bf16 v[48:63], a[188:191], a[248:251], v[48:63]
    v_mfma_f32_32x32x16_bf16 v[112:127], a[188:191], a[252:255], v[112:127]
    s_waitcnt vmcnt(14)
    s_waitcnt lgkmcnt(0)
    v_mfma_f32_32x32x16_bf16 v[0:15], a[160:163], a[192:195], v[0:15]
    ds_read_b64_tr_b16 a[176:177], v242 offset:36864
    ds_read_b64_tr_b16 a[178:179], v242 offset:37888
    v_mfma_f32_32x32x16_bf16 v[64:79], a[160:163], a[196:199], v[64:79]
    ds_read_b64_tr_b16 a[180:181], v243 offset:36864
    ds_read_b64_tr_b16 a[182:183], v243 offset:37888
    v_mfma_f32_32x32x16_bf16 v[16:31], a[164:167], a[192:195], v[16:31]
    ds_read_b64_tr_b16 a[184:185], v244 offset:36864
    ds_read_b64_tr_b16 a[186:187], v244 offset:37888
    v_mfma_f32_32x32x16_bf16 v[80:95], a[164:167], a[196:199], v[80:95]
    ds_read_b64_tr_b16 a[188:189], v245 offset:36864
    ds_read_b64_tr_b16 a[190:191], v245 offset:37888
    v_mfma_f32_32x32x16_bf16 v[32:47], a[168:171], a[192:195], v[32:47]
    v_mfma_f32_32x32x16_bf16 v[96:111], a[168:171], a[196:199], v[96:111]
    s_cmp_lg_u32 s69, 0
    s_cbranch_scc1 L_k2_notk1
    s_waitcnt vmcnt(5)
    v_mov_b32 v152, v253
    v_mov_b32 v254, v148
    v_lshlrev_b32 v253, 7, v241
    v_add_u32 v253, 0, v253
    s_mov_b32 s55, 0
L_ka_fl_all0:
    v_cmp_ne_u32 vcc, s58, v254
    s_cbranch_vccz L_ka_fl_all0_ok
    s_sleep 8
    buffer_load_dword v254, v253, s[8:11], s57 offen sc1
    s_add_u32 s55, s55, 1
    s_cmp_lt_u32 s55, 0x40000
    s_waitcnt vmcnt(0)
    s_cbranch_scc1 L_ka_fl_all0
L_ka_fl_all0_ok:
    v_mov_b32 v254, v149
    v_lshlrev_b32 v253, 7, v241
    v_add_u32 v253, 8192, v253
    s_mov_b32 s55, 0
L_ka_fl_all1:
    v_cmp_ne_u32 vcc, s58, v254
    s_cbranch_vccz L_ka_fl_all1_ok
    s_sleep 8
    buffer_load_dword v254, v253, s[8:11], s57 offen sc1
    s_add_u32 s55, s55, 1
    s_cmp_lt_u32 s55, 0x40000
    s_waitcnt vmcnt(0)
    s_cbranch_scc1 L_ka_fl_all1
L_ka_fl_all1_ok:
    v_mov_b32 v254, v150
    v_lshlrev_b32 v253, 7, v241
    v_add_u32 v253, 16384, v253
    s_mov_b32 s55, 0
L_ka_fl_all2:
    v_cmp_ne_u32 vcc, s58, v254
    s_cbranch_vccz L_ka_fl_all2_ok
    s_sleep 8
    buffer_load_dword v254, v253, s[8:11], s57 offen sc1
    s_add_u32 s55, s55, 1
    s_cmp_lt_u32 s55, 0x40000
    s_waitcnt vmcnt(0)
    s_cbranch_scc1 L_ka_fl_all2
L_ka_fl_all2_ok:
    v_mov_b32 v254, v151
    v_lshlrev_b32 v253, 7, v241
    v_add_u32 v253, 24576, v253
    s_mov_b32 s55, 0
L_ka_fl_all3:
    v_cmp_ne_u32 vcc, s58, v254
    s_cbranch_vccz L_ka_fl_all3_ok
    s_sleep 8
    buffer_load_dword v254, v253, s[8:11], s57 offen sc1
    s_add_u32 s55, s55, 1
    s_cmp_lt_u32 s55, 0x40000
    s_waitcnt vmcnt(0)
    s_cbranch_scc1 L_ka_fl_all3
L_ka_fl_all3_ok:
    v_mov_b32 v253, v152
    s_mov_b32 s54, 0x480000
    buffer_load_dwordx4 v[160:163], v240, s[8:11], s54 offen offset:0 sc1
    buffer_load_dwordx4 v[164:167], v240, s[8:11], s54 offen offset:1024 sc1
    buffer_load_dwordx4 v[168:171], v240, s[8:11], s54 offen offset:2048 sc1
    buffer_load_dwordx4 v[172:175], v240, s[8:11], s54 offen offset:3072 sc1
    s_add_u32 s54, s54, 4096
    buffer_load_dwordx4 v[176:179], v240, s[8:11], s54 offen offset:0 sc1
    buffer_load_dwordx4 v[180:183], v240, s[8:11], s54 offen offset:1024 sc1
    buffer_load_dwordx4 v[184:187], v240, s[8:11], s54 offen offset:2048 sc1
    buffer_load_dwordx4 v[188:191], v240, s[8:11], s54 offen offset:3072 sc1
L_k2_notk1:
    v_mfma_f32_32x32x16_bf16 v[48:63], a[172:175], a[192:195], v[48:63]
    v_mfma_f32_32x32x16_bf16 v[112:127], a[172:175], a[196:199], v[112:127]
    s_waitcnt vmcnt(11)
    s_waitcnt lgkmcnt(0)
    v_mfma_f32_32x32x16_bf16 v[0:15], a[176:179], a[200:203], v[0:15]
    ds_read_b64_tr_b16 a[160:161], v242 offset:40960
    ds_read_b64_tr_b16 a[162:163], v242 offset:41984
    v_mfma_f32_32x32x16_bf16 v[64:79], a[176:179], a[204:207], v[64:79]
    ds_read_b64_tr_b16 a[164:165], v243 offset:40960
    ds_read_b64_tr_b16 a[166:167], v243 offset:41984
    v_mfma_f32_32x32x16_bf16 v[16:31], a[180:183], a[200:203], v[16:31]
    ds_read_b64_tr_b16 a[168:169], v244 offset:40960
    ds_read_b64_tr_b16 a[170:171], v244 offset:41984
    v_mfma_f32_32x32x16_bf16 v[80:95], a[180:183], a[204:207], v[80:95]
    ds_read_b64_tr_b16 a[172:173], v245 offset:40960
    ds_read_b64_tr_b16 a[174:175], v245 offset:41984
    v_mfma_f32_32x32x16_bf16 v[32:47], a[184:187], a[200:203], v[32:47]
    v_mfma_f32_32x32x16_bf16 v[96:111], a[184:187], a[204:207], v[96:111]
    buffer_load_dword v254, v253, s[8:11], s57 offen sc1
    v_mfma_f32_32x32x16_bf16 v[48:63], a[188:191], a[200:203], v[48:63]
    v_mfma_f32_32x32x16_bf16 v[112:127], a[188:191], a[204:207], v[112:127]
    s_waitcnt vmcnt(9)
    s_waitcnt lgkmcnt(0)
    v_mfma_f32_32x32x16_bf16 v[0:15], a[160:163], a[208:211], v[0:15]
    ds_read_b64_tr_b16 a[176:177], v242 offset:45056
    ds_read_b64_tr_b16 a[178:179], v242 offset:46080
    v_mfma_f32_32x32x16_bf16 v[64:79], a[160:163], a[212:215], v[64:79]
    ds_read_b64_tr_b16 a[180:181], v243 offset:45056
    ds_read_b64_tr_b16 a[182:183], v243 offset:46080
    v_mfma_f32_32x32x16_bf16 v[16:31], a[164:167], a[208:211], v[16:31]
    ds_read_b64_tr_b16 a[184:185], v244 offset:45056
    ds_read_b64_tr_b16 a[186:187], v244 offset:46080
    v_mfma_f32_32x32x16_bf16 v[80:95], a[164:167], a[212:215], v[80:95]
    ds_read_b64_tr_b16 a[188:189], v245 offset:45056
    ds_read_b64_tr_b16 a[190:191], v245 offset:46080
    v_mfma_f32_32x32x16_bf16 v[32:47], a[168:171], a[208:211], v[32:47]
    v_mfma_f32_32x32x16_bf16 v[96:111], a[168:171], a[212:215], v[96:111]
    v_mfma_f32_32x32x16_bf16 v[48:63], a[172:175], a[208:211], v[48:63]
    v_mfma_f32_32x32x16_bf16 v[112:127], a[172:175], a[212:215], v[112:127]
    s_waitcnt vmcnt(6)
    s_waitcnt lgkmcnt(0)
    s_waitcnt vmcnt(1)
    s_barrier
    s_waitcnt vmcnt(0)
    s_mov_b32 s55, 0
L_ka_fl_kv:
    v_cmp_ne_u32 vcc, s58, v254
    s_cbranch_vccz L_ka_fl_kv_ok
    s_sleep 8
    buffer_load_dword v254, v253, s[8:11], s57 offen sc1
    s_add_u32 s55, s55, 1
    s_cmp_lt_u32 s55, 0x40000
    s_waitcnt vmcnt(0)
    s_cbranch_scc1 L_ka_fl_kv
L_ka_fl_kv_ok:
    v_mfma_f32_32x32x16_bf16 v[0:15], a[176:179], a[216:219], v[0:15]
    v_mfma_f32_32x32x16_bf16 v[64:79], a[176:179], a[220:223], v[64:79]
    v_mfma_f32_32x32x16_bf16 v[16:31], a[180:183], a[216:219], v[16:31]
    v_mfma_f32_32x32x16_bf16 v[80:95], a[180:183], a[220:223], v[80:95]
    v_mfma_f32_32x32x16_bf16 v[32:47], a[184:187], a[216:219], v[32:47]
    s_add_u32 m0, s3, 65536
    s_nop 0
    buffer_load_dwordx4 v240, s[8:11], s63 offen offset:0 sc1 lds
    buffer_load_dwordx4 v240, s[8:11], s63 offen offset:1024 sc1 lds
    buffer_load_dwordx4 v240, s[8:11], s63 offen offset:2048 sc1 lds
    buffer_load_dwordx4 v240, s[8:11], s63 offen offset:3072 sc1 lds
    s_add_u32 s63, s63, 16384
    v_mfma_f32_32x32x16_bf16 v[96:111], a[184:187], a[220:223], v[96:111]
    v_mfma_f32_32x32x16_bf16 v[48:63], a[188:191], a[216:219], v[48:63]
    s_add_u32 m0, s3, 81920
    s_nop 0
    buffer_load_dwordx4 v240, s[8:11], s63 offen offset:0 sc1 lds
    buffer_load_dwordx4 v240, s[8:11], s63 offen offset:1024 sc1 lds
    buffer_load_dwordx4 v240, s[8:11], s63 offen offset:2048 sc1 lds
    buffer_load_dwordx4 v240, s[8:11], s63 offen offset:3072 sc1 lds
    s_add_u32 s63, s63, 16384
    v_mfma_f32_32x32x16_bf16 v[112:127], a[188:191], a[220:223], v[112:127]
    s_add_u32 m0, s3, 98304
    s_nop 0
    buffer_load_dwordx4 v240, s[8:11], s63 offen offset:0 sc1 lds
    buffer_load_dwordx4 v240, s[8:11], s63 offen offset:1024 sc1 lds
    buffer_load_dwordx4 v240, s[8:11], s63 offen offset:2048 sc1 lds
    buffer_load_dwordx4 v240, s[8:11], s63 offen offset:3072 sc1 lds
    s_add_u32 s63, s63, 16384
    s_cmp_ge_u32 s44, 2
    s_cbranch_scc1 L_ka_nov_1
    s_add_u32 m0, s3, 114688
    s_nop 0
    buffer_load_dwordx4 v240, s[8:11], s63 offen offset:0 sc1 lds
    buffer_load_dwordx4 v240, s[8:11], s63 offen offset:1024 sc1 lds
    buffer_load_dwordx4 v240, s[8:11], s63 offen offset:2048 sc1 lds
    buffer_load_dwordx4 v240, s[8:11], s63 offen offset:3072 sc1 lds
    s_add_u32 s63, s63, 16384
L_ka_nov_1:
    s_cmp_ge_u32 s44, 2
    s_cbranch_scc1 L_ka_nov_2
    s_add_u32 m0, s3, 0
    s_nop 0
    buffer_load_dwordx4 v240, s[8:11], s63 offen offset:0 sc1 lds
    buffer_load_dwordx4 v240, s[8:11], s63 offen offset:1024 sc1 lds
    buffer_load_dwordx4 v240, s[8:11], s63 offen offset:2048 sc1 lds
    buffer_load_dwordx4 v240, s[8:11], s63 offen offset:3072 sc1 lds
    s_add_u32 s63, s63, 16384
L_ka_nov_2:
    v_lshrrev_b32 v252, 5, v241
    v_bfe_u32 v254, v241, 2, 2
    v_lshl_add_u32 v252, v252, 2, v254
    v_mul_u32_u24 v252, 1152, v252
    v_bfe_u32 v254, v241, 4, 1
    v_lshl_add_u32 v252, v254, 5, v252
    v_and_b32 v254, 3, v241
    v_lshl_add_u32 v252, v254, 3, v252
    s_lshl_b32 s52, s44, 6
    s_add_u32 s52, s52, 131072
    v_add_u32 v252, s52, v252
    ds_read_b64_tr_b16 v[128:129], v252 offset:0
    ds_read_b64_tr_b16 v[130:131], v252 offset:9216
    ds_read_b64_tr_b16 v[132:133], v252 offset:256
    ds_read_b64_tr_b16 v[134:135], v252 offset:9472
    ds_read_b64_tr_b16 v[136:137], v252 offset:512
    ds_read_b64_tr_b16 v[138:139], v252 offset:9728
    ds_read_b64_tr_b16 v[140:141], v252 offset:768
    ds_read_b64_tr_b16 v[142:143], v252 offset:9984
    ds_read_b64_tr_b16 v[144:145], v252 offset:1024
    ds_read_b64_tr_b16 v[146:147], v252 offset:10240
    s_mul_i32 s52, s2, 18432
    s_lshl_b32 s53, s44, 10
    s_add_u32 s52, s52, s53
    s_add_u32 s52, s52, 0x4000000
    s_waitcnt lgkmcnt(0)
    buffer_store_dwordx4 v[128:131], v240, s[8:11], s52 offen sc1
    s_add_u32 s52, s52, 4096
    buffer_store_dwordx4 v[132:135], v240, s[8:11], s52 offen sc1
    s_add_u32 s52, s52, 4096
    buffer_store_dwordx4 v[136:139], v240, s[8:11], s52 offen sc1
    s_add_u32 s52, s52, 4096
    buffer_store_dwordx4 v[140:143], v240, s[8:11], s52 offen sc1
    s_add_u32 s52, s52, 4096
    s_cmp_lt_u32 s44, 2
    s_cselect_b32 s52, s52, 0x40000000
    buffer_store_dwordx4 v[144:147], v240, s[8:11], s52 offen sc1
    s_cmp_lg_u32 s2, 0
    s_cbranch_scc1 L_k2_notopk
    s_cmp_lg_u32 s44, 1
    s_cbranch_scc1 L_k2_notopk
    v_mov_b32 v152, 0
    v_mov_b32 v153, 0
    v_mov_b32 v154, 0
    v_mov_b32 v155, 0
    s_mov_b32 s52, 0x483000
    buffer_store_dwordx4 v[152:155], v240, s[8:11], s52 offen offset:0 sc1
    buffer_store_dwordx4 v[152:155], v240, s[8:11], s52 offen offset:1024 sc1
    buffer_store_dwordx4 v[152:155], v240, s[8:11], s52 offen offset:2048 sc1
    buffer_store_dwordx4 v[152:155], v240, s[8:11], s52 offen offset:3072 sc1
    s_mov_b32 s52, 0x484000
    buffer_store_dwordx4 v[152:155], v240, s[8:11], s52 offen offset:0 sc1
    buffer_store_dwordx4 v[152:155], v240, s[8:11], s52 offen offset:1024 sc1
    buffer_store_dwordx4 v[152:155], v240, s[8:11], s52 offen offset:2048 sc1
    buffer_store_dwordx4 v[152:155], v240, s[8:11], s52 offen offset:3072 sc1
    s_mov_b32 s52, 0x485000
    buffer_store_dwordx4 v[152:155], v240, s[8:11], s52 offen offset:0 sc1
    buffer_store_dwordx4 v[152:155], v240, s[8:11], s52 offen offset:1024 sc1
    buffer_store_dwordx4 v[152:155], v240, s[8:11], s52 offen offset:2048 sc1
    buffer_store_dwordx4 v[152:155], v240, s[8:11], s52 offen offset:3072 sc1
    s_mov_b32 s52, 0x486000
    buffer_store_dwordx4 v[152:155], v240, s[8:11], s52 offen offset:0 sc1
    buffer_store_dwordx4 v[152:155], v240, s[8:11], s52 offen offset:1024 sc1
    buffer_store_dwordx4 v[152:155], v240, s[8:11], s52 offen offset:2048 sc1
    buffer_store_dwordx4 v[152:155], v240, s[8:11], s52 offen offset:3072 sc1
    s_mov_b32 s52, 0x487000
    buffer_store_dwordx4 v[152:155], v240, s[8:11], s52 offen offset:0 sc1
    buffer_store_dwordx4 v[152:155], v240, s[8:11], s52 offen offset:1024 sc1
L_k2_notopk:
    s_cmp_lg_u32 s69, 0
    s_cbranch_scc1 L_k2_notk
    s_waitcnt vmcnt(13)
    v_lshlrev_b32 v224, 2, v241
    v_sub_u32 v224, 2047, v224
    s_mov_b32 s52, 0xffff0000
    s_mov_b32 s54, m0
    v_ashrrev_i32 v225, 31, v160
    v_or_b32 v225, 0x80000000, v225
    v_xor_b32 v225, v225, v160
    v_subrev_u32 v226, 0, v224
    v_and_or_b32 v160, v225, s52, v226
    v_ashrrev_i32 v225, 31, v161
    v_or_b32 v225, 0x80000000, v225
    v_xor_b32 v225, v225, v161
    v_subrev_u32 v226, 1, v224
    v_and_or_b32 v161, v225, s52, v226
    v_ashrrev_i32 v225, 31, v162
    v_or_b32 v225, 0x80000000, v225
    v_xor_b32 v225, v225, v162
    v_subrev_u32 v226, 2, v224
    v_and_or_b32 v162, v225, s52, v226
    v_ashrrev_i32 v225, 31, v163
    v_or_b32 v225, 0x80000000, v225
    v_xor_b32 v225, v225, v163
    v_subrev_u32 v226, 3, v224
    v_and_or_b32 v163, v225, s52, v226
    v_ashrrev_i32 v225, 31, v164
    v_or_b32 v225, 0x80000000, v225
    v_xor_b32 v225, v225, v164
    v_subrev_u32 v226, 256, v224
    v_and_or_b32 v164, v225, s52, v226
    v_ashrrev_i32 v225, 31, v165
    v_or_b32 v225, 0x80000000, v225
    v_xor_b32 v225, v225, v165
    v_subrev_u32 v226, 257, v224
    v_and_or_b32 v165, v225, s52, v226
    v_ashrrev_i32 v225, 31, v166
    v_or_b32 v225, 0x80000000, v225
    v_xor_b32 v225, v225, v166
    v_subrev_u32 v226, 258, v224
    v_and_or_b32 v166, v225, s52, v226
    v_ashrrev_i32 v225, 31, v167
    v_or_b32 v225, 0x80000000, v225
    v_xor_b32 v225, v225, v167
    v_subrev_u32 v226, 259, v224
    v_and_or_b32 v167, v225, s52, v226
    v_ashrrev_i32 v225, 31, v168
    v_or_b32 v225, 0x80000000, v225
    v_xor_b32 v225, v225, v168
    v_subrev_u32 v226, 512, v224
    v_and_or_b32 v168, v225, s52, v226
    v_ashrrev_i32 v225, 31, v169
    v_or_b32 v225, 0x80000000, v225
    v_xor_b32 v225, v225, v169
    v_subrev_u32 v226, 513, v224
    v_and_or_b32 v169, v225, s52, v226
    v_ashrrev_i32 v225, 31, v170
    v_or_b32 v225, 0x80000000, v225
    v_xor_b32 v225, v225, v170
    v_subrev_u32 v226, 514, v224
    v_and_or_b32 v170, v225, s52, v226
    v_ashrrev_i32 v225, 31, v171
    v_or_b32 v225, 0x80000000, v225
    v_xor_b32 v225, v225, v171
    v_subrev_u32 v226, 515, v224
    v_and_or_b32 v171, v225, s52, v226
    v_ashrrev_i32 v225, 31, v172
    v_or_b32 v225, 0x80000000, v225
    v_xor_b32 v225, v225, v172
    v_subrev_u32 v226, 768, v224
    v_and_or_b32 v172, v225, s52, v226
    v_ashrrev_i32 v225, 31, v173
    v_or_b32 v225, 0x80000000, v225
    v_xor_b32 v225, v225, v173
    v_subrev_u32 v226, 769, v224
    v_and_or_b32 v173, v225, s52, v226
    v_ashrrev_i32 v225, 31, v174
    v_or_b32 v225, 0x80000000, v225
    v_xor_b32 v225, v225, v174
    v_subrev_u32 v226, 770, v224
    v_and_or_b32 v174, v225, s52, v226
    v_ashrrev_i32 v225, 31, v175
    v_or_b32 v225, 0x80000000, v225
    v_xor_b32 v225, v225, v175
    v_subrev_u32 v226, 771, v224
    v_and_or_b32 v175, v225, s52, v226
    v_ashrrev_i32 v225, 31, v176
    v_or_b32 v225, 0x80000000, v225
    v_xor_b32 v225, v225, v176
    v_subrev_u32 v226, 1024, v224
    v_and_or_b32 v176, v225, s52, v226
    v_ashrrev_i32 v225, 31, v177
    v_or_b32 v225, 0x80000000, v225
    v_xor_b32 v225, v225, v177
    v_subrev_u32 v226, 1025, v224
    v_and_or_b32 v177, v225, s52, v226
    v_ashrrev_i32 v225, 31, v178
    v_or_b32 v225, 0x80000000, v225
    v_xor_b32 v225, v225, v178
    v_subrev_u32 v226, 1026, v224
    v_and_or_b32 v178, v225, s52, v226
    v_ashrrev_i32 v225, 31, v179
    v_or_b32 v225, 0x80000000, v225
    v_xor_b32 v225, v225, v179
    v_subrev_u32 v226, 1027, v224
    v_and_or_b32 v179, v225, s52, v226
    v_ashrrev_i32 v225, 31, v180
    v_or_b32 v225, 0x80000000, v225
    v_xor_b32 v225, v225, v180
    v_subrev_u32 v226, 1280, v224
    v_and_or_b32 v180, v225, s52, v226
    v_ashrrev_i32 v225, 31, v181
    v_or_b32 v225, 0x80000000, v225
    v_xor_b32 v225, v225, v181
    v_subrev_u32 v226, 1281, v224
    v_and_or_b32 v181, v225, s52, v226
    v_ashrrev_i32 v225, 31, v182
    v_or_b32 v225, 0x80000000, v225
    v_xor_b32 v225, v225, v182
    v_subrev_u32 v226, 1282, v224
    v_and_or_b32 v182, v225, s52, v226
    v_ashrrev_i32 v225, 31, v183
    v_or_b32 v225, 0x80000000, v225
    v_xor_b32 v225, v225, v183
    v_subrev_u32 v226, 1283, v224
    v_and_or_b32 v183, v225, s52, v226
    v_ashrrev_i32 v225, 31, v184
    v_or_b32 v225, 0x80000000, v225
    v_xor_b32 v225, v225, v184
    v_subrev_u32 v226, 1536, v224
    v_and_or_b32 v184, v225, s52, v226
    v_ashrrev_i32 v225, 31, v185
    v_or_b32 v225, 0x80000000, v225
    v_xor_b32 v225, v225, v185
    v_subrev_u32 v226, 1537, v224
    v_and_or_b32 v185, v225, s52, v226
    v_ashrrev_i32 v225, 31, v186
    v_or_b32 v225, 0x80000000, v225
    v_xor_b32 v225, v225, v186
    v_subrev_u32 v226, 1538, v224
    v_and_or_b32 v186, v225, s52, v226
    v_ashrrev_i32 v225, 31, v187
    v_or_b32 v225, 0x80000000, v225
    v_xor_b32 v225, v225, v187
    v_subrev_u32 v226, 1539, v224
    v_and_or_b32 v187, v225, s52, v226
    v_ashrrev_i32 v225, 31, v188
    v_or_b32 v225, 0x80000000, v225
    v_xor_b32 v225, v225, v188
    v_subrev_u32 v226, 1792, v224
    v_and_or_b32 v188, v225, s52, v226
    v_ashrrev_i32 v225, 31, v189
    v_or_b32 v225, 0x80000000, v225
    v_xor_b32 v225, v225, v189
    v_subrev_u32 v226, 1793, v224
    v_and_or_b32 v189, v225, s52, v226
    v_ashrrev_i32 v225, 31, v190
    v_or_b32 v225, 0x80000000, v225
    v_xor_b32 v225, v225, v190
    v_subrev_u32 v226, 1794, v224
    v_and_or_b32 v190, v225, s52, v226
    v_ashrrev_i32 v225, 31, v191
    v_or_b32 v225, 0x80000000, v225
    v_xor_b32 v225, v225, v191
    v_subrev_u32 v226, 1795, v224
    v_and_or_b32 v191, v225, s52, v226
    s_mov_b32 s52, 0
    v_mov_b32 v232, 0
    s_mov_b32 m0, 0
L_k3_tk:
    v_mov_b32 v224, 0
    v_mov_b32 v225, 0
    v_subrev_u32 v226, s52, v160
    v_subrev_u32 v227, s52, v161
    v_subrev_u32 v228, s52, v162
    v_subrev_u32 v229, s52, v163
    v_max3_u32 v224, v224, v226, v227
    v_max3_u32 v225, v225, v228, v229
    v_subrev_u32 v226, s52, v164
    v_subrev_u32 v227, s52, v165
    v_subrev_u32 v228, s52, v166
    v_subrev_u32 v229, s52, v167
    v_max3_u32 v224, v224, v226, v227
    v_max3_u32 v225, v225, v228, v229
    v_subrev_u32 v226, s52, v168
    v_subrev_u32 v227, s52, v169
    v_subrev_u32 v228, s52, v170
    v_subrev_u32 v229, s52, v171
    v_max3_u32 v224, v224, v226, v227
    v_max3_u32 v225, v225, v228, v229
    v_subrev_u32 v226, s52, v172
    v_subrev_u32 v227, s52, v173
    v_subrev_u32 v228, s52, v174
    v_subrev_u32 v229, s52, v175
    v_max3_u32 v224, v224, v226, v227
    v_max3_u32 v225, v225, v228, v229
    v_subrev_u32 v226, s52, v176
    v_subrev_u32 v227, s52, v177
    v_subrev_u32 v228, s52, v178
    v_subrev_u32 v229, s52, v179
    v_max3_u32 v224, v224, v226, v227
    v_max3_u32 v225, v225, v228, v229
    v_subrev_u32 v226, s52, v180
    v_subrev_u32 v227, s52, v181
    v_subrev_u32 v228, s52, v182
    v_subrev_u32 v229, s52, v183
    v_max3_u32 v224, v224, v226, v227
    v_max3_u32 v225, v225, v228, v229
    v_subrev_u32 v226, s52, v184
    v_subrev_u32 v227, s52, v185
    v_subrev_u32 v228, s52, v186
    v_subrev_u32 v229, s52, v187
    v_max3_u32 v224, v224, v226, v227
    v_max3_u32 v225, v225, v228, v229
    v_subrev_u32 v226, s52, v188
    v_subrev_u32 v227, s52, v189
    v_subrev_u32 v228, s52, v190
    v_subrev_u32 v229, s52, v191
    v_max3_u32 v224, v224, v226, v227
    v_max3_u32 v225, v225, v228, v229
    v_max_u32 v224, v224, v225
    s_nop 1
    v_max_u32_dpp v224, v224, v224 quad_perm:[1,0,3,2] row_mask:0xf bank_mask:0xf
    s_nop 1
    v_max_u32_dpp v224, v224, v224 quad_perm:[2,3,0,1] row_mask:0xf bank_mask:0xf
    s_nop 1
    v_max_u32_dpp v224, v224, v224 row_half_mirror row_mask:0xf bank_mask:0xf
    s_nop 1
    v_max_u32_dpp v224, v224, v224 row_mirror row_mask:0xf bank_mask:0xf
    v_mov_b32 v225, v224
    s_nop 1
    v_permlane16_swap_b32 v224, v225
    v_max_u32 v224, v224, v225
    v_mov_b32 v225, v224
    s_nop 1
    v_permlane32_swap_b32 v224, v225
    v_max_u32 v224, v224, v225
    s_nop 0
    v_readfirstlane_b32 s53, v224
    s_nop 3
    s_add_u32 s52, s52, s53
    s_nop 0
    v_writelane_b32 v232, s52, m0
    s_add_u32 m0, m0, 1
    s_cmp_lt_u32 m0, 8
    s_cbranch_scc1 L_k3_tk
    s_mov_b32 m0, s54
    v_and_b32 v224, 0xffff, v232
    v_sub_u32 v224, 2047, v224
    v_mov_b32 v225, s58
    v_mov_b32 v227, s58
    v_ashrrev_i32 v226, 31, v232
    v_not_b32 v226, v226
    v_or_b32 v226, 0x80000000, v226
    v_xor_b32 v226, v226, v232
    v_and_b32 v226, 0xffff0000, v226
    v_mul_f32 v226, 0xbfb8aa3b, v226
    v_exp_f32 v226, v226
    s_nop 0
    v_add_f32 v226, 1.0, v226
    v_rcp_f32 v226, v226
    s_nop 0
    v_cvt_pk_bf16_f32 v226, v226, v226
    v_and_b32 v226, 0xffff0000, v226
    v_lshlrev_b32 v228, 3, v241
    s_mov_b32 s52, 0x482000
    s_mov_b64 exec, 0xff
    buffer_store_dwordx2 v[224:225], v228, s[8:11], s52 offen sc1
    buffer_store_dwordx2 v[226:227], v228, s[8:11], s52 offen offset:64 sc1
    s_mov_b64 exec, -1
L_k2_notk:
    s_mov_b32 s52, 0x3e0293ee
    s_nop 7
    v_mul_f32 v64, s52, v64
    v_mul_f32 v65, s52, v65
    v_mul_f32 v66, s52, v66
    v_mul_f32 v67, s52, v67
    v_mul_f32 v68, s52, v68
    v_mul_f32 v69, s52, v69
    v_mul_f32 v70, s52, v70
    v_mul_f32 v71, s52, v71
    v_mul_f32 v72, s52, v72
    v_mul_f32 v73, s52, v73
    v_mul_f32 v74, s52, v74
    v_mul_f32 v75, s52, v75
    v_mul_f32 v76, s52, v76
    v_mul_f32 v77, s52, v77
    v_mul_f32 v78, s52, v78
    v_mul_f32 v79, s52, v79
    v_mul_f32 v80, s52, v80
    v_mul_f32 v81, s52, v81
    v_mul_f32 v82, s52, v82
    v_mul_f32 v83, s52, v83
    v_mul_f32 v84, s52, v84
    v_mul_f32 v85, s52, v85
    v_mul_f32 v86, s52, v86
    v_mul_f32 v87, s52, v87
    v_mul_f32 v88, s52, v88
    v_mul_f32 v89, s52, v89
    v_mul_f32 v90, s52, v90
    v_mul_f32 v91, s52, v91
    v_mul_f32 v92, s52, v92
    v_mul_f32 v93, s52, v93
    v_mul_f32 v94, s52, v94
    v_mul_f32 v95, s52, v95
    v_mul_f32 v96, s52, v96
    v_mul_f32 v97, s52, v97
    v_mul_f32 v98, s52, v98
    v_mul_f32 v99, s52, v99
    v_mul_f32 v100, s52, v100
    v_mul_f32 v101, s52, v101
    v_mul_f32 v102, s52, v102
    v_mul_f32 v103, s52, v103
    v_mul_f32 v104, s52, v104
    v_mul_f32 v105, s52, v105
    v_mul_f32 v106, s52, v106
    v_mul_f32 v107, s52, v107
    v_mul_f32 v108, s52, v108
    v_mul_f32 v109, s52, v109
    v_mul_f32 v110, s52, v110
    v_mul_f32 v111, s52, v111
    v_mul_f32 v112, s52, v112
    v_mul_f32 v113, s52, v113
    v_mul_f32 v114, s52, v114
    v_mul_f32 v115, s52, v115
    v_mul_f32 v116, s52, v116
    v_mul_f32 v117, s52, v117
    v_mul_f32 v118, s52, v118
    v_mul_f32 v119, s52, v119
    v_mul_f32 v120, s52, v120
    v_mul_f32 v121, s52, v121
    v_mul_f32 v122, s52, v122
    v_mul_f32 v123, s52, v123
    v_mul_f32 v124, s52, v124
    v_mul_f32 v125, s52, v125
    v_mul_f32 v126, s52, v126
    v_mul_f32 v127, s52, v127
    v_cvt_pk_bf16_f32 v192, v64, v65
    v_cvt_pk_bf16_f32 v193, v66, v67
    v_cvt_pk_bf16_f32 v194, v68, v69
    v_cvt_pk_bf16_f32 v195, v70, v71
    v_cvt_pk_bf16_f32 v196, v72, v73
    v_cvt_pk_bf16_f32 v197, v74, v75
    v_cvt_pk_bf16_f32 v198, v76, v77
    v_cvt_pk_bf16_f32 v199, v78, v79
    v_cvt_pk_bf16_f32 v200, v80, v81
    v_cvt_pk_bf16_f32 v201, v82, v83
    v_cvt_pk_bf16_f32 v202, v84, v85
    v_cvt_pk_bf16_f32 v203, v86, v87
    v_cvt_pk_bf16_f32 v204, v88, v89
    v_cvt_pk_bf16_f32 v205, v90, v91
    v_cvt_pk_bf16_f32 v206, v92, v93
    v_cvt_pk_bf16_f32 v207, v94, v95
    v_cvt_pk_bf16_f32 v208, v96, v97
    v_cvt_pk_bf16_f32 v209, v98, v99
    v_cvt_pk_bf16_f32 v210, v100, v101
    v_cvt_pk_bf16_f32 v211, v102, v103
    v_cvt_pk_bf16_f32 v212, v104, v105
    v_cvt_pk_bf16_f32 v213, v106, v107
    v_cvt_pk_bf16_f32 v214, v108, v109
    v_cvt_pk_bf16_f32 v215, v110, v111
    v_cvt_pk_bf16_f32 v216, v112, v113
    v_cvt_pk_bf16_f32 v217, v114, v115
    v_cvt_pk_bf16_f32 v218, v116, v117
    v_cvt_pk_bf16_f32 v219, v118, v119
    v_cvt_pk_bf16_f32 v220, v120, v121
    v_cvt_pk_bf16_f32 v221, v122, v123
    v_cvt_pk_bf16_f32 v222, v124, v125
    v_cvt_pk_bf16_f32 v223, v126, v127
    v_mul_f32 v0, s52, v0
    v_mul_f32 v1, s52, v1
    v_mul_f32 v2, s52, v2
    v_mul_f32 v3, s52, v3
    v_mul_f32 v4, s52, v4
    v_mul_f32 v5, s52, v5
    v_mul_f32 v6, s52, v6
    v_mul_f32 v7, s52, v7
    v_mul_f32 v8, s52, v8
    v_mul_f32 v9, s52, v9
    v_mul_f32 v10, s52, v10
    v_mul_f32 v11, s52, v11
    v_mul_f32 v12, s52, v12
    v_mul_f32 v13, s52, v13
    v_mul_f32 v14, s52, v14
    v_mul_f32 v15, s52, v15
    v_mul_f32 v16, s52, v16
    v_mul_f32 v17, s52, v17
    v_mul_f32 v18, s52, v18
    v_mul_f32 v19, s52, v19
    v_mul_f32 v20, s52, v20
    v_mul_f32 v21, s52, v21
    v_mul_f32 v22, s52, v22
    v_mul_f32 v23, s52, v23
    v_mul_f32 v24, s52, v24
    v_mul_f32 v25, s52, v25
    v_mul_f32 v26, s52, v26
    v_mul_f32 v27, s52, v27
    v_mul_f32 v28, s52, v28
    v_mul_f32 v29, s52, v29
    v_mul_f32 v30, s52, v30
    v_mul_f32 v31, s52, v31
    v_mul_f32 v32, s52, v32
    v_mul_f32 v33, s52, v33
    v_mul_f32 v34, s52, v34
    v_mul_f32 v35, s52, v35
    v_mul_f32 v36, s52, v36
    v_mul_f32 v37, s52, v37
    v_mul_f32 v38, s52, v38
    v_mul_f32 v39, s52, v39
    v_mul_f32 v40, s52, v40
    v_mul_f32 v41, s52, v41
    v_mul_f32 v42, s52, v42
    v_mul_f32 v43, s52, v43
    v_mul_f32 v44, s52, v44
    v_mul_f32 v45, s52, v45
    v_mul_f32 v46, s52, v46
    v_mul_f32 v47, s52, v47
    v_mul_f32 v48, s52, v48
    v_mul_f32 v49, s52, v49
    v_mul_f32 v50, s52, v50
    v_mul_f32 v51, s52, v51
    v_mul_f32 v52, s52, v52
    v_mul_f32 v53, s52, v53
    v_mul_f32 v54, s52, v54
    v_mul_f32 v55, s52, v55
    v_mul_f32 v56, s52, v56
    v_mul_f32 v57, s52, v57
    v_mul_f32 v58, s52, v58
    v_mul_f32 v59, s52, v59
    v_mul_f32 v60, s52, v60
    v_mul_f32 v61, s52, v61
    v_mul_f32 v62, s52, v62
    v_mul_f32 v63, s52, v63
    v_cvt_pk_bf16_f32 v64, v0, v1
    v_cvt_pk_bf16_f32 v65, v2, v3
    v_cvt_pk_bf16_f32 v66, v4, v5
    v_cvt_pk_bf16_f32 v67, v6, v7
    v_cvt_pk_bf16_f32 v68, v8, v9
    v_cvt_pk_bf16_f32 v69, v10, v11
    v_cvt_pk_bf16_f32 v70, v12, v13
    v_cvt_pk_bf16_f32 v71, v14, v15
    v_cvt_pk_bf16_f32 v72, v16, v17
    v_cvt_pk_bf16_f32 v73, v18, v19
    v_cvt_pk_bf16_f32 v74, v20, v21
    v_cvt_pk_bf16_f32 v75, v22, v23
    v_cvt_pk_bf16_f32 v76, v24, v25
    v_cvt_pk_bf16_f32 v77, v26, v27
    v_cvt_pk_bf16_f32 v78, v28, v29
    v_cvt_pk_bf16_f32 v79, v30, v31
    v_cvt_pk_bf16_f32 v80, v32, v33
    v_cvt_pk_bf16_f32 v81, v34, v35
    v_cvt_pk_bf16_f32 v82, v36, v37
    v_cvt_pk_bf16_f32 v83, v38, v39
    v_cvt_pk_bf16_f32 v84, v40, v41
    v_cvt_pk_bf16_f32 v85, v42, v43
    v_cvt_pk_bf16_f32 v86, v44, v45
    v_cvt_pk_bf16_f32 v87, v46, v47
    v_cvt_pk_bf16_f32 v88, v48, v49
    v_cvt_pk_bf16_f32 v89, v50, v51
    v_cvt_pk_bf16_f32 v90, v52, v53
    v_cvt_pk_bf16_f32 v91, v54, v55
    v_cvt_pk_bf16_f32 v92, v56, v57
    v_cvt_pk_bf16_f32 v93, v58, v59
    v_cvt_pk_bf16_f32 v94, v60, v61
    v_cvt_pk_bf16_f32 v95, v62, v63
    v_mov_b32 v184, v240
    v_add_u32 v183, 0x10000, v240
    v_lshlrev_b32 v252, 7, v241
    v_cmp_gt_u32 vcc, 32, v241
    v_mov_b32 v250, 0x40000000
    s_mov_b32 s56, 0
    v_cndmask_b32 v250, v250, v252, vcc
    s_cmp_lt_u32 s44, 2
    s_cselect_b32 s52, 1, 7
    s_lshl_b32 s52, s52, 14
    s_add_u32 m0, s52, s3
    v_and_b32 v187, 31, v241
    v_lshrrev_b32 v188, 5, v241
    v_lshlrev_b32 v188, 2, v188
    v_sub_u32 v187, v187, v188
    v_mov_b32 v188, 0xff800000
    v_cmp_gt_i32 s[74:75], 0, v187
    v_cmp_gt_i32 s[76:77], 1, v187
    v_cmp_gt_i32 s[78:79], 2, v187
    v_cmp_gt_i32 vcc, 3, v187
    v_cndmask_b32 v144, 0, v188, s[74:75]
    v_cndmask_b32 v145, 0, v188, s[76:77]
    v_cndmask_b32 v146, 0, v188, s[78:79]
    v_cndmask_b32 v147, 0, v188, vcc
    v_cmp_gt_i32 s[74:75], 8, v187
    v_cmp_gt_i32 s[76:77], 9, v187
    v_cmp_gt_i32 s[78:79], 10, v187
    v_cmp_gt_i32 vcc, 11, v187
    v_cndmask_b32 v148, 0, v188, s[74:75]
    v_cndmask_b32 v149, 0, v188, s[76:77]
    v_cndmask_b32 v150, 0, v188, s[78:79]
    v_cndmask_b32 v151, 0, v188, vcc
    v_cmp_gt_i32 s[74:75], 16, v187
    v_cmp_gt_i32 s[76:77], 17, v187
    v_cmp_gt_i32 s[78:79], 18, v187
    v_cmp_gt_i32 vcc, 19, v187
    v_cndmask_b32 v152, 0, v188, s[74:75]
    v_cndmask_b32 v153, 0, v188, s[76:77]
    v_cndmask_b32 v154, 0, v188, s[78:79]
    v_cndmask_b32 v155, 0, v188, vcc
    v_cmp_gt_i32 s[74:75], 24, v187
    v_cmp_gt_i32 s[76:77], 25, v187
    v_cmp_gt_i32 s[78:79], 26, v187
    v_cmp_gt_i32 vcc, 27, v187
    v_cndmask_b32 v156, 0, v188, s[74:75]
    v_cndmask_b32 v157, 0, v188, s[76:77]
    v_cndmask_b32 v158, 0, v188, s[78:79]
    v_cndmask_b32 v159, 0, v188, vcc
    v_mov_b32 v128, 0
    v_mov_b32 v224, 0
    v_mov_b32 v129, 0
    v_mov_b32 v225, 0
    v_mov_b32 v130, 0
    v_mov_b32 v226, 0
    v_mov_b32 v131, 0
    v_mov_b32 v227, 0
    v_mov_b32 v132, 0
    v_mov_b32 v228, 0
    v_mov_b32 v133, 0
    v_mov_b32 v229, 0
    v_mov_b32 v134, 0
    v_mov_b32 v230, 0
    v_mov_b32 v135, 0
    v_mov_b32 v231, 0
    v_mov_b32 v136, 0
    v_mov_b32 v232, 0
    v_mov_b32 v137, 0
    v_mov_b32 v233, 0
    v_mov_b32 v138, 0
    v_mov_b32 v234, 0
    v_mov_b32 v139, 0
    v_mov_b32 v235, 0
    v_mov_b32 v140, 0
    v_mov_b32 v236, 0
    v_mov_b32 v141, 0
    v_mov_b32 v237, 0
    v_mov_b32 v142, 0
    v_mov_b32 v238, 0
    v_mov_b32 v143, 0
    v_mov_b32 v239, 0
    v_mov_b32 v182, 0
    v_mov_b32 v185, 0
    s_cmp_eq_u32 s46, 0
    s_cselect_b32 s70, s44, 99
    s_sub_u32 s51, s46, 1
    s_waitcnt vmcnt(8)
    s_barrier
    ds_read_b128 a[0:3], v183 offset:0
    ds_read_b128 a[4:7], v183 offset:1024
    ds_read_b128 a[8:11], v183 offset:2048
    ds_read_b128 a[12:15], v183 offset:3072
    ds_read_b128 a[16:19], v183 offset:4096
    ds_read_b128 a[20:23], v183 offset:5120
    ds_read_b128 a[24:27], v183 offset:6144
    ds_read_b128 a[28:31], v183 offset:7168
    s_waitcnt lgkmcnt(4)
    v_mfma_f32_32x32x16_bf16 v[96:111], a[0:3], v[64:67], v[128:143]
    v_mfma_f32_32x32x16_bf16 v[96:111], a[4:7], v[68:71], v[96:111]
    v_mfma_f32_32x32x16_bf16 v[96:111], a[8:11], v[72:75], v[96:111]
    v_mfma_f32_32x32x16_bf16 v[96:111], a[12:15], v[76:79], v[96:111]
    s_waitcnt lgkmcnt(0)
    v_mfma_f32_32x32x16_bf16 v[96:111], a[16:19], v[80:83], v[96:111]
    v_mfma_f32_32x32x16_bf16 v[96:111], a[20:23], v[84:87], v[96:111]
    v_mfma_f32_32x32x16_bf16 v[96:111], a[24:27], v[88:91], v[96:111]
    v_mfma_f32_32x32x16_bf16 v[96:111], a[28:31], v[92:95], v[96:111]
    s_waitcnt vmcnt(4)
    s_barrier
    buffer_load_dwordx4 v240, s[8:11], s63 offen offset:0 sc1 lds
    s_nop 8
    v_exp_f32 v176, v96
    v_exp_f32 v177, v97
    v_exp_f32 v178, v98
    v_add_f32 v180, v176, v177
    v_cvt_pk_bf16_f32 v160, v176, v177
    buffer_load_dwordx4 v240, s[8:11], s63 offen offset:1024 sc1 lds
    v_exp_f32 v179, v99
    v_add_f32 v180, v180, v178
    v_exp_f32 v176, v100
    v_add_f32 v180, v180, v179
    v_cvt_pk_bf16_f32 v161, v178, v179
    v_exp_f32 v177, v101
    v_add_f32 v180, v180, v176
    s_cmp_gt_u32 s70, 0
    s_cbranch_scc1 L_k2_m_3
    v_mfma_f32_32x32x16_bf16 v[112:127], a[0:3], v[192:195], v[144:159]
    s_branch L_k2_m_4
L_k2_m_3:
    v_mfma_f32_32x32x16_bf16 v[112:127], a[0:3], v[192:195], v[224:239]
L_k2_m_4:
    v_exp_f32 v178, v102
    v_add_f32 v180, v180, v177
    v_cvt_pk_bf16_f32 v162, v176, v177
    v_mfma_f32_32x32x16_bf16 v[112:127], a[4:7], v[196:199], v[112:127]
    buffer_load_dwordx4 v240, s[8:11], s63 offen offset:2048 sc1 lds
    v_exp_f32 v179, v103
    v_add_f32 v180, v180, v178
    v_mfma_f32_32x32x16_bf16 v[112:127], a[8:11], v[200:203], v[112:127]
    v_exp_f32 v176, v104
    v_add_f32 v180, v180, v179
    v_cvt_pk_bf16_f32 v163, v178, v179
    v_mfma_f32_32x32x16_bf16 v[112:127], a[12:15], v[204:207], v[112:127]
    v_exp_f32 v177, v105
    v_add_f32 v180, v180, v176
    v_mfma_f32_32x32x16_bf16 v[112:127], a[16:19], v[208:211], v[112:127]
    v_exp_f32 v178, v106
    v_add_f32 v180, v180, v177
    v_cvt_pk_bf16_f32 v164, v176, v177
    v_mfma_f32_32x32x16_bf16 v[112:127], a[20:23], v[212:215], v[112:127]
    buffer_load_dwordx4 v240, s[8:11], s63 offen offset:3072 sc1 lds
    v_exp_f32 v179, v107
    v_add_f32 v180, v180, v178
    v_mfma_f32_32x32x16_bf16 v[112:127], a[24:27], v[216:219], v[112:127]
    v_exp_f32 v176, v108
    v_add_f32 v180, v180, v179
    v_cvt_pk_bf16_f32 v165, v178, v179
    v_mfma_f32_32x32x16_bf16 v[112:127], a[28:31], v[220:223], v[112:127]
    v_exp_f32 v177, v109
    s_add_u32 s63, s63, 16384
    v_add_f32 v180, v180, v176
    ds_read_b128 a[0:3], v183 offset:16384
    v_exp_f32 v178, v110
    v_add_f32 v180, v180, v177
    v_cvt_pk_bf16_f32 v166, v176, v177
    ds_read_b128 a[4:7], v183 offset:17408
    v_exp_f32 v179, v111
    s_add_u32 m0, m0, 16384
    v_add_f32 v180, v180, v178
    ds_read_b128 a[8:11], v183 offset:18432
    v_exp_f32 v176, v112
    v_add_f32 v180, v180, v179
    v_cvt_pk_bf16_f32 v167, v178, v179
    ds_read_b128 a[12:15], v183 offset:19456
    v_exp_f32 v177, v113
    s_and_b32 m0, m0, 0x1ffff
    v_mov_b32 v187, v180
    v_mov_b32 v188, v180
    v_cmp_lt_f32 s[78:79], s66, v180
    ds_read_b128 a[16:19], v183 offset:20480
    v_exp_f32 v178, v114
    v_permlane32_swap_b32 v187, v188
    v_add_f32 v181, v176, v177
    v_cvt_pk_bf16_f32 v168, v176, v177
    ds_read_b128 a[20:23], v183 offset:21504
    v_exp_f32 v179, v115
    s_cmp_lt_u32 s63, s64
    s_cselect_b32 s63, s63, 0x40000000
    v_add_f32 v187, v187, v188
    v_add_f32 v181, v181, v178
    ds_read_b128 a[24:27], v183 offset:22528
    v_exp_f32 v176, v116
    v_cmp_gt_f32 vcc, s67, v187
    v_add_f32 v181, v181, v179
    v_cvt_pk_bf16_f32 v169, v178, v179
    ds_read_b128 a[28:31], v183 offset:23552
    v_exp_f32 v177, v117
    v_add_f32 v181, v181, v176
    s_or_b64 vcc, vcc, s[78:79]
    s_cbranch_scc1 L_k2_site_5_s
L_k2_site_5_r:
    s_waitcnt lgkmcnt(4)
    v_mfma_f32_32x32x16_bf16 v[96:111], a[0:3], v[64:67], v[128:143]
    ds_read_b128 a[32:35], v183 offset:8192
    v_exp_f32 v178, v118
    v_add_f32 v181, v181, v177
    v_cvt_pk_bf16_f32 v170, v176, v177
    v_mfma_f32_32x32x16_bf16 v[96:111], a[4:7], v[68:71], v[96:111]
    ds_read_b128 a[36:39], v183 offset:9216
    v_exp_f32 v179, v119
    v_add_f32 v181, v181, v178
    v_add_f32 v182, v182, v180
    v_mfma_f32_32x32x16_bf16 v[96:111], a[8:11], v[72:75], v[96:111]
    ds_read_b128 a[40:43], v183 offset:10240
    v_exp_f32 v176, v120
    v_add_f32 v181, v181, v179
    v_cvt_pk_bf16_f32 v171, v178, v179
    v_mfma_f32_32x32x16_bf16 v[96:111], a[12:15], v[76:79], v[96:111]
    ds_read_b128 a[44:47], v183 offset:11264
    v_exp_f32 v177, v121
    v_add_f32 v181, v181, v176
    s_waitcnt lgkmcnt(4)
    v_mfma_f32_32x32x16_bf16 v[96:111], a[16:19], v[80:83], v[96:111]
    ds_read_b128 a[48:51], v183 offset:12288
    v_exp_f32 v178, v122
    v_add_f32 v181, v181, v177
    v_cvt_pk_bf16_f32 v172, v176, v177
    v_mfma_f32_32x32x16_bf16 v[96:111], a[20:23], v[84:87], v[96:111]
    ds_read_b128 a[52:55], v183 offset:13312
    v_exp_f32 v179, v123
    v_add_f32 v181, v181, v178
    v_mfma_f32_32x32x16_bf16 v[96:111], a[24:27], v[88:91], v[96:111]
    ds_read_b128 a[56:59], v183 offset:14336
    v_exp_f32 v176, v124
    v_add_f32 v181, v181, v179
    v_cvt_pk_bf16_f32 v173, v178, v179
    v_mfma_f32_32x32x16_bf16 v[96:111], a[28:31], v[92:95], v[96:111]
    ds_read_b128 a[60:63], v183 offset:15360
    v_exp_f32 v177, v125
    v_add_f32 v181, v181, v176
    s_waitcnt lgkmcnt(4)
    v_mfma_f32_32x32x16_bf16 v[0:15], a[32:35], v[160:163], 0
    v_exp_f32 v178, v126
    v_add_f32 v181, v181, v177
    v_cvt_pk_bf16_f32 v174, v176, v177
    v_mfma_f32_32x32x16_bf16 v[16:31], a[36:39], v[160:163], 0
    buffer_load_dwordx4 v240, s[8:11], s63 offen offset:0 sc1 lds
    v_exp_f32 v179, v127
    v_add_f32 v181, v181, v178
    v_mfma_f32_32x32x16_bf16 v[32:47], a[40:43], v[160:163], 0
    v_exp_f32 v176, v96
    v_add_f32 v181, v181, v179
    v_cvt_pk_bf16_f32 v175, v178, v179
    v_mfma_f32_32x32x16_bf16 v[48:63], a[44:47], v[160:163], 0
    v_exp_f32 v177, v97
    v_mov_b32 v187, v181
    v_mov_b32 v188, v181
    v_cmp_lt_f32 s[78:79], s66, v181
    s_waitcnt lgkmcnt(0)
    v_mfma_f32_32x32x16_bf16 v[0:15], a[48:51], v[164:167], v[0:15]
    v_exp_f32 v178, v98
    v_permlane32_swap_b32 v187, v188
    v_add_f32 v180, v176, v177
    v_cvt_pk_bf16_f32 v160, v176, v177
    v_mfma_f32_32x32x16_bf16 v[16:31], a[52:55], v[164:167], v[16:31]
    buffer_load_dwordx4 v240, s[8:11], s63 offen offset:1024 sc1 lds
    v_exp_f32 v179, v99
    v_add_f32 v187, v187, v188
    v_add_f32 v180, v180, v178
    v_mfma_f32_32x32x16_bf16 v[32:47], a[56:59], v[164:167], v[32:47]
    v_exp_f32 v176, v100
    v_cmp_gt_f32 vcc, s67, v187
    v_add_f32 v180, v180, v179
    v_cvt_pk_bf16_f32 v161, v178, v179
    v_mfma_f32_32x32x16_bf16 v[48:63], a[60:63], v[164:167], v[48:63]
    v_exp_f32 v177, v101
    v_add_f32 v180, v180, v176
    s_or_b64 vcc, vcc, s[78:79]
    s_cbranch_scc1 L_k2_site_6_s
L_k2_site_6_r:
    s_cmp_ge_u32 s70, 1
    s_cbranch_scc0 L_k2_vn_8
    s_cmp_gt_u32 s70, 1
    s_cbranch_scc1 L_k2_m_9
    v_mfma_f32_32x32x16_bf16 v[112:127], a[0:3], v[192:195], v[144:159]
    s_branch L_k2_m_10
L_k2_m_9:
    v_mfma_f32_32x32x16_bf16 v[112:127], a[0:3], v[192:195], v[224:239]
L_k2_m_10:
    v_exp_f32 v178, v102
    v_add_f32 v180, v180, v177
    v_cvt_pk_bf16_f32 v162, v176, v177
    v_mfma_f32_32x32x16_bf16 v[112:127], a[4:7], v[196:199], v[112:127]
    buffer_load_dwordx4 v240, s[8:11], s63 offen offset:2048 sc1 lds
    v_exp_f32 v179, v103
    v_add_f32 v180, v180, v178
    v_add_f32 v185, v185, v181
    v_mfma_f32_32x32x16_bf16 v[112:127], a[8:11], v[200:203], v[112:127]
    v_exp_f32 v176, v104
    v_add_f32 v180, v180, v179
    v_cvt_pk_bf16_f32 v163, v178, v179
    v_mfma_f32_32x32x16_bf16 v[112:127], a[12:15], v[204:207], v[112:127]
    v_exp_f32 v177, v105
    v_add_f32 v180, v180, v176
    v_mfma_f32_32x32x16_bf16 v[112:127], a[16:19], v[208:211], v[112:127]
    v_exp_f32 v178, v106
    v_add_f32 v180, v180, v177
    v_cvt_pk_bf16_f32 v164, v176, v177
    v_mfma_f32_32x32x16_bf16 v[112:127], a[20:23], v[212:215], v[112:127]
    buffer_load_dwordx4 v240, s[8:11], s63 offen offset:3072 sc1 lds
    v_exp_f32 v179, v107
    v_add_f32 v180, v180, v178
    v_mfma_f32_32x32x16_bf16 v[112:127], a[24:27], v[216:219], v[112:127]
    v_exp_f32 v176, v108
    v_add_f32 v180, v180, v179
    v_cvt_pk_bf16_f32 v165, v178, v179
    v_mfma_f32_32x32x16_bf16 v[112:127], a[28:31], v[220:223], v[112:127]
    v_exp_f32 v177, v109
    s_add_u32 s63, s63, 16384
    v_add_f32 v180, v180, v176
    v_mfma_f32_32x32x16_bf16 a[64:79], a[32:35], v[168:171], 0
    ds_read_b128 a[0:3], v183 offset:32768
    v_exp_f32 v178, v110
    v_add_f32 v180, v180, v177
    v_cvt_pk_bf16_f32 v166, v176, v177
    v_mfma_f32_32x32x16_bf16 a[80:95], a[36:39], v[168:171], 0
    ds_read_b128 a[4:7], v183 offset:33792
    v_exp_f32 v179, v111
    s_add_u32 m0, m0, 16384
    v_add_f32 v180, v180, v178
    v_mfma_f32_32x32x16_bf16 a[96:111], a[40:43], v[168:171], 0
    ds_read_b128 a[8:11], v183 offset:34816
    v_exp_f32 v176, v112
    v_add_f32 v180, v180, v179
    v_cvt_pk_bf16_f32 v167, v178, v179
    v_mfma_f32_32x32x16_bf16 a[112:127], a[44:47], v[168:171], 0
    ds_read_b128 a[12:15], v183 offset:35840
    v_exp_f32 v177, v113
    s_and_b32 m0, m0, 0x1ffff
    v_cmp_lt_f32 vcc, s66, v180
    v_mfma_f32_32x32x16_bf16 a[64:79], a[48:51], v[172:175], a[64:79]
    ds_read_b128 a[16:19], v183 offset:36864
    v_exp_f32 v178, v114
    v_add_f32 v181, v176, v177
    v_cvt_pk_bf16_f32 v168, v176, v177
    v_mfma_f32_32x32x16_bf16 a[80:95], a[52:55], v[172:175], a[80:95]
    ds_read_b128 a[20:23], v183 offset:37888
    v_exp_f32 v179, v115
    s_cmp_lt_u32 s63, s64
    s_cselect_b32 s63, s63, 0x40000000
    v_add_f32 v181, v181, v178
    v_mfma_f32_32x32x16_bf16 a[96:111], a[56:59], v[172:175], a[96:111]
    ds_read_b128 a[24:27], v183 offset:38912
    v_exp_f32 v176, v116
    v_add_f32 v181, v181, v179
    v_cvt_pk_bf16_f32 v169, v178, v179
    v_mfma_f32_32x32x16_bf16 a[112:127], a[60:63], v[172:175], a[112:127]
    ds_read_b128 a[28:31], v183 offset:39936
    v_exp_f32 v177, v117
    v_add_f32 v181, v181, v176
    s_cbranch_vccnz L_k2_site_11_s
L_k2_site_11_r:
    s_branch L_k2_ve_7
L_k2_vn_8:
    v_exp_f32 v178, v102
    v_add_f32 v180, v180, v177
    v_cvt_pk_bf16_f32 v162, v176, v177
    buffer_load_dwordx4 v240, s[8:11], s63 offen offset:2048 sc1 lds
    v_exp_f32 v179, v103
    v_add_f32 v180, v180, v178
    v_add_f32 v185, v185, v181
    v_exp_f32 v176, v104
    v_add_f32 v180, v180, v179
    v_cvt_pk_bf16_f32 v163, v178, v179
    v_exp_f32 v177, v105
    v_add_f32 v180, v180, v176
    v_exp_f32 v178, v106
    v_add_f32 v180, v180, v177
    v_cvt_pk_bf16_f32 v164, v176, v177
    buffer_load_dwordx4 v240, s[8:11], s63 offen offset:3072 sc1 lds
    v_exp_f32 v179, v107
    v_add_f32 v180, v180, v178
    v_exp_f32 v176, v108
    v_add_f32 v180, v180, v179
    v_cvt_pk_bf16_f32 v165, v178, v179
    v_exp_f32 v177, v109
    s_add_u32 s63, s63, 16384
    v_add_f32 v180, v180, v176
    v_mfma_f32_32x32x16_bf16 a[64:79], a[32:35], v[168:171], 0
    ds_read_b128 a[0:3], v183 offset:32768
    v_exp_f32 v178, v110
    v_add_f32 v180, v180, v177
    v_cvt_pk_bf16_f32 v166, v176, v177
    v_mfma_f32_32x32x16_bf16 a[80:95], a[36:39], v[168:171], 0
    ds_read_b128 a[4:7], v183 offset:33792
    v_exp_f32 v179, v111
    s_add_u32 m0, m0, 16384
    v_add_f32 v180, v180, v178
    v_mfma_f32_32x32x16_bf16 a[96:111], a[40:43], v[168:171], 0
    ds_read_b128 a[8:11], v183 offset:34816
    v_add_f32 v180, v180, v179
    v_cvt_pk_bf16_f32 v167, v178, v179
    v_mfma_f32_32x32x16_bf16 a[112:127], a[44:47], v[168:171], 0
    ds_read_b128 a[12:15], v183 offset:35840
    s_and_b32 m0, m0, 0x1ffff
    v_cmp_lt_f32 vcc, s66, v180
    v_mfma_f32_32x32x16_bf16 a[64:79], a[48:51], v[172:175], a[64:79]
    ds_read_b128 a[16:19], v183 offset:36864
    v_mfma_f32_32x32x16_bf16 a[80:95], a[52:55], v[172:175], a[80:95]
    ds_read_b128 a[20:23], v183 offset:37888
    s_cmp_lt_u32 s63, s64
    s_cselect_b32 s63, s63, 0x40000000
    v_mfma_f32_32x32x16_bf16 a[96:111], a[56:59], v[172:175], a[96:111]
    ds_read_b128 a[24:27], v183 offset:38912
    v_mfma_f32_32x32x16_bf16 a[112:127], a[60:63], v[172:175], a[112:127]
    ds_read_b128 a[28:31], v183 offset:39936
    s_cbranch_vccnz L_k2_site_12_s
L_k2_site_12_r:
L_k2_ve_7:
    s_cmp_ge_u32 s70, 1
    s_cbranch_scc0 L_k2_vn_14
    s_waitcnt lgkmcnt(4)
    v_mfma_f32_32x32x16_bf16 v[96:111], a[0:3], v[64:67], v[128:143]
    ds_read_b128 a[32:35], v183 offset:24576
    v_exp_f32 v178, v118
    v_add_f32 v181, v181, v177
    v_cvt_pk_bf16_f32 v170, v176, v177
    v_mfma_f32_32x32x16_bf16 v[96:111], a[4:7], v[68:71], v[96:111]
    ds_read_b128 a[36:39], v183 offset:25600
    v_exp_f32 v179, v119
    v_add_f32 v181, v181, v178
    v_add_f32 v182, v182, v180
    v_mfma_f32_32x32x16_bf16 v[96:111], a[8:11], v[72:75], v[96:111]
    ds_read_b128 a[40:43], v183 offset:26624
    v_exp_f32 v176, v120
    v_add_f32 v181, v181, v179
    v_cvt_pk_bf16_f32 v171, v178, v179
    v_mfma_f32_32x32x16_bf16 v[96:111], a[12:15], v[76:79], v[96:111]
    ds_read_b128 a[44:47], v183 offset:27648
    v_exp_f32 v177, v121
    v_add_f32 v181, v181, v176
    s_waitcnt lgkmcnt(4)
    v_mfma_f32_32x32x16_bf16 v[96:111], a[16:19], v[80:83], v[96:111]
    ds_read_b128 a[48:51], v183 offset:28672
    v_exp_f32 v178, v122
    v_add_f32 v181, v181, v177
    v_cvt_pk_bf16_f32 v172, v176, v177
    v_mfma_f32_32x32x16_bf16 v[96:111], a[20:23], v[84:87], v[96:111]
    ds_read_b128 a[52:55], v183 offset:29696
    v_exp_f32 v179, v123
    v_add_f32 v181, v181, v178
    v_mfma_f32_32x32x16_bf16 v[96:111], a[24:27], v[88:91], v[96:111]
    ds_read_b128 a[56:59], v183 offset:30720
    v_exp_f32 v176, v124
    v_add_f32 v181, v181, v179
    v_cvt_pk_bf16_f32 v173, v178, v179
    v_mfma_f32_32x32x16_bf16 v[96:111], a[28:31], v[92:95], v[96:111]
    ds_read_b128 a[60:63], v183 offset:31744
    v_exp_f32 v177, v125
    v_add_f32 v181, v181, v176
    s_waitcnt vmcnt(4)
    s_barrier
    s_waitcnt lgkmcnt(4)
    v_mfma_f32_32x32x16_bf16 v[0:15], a[32:35], v[160:163], v[0:15]
    v_exp_f32 v178, v126
    v_add_f32 v181, v181, v177
    v_cvt_pk_bf16_f32 v174, v176, v177
    v_mfma_f32_32x32x16_bf16 v[16:31], a[36:39], v[160:163], v[16:31]
    buffer_load_dwordx4 v240, s[8:11], s63 offen offset:0 sc1 lds
    v_exp_f32 v179, v127
    v_add_f32 v181, v181, v178
    v_mfma_f32_32x32x16_bf16 v[32:47], a[40:43], v[160:163], v[32:47]
    v_exp_f32 v176, v96
    v_add_f32 v181, v181, v179
    v_cvt_pk_bf16_f32 v175, v178, v179
    v_mfma_f32_32x32x16_bf16 v[48:63], a[44:47], v[160:163], v[48:63]
    v_exp_f32 v177, v97
    v_cmp_lt_f32 vcc, s66, v181
    s_waitcnt lgkmcnt(0)
    v_mfma_f32_32x32x16_bf16 v[0:15], a[48:51], v[164:167], v[0:15]
    v_exp_f32 v178, v98
    v_add_f32 v180, v176, v177
    v_cvt_pk_bf16_f32 v160, v176, v177
    v_mfma_f32_32x32x16_bf16 v[16:31], a[52:55], v[164:167], v[16:31]
    buffer_load_dwordx4 v240, s[8:11], s63 offen offset:1024 sc1 lds
    v_exp_f32 v179, v99
    v_add_f32 v180, v180, v178
    v_mfma_f32_32x32x16_bf16 v[32:47], a[56:59], v[164:167], v[32:47]
    v_exp_f32 v176, v100
    v_add_f32 v180, v180, v179
    v_cvt_pk_bf16_f32 v161, v178, v179
    v_mfma_f32_32x32x16_bf16 v[48:63], a[60:63], v[164:167], v[48:63]
    v_exp_f32 v177, v101
    v_add_f32 v180, v180, v176
    s_cbranch_vccnz L_k2_site_15_s
L_k2_site_15_r:
    s_branch L_k2_ve_13
L_k2_vn_14:
    s_waitcnt lgkmcnt(4)
    v_mfma_f32_32x32x16_bf16 v[96:111], a[0:3], v[64:67], v[128:143]
    ds_read_b128 a[32:35], v183 offset:24576
    v_mfma_f32_32x32x16_bf16 v[96:111], a[4:7], v[68:71], v[96:111]
    ds_read_b128 a[36:39], v183 offset:25600
    v_add_f32 v182, v182, v180
    v_mfma_f32_32x32x16_bf16 v[96:111], a[8:11], v[72:75], v[96:111]
    ds_read_b128 a[40:43], v183 offset:26624
    v_mfma_f32_32x32x16_bf16 v[96:111], a[12:15], v[76:79], v[96:111]
    ds_read_b128 a[44:47], v183 offset:27648
    s_waitcnt lgkmcnt(4)
    v_mfma_f32_32x32x16_bf16 v[96:111], a[16:19], v[80:83], v[96:111]
    ds_read_b128 a[48:51], v183 offset:28672
    v_mfma_f32_32x32x16_bf16 v[96:111], a[20:23], v[84:87], v[96:111]
    ds_read_b128 a[52:55], v183 offset:29696
    v_mfma_f32_32x32x16_bf16 v[96:111], a[24:27], v[88:91], v[96:111]
    ds_read_b128 a[56:59], v183 offset:30720
    v_mfma_f32_32x32x16_bf16 v[96:111], a[28:31], v[92:95], v[96:111]
    ds_read_b128 a[60:63], v183 offset:31744
    s_waitcnt vmcnt(4)
    s_barrier
    s_waitcnt lgkmcnt(4)
    v_mfma_f32_32x32x16_bf16 v[0:15], a[32:35], v[160:163], v[0:15]
    v_mfma_f32_32x32x16_bf16 v[16:31], a[36:39], v[160:163], v[16:31]
    buffer_load_dwordx4 v240, s[8:11], s63 offen offset:0 sc1 lds
    v_mfma_f32_32x32x16_bf16 v[32:47], a[40:43], v[160:163], v[32:47]
    s_nop 3
    v_exp_f32 v176, v96
    v_mfma_f32_32x32x16_bf16 v[48:63], a[44:47], v[160:163], v[48:63]
    v_exp_f32 v177, v97
    s_waitcnt lgkmcnt(0)
    v_mfma_f32_32x32x16_bf16 v[0:15], a[48:51], v[164:167], v[0:15]
    v_exp_f32 v178, v98
    v_add_f32 v180, v176, v177
    v_cvt_pk_bf16_f32 v160, v176, v177
    v_mfma_f32_32x32x16_bf16 v[16:31], a[52:55], v[164:167], v[16:31]
    buffer_load_dwordx4 v240, s[8:11], s63 offen offset:1024 sc1 lds
    v_exp_f32 v179, v99
    v_add_f32 v180, v180, v178
    v_mfma_f32_32x32x16_bf16 v[32:47], a[56:59], v[164:167], v[32:47]
    v_exp_f32 v176, v100
    v_add_f32 v180, v180, v179
    v_cvt_pk_bf16_f32 v161, v178, v179
    v_mfma_f32_32x32x16_bf16 v[48:63], a[60:63], v[164:167], v[48:63]
    v_exp_f32 v177, v101
    v_add_f32 v180, v180, v176
L_k2_ve_13:
    s_cmp_ge_u32 s70, 2
    s_cbranch_scc0 L_k2_vn_17
    s_cmp_gt_u32 s70, 2
    s_cbranch_scc1 L_k2_m_18
    v_mfma_f32_32x32x16_bf16 v[112:127], a[0:3], v[192:195], v[144:159]
    s_branch L_k2_m_19
L_k2_m_18:
    v_mfma_f32_32x32x16_bf16 v[112:127], a[0:3], v[192:195], v[224:239]
L_k2_m_19:
    v_exp_f32 v178, v102
    v_add_f32 v180, v180, v177
    v_cvt_pk_bf16_f32 v162, v176, v177
    v_mfma_f32_32x32x16_bf16 v[112:127], a[4:7], v[196:199], v[112:127]
    buffer_load_dwordx4 v240, s[8:11], s63 offen offset:2048 sc1 lds
    v_exp_f32 v179, v103
    v_add_f32 v180, v180, v178
    v_add_f32 v185, v185, v181
    v_mfma_f32_32x32x16_bf16 v[112:127], a[8:11], v[200:203], v[112:127]
    v_exp_f32 v176, v104
    v_add_f32 v180, v180, v179
    v_cvt_pk_bf16_f32 v163, v178, v179
    v_mfma_f32_32x32x16_bf16 v[112:127], a[12:15], v[204:207], v[112:127]
    v_exp_f32 v177, v105
    v_add_f32 v180, v180, v176
    v_mfma_f32_32x32x16_bf16 v[112:127], a[16:19], v[208:211], v[112:127]
    v_exp_f32 v178, v106
    v_add_f32 v180, v180, v177
    v_cvt_pk_bf16_f32 v164, v176, v177
    v_mfma_f32_32x32x16_bf16 v[112:127], a[20:23], v[212:215], v[112:127]
    buffer_load_dwordx4 v240, s[8:11], s63 offen offset:3072 sc1 lds
    v_exp_f32 v179, v107
    v_add_f32 v180, v180, v178
    v_mfma_f32_32x32x16_bf16 v[112:127], a[24:27], v[216:219], v[112:127]
    v_exp_f32 v176, v108
    v_add_f32 v180, v180, v179
    v_cvt_pk_bf16_f32 v165, v178, v179
    v_mfma_f32_32x32x16_bf16 v[112:127], a[28:31], v[220:223], v[112:127]
    v_exp_f32 v177, v109
    s_add_u32 s63, s63, 16384
    v_add_f32 v180, v180, v176
    v_mfma_f32_32x32x16_bf16 a[64:79], a[32:35], v[168:171], a[64:79]
    ds_read_b128 a[0:3], v183 offset:49152
    v_exp_f32 v178, v110
    v_add_f32 v180, v180, v177
    v_cvt_pk_bf16_f32 v166, v176, v177
    v_mfma_f32_32x32x16_bf16 a[80:95], a[36:39], v[168:171], a[80:95]
    ds_read_b128 a[4:7], v183 offset:50176
    v_exp_f32 v179, v111
    s_add_u32 m0, m0, 16384
    v_add_f32 v180, v180, v178
    v_mfma_f32_32x32x16_bf16 a[96:111], a[40:43], v[168:171], a[96:111]
    ds_read_b128 a[8:11], v183 offset:51200
    v_exp_f32 v176, v112
    v_add_f32 v180, v180, v179
    v_cvt_pk_bf16_f32 v167, v178, v179
    v_mfma_f32_32x32x16_bf16 a[112:127], a[44:47], v[168:171], a[112:127]
    ds_read_b128 a[12:15], v183 offset:52224
    v_exp_f32 v177, v113
    s_and_b32 m0, m0, 0x1ffff
    v_cmp_lt_f32 vcc, s66, v180
    v_mfma_f32_32x32x16_bf16 a[64:79], a[48:51], v[172:175], a[64:79]
    ds_read_b128 a[16:19], v183 offset:53248
    v_exp_f32 v178, v114
    v_add_f32 v181, v176, v177
    v_cvt_pk_bf16_f32 v168, v176, v177
    v_mfma_f32_32x32x16_bf16 a[80:95], a[52:55], v[172:175], a[80:95]
    ds_read_b128 a[20:23], v183 offset:54272
    v_exp_f32 v179, v115
    s_cmp_lt_u32 s63, s64
    s_cselect_b32 s63, s63, 0x40000000
    v_add_f32 v181, v181, v178
    v_mfma_f32_32x32x16_bf16 a[96:111], a[56:59], v[172:175], a[96:111]
    ds_read_b128 a[24:27], v183 offset:55296
    v_exp_f32 v176, v116
    v_add_f32 v181, v181, v179
    v_cvt_pk_bf16_f32 v169, v178, v179
    v_mfma_f32_32x32x16_bf16 a[112:127], a[60:63], v[172:175], a[112:127]
    ds_read_b128 a[28:31], v183 offset:56320
    v_exp_f32 v177, v117
    v_add_f32 v181, v181, v176
    s_cbranch_vccnz L_k2_site_20_s
L_k2_site_20_r:
    s_branch L_k2_ve_16
L_k2_vn_17:
    s_cmp_ge_u32 s70, 1
    s_cbranch_scc0 L_k2_vn_21
    v_exp_f32 v178, v102
    v_add_f32 v180, v180, v177
    v_cvt_pk_bf16_f32 v162, v176, v177
    buffer_load_dwordx4 v240, s[8:11], s63 offen offset:2048 sc1 lds
    v_exp_f32 v179, v103
    v_add_f32 v180, v180, v178
    v_add_f32 v185, v185, v181
    v_exp_f32 v176, v104
    v_add_f32 v180, v180, v179
    v_cvt_pk_bf16_f32 v163, v178, v179
    v_exp_f32 v177, v105
    v_add_f32 v180, v180, v176
    v_exp_f32 v178, v106
    v_add_f32 v180, v180, v177
    v_cvt_pk_bf16_f32 v164, v176, v177
    buffer_load_dwordx4 v240, s[8:11], s63 offen offset:3072 sc1 lds
    v_exp_f32 v179, v107
    v_add_f32 v180, v180, v178
    v_exp_f32 v176, v108
    v_add_f32 v180, v180, v179
    v_cvt_pk_bf16_f32 v165, v178, v179
    v_exp_f32 v177, v109
    s_add_u32 s63, s63, 16384
    v_add_f32 v180, v180, v176
    v_mfma_f32_32x32x16_bf16 a[64:79], a[32:35], v[168:171], a[64:79]
    ds_read_b128 a[0:3], v183 offset:49152
    v_exp_f32 v178, v110
    v_add_f32 v180, v180, v177
    v_cvt_pk_bf16_f32 v166, v176, v177
    v_mfma_f32_32x32x16_bf16 a[80:95], a[36:39], v[168:171], a[80:95]
    ds_read_b128 a[4:7], v183 offset:50176
    v_exp_f32 v179, v111
    s_add_u32 m0, m0, 16384
    v_add_f32 v180, v180, v178
    v_mfma_f32_32x32x16_bf16 a[96:111], a[40:43], v[168:171], a[96:111]
    ds_read_b128 a[8:11], v183 offset:51200
    v_add_f32 v180, v180, v179
    v_cvt_pk_bf16_f32 v167, v178, v179
    v_mfma_f32_32x32x16_bf16 a[112:127], a[44:47], v[168:171], a[112:127]
    ds_read_b128 a[12:15], v183 offset:52224
    s_and_b32 m0, m0, 0x1ffff
    v_cmp_lt_f32 vcc, s66, v180
    v_mfma_f32_32x32x16_bf16 a[64:79], a[48:51], v[172:175], a[64:79]
    ds_read_b128 a[16:19], v183 offset:53248
    v_mfma_f32_32x32x16_bf16 a[80:95], a[52:55], v[172:175], a[80:95]
    ds_read_b128 a[20:23], v183 offset:54272
    s_cmp_lt_u32 s63, s64
    s_cselect_b32 s63, s63, 0x40000000
    v_mfma_f32_32x32x16_bf16 a[96:111], a[56:59], v[172:175], a[96:111]
    ds_read_b128 a[24:27], v183 offset:55296
    v_mfma_f32_32x32x16_bf16 a[112:127], a[60:63], v[172:175], a[112:127]
    ds_read_b128 a[28:31], v183 offset:56320
    s_cbranch_vccnz L_k2_site_22_s
L_k2_site_22_r:
    s_branch L_k2_ve_16
L_k2_vn_21:
    v_exp_f32 v178, v102
    v_add_f32 v180, v180, v177
    v_cvt_pk_bf16_f32 v162, v176, v177
    buffer_load_dwordx4 v240, s[8:11], s63 offen offset:2048 sc1 lds
    v_exp_f32 v179, v103
    v_add_f32 v180, v180, v178
    v_exp_f32 v176, v104
    v_add_f32 v180, v180, v179
    v_cvt_pk_bf16_f32 v163, v178, v179
    v_exp_f32 v177, v105
    v_add_f32 v180, v180, v176
    v_exp_f32 v178, v106
    v_add_f32 v180, v180, v177
    v_cvt_pk_bf16_f32 v164, v176, v177
    buffer_load_dwordx4 v240, s[8:11], s63 offen offset:3072 sc1 lds
    v_exp_f32 v179, v107
    v_add_f32 v180, v180, v178
    v_exp_f32 v176, v108
    v_add_f32 v180, v180, v179
    v_cvt_pk_bf16_f32 v165, v178, v179
    v_exp_f32 v177, v109
    s_add_u32 s63, s63, 16384
    v_add_f32 v180, v180, v176
    ds_read_b128 a[0:3], v183 offset:49152
    v_exp_f32 v178, v110
    v_add_f32 v180, v180, v177
    v_cvt_pk_bf16_f32 v166, v176, v177
    ds_read_b128 a[4:7], v183 offset:50176
    v_exp_f32 v179, v111
    s_add_u32 m0, m0, 16384
    v_add_f32 v180, v180, v178
    ds_read_b128 a[8:11], v183 offset:51200
    v_add_f32 v180, v180, v179
    v_cvt_pk_bf16_f32 v167, v178, v179
    ds_read_b128 a[12:15], v183 offset:52224
    s_and_b32 m0, m0, 0x1ffff
    v_cmp_lt_f32 vcc, s66, v180
    ds_read_b128 a[16:19], v183 offset:53248
    ds_read_b128 a[20:23], v183 offset:54272
    s_cmp_lt_u32 s63, s64
    s_cselect_b32 s63, s63, 0x40000000
    ds_read_b128 a[24:27], v183 offset:55296
    ds_read_b128 a[28:31], v183 offset:56320
    s_cbranch_vccnz L_k2_site_23_s
L_k2_site_23_r:
L_k2_ve_16:
    s_cmp_ge_u32 s70, 2
    s_cbranch_scc0 L_k2_vn_25
    s_waitcnt lgkmcnt(4)
    v_mfma_f32_32x32x16_bf16 v[96:111], a[0:3], v[64:67], v[128:143]
    ds_read_b128 a[32:35], v183 offset:40960
    v_exp_f32 v178, v118
    v_add_f32 v181, v181, v177
    v_cvt_pk_bf16_f32 v170, v176, v177
    v_mfma_f32_32x32x16_bf16 v[96:111], a[4:7], v[68:71], v[96:111]
    ds_read_b128 a[36:39], v183 offset:41984
    v_exp_f32 v179, v119
    v_add_f32 v181, v181, v178
    v_add_f32 v182, v182, v180
    v_mfma_f32_32x32x16_bf16 v[96:111], a[8:11], v[72:75], v[96:111]
    ds_read_b128 a[40:43], v183 offset:43008
    v_exp_f32 v176, v120
    v_add_f32 v181, v181, v179
    v_cvt_pk_bf16_f32 v171, v178, v179
    v_mfma_f32_32x32x16_bf16 v[96:111], a[12:15], v[76:79], v[96:111]
    ds_read_b128 a[44:47], v183 offset:44032
    v_exp_f32 v177, v121
    v_add_f32 v181, v181, v176
    s_waitcnt lgkmcnt(4)
    v_mfma_f32_32x32x16_bf16 v[96:111], a[16:19], v[80:83], v[96:111]
    ds_read_b128 a[48:51], v183 offset:45056
    v_exp_f32 v178, v122
    v_add_f32 v181, v181, v177
    v_cvt_pk_bf16_f32 v172, v176, v177
    v_mfma_f32_32x32x16_bf16 v[96:111], a[20:23], v[84:87], v[96:111]
    ds_read_b128 a[52:55], v183 offset:46080
    v_exp_f32 v179, v123
    v_add_f32 v181, v181, v178
    v_mfma_f32_32x32x16_bf16 v[96:111], a[24:27], v[88:91], v[96:111]
    ds_read_b128 a[56:59], v183 offset:47104
    v_exp_f32 v176, v124
    v_add_f32 v181, v181, v179
    v_cvt_pk_bf16_f32 v173, v178, v179
    v_mfma_f32_32x32x16_bf16 v[96:111], a[28:31], v[92:95], v[96:111]
    ds_read_b128 a[60:63], v183 offset:48128
    v_exp_f32 v177, v125
    v_add_f32 v181, v181, v176
    s_waitcnt lgkmcnt(4)
    v_mfma_f32_32x32x16_bf16 v[0:15], a[32:35], v[160:163], v[0:15]
    v_exp_f32 v178, v126
    v_add_f32 v181, v181, v177
    v_cvt_pk_bf16_f32 v174, v176, v177
    v_mfma_f32_32x32x16_bf16 v[16:31], a[36:39], v[160:163], v[16:31]
    buffer_load_dwordx4 v240, s[8:11], s63 offen offset:0 sc1 lds
    v_exp_f32 v179, v127
    v_add_f32 v181, v181, v178
    v_mfma_f32_32x32x16_bf16 v[32:47], a[40:43], v[160:163], v[32:47]
    v_exp_f32 v176, v96
    v_add_f32 v181, v181, v179
    v_cvt_pk_bf16_f32 v175, v178, v179
    v_mfma_f32_32x32x16_bf16 v[48:63], a[44:47], v[160:163], v[48:63]
    v_exp_f32 v177, v97
    v_cmp_lt_f32 vcc, s66, v181
    s_waitcnt lgkmcnt(0)
    v_mfma_f32_32x32x16_bf16 v[0:15], a[48:51], v[164:167], v[0:15]
    v_exp_f32 v178, v98
    v_add_f32 v180, v176, v177
    v_cvt_pk_bf16_f32 v160, v176, v177
    v_mfma_f32_32x32x16_bf16 v[16:31], a[52:55], v[164:167], v[16:31]
    buffer_load_dwordx4 v240, s[8:11], s63 offen offset:1024 sc1 lds
    v_exp_f32 v179, v99
    v_add_f32 v180, v180, v178
    v_mfma_f32_32x32x16_bf16 v[32:47], a[56:59], v[164:167], v[32:47]
    v_exp_f32 v176, v100
    v_add_f32 v180, v180, v179
    v_cvt_pk_bf16_f32 v161, v178, v179
    v_mfma_f32_32x32x16_bf16 v[48:63], a[60:63], v[164:167], v[48:63]
    v_exp_f32 v177, v101
    v_add_f32 v180, v180, v176
    s_cbranch_vccnz L_k2_site_26_s
L_k2_site_26_r:
    s_branch L_k2_ve_24
L_k2_vn_25:
    s_waitcnt lgkmcnt(4)
    v_mfma_f32_32x32x16_bf16 v[96:111], a[0:3], v[64:67], v[128:143]
    ds_read_b128 a[32:35], v183 offset:40960
    v_mfma_f32_32x32x16_bf16 v[96:111], a[4:7], v[68:71], v[96:111]
    ds_read_b128 a[36:39], v183 offset:41984
    v_add_f32 v182, v182, v180
    v_mfma_f32_32x32x16_bf16 v[96:111], a[8:11], v[72:75], v[96:111]
    ds_read_b128 a[40:43], v183 offset:43008
    v_mfma_f32_32x32x16_bf16 v[96:111], a[12:15], v[76:79], v[96:111]
    ds_read_b128 a[44:47], v183 offset:44032
    s_waitcnt lgkmcnt(4)
    v_mfma_f32_32x32x16_bf16 v[96:111], a[16:19], v[80:83], v[96:111]
    ds_read_b128 a[48:51], v183 offset:45056
    v_mfma_f32_32x32x16_bf16 v[96:111], a[20:23], v[84:87], v[96:111]
    ds_read_b128 a[52:55], v183 offset:46080
    v_mfma_f32_32x32x16_bf16 v[96:111], a[24:27], v[88:91], v[96:111]
    ds_read_b128 a[56:59], v183 offset:47104
    v_mfma_f32_32x32x16_bf16 v[96:111], a[28:31], v[92:95], v[96:111]
    ds_read_b128 a[60:63], v183 offset:48128
    s_waitcnt lgkmcnt(4)
    v_mfma_f32_32x32x16_bf16 v[0:15], a[32:35], v[160:163], v[0:15]
    v_mfma_f32_32x32x16_bf16 v[16:31], a[36:39], v[160:163], v[16:31]
    buffer_load_dwordx4 v240, s[8:11], s63 offen offset:0 sc1 lds
    v_mfma_f32_32x32x16_bf16 v[32:47], a[40:43], v[160:163], v[32:47]
    s_nop 5
    v_exp_f32 v176, v96
    v_mfma_f32_32x32x16_bf16 v[48:63], a[44:47], v[160:163], v[48:63]
    v_exp_f32 v177, v97
    s_waitcnt lgkmcnt(0)
    v_mfma_f32_32x32x16_bf16 v[0:15], a[48:51], v[164:167], v[0:15]
    v_exp_f32 v178, v98
    v_add_f32 v180, v176, v177
    v_cvt_pk_bf16_f32 v160, v176, v177
    v_mfma_f32_32x32x16_bf16 v[16:31], a[52:55], v[164:167], v[16:31]
    buffer_load_dwordx4 v240, s[8:11], s63 offen offset:1024 sc1 lds
    v_exp_f32 v179, v99
    v_add_f32 v180, v180, v178
    v_mfma_f32_32x32x16_bf16 v[32:47], a[56:59], v[164:167], v[32:47]
    v_exp_f32 v176, v100
    v_add_f32 v180, v180, v179
    v_cvt_pk_bf16_f32 v161, v178, v179
    v_mfma_f32_32x32x16_bf16 v[48:63], a[60:63], v[164:167], v[48:63]
    v_exp_f32 v177, v101
    v_add_f32 v180, v180, v176
L_k2_ve_24:
    s_cmp_ge_u32 s70, 3
    s_cbranch_scc0 L_k2_vn_28
    s_cmp_gt_u32 s70, 3
    s_cbranch_scc1 L_k2_m_29
    v_mfma_f32_32x32x16_bf16 v[112:127], a[0:3], v[192:195], v[144:159]
    s_branch L_k2_m_30
L_k2_m_29:
    v_mfma_f32_32x32x16_bf16 v[112:127], a[0:3], v[192:195], v[224:239]
L_k2_m_30:
    v_exp_f32 v178, v102
    v_add_f32 v180, v180, v177
    v_cvt_pk_bf16_f32 v162, v176, v177
    v_mfma_f32_32x32x16_bf16 v[112:127], a[4:7], v[196:199], v[112:127]
    buffer_load_dwordx4 v240, s[8:11], s63 offen offset:2048 sc1 lds
    v_exp_f32 v179, v103
    v_add_f32 v180, v180, v178
    v_add_f32 v185, v185, v181
    v_mfma_f32_32x32x16_bf16 v[112:127], a[8:11], v[200:203], v[112:127]
    v_exp_f32 v176, v104
    v_add_f32 v180, v180, v179
    v_cvt_pk_bf16_f32 v163, v178, v179
    v_mfma_f32_32x32x16_bf16 v[112:127], a[12:15], v[204:207], v[112:127]
    v_exp_f32 v177, v105
    v_add_f32 v180, v180, v176
    v_mfma_f32_32x32x16_bf16 v[112:127], a[16:19], v[208:211], v[112:127]
    v_exp_f32 v178, v106
    v_add_f32 v180, v180, v177
    v_cvt_pk_bf16_f32 v164, v176, v177
    v_mfma_f32_32x32x16_bf16 v[112:127], a[20:23], v[212:215], v[112:127]
    buffer_load_dwordx4 v240, s[8:11], s63 offen offset:3072 sc1 lds
    v_exp_f32 v179, v107
    v_add_f32 v180, v180, v178
    v_mfma_f32_32x32x16_bf16 v[112:127], a[24:27], v[216:219], v[112:127]
    v_exp_f32 v176, v108
    v_add_f32 v180, v180, v179
    v_cvt_pk_bf16_f32 v165, v178, v179
    v_mfma_f32_32x32x16_bf16 v[112:127], a[28:31], v[220:223], v[112:127]
    v_exp_f32 v177, v109
    s_add_u32 s63, s63, 16384
    v_add_f32 v180, v180, v176
    v_mfma_f32_32x32x16_bf16 a[64:79], a[32:35], v[168:171], a[64:79]
    ds_read_b128 a[0:3], v184 offset:0
    v_exp_f32 v178, v110
    v_add_f32 v180, v180, v177
    v_cvt_pk_bf16_f32 v166, v176, v177
    v_mfma_f32_32x32x16_bf16 a[80:95], a[36:39], v[168:171], a[80:95]
    ds_read_b128 a[4:7], v184 offset:1024
    v_exp_f32 v179, v111
    s_add_u32 m0, m0, 16384
    v_add_f32 v180, v180, v178
    v_mfma_f32_32x32x16_bf16 a[96:111], a[40:43], v[168:171], a[96:111]
    ds_read_b128 a[8:11], v184 offset:2048
    v_exp_f32 v176, v112
    v_add_f32 v180, v180, v179
    v_cvt_pk_bf16_f32 v167, v178, v179
    v_mfma_f32_32x32x16_bf16 a[112:127], a[44:47], v[168:171], a[112:127]
    ds_read_b128 a[12:15], v184 offset:3072
    v_exp_f32 v177, v113
    s_and_b32 m0, m0, 0x1ffff
    v_cmp_lt_f32 vcc, s66, v180
    v_mfma_f32_32x32x16_bf16 a[64:79], a[48:51], v[172:175], a[64:79]
    ds_read_b128 a[16:19], v184 offset:4096
    v_exp_f32 v178, v114
    v_add_f32 v181, v176, v177
    v_cvt_pk_bf16_f32 v168, v176, v177
    v_mfma_f32_32x32x16_bf16 a[80:95], a[52:55], v[172:175], a[80:95]
    ds_read_b128 a[20:23], v184 offset:5120
    v_exp_f32 v179, v115
    s_cmp_lt_u32 s63, s64
    s_cselect_b32 s63, s63, 0x40000000
    v_add_f32 v181, v181, v178
    v_mfma_f32_32x32x16_bf16 a[96:111], a[56:59], v[172:175], a[96:111]
    ds_read_b128 a[24:27], v184 offset:6144
    v_exp_f32 v176, v116
    v_add_f32 v181, v181, v179
    v_cvt_pk_bf16_f32 v169, v178, v179
    v_mfma_f32_32x32x16_bf16 a[112:127], a[60:63], v[172:175], a[112:127]
    ds_read_b128 a[28:31], v184 offset:7168
    v_exp_f32 v177, v117
    v_add_f32 v181, v181, v176
    v_swap_b32 v183, v184
    s_cbranch_vccnz L_k2_site_31_s
L_k2_site_31_r:
    s_branch L_k2_ve_27
L_k2_vn_28:
    s_cmp_ge_u32 s70, 2
    s_cbranch_scc0 L_k2_vn_32
    v_exp_f32 v178, v102
    v_add_f32 v180, v180, v177
    v_cvt_pk_bf16_f32 v162, v176, v177
    buffer_load_dwordx4 v240, s[8:11], s63 offen offset:2048 sc1 lds
    v_exp_f32 v179, v103
    v_add_f32 v180, v180, v178
    v_add_f32 v185, v185, v181
    v_exp_f32 v176, v104
    v_add_f32 v180, v180, v179
    v_cvt_pk_bf16_f32 v163, v178, v179
    v_exp_f32 v177, v105
    v_add_f32 v180, v180, v176
    v_exp_f32 v178, v106
    v_add_f32 v180, v180, v177
    v_cvt_pk_bf16_f32 v164, v176, v177
    buffer_load_dwordx4 v240, s[8:11], s63 offen offset:3072 sc1 lds
    v_exp_f32 v179, v107
    v_add_f32 v180, v180, v178
    v_exp_f32 v176, v108
    v_add_f32 v180, v180, v179
    v_cvt_pk_bf16_f32 v165, v178, v179
    v_exp_f32 v177, v109
    s_add_u32 s63, s63, 16384
    v_add_f32 v180, v180, v176
    v_mfma_f32_32x32x16_bf16 a[64:79], a[32:35], v[168:171], a[64:79]
    ds_read_b128 a[0:3], v184 offset:0
    v_exp_f32 v178, v110
    v_add_f32 v180, v180, v177
    v_cvt_pk_bf16_f32 v166, v176, v177
    v_mfma_f32_32x32x16_bf16 a[80:95], a[36:39], v[168:171], a[80:95]
    ds_read_b128 a[4:7], v184 offset:1024
    v_exp_f32 v179, v111
    s_add_u32 m0, m0, 16384
    v_add_f32 v180, v180, v178
    v_mfma_f32_32x32x16_bf16 a[96:111], a[40:43], v[168:171], a[96:111]
    ds_read_b128 a[8:11], v184 offset:2048
    v_add_f32 v180, v180, v179
    v_cvt_pk_bf16_f32 v167, v178, v179
    v_mfma_f32_32x32x16_bf16 a[112:127], a[44:47], v[168:171], a[112:127]
    ds_read_b128 a[12:15], v184 offset:3072
    s_and_b32 m0, m0, 0x1ffff
    v_cmp_lt_f32 vcc, s66, v180
    v_mfma_f32_32x32x16_bf16 a[64:79], a[48:51], v[172:175], a[64:79]
    ds_read_b128 a[16:19], v184 offset:4096
    v_mfma_f32_32x32x16_bf16 a[80:95], a[52:55], v[172:175], a[80:95]
    ds_read_b128 a[20:23], v184 offset:5120
    s_cmp_lt_u32 s63, s64
    s_cselect_b32 s63, s63, 0x40000000
    v_mfma_f32_32x32x16_bf16 a[96:111], a[56:59], v[172:175], a[96:111]
    ds_read_b128 a[24:27], v184 offset:6144
    v_mfma_f32_32x32x16_bf16 a[112:127], a[60:63], v[172:175], a[112:127]
    ds_read_b128 a[28:31], v184 offset:7168
    v_swap_b32 v183, v184
    s_cbranch_vccnz L_k2_site_33_s
L_k2_site_33_r:
    s_branch L_k2_ve_27
L_k2_vn_32:
    v_exp_f32 v178, v102
    v_add_f32 v180, v180, v177
    v_cvt_pk_bf16_f32 v162, v176, v177
    buffer_load_dwordx4 v240, s[8:11], s63 offen offset:2048 sc1 lds
    v_exp_f32 v179, v103
    v_add_f32 v180, v180, v178
    v_exp_f32 v176, v104
    v_add_f32 v180, v180, v179
    v_cvt_pk_bf16_f32 v163, v178, v179
    v_exp_f32 v177, v105
    v_add_f32 v180, v180, v176
    v_exp_f32 v178, v106
    v_add_f32 v180, v180, v177
    v_cvt_pk_bf16_f32 v164, v176, v177
    buffer_load_dwordx4 v240, s[8:11], s63 offen offset:3072 sc1 lds
    v_exp_f32 v179, v107
    v_add_f32 v180, v180, v178
    v_exp_f32 v176, v108
    v_add_f32 v180, v180, v179
    v_cvt_pk_bf16_f32 v165, v178, v179
    v_exp_f32 v177, v109
    s_add_u32 s63, s63, 16384
    v_add_f32 v180, v180, v176
    ds_read_b128 a[0:3], v184 offset:0
    v_exp_f32 v178, v110
    v_add_f32 v180, v180, v177
    v_cvt_pk_bf16_f32 v166, v176, v177
    ds_read_b128 a[4:7], v184 offset:1024
    v_exp_f32 v179, v111
    s_add_u32 m0, m0, 16384
    v_add_f32 v180, v180, v178
    ds_read_b128 a[8:11], v184 offset:2048
    v_add_f32 v180, v180, v179
    v_cvt_pk_bf16_f32 v167, v178, v179
    ds_read_b128 a[12:15], v184 offset:3072
    s_and_b32 m0, m0, 0x1ffff
    v_cmp_lt_f32 vcc, s66, v180
    ds_read_b128 a[16:19], v184 offset:4096
    ds_read_b128 a[20:23], v184 offset:5120
    s_cmp_lt_u32 s63, s64
    s_cselect_b32 s63, s63, 0x40000000
    ds_read_b128 a[24:27], v184 offset:6144
    ds_read_b128 a[28:31], v184 offset:7168
    v_swap_b32 v183, v184
    s_cbranch_vccnz L_k2_site_34_s
L_k2_site_34_r:
L_k2_ve_27:
    s_cmp_lg_u32 s44, 0
    s_cbranch_scc1 L_ka_sf_wof
    s_lshl_b32 s55, s2, 7
    s_add_u32 s55, s55, 0x490000
    v_mov_b32 v254, s58
    s_mov_b64 exec, 1
    buffer_store_dword v254, v255, s[8:11], s55 offen offset:12 sc1
    s_mov_b64 exec, -1
L_ka_sf_wof:
    s_cmp_eq_u32 s46, 0
    s_cbranch_scc1 L_k2_trans
    s_cmp_eq_u32 s51, 0
    s_cbranch_scc1 L_k2_dtail
    .p2align 6
L_k2_dloop:
    s_waitcnt lgkmcnt(4)
    v_mfma_f32_32x32x16_bf16 v[96:111], a[0:3], v[64:67], v[128:143]
    ds_read_b128 a[32:35], v184 offset:57344
    v_exp_f32 v178, v118
    v_add_f32 v181, v181, v177
    v_cvt_pk_bf16_f32 v170, v176, v177
    v_mfma_f32_32x32x16_bf16 v[96:111], a[4:7], v[68:71], v[96:111]
    ds_read_b128 a[36:39], v184 offset:58368
    v_exp_f32 v179, v119
    v_add_f32 v181, v181, v178
    v_add_f32 v182, v182, v180
    v_mfma_f32_32x32x16_bf16 v[96:111], a[8:11], v[72:75], v[96:111]
    ds_read_b128 a[40:43], v184 offset:59392
    v_exp_f32 v176, v120
    v_add_f32 v181, v181, v179
    v_cvt_pk_bf16_f32 v171, v178, v179
    v_mfma_f32_32x32x16_bf16 v[96:111], a[12:15], v[76:79], v[96:111]
    ds_read_b128 a[44:47], v184 offset:60416
    v_exp_f32 v177, v121
    v_add_f32 v181, v181, v176
    s_waitcnt lgkmcnt(4)
    v_mfma_f32_32x32x16_bf16 v[96:111], a[16:19], v[80:83], v[96:111]
    ds_read_b128 a[48:51], v184 offset:61440
    v_exp_f32 v178, v122
    v_add_f32 v181, v181, v177
    v_cvt_pk_bf16_f32 v172, v176, v177
    v_mfma_f32_32x32x16_bf16 v[96:111], a[20:23], v[84:87], v[96:111]
    ds_read_b128 a[52:55], v184 offset:62464
    v_exp_f32 v179, v123
    v_add_f32 v181, v181, v178
    v_mfma_f32_32x32x16_bf16 v[96:111], a[24:27], v[88:91], v[96:111]
    ds_read_b128 a[56:59], v184 offset:63488
    v_exp_f32 v176, v124
    v_add_f32 v181, v181, v179
    v_cvt_pk_bf16_f32 v173, v178, v179
    v_mfma_f32_32x32x16_bf16 v[96:111], a[28:31], v[92:95], v[96:111]
    ds_read_b128 a[60:63], v184 offset:64512
    v_exp_f32 v177, v125
    v_add_f32 v181, v181, v176
    s_waitcnt vmcnt(4)
    s_barrier
    s_waitcnt lgkmcnt(4)
    v_mfma_f32_32x32x16_bf16 v[0:15], a[32:35], v[160:163], v[0:15]
    v_exp_f32 v178, v126
    v_add_f32 v181, v181, v177
    v_cvt_pk_bf16_f32 v174, v176, v177
    v_mfma_f32_32x32x16_bf16 v[16:31], a[36:39], v[160:163], v[16:31]
    buffer_load_dwordx4 v240, s[8:11], s63 offen offset:0 sc1 lds
    v_exp_f32 v179, v127
    v_add_f32 v181, v181, v178
    v_mfma_f32_32x32x16_bf16 v[32:47], a[40:43], v[160:163], v[32:47]
    v_exp_f32 v176, v96
    v_add_f32 v181, v181, v179
    v_cvt_pk_bf16_f32 v175, v178, v179
    v_mfma_f32_32x32x16_bf16 v[48:63], a[44:47], v[160:163], v[48:63]
    s_cmp_lt_u32 s56, s34
    s_cbranch_scc0 L_k2_pf_35
    buffer_load_dword v252, v250, s[32:35], s56 offen
    s_add_u32 s56, s56, 4096
L_k2_pf_35:
    v_exp_f32 v177, v97
    v_cmp_lt_f32 vcc, s66, v181
    s_waitcnt lgkmcnt(0)
    v_mfma_f32_32x32x16_bf16 v[0:15], a[48:51], v[164:167], v[0:15]
    v_exp_f32 v178, v98
    v_add_f32 v180, v176, v177
    v_cvt_pk_bf16_f32 v160, v176, v177
    v_mfma_f32_32x32x16_bf16 v[16:31], a[52:55], v[164:167], v[16:31]
    buffer_load_dwordx4 v240, s[8:11], s63 offen offset:1024 sc1 lds
    v_exp_f32 v179, v99
    v_add_f32 v180, v180, v178
    v_mfma_f32_32x32x16_bf16 v[32:47], a[56:59], v[164:167], v[32:47]
    v_exp_f32 v176, v100
    v_add_f32 v180, v180, v179
    v_cvt_pk_bf16_f32 v161, v178, v179
    v_mfma_f32_32x32x16_bf16 v[48:63], a[60:63], v[164:167], v[48:63]
    v_exp_f32 v177, v101
    v_add_f32 v180, v180, v176
    s_cbranch_vccnz L_k2_site_36_s
L_k2_site_36_r:
    v_mfma_f32_32x32x16_bf16 v[112:127], a[0:3], v[192:195], v[224:239]
    v_exp_f32 v178, v102
    v_add_f32 v180, v180, v177
    v_cvt_pk_bf16_f32 v162, v176, v177
    v_mfma_f32_32x32x16_bf16 v[112:127], a[4:7], v[196:199], v[112:127]
    buffer_load_dwordx4 v240, s[8:11], s63 offen offset:2048 sc1 lds
    v_exp_f32 v179, v103
    v_add_f32 v180, v180, v178
    v_add_f32 v185, v185, v181
    v_mfma_f32_32x32x16_bf16 v[112:127], a[8:11], v[200:203], v[112:127]
    v_exp_f32 v176, v104
    v_add_f32 v180, v180, v179
    v_cvt_pk_bf16_f32 v163, v178, v179
    v_mfma_f32_32x32x16_bf16 v[112:127], a[12:15], v[204:207], v[112:127]
    v_exp_f32 v177, v105
    v_add_f32 v180, v180, v176
    v_mfma_f32_32x32x16_bf16 v[112:127], a[16:19], v[208:211], v[112:127]
    v_exp_f32 v178, v106
    v_add_f32 v180, v180, v177
    v_cvt_pk_bf16_f32 v164, v176, v177
    v_mfma_f32_32x32x16_bf16 v[112:127], a[20:23], v[212:215], v[112:127]
    buffer_load_dwordx4 v240, s[8:11], s63 offen offset:3072 sc1 lds
    v_exp_f32 v179, v107
    v_add_f32 v180, v180, v178
    v_mfma_f32_32x32x16_bf16 v[112:127], a[24:27], v[216:219], v[112:127]
    v_exp_f32 v176, v108
    v_add_f32 v180, v180, v179
    v_cvt_pk_bf16_f32 v165, v178, v179
    v_mfma_f32_32x32x16_bf16 v[112:127], a[28:31], v[220:223], v[112:127]
    v_exp_f32 v177, v109
    s_add_u32 s63, s63, 16384
    v_add_f32 v180, v180, v176
    v_mfma_f32_32x32x16_bf16 a[64:79], a[32:35], v[168:171], a[64:79]
    ds_read_b128 a[0:3], v183 offset:16384
    v_exp_f32 v178, v110
    v_add_f32 v180, v180, v177
    v_cvt_pk_bf16_f32 v166, v176, v177
    v_mfma_f32_32x32x16_bf16 a[80:95], a[36:39], v[168:171], a[80:95]
    ds_read_b128 a[4:7], v183 offset:17408
    v_exp_f32 v179, v111
    s_add_u32 m0, m0, 16384
    v_add_f32 v180, v180, v178
    v_mfma_f32_32x32x16_bf16 a[96:111], a[40:43], v[168:171], a[96:111]
    ds_read_b128 a[8:11], v183 offset:18432
    v_exp_f32 v176, v112
    v_add_f32 v180, v180, v179
    v_cvt_pk_bf16_f32 v167, v178, v179
    v_mfma_f32_32x32x16_bf16 a[112:127], a[44:47], v[168:171], a[112:127]
    ds_read_b128 a[12:15], v183 offset:19456
    v_exp_f32 v177, v113
    s_and_b32 m0, m0, 0x1ffff
    v_cmp_lt_f32 vcc, s66, v180
    v_mfma_f32_32x32x16_bf16 a[64:79], a[48:51], v[172:175], a[64:79]
    ds_read_b128 a[16:19], v183 offset:20480
    v_exp_f32 v178, v114
    v_add_f32 v181, v176, v177
    v_cvt_pk_bf16_f32 v168, v176, v177
    v_mfma_f32_32x32x16_bf16 a[80:95], a[52:55], v[172:175], a[80:95]
    ds_read_b128 a[20:23], v183 offset:21504
    v_exp_f32 v179, v115
    s_cmp_lt_u32 s63, s64
    s_cselect_b32 s63, s63, 0x40000000
    v_add_f32 v181, v181, v178
    v_mfma_f32_32x32x16_bf16 a[96:111], a[56:59], v[172:175], a[96:111]
    ds_read_b128 a[24:27], v183 offset:22528
    v_exp_f32 v176, v116
    v_add_f32 v181, v181, v179
    v_cvt_pk_bf16_f32 v169, v178, v179
    v_mfma_f32_32x32x16_bf16 a[112:127], a[60:63], v[172:175], a[112:127]
    ds_read_b128 a[28:31], v183 offset:23552
    v_exp_f32 v177, v117
    v_add_f32 v181, v181, v176
    s_cbranch_vccnz L_k2_site_37_s
L_k2_site_37_r:
    s_waitcnt lgkmcnt(4)
    v_mfma_f32_32x32x16_bf16 v[96:111], a[0:3], v[64:67], v[128:143]
    ds_read_b128 a[32:35], v183 offset:8192
    v_exp_f32 v178, v118
    v_add_f32 v181, v181, v177
    v_cvt_pk_bf16_f32 v170, v176, v177
    v_mfma_f32_32x32x16_bf16 v[96:111], a[4:7], v[68:71], v[96:111]
    ds_read_b128 a[36:39], v183 offset:9216
    v_exp_f32 v179, v119
    v_add_f32 v181, v181, v178
    v_add_f32 v182, v182, v180
    v_mfma_f32_32x32x16_bf16 v[96:111], a[8:11], v[72:75], v[96:111]
    ds_read_b128 a[40:43], v183 offset:10240
    v_exp_f32 v176, v120
    v_add_f32 v181, v181, v179
    v_cvt_pk_bf16_f32 v171, v178, v179
    v_mfma_f32_32x32x16_bf16 v[96:111], a[12:15], v[76:79], v[96:111]
    ds_read_b128 a[44:47], v183 offset:11264
    v_exp_f32 v177, v121
    v_add_f32 v181, v181, v176
    s_waitcnt lgkmcnt(4)
    v_mfma_f32_32x32x16_bf16 v[96:111], a[16:19], v[80:83], v[96:111]
    ds_read_b128 a[48:51], v183 offset:12288
    v_exp_f32 v178, v122
    v_add_f32 v181, v181, v177
    v_cvt_pk_bf16_f32 v172, v176, v177
    v_mfma_f32_32x32x16_bf16 v[96:111], a[20:23], v[84:87], v[96:111]
    ds_read_b128 a[52:55], v183 offset:13312
    v_exp_f32 v179, v123
    v_add_f32 v181, v181, v178
    v_mfma_f32_32x32x16_bf16 v[96:111], a[24:27], v[88:91], v[96:111]
    ds_read_b128 a[56:59], v183 offset:14336
    v_exp_f32 v176, v124
    v_add_f32 v181, v181, v179
    v_cvt_pk_bf16_f32 v173, v178, v179
    v_mfma_f32_32x32x16_bf16 v[96:111], a[28:31], v[92:95], v[96:111]
    ds_read_b128 a[60:63], v183 offset:15360
    v_exp_f32 v177, v125
    v_add_f32 v181, v181, v176
    s_waitcnt lgkmcnt(4)
    v_mfma_f32_32x32x16_bf16 v[0:15], a[32:35], v[160:163], v[0:15]
    v_exp_f32 v178, v126
    v_add_f32 v181, v181, v177
    v_cvt_pk_bf16_f32 v174, v176, v177
    v_mfma_f32_32x32x16_bf16 v[16:31], a[36:39], v[160:163], v[16:31]
    buffer_load_dwordx4 v240, s[8:11], s63 offen offset:0 sc1 lds
    v_exp_f32 v179, v127
    v_add_f32 v181, v181, v178
    v_mfma_f32_32x32x16_bf16 v[32:47], a[40:43], v[160:163], v[32:47]
    v_exp_f32 v176, v96
    v_add_f32 v181, v181, v179
    v_cvt_pk_bf16_f32 v175, v178, v179
    v_mfma_f32_32x32x16_bf16 v[48:63], a[44:47], v[160:163], v[48:63]
    v_exp_f32 v177, v97
    v_cmp_lt_f32 vcc, s66, v181
    s_waitcnt lgkmcnt(0)
    v_mfma_f32_32x32x16_bf16 v[0:15], a[48:51], v[164:167], v[0:15]
    v_exp_f32 v178, v98
    v_add_f32 v180, v176, v177
    v_cvt_pk_bf16_f32 v160, v176, v177
    v_mfma_f32_32x32x16_bf16 v[16:31], a[52:55], v[164:167], v[16:31]
    buffer_load_dwordx4 v240, s[8:11], s63 offen offset:1024 sc1 lds
    v_exp_f32 v179, v99
    v_add_f32 v180, v180, v178
    v_mfma_f32_32x32x16_bf16 v[32:47], a[56:59], v[164:167], v[32:47]
    v_exp_f32 v176, v100
    v_add_f32 v180, v180, v179
    v_cvt_pk_bf16_f32 v161, v178, v179
    v_mfma_f32_32x32x16_bf16 v[48:63], a[60:63], v[164:167], v[48:63]
    v_exp_f32 v177, v101
    v_add_f32 v180, v180, v176
    s_cbranch_vccnz L_k2_site_38_s
L_k2_site_38_r:
    v_mfma_f32_32x32x16_bf16 v[112:127], a[0:3], v[192:195], v[224:239]
    v_exp_f32 v178, v102
    v_add_f32 v180, v180, v177
    v_cvt_pk_bf16_f32 v162, v176, v177
    v_mfma_f32_32x32x16_bf16 v[112:127], a[4:7], v[196:199], v[112:127]
    buffer_load_dwordx4 v240, s[8:11], s63 offen offset:2048 sc1 lds
    v_exp_f32 v179, v103
    v_add_f32 v180, v180, v178
    v_add_f32 v185, v185, v181
    v_mfma_f32_32x32x16_bf16 v[112:127], a[8:11], v[200:203], v[112:127]
    v_exp_f32 v176, v104
    v_add_f32 v180, v180, v179
    v_cvt_pk_bf16_f32 v163, v178, v179
    v_mfma_f32_32x32x16_bf16 v[112:127], a[12:15], v[204:207], v[112:127]
    v_exp_f32 v177, v105
    v_add_f32 v180, v180, v176
    v_mfma_f32_32x32x16_bf16 v[112:127], a[16:19], v[208:211], v[112:127]
    v_exp_f32 v178, v106
    v_add_f32 v180, v180, v177
    v_cvt_pk_bf16_f32 v164, v176, v177
    v_mfma_f32_32x32x16_bf16 v[112:127], a[20:23], v[212:215], v[112:127]
    buffer_load_dwordx4 v240, s[8:11], s63 offen offset:3072 sc1 lds
    v_exp_f32 v179, v107
    v_add_f32 v180, v180, v178
    v_mfma_f32_32x32x16_bf16 v[112:127], a[24:27], v[216:219], v[112:127]
    v_exp_f32 v176, v108
    v_add_f32 v180, v180, v179
    v_cvt_pk_bf16_f32 v165, v178, v179
    v_mfma_f32_32x32x16_bf16 v[112:127], a[28:31], v[220:223], v[112:127]
    v_exp_f32 v177, v109
    s_add_u32 s63, s63, 16384
    v_add_f32 v180, v180, v176
    v_mfma_f32_32x32x16_bf16 a[64:79], a[32:35], v[168:171], a[64:79]
    ds_read_b128 a[0:3], v183 offset:32768
    v_exp_f32 v178, v110
    v_add_f32 v180, v180, v177
    v_cvt_pk_bf16_f32 v166, v176, v177
    v_mfma_f32_32x32x16_bf16 a[80:95], a[36:39], v[168:171], a[80:95]
    ds_read_b128 a[4:7], v183 offset:33792
    v_exp_f32 v179, v111
    s_add_u32 m0, m0, 16384
    v_add_f32 v180, v180, v178
    v_mfma_f32_32x32x16_bf16 a[96:111], a[40:43], v[168:171], a[96:111]
    ds_read_b128 a[8:11], v183 offset:34816
    v_exp_f32 v176, v112
    v_add_f32 v180, v180, v179
    v_cvt_pk_bf16_f32 v167, v178, v179
    v_mfma_f32_32x32x16_bf16 a[112:127], a[44:47], v[168:171], a[112:127]
    ds_read_b128 a[12:15], v183 offset:35840
    v_exp_f32 v177, v113
    s_and_b32 m0, m0, 0x1ffff
    v_cmp_lt_f32 vcc, s66, v180
    v_mfma_f32_32x32x16_bf16 a[64:79], a[48:51], v[172:175], a[64:79]
    ds_read_b128 a[16:19], v183 offset:36864
    v_exp_f32 v178, v114
    v_add_f32 v181, v176, v177
    v_cvt_pk_bf16_f32 v168, v176, v177
    v_mfma_f32_32x32x16_bf16 a[80:95], a[52:55], v[172:175], a[80:95]
    ds_read_b128 a[20:23], v183 offset:37888
    v_exp_f32 v179, v115
    s_cmp_lt_u32 s63, s64
    s_cselect_b32 s63, s63, 0x40000000
    v_add_f32 v181, v181, v178
    v_mfma_f32_32x32x16_bf16 a[96:111], a[56:59], v[172:175], a[96:111]
    ds_read_b128 a[24:27], v183 offset:38912
    v_exp_f32 v176, v116
    v_add_f32 v181, v181, v179
    v_cvt_pk_bf16_f32 v169, v178, v179
    v_mfma_f32_32x32x16_bf16 a[112:127], a[60:63], v[172:175], a[112:127]
    ds_read_b128 a[28:31], v183 offset:39936
    v_exp_f32 v177, v117
    v_add_f32 v181, v181, v176
    s_cbranch_vccnz L_k2_site_39_s
L_k2_site_39_r:
    s_waitcnt lgkmcnt(4)
    v_mfma_f32_32x32x16_bf16 v[96:111], a[0:3], v[64:67], v[128:143]
    ds_read_b128 a[32:35], v183 offset:24576
    v_exp_f32 v178, v118
    v_add_f32 v181, v181, v177
    v_cvt_pk_bf16_f32 v170, v176, v177
    v_mfma_f32_32x32x16_bf16 v[96:111], a[4:7], v[68:71], v[96:111]
    ds_read_b128 a[36:39], v183 offset:25600
    v_exp_f32 v179, v119
    v_add_f32 v181, v181, v178
    v_add_f32 v182, v182, v180
    v_mfma_f32_32x32x16_bf16 v[96:111], a[8:11], v[72:75], v[96:111]
    ds_read_b128 a[40:43], v183 offset:26624
    v_exp_f32 v176, v120
    v_add_f32 v181, v181, v179
    v_cvt_pk_bf16_f32 v171, v178, v179
    v_mfma_f32_32x32x16_bf16 v[96:111], a[12:15], v[76:79], v[96:111]
    ds_read_b128 a[44:47], v183 offset:27648
    v_exp_f32 v177, v121
    v_add_f32 v181, v181, v176
    s_waitcnt lgkmcnt(4)
    v_mfma_f32_32x32x16_bf16 v[96:111], a[16:19], v[80:83], v[96:111]
    ds_read_b128 a[48:51], v183 offset:28672
    v_exp_f32 v178, v122
    v_add_f32 v181, v181, v177
    v_cvt_pk_bf16_f32 v172, v176, v177
    v_mfma_f32_32x32x16_bf16 v[96:111], a[20:23], v[84:87], v[96:111]
    ds_read_b128 a[52:55], v183 offset:29696
    v_exp_f32 v179, v123
    v_add_f32 v181, v181, v178
    v_mfma_f32_32x32x16_bf16 v[96:111], a[24:27], v[88:91], v[96:111]
    ds_read_b128 a[56:59], v183 offset:30720
    v_exp_f32 v176, v124
    v_add_f32 v181, v181, v179
    v_cvt_pk_bf16_f32 v173, v178, v179
    v_mfma_f32_32x32x16_bf16 v[96:111], a[28:31], v[92:95], v[96:111]
    ds_read_b128 a[60:63], v183 offset:31744
    v_exp_f32 v177, v125
    v_add_f32 v181, v181, v176
    s_waitcnt vmcnt(4)
    s_barrier
    s_waitcnt lgkmcnt(4)
    v_mfma_f32_32x32x16_bf16 v[0:15], a[32:35], v[160:163], v[0:15]
    v_exp_f32 v178, v126
    v_add_f32 v181, v181, v177
    v_cvt_pk_bf16_f32 v174, v176, v177
    v_mfma_f32_32x32x16_bf16 v[16:31], a[36:39], v[160:163], v[16:31]
    buffer_load_dwordx4 v240, s[8:11], s63 offen offset:0 sc1 lds
    v_exp_f32 v179, v127
    v_add_f32 v181, v181, v178
    v_mfma_f32_32x32x16_bf16 v[32:47], a[40:43], v[160:163], v[32:47]
    v_exp_f32 v176, v96
    v_add_f32 v181, v181, v179
    v_cvt_pk_bf16_f32 v175, v178, v179
    v_mfma_f32_32x32x16_bf16 v[48:63], a[44:47], v[160:163], v[48:63]
    v_exp_f32 v177, v97
    v_cmp_lt_f32 vcc, s66, v181
    s_waitcnt lgkmcnt(0)
    v_mfma_f32_32x32x16_bf16 v[0:15], a[48:51], v[164:167], v[0:15]
    v_exp_f32 v178, v98
    v_add_f32 v180, v176, v177
    v_cvt_pk_bf16_f32 v160, v176, v177
    v_mfma_f32_32x32x16_bf16 v[16:31], a[52:55], v[164:167], v[16:31]
    buffer_load_dwordx4 v240, s[8:11], s63 offen offset:1024 sc1 lds
    v_exp_f32 v179, v99
    v_add_f32 v180, v180, v178
    v_mfma_f32_32x32x16_bf16 v[32:47], a[56:59], v[164:167], v[32:47]
    v_exp_f32 v176, v100
    v_add_f32 v180, v180, v179
    v_cvt_pk_bf16_f32 v161, v178, v179
    v_mfma_f32_32x32x16_bf16 v[48:63], a[60:63], v[164:167], v[48:63]
    v_exp_f32 v177, v101
    v_add_f32 v180, v180, v176
    s_cbranch_vccnz L_k2_site_40_s
L_k2_site_40_r:
    v_mfma_f32_32x32x16_bf16 v[112:127], a[0:3], v[192:195], v[224:239]
    v_exp_f32 v178, v102
    v_add_f32 v180, v180, v177
    v_cvt_pk_bf16_f32 v162, v176, v177
    v_mfma_f32_32x32x16_bf16 v[112:127], a[4:7], v[196:199], v[112:127]
    buffer_load_dwordx4 v240, s[8:11], s63 offen offset:2048 sc1 lds
    v_exp_f32 v179, v103
    v_add_f32 v180, v180, v178
    v_add_f32 v185, v185, v181
    v_mfma_f32_32x32x16_bf16 v[112:127], a[8:11], v[200:203], v[112:127]
    v_exp_f32 v176, v104
    v_add_f32 v180, v180, v179
    v_cvt_pk_bf16_f32 v163, v178, v179
    v_mfma_f32_32x32x16_bf16 v[112:127], a[12:15], v[204:207], v[112:127]
    v_exp_f32 v177, v105
    v_add_f32 v180, v180, v176
    v_mfma_f32_32x32x16_bf16 v[112:127], a[16:19], v[208:211], v[112:127]
    v_exp_f32 v178, v106
    v_add_f32 v180, v180, v177
    v_cvt_pk_bf16_f32 v164, v176, v177
    v_mfma_f32_32x32x16_bf16 v[112:127], a[20:23], v[212:215], v[112:127]
    buffer_load_dwordx4 v240, s[8:11], s63 offen offset:3072 sc1 lds
    v_exp_f32 v179, v107
    v_add_f32 v180, v180, v178
    v_mfma_f32_32x32x16_bf16 v[112:127], a[24:27], v[216:219], v[112:127]
    v_exp_f32 v176, v108
    v_add_f32 v180, v180, v179
    v_cvt_pk_bf16_f32 v165, v178, v179
    v_mfma_f32_32x32x16_bf16 v[112:127], a[28:31], v[220:223], v[112:127]
    v_exp_f32 v177, v109
    s_add_u32 s63, s63, 16384
    v_add_f32 v180, v180, v176
    v_mfma_f32_32x32x16_bf16 a[64:79], a[32:35], v[168:171], a[64:79]
    ds_read_b128 a[0:3], v183 offset:49152
    v_exp_f32 v178, v110
    v_add_f32 v180, v180, v177
    v_cvt_pk_bf16_f32 v166, v176, v177
    v_mfma_f32_32x32x16_bf16 a[80:95], a[36:39], v[168:171], a[80:95]
    ds_read_b128 a[4:7], v183 offset:50176
    v_exp_f32 v179, v111
    s_add_u32 m0, m0, 16384
    v_add_f32 v180, v180, v178
    v_mfma_f32_32x32x16_bf16 a[96:111], a[40:43], v[168:171], a[96:111]
    ds_read_b128 a[8:11], v183 offset:51200
    v_exp_f32 v176, v112
    v_add_f32 v180, v180, v179
    v_cvt_pk_bf16_f32 v167, v178, v179
    v_mfma_f32_32x32x16_bf16 a[112:127], a[44:47], v[168:171], a[112:127]
    ds_read_b128 a[12:15], v183 offset:52224
    v_exp_f32 v177, v113
    s_and_b32 m0, m0, 0x1ffff
    v_cmp_lt_f32 vcc, s66, v180
    v_mfma_f32_32x32x16_bf16 a[64:79], a[48:51], v[172:175], a[64:79]
    ds_read_b128 a[16:19], v183 offset:53248
    v_exp_f32 v178, v114
    v_add_f32 v181, v176, v177
    v_cvt_pk_bf16_f32 v168, v176, v177
    v_mfma_f32_32x32x16_bf16 a[80:95], a[52:55], v[172:175], a[80:95]
    ds_read_b128 a[20:23], v183 offset:54272
    v_exp_f32 v179, v115
    s_cmp_lt_u32 s63, s64
    s_cselect_b32 s63, s63, 0x40000000
    v_add_f32 v181, v181, v178
    v_mfma_f32_32x32x16_bf16 a[96:111], a[56:59], v[172:175], a[96:111]
    ds_read_b128 a[24:27], v183 offset:55296
    v_exp_f32 v176, v116
    v_add_f32 v181, v181, v179
    v_cvt_pk_bf16_f32 v169, v178, v179
    v_mfma_f32_32x32x16_bf16 a[112:127], a[60:63], v[172:175], a[112:127]
    ds_read_b128 a[28:31], v183 offset:56320
    v_exp_f32 v177, v117
    v_add_f32 v181, v181, v176
    s_cbranch_vccnz L_k2_site_41_s
L_k2_site_41_r:
    s_waitcnt lgkmcnt(4)
    v_mfma_f32_32x32x16_bf16 v[96:111], a[0:3], v[64:67], v[128:143]
    ds_read_b128 a[32:35], v183 offset:40960
    v_exp_f32 v178, v118
    v_add_f32 v181, v181, v177
    v_cvt_pk_bf16_f32 v170, v176, v177
    v_mfma_f32_32x32x16_bf16 v[96:111], a[4:7], v[68:71], v[96:111]
    ds_read_b128 a[36:39], v183 offset:41984
    v_exp_f32 v179, v119
    v_add_f32 v181, v181, v178
    v_add_f32 v182, v182, v180
    v_mfma_f32_32x32x16_bf16 v[96:111], a[8:11], v[72:75], v[96:111]
    ds_read_b128 a[40:43], v183 offset:43008
    v_exp_f32 v176, v120
    v_add_f32 v181, v181, v179
    v_cvt_pk_bf16_f32 v171, v178, v179
    v_mfma_f32_32x32x16_bf16 v[96:111], a[12:15], v[76:79], v[96:111]
    ds_read_b128 a[44:47], v183 offset:44032
    v_exp_f32 v177, v121
    v_add_f32 v181, v181, v176
    s_waitcnt lgkmcnt(4)
    v_mfma_f32_32x32x16_bf16 v[96:111], a[16:19], v[80:83], v[96:111]
    ds_read_b128 a[48:51], v183 offset:45056
    v_exp_f32 v178, v122
    v_add_f32 v181, v181, v177
    v_cvt_pk_bf16_f32 v172, v176, v177
    v_mfma_f32_32x32x16_bf16 v[96:111], a[20:23], v[84:87], v[96:111]
    ds_read_b128 a[52:55], v183 offset:46080
    v_exp_f32 v179, v123
    v_add_f32 v181, v181, v178
    v_mfma_f32_32x32x16_bf16 v[96:111], a[24:27], v[88:91], v[96:111]
    ds_read_b128 a[56:59], v183 offset:47104
    v_exp_f32 v176, v124
    v_add_f32 v181, v181, v179
    v_cvt_pk_bf16_f32 v173, v178, v179
    v_mfma_f32_32x32x16_bf16 v[96:111], a[28:31], v[92:95], v[96:111]
    ds_read_b128 a[60:63], v183 offset:48128
    v_exp_f32 v177, v125
    v_add_f32 v181, v181, v176
    s_waitcnt lgkmcnt(4)
    v_mfma_f32_32x32x16_bf16 v[0:15], a[32:35], v[160:163], v[0:15]
    v_exp_f32 v178, v126
    v_add_f32 v181, v181, v177
    v_cvt_pk_bf16_f32 v174, v176, v177
    v_mfma_f32_32x32x16_bf16 v[16:31], a[36:39], v[160:163], v[16:31]
    buffer_load_dwordx4 v240, s[8:11], s63 offen offset:0 sc1 lds
    v_exp_f32 v179, v127
    v_add_f32 v181, v181, v178
    v_mfma_f32_32x32x16_bf16 v[32:47], a[40:43], v[160:163], v[32:47]
    v_exp_f32 v176, v96
    v_add_f32 v181, v181, v179
    v_cvt_pk_bf16_f32 v175, v178, v179
    v_mfma_f32_32x32x16_bf16 v[48:63], a[44:47], v[160:163], v[48:63]
    v_exp_f32 v177, v97
    v_cmp_lt_f32 vcc, s66, v181
    s_waitcnt lgkmcnt(0)
    v_mfma_f32_32x32x16_bf16 v[0:15], a[48:51], v[164:167], v[0:15]
    v_exp_f32 v178, v98
    v_add_f32 v180, v176, v177
    v_cvt_pk_bf16_f32 v160, v176, v177
    v_mfma_f32_32x32x16_bf16 v[16:31], a[52:55], v[164:167], v[16:31]
    buffer_load_dwordx4 v240, s[8:11], s63 offen offset:1024 sc1 lds
    v_exp_f32 v179, v99
    v_add_f32 v180, v180, v178
    v_mfma_f32_32x32x16_bf16 v[32:47], a[56:59], v[164:167], v[32:47]
    v_exp_f32 v176, v100
    v_add_f32 v180, v180, v179
    v_cvt_pk_bf16_f32 v161, v178, v179
    v_mfma_f32_32x32x16_bf16 v[48:63], a[60:63], v[164:167], v[48:63]
    v_exp_f32 v177, v101
    v_add_f32 v180, v180, v176
    s_cbranch_vccnz L_k2_site_42_s
L_k2_site_42_r:
    v_mfma_f32_32x32x16_bf16 v[112:127], a[0:3], v[192:195], v[224:239]
    v_exp_f32 v178, v102
    v_add_f32 v180, v180, v177
    v_cvt_pk_bf16_f32 v162, v176, v177
    v_mfma_f32_32x32x16_bf16 v[112:127], a[4:7], v[196:199], v[112:127]
    buffer_load_dwordx4 v240, s[8:11], s63 offen offset:2048 sc1 lds
    v_exp_f32 v179, v103
    v_add_f32 v180, v180, v178
    v_add_f32 v185, v185, v181
    v_mfma_f32_32x32x16_bf16 v[112:127], a[8:11], v[200:203], v[112:127]
    v_exp_f32 v176, v104
    v_add_f32 v180, v180, v179
    v_cvt_pk_bf16_f32 v163, v178, v179
    v_mfma_f32_32x32x16_bf16 v[112:127], a[12:15], v[204:207], v[112:127]
    v_exp_f32 v177, v105
    v_add_f32 v180, v180, v176
    v_mfma_f32_32x32x16_bf16 v[112:127], a[16:19], v[208:211], v[112:127]
    v_exp_f32 v178, v106
    v_add_f32 v180, v180, v177
    v_cvt_pk_bf16_f32 v164, v176, v177
    v_mfma_f32_32x32x16_bf16 v[112:127], a[20:23], v[212:215], v[112:127]
    buffer_load_dwordx4 v240, s[8:11], s63 offen offset:3072 sc1 lds
    v_exp_f32 v179, v107
    v_add_f32 v180, v180, v178
    v_mfma_f32_32x32x16_bf16 v[112:127], a[24:27], v[216:219], v[112:127]
    v_exp_f32 v176, v108
    v_add_f32 v180, v180, v179
    v_cvt_pk_bf16_f32 v165, v178, v179
    v_mfma_f32_32x32x16_bf16 v[112:127], a[28:31], v[220:223], v[112:127]
    v_exp_f32 v177, v109
    s_add_u32 s63, s63, 16384
    v_add_f32 v180, v180, v176
    v_mfma_f32_32x32x16_bf16 a[64:79], a[32:35], v[168:171], a[64:79]
    ds_read_b128 a[0:3], v184 offset:0
    v_exp_f32 v178, v110
    v_add_f32 v180, v180, v177
    v_cvt_pk_bf16_f32 v166, v176, v177
    v_mfma_f32_32x32x16_bf16 a[80:95], a[36:39], v[168:171], a[80:95]
    ds_read_b128 a[4:7], v184 offset:1024
    v_exp_f32 v179, v111
    s_add_u32 m0, m0, 16384
    v_add_f32 v180, v180, v178
    v_mfma_f32_32x32x16_bf16 a[96:111], a[40:43], v[168:171], a[96:111]
    ds_read_b128 a[8:11], v184 offset:2048
    v_exp_f32 v176, v112
    v_add_f32 v180, v180, v179
    v_cvt_pk_bf16_f32 v167, v178, v179
    v_mfma_f32_32x32x16_bf16 a[112:127], a[44:47], v[168:171], a[112:127]
    ds_read_b128 a[12:15], v184 offset:3072
    v_exp_f32 v177, v113
    s_and_b32 m0, m0, 0x1ffff
    v_cmp_lt_f32 vcc, s66, v180
    v_mfma_f32_32x32x16_bf16 a[64:79], a[48:51], v[172:175], a[64:79]
    ds_read_b128 a[16:19], v184 offset:4096
    v_exp_f32 v178, v114
    v_add_f32 v181, v176, v177
    v_cvt_pk_bf16_f32 v168, v176, v177
    v_mfma_f32_32x32x16_bf16 a[80:95], a[52:55], v[172:175], a[80:95]
    ds_read_b128 a[20:23], v184 offset:5120
    v_exp_f32 v179, v115
    s_cmp_lt_u32 s63, s64
    s_cselect_b32 s63, s63, 0x40000000
    v_add_f32 v181, v181, v178
    v_mfma_f32_32x32x16_bf16 a[96:111], a[56:59], v[172:175], a[96:111]
    ds_read_b128 a[24:27], v184 offset:6144
    v_exp_f32 v176, v116
    v_add_f32 v181, v181, v179
    v_cvt_pk_bf16_f32 v169, v178, v179
    v_mfma_f32_32x32x16_bf16 a[112:127], a[60:63], v[172:175], a[112:127]
    ds_read_b128 a[28:31], v184 offset:7168
    v_exp_f32 v177, v117
    v_add_f32 v181, v181, v176
    v_swap_b32 v183, v184
    s_cbranch_vccnz L_k2_site_43_s
L_k2_site_43_r:
    s_sub_u32 s51, s51, 1
    s_cmp_lg_u32 s51, 0
    s_cbranch_scc1 L_k2_dloop
L_k2_dtail:
    s_waitcnt lgkmcnt(4)
    v_mfma_f32_32x32x16_bf16 v[96:111], a[0:3], v[64:67], v[128:143]
    ds_read_b128 a[32:35], v184 offset:57344
    v_exp_f32 v178, v118
    v_add_f32 v181, v181, v177
    v_cvt_pk_bf16_f32 v170, v176, v177
    v_mfma_f32_32x32x16_bf16 v[96:111], a[4:7], v[68:71], v[96:111]
    ds_read_b128 a[36:39], v184 offset:58368
    v_exp_f32 v179, v119
    v_add_f32 v181, v181, v178
    v_add_f32 v182, v182, v180
    v_mfma_f32_32x32x16_bf16 v[96:111], a[8:11], v[72:75], v[96:111]
    ds_read_b128 a[40:43], v184 offset:59392
    v_exp_f32 v176, v120
    v_add_f32 v181, v181, v179
    v_cvt_pk_bf16_f32 v171, v178, v179
    v_mfma_f32_32x32x16_bf16 v[96:111], a[12:15], v[76:79], v[96:111]
    ds_read_b128 a[44:47], v184 offset:60416
    v_exp_f32 v177, v121
    v_add_f32 v181, v181, v176
    s_waitcnt lgkmcnt(4)
    v_mfma_f32_32x32x16_bf16 v[96:111], a[16:19], v[80:83], v[96:111]
    ds_read_b128 a[48:51], v184 offset:61440
    v_exp_f32 v178, v122
    v_add_f32 v181, v181, v177
    v_cvt_pk_bf16_f32 v172, v176, v177
    v_mfma_f32_32x32x16_bf16 v[96:111], a[20:23], v[84:87], v[96:111]
    ds_read_b128 a[52:55], v184 offset:62464
    v_exp_f32 v179, v123
    v_add_f32 v181, v181, v178
    v_mfma_f32_32x32x16_bf16 v[96:111], a[24:27], v[88:91], v[96:111]
    ds_read_b128 a[56:59], v184 offset:63488
    v_exp_f32 v176, v124
    v_add_f32 v181, v181, v179
    v_cvt_pk_bf16_f32 v173, v178, v179
    v_mfma_f32_32x32x16_bf16 v[96:111], a[28:31], v[92:95], v[96:111]
    ds_read_b128 a[60:63], v184 offset:64512
    v_exp_f32 v177, v125
    v_add_f32 v181, v181, v176
    s_waitcnt vmcnt(4)
    s_barrier
    s_waitcnt lgkmcnt(4)
    v_mfma_f32_32x32x16_bf16 v[0:15], a[32:35], v[160:163], v[0:15]
    v_exp_f32 v178, v126
    v_add_f32 v181, v181, v177
    v_cvt_pk_bf16_f32 v174, v176, v177
    v_mfma_f32_32x32x16_bf16 v[16:31], a[36:39], v[160:163], v[16:31]
    buffer_load_dwordx4 v240, s[8:11], s63 offen offset:0 sc1 lds
    v_exp_f32 v179, v127
    v_add_f32 v181, v181, v178
    v_mfma_f32_32x32x16_bf16 v[32:47], a[40:43], v[160:163], v[32:47]
    v_exp_f32 v176, v96
    v_add_f32 v181, v181, v179
    v_cvt_pk_bf16_f32 v175, v178, v179
    v_mfma_f32_32x32x16_bf16 v[48:63], a[44:47], v[160:163], v[48:63]
    s_cmp_lt_u32 s56, s34
    s_cbranch_scc0 L_k2_pf_44
    buffer_load_dword v252, v250, s[32:35], s56 offen
    s_add_u32 s56, s56, 4096
L_k2_pf_44:
    v_exp_f32 v177, v97
    v_cmp_lt_f32 vcc, s66, v181
    s_waitcnt lgkmcnt(0)
    v_mfma_f32_32x32x16_bf16 v[0:15], a[48:51], v[164:167], v[0:15]
    v_exp_f32 v178, v98
    v_add_f32 v180, v176, v177
    v_cvt_pk_bf16_f32 v160, v176, v177
    v_mfma_f32_32x32x16_bf16 v[16:31], a[52:55], v[164:167], v[16:31]
    buffer_load_dwordx4 v240, s[8:11], s63 offen offset:1024 sc1 lds
    v_exp_f32 v179, v99
    v_add_f32 v180, v180, v178
    v_mfma_f32_32x32x16_bf16 v[32:47], a[56:59], v[164:167], v[32:47]
    v_exp_f32 v176, v100
    v_add_f32 v180, v180, v179
    v_cvt_pk_bf16_f32 v161, v178, v179
    v_mfma_f32_32x32x16_bf16 v[48:63], a[60:63], v[164:167], v[48:63]
    v_exp_f32 v177, v101
    v_add_f32 v180, v180, v176
    s_cbranch_vccnz L_k2_site_45_s
L_k2_site_45_r:
    s_cmp_gt_u32 s44, 0
    s_cbranch_scc1 L_k2_m_46
    v_mfma_f32_32x32x16_bf16 v[112:127], a[0:3], v[192:195], v[144:159]
    s_branch L_k2_m_47
L_k2_m_46:
    v_mfma_f32_32x32x16_bf16 v[112:127], a[0:3], v[192:195], v[224:239]
L_k2_m_47:
    v_exp_f32 v178, v102
    v_add_f32 v180, v180, v177
    v_cvt_pk_bf16_f32 v162, v176, v177
    v_mfma_f32_32x32x16_bf16 v[112:127], a[4:7], v[196:199], v[112:127]
    buffer_load_dwordx4 v240, s[8:11], s63 offen offset:2048 sc1 lds
    v_exp_f32 v179, v103
    v_add_f32 v180, v180, v178
    v_add_f32 v185, v185, v181
    v_mfma_f32_32x32x16_bf16 v[112:127], a[8:11], v[200:203], v[112:127]
    v_exp_f32 v176, v104
    v_add_f32 v180, v180, v179
    v_cvt_pk_bf16_f32 v163, v178, v179
    v_mfma_f32_32x32x16_bf16 v[112:127], a[12:15], v[204:207], v[112:127]
    v_exp_f32 v177, v105
    v_add_f32 v180, v180, v176
    v_mfma_f32_32x32x16_bf16 v[112:127], a[16:19], v[208:211], v[112:127]
    v_exp_f32 v178, v106
    v_add_f32 v180, v180, v177
    v_cvt_pk_bf16_f32 v164, v176, v177
    v_mfma_f32_32x32x16_bf16 v[112:127], a[20:23], v[212:215], v[112:127]
    buffer_load_dwordx4 v240, s[8:11], s63 offen offset:3072 sc1 lds
    v_exp_f32 v179, v107
    v_add_f32 v180, v180, v178
    v_mfma_f32_32x32x16_bf16 v[112:127], a[24:27], v[216:219], v[112:127]
    v_exp_f32 v176, v108
    v_add_f32 v180, v180, v179
    v_cvt_pk_bf16_f32 v165, v178, v179
    v_mfma_f32_32x32x16_bf16 v[112:127], a[28:31], v[220:223], v[112:127]
    v_exp_f32 v177, v109
    s_add_u32 s63, s63, 16384
    v_add_f32 v180, v180, v176
    v_mfma_f32_32x32x16_bf16 a[64:79], a[32:35], v[168:171], a[64:79]
    ds_read_b128 a[0:3], v183 offset:16384
    v_exp_f32 v178, v110
    v_add_f32 v180, v180, v177
    v_cvt_pk_bf16_f32 v166, v176, v177
    v_mfma_f32_32x32x16_bf16 a[80:95], a[36:39], v[168:171], a[80:95]
    ds_read_b128 a[4:7], v183 offset:17408
    v_exp_f32 v179, v111
    s_add_u32 m0, m0, 16384
    v_add_f32 v180, v180, v178
    v_mfma_f32_32x32x16_bf16 a[96:111], a[40:43], v[168:171], a[96:111]
    ds_read_b128 a[8:11], v183 offset:18432
    v_exp_f32 v176, v112
    v_add_f32 v180, v180, v179
    v_cvt_pk_bf16_f32 v167, v178, v179
    v_mfma_f32_32x32x16_bf16 a[112:127], a[44:47], v[168:171], a[112:127]
    ds_read_b128 a[12:15], v183 offset:19456
    v_exp_f32 v177, v113
    s_and_b32 m0, m0, 0x1ffff
    v_cmp_lt_f32 vcc, s66, v180
    v_mfma_f32_32x32x16_bf16 a[64:79], a[48:51], v[172:175], a[64:79]
    ds_read_b128 a[16:19], v183 offset:20480
    v_exp_f32 v178, v114
    v_add_f32 v181, v176, v177
    v_cvt_pk_bf16_f32 v168, v176, v177
    v_mfma_f32_32x32x16_bf16 a[80:95], a[52:55], v[172:175], a[80:95]
    ds_read_b128 a[20:23], v183 offset:21504
    v_exp_f32 v179, v115
    s_cmp_lt_u32 s63, s64
    s_cselect_b32 s63, s63, 0x40000000
    v_add_f32 v181, v181, v178
    v_mfma_f32_32x32x16_bf16 a[96:111], a[56:59], v[172:175], a[96:111]
    ds_read_b128 a[24:27], v183 offset:22528
    v_exp_f32 v176, v116
    v_add_f32 v181, v181, v179
    v_cvt_pk_bf16_f32 v169, v178, v179
    v_mfma_f32_32x32x16_bf16 a[112:127], a[60:63], v[172:175], a[112:127]
    ds_read_b128 a[28:31], v183 offset:23552
    v_exp_f32 v177, v117
    v_add_f32 v181, v181, v176
    s_cbranch_vccnz L_k2_site_48_s
L_k2_site_48_r:
    s_waitcnt lgkmcnt(4)
    v_mfma_f32_32x32x16_bf16 v[96:111], a[0:3], v[64:67], v[128:143]
    ds_read_b128 a[32:35], v183 offset:8192
    v_exp_f32 v178, v118
    v_add_f32 v181, v181, v177
    v_cvt_pk_bf16_f32 v170, v176, v177
    v_mfma_f32_32x32x16_bf16 v[96:111], a[4:7], v[68:71], v[96:111]
    ds_read_b128 a[36:39], v183 offset:9216
    v_exp_f32 v179, v119
    v_add_f32 v181, v181, v178
    v_add_f32 v182, v182, v180
    v_mfma_f32_32x32x16_bf16 v[96:111], a[8:11], v[72:75], v[96:111]
    ds_read_b128 a[40:43], v183 offset:10240
    v_exp_f32 v176, v120
    v_add_f32 v181, v181, v179
    v_cvt_pk_bf16_f32 v171, v178, v179
    v_mfma_f32_32x32x16_bf16 v[96:111], a[12:15], v[76:79], v[96:111]
    ds_read_b128 a[44:47], v183 offset:11264
    v_exp_f32 v177, v121
    v_add_f32 v181, v181, v176
    s_waitcnt lgkmcnt(4)
    v_mfma_f32_32x32x16_bf16 v[96:111], a[16:19], v[80:83], v[96:111]
    ds_read_b128 a[48:51], v183 offset:12288
    v_exp_f32 v178, v122
    v_add_f32 v181, v181, v177
    v_cvt_pk_bf16_f32 v172, v176, v177
    v_mfma_f32_32x32x16_bf16 v[96:111], a[20:23], v[84:87], v[96:111]
    ds_read_b128 a[52:55], v183 offset:13312
    v_exp_f32 v179, v123
    v_add_f32 v181, v181, v178
    v_mfma_f32_32x32x16_bf16 v[96:111], a[24:27], v[88:91], v[96:111]
    ds_read_b128 a[56:59], v183 offset:14336
    v_exp_f32 v176, v124
    v_add_f32 v181, v181, v179
    v_cvt_pk_bf16_f32 v173, v178, v179
    v_mfma_f32_32x32x16_bf16 v[96:111], a[28:31], v[92:95], v[96:111]
    ds_read_b128 a[60:63], v183 offset:15360
    v_exp_f32 v177, v125
    v_add_f32 v181, v181, v176
    s_waitcnt lgkmcnt(4)
    v_mfma_f32_32x32x16_bf16 v[0:15], a[32:35], v[160:163], v[0:15]
    v_exp_f32 v178, v126
    v_add_f32 v181, v181, v177
    v_cvt_pk_bf16_f32 v174, v176, v177
    v_mfma_f32_32x32x16_bf16 v[16:31], a[36:39], v[160:163], v[16:31]
    buffer_load_dwordx4 v240, s[8:11], s63 offen offset:0 sc1 lds
    v_exp_f32 v179, v127
    v_add_f32 v181, v181, v178
    v_mfma_f32_32x32x16_bf16 v[32:47], a[40:43], v[160:163], v[32:47]
    v_exp_f32 v176, v96
    v_add_f32 v181, v181, v179
    v_cvt_pk_bf16_f32 v175, v178, v179
    v_mfma_f32_32x32x16_bf16 v[48:63], a[44:47], v[160:163], v[48:63]
    v_exp_f32 v177, v97
    v_cmp_lt_f32 vcc, s66, v181
    s_waitcnt lgkmcnt(0)
    v_mfma_f32_32x32x16_bf16 v[0:15], a[48:51], v[164:167], v[0:15]
    v_exp_f32 v178, v98
    v_add_f32 v180, v176, v177
    v_cvt_pk_bf16_f32 v160, v176, v177
    v_mfma_f32_32x32x16_bf16 v[16:31], a[52:55], v[164:167], v[16:31]
    buffer_load_dwordx4 v240, s[8:11], s63 offen offset:1024 sc1 lds
    v_exp_f32 v179, v99
    v_add_f32 v180, v180, v178
    v_mfma_f32_32x32x16_bf16 v[32:47], a[56:59], v[164:167], v[32:47]
    v_exp_f32 v176, v100
    v_add_f32 v180, v180, v179
    v_cvt_pk_bf16_f32 v161, v178, v179
    v_mfma_f32_32x32x16_bf16 v[48:63], a[60:63], v[164:167], v[48:63]
    v_exp_f32 v177, v101
    v_add_f32 v180, v180, v176
    s_cbranch_vccnz L_k2_site_49_s
L_k2_site_49_r:
    s_cmp_ge_u32 s44, 1
    s_cbranch_scc0 L_k2_vn_51
    s_cmp_gt_u32 s44, 1
    s_cbranch_scc1 L_k2_m_52
    v_mfma_f32_32x32x16_bf16 v[112:127], a[0:3], v[192:195], v[144:159]
    s_branch L_k2_m_53
L_k2_m_52:
    v_mfma_f32_32x32x16_bf16 v[112:127], a[0:3], v[192:195], v[224:239]
L_k2_m_53:
    v_exp_f32 v178, v102
    v_add_f32 v180, v180, v177
    v_cvt_pk_bf16_f32 v162, v176, v177
    v_mfma_f32_32x32x16_bf16 v[112:127], a[4:7], v[196:199], v[112:127]
    buffer_load_dwordx4 v240, s[8:11], s63 offen offset:2048 sc1 lds
    v_exp_f32 v179, v103
    v_add_f32 v180, v180, v178
    v_add_f32 v185, v185, v181
    v_mfma_f32_32x32x16_bf16 v[112:127], a[8:11], v[200:203], v[112:127]
    v_exp_f32 v176, v104
    v_add_f32 v180, v180, v179
    v_cvt_pk_bf16_f32 v163, v178, v179
    v_mfma_f32_32x32x16_bf16 v[112:127], a[12:15], v[204:207], v[112:127]
    v_exp_f32 v177, v105
    v_add_f32 v180, v180, v176
    v_mfma_f32_32x32x16_bf16 v[112:127], a[16:19], v[208:211], v[112:127]
    v_exp_f32 v178, v106
    v_add_f32 v180, v180, v177
    v_cvt_pk_bf16_f32 v164, v176, v177
    v_mfma_f32_32x32x16_bf16 v[112:127], a[20:23], v[212:215], v[112:127]
    buffer_load_dwordx4 v240, s[8:11], s63 offen offset:3072 sc1 lds
    v_exp_f32 v179, v107
    v_add_f32 v180, v180, v178
    v_mfma_f32_32x32x16_bf16 v[112:127], a[24:27], v[216:219], v[112:127]
    v_exp_f32 v176, v108
    v_add_f32 v180, v180, v179
    v_cvt_pk_bf16_f32 v165, v178, v179
    v_mfma_f32_32x32x16_bf16 v[112:127], a[28:31], v[220:223], v[112:127]
    v_exp_f32 v177, v109
    s_add_u32 s63, s63, 16384
    v_add_f32 v180, v180, v176
    v_mfma_f32_32x32x16_bf16 a[64:79], a[32:35], v[168:171], a[64:79]
    ds_read_b128 a[0:3], v183 offset:32768
    v_exp_f32 v178, v110
    v_add_f32 v180, v180, v177
    v_cvt_pk_bf16_f32 v166, v176, v177
    v_mfma_f32_32x32x16_bf16 a[80:95], a[36:39], v[168:171], a[80:95]
    ds_read_b128 a[4:7], v183 offset:33792
    v_exp_f32 v179, v111
    s_add_u32 m0, m0, 16384
    v_add_f32 v180, v180, v178
    v_mfma_f32_32x32x16_bf16 a[96:111], a[40:43], v[168:171], a[96:111]
    ds_read_b128 a[8:11], v183 offset:34816
    v_exp_f32 v176, v112
    v_add_f32 v180, v180, v179
    v_cvt_pk_bf16_f32 v167, v178, v179
    v_mfma_f32_32x32x16_bf16 a[112:127], a[44:47], v[168:171], a[112:127]
    ds_read_b128 a[12:15], v183 offset:35840
    v_exp_f32 v177, v113
    s_and_b32 m0, m0, 0x1ffff
    v_cmp_lt_f32 vcc, s66, v180
    v_mfma_f32_32x32x16_bf16 a[64:79], a[48:51], v[172:175], a[64:79]
    ds_read_b128 a[16:19], v183 offset:36864
    v_exp_f32 v178, v114
    v_add_f32 v181, v176, v177
    v_cvt_pk_bf16_f32 v168, v176, v177
    v_mfma_f32_32x32x16_bf16 a[80:95], a[52:55], v[172:175], a[80:95]
    ds_read_b128 a[20:23], v183 offset:37888
    v_exp_f32 v179, v115
    s_cmp_lt_u32 s63, s64
    s_cselect_b32 s63, s63, 0x40000000
    v_add_f32 v181, v181, v178
    v_mfma_f32_32x32x16_bf16 a[96:111], a[56:59], v[172:175], a[96:111]
    ds_read_b128 a[24:27], v183 offset:38912
    v_exp_f32 v176, v116
    v_add_f32 v181, v181, v179
    v_cvt_pk_bf16_f32 v169, v178, v179
    v_mfma_f32_32x32x16_bf16 a[112:127], a[60:63], v[172:175], a[112:127]
    ds_read_b128 a[28:31], v183 offset:39936
    v_exp_f32 v177, v117
    v_add_f32 v181, v181, v176
    s_cbranch_vccnz L_k2_site_54_s
L_k2_site_54_r:
    s_branch L_k2_ve_50
L_k2_vn_51:
    v_exp_f32 v178, v102
    v_add_f32 v180, v180, v177
    v_cvt_pk_bf16_f32 v162, v176, v177
    buffer_load_dwordx4 v240, s[8:11], s63 offen offset:2048 sc1 lds
    v_exp_f32 v179, v103
    v_add_f32 v180, v180, v178
    v_add_f32 v185, v185, v181
    v_exp_f32 v176, v104
    v_add_f32 v180, v180, v179
    v_cvt_pk_bf16_f32 v163, v178, v179
    v_exp_f32 v177, v105
    v_add_f32 v180, v180, v176
    v_exp_f32 v178, v106
    v_add_f32 v180, v180, v177
    v_cvt_pk_bf16_f32 v164, v176, v177
    buffer_load_dwordx4 v240, s[8:11], s63 offen offset:3072 sc1 lds
    v_exp_f32 v179, v107
    v_add_f32 v180, v180, v178
    v_exp_f32 v176, v108
    v_add_f32 v180, v180, v179
    v_cvt_pk_bf16_f32 v165, v178, v179
    v_exp_f32 v177, v109
    s_add_u32 s63, s63, 16384
    v_add_f32 v180, v180, v176
    v_mfma_f32_32x32x16_bf16 a[64:79], a[32:35], v[168:171], a[64:79]
    ds_read_b128 a[0:3], v183 offset:32768
    v_exp_f32 v178, v110
    v_add_f32 v180, v180, v177
    v_cvt_pk_bf16_f32 v166, v176, v177
    v_mfma_f32_32x32x16_bf16 a[80:95], a[36:39], v[168:171], a[80:95]
    ds_read_b128 a[4:7], v183 offset:33792
    v_exp_f32 v179, v111
    s_add_u32 m0, m0, 16384
    v_add_f32 v180, v180, v178
    v_mfma_f32_32x32x16_bf16 a[96:111], a[40:43], v[168:171], a[96:111]
    ds_read_b128 a[8:11], v183 offset:34816
    v_add_f32 v180, v180, v179
    v_cvt_pk_bf16_f32 v167, v178, v179
    v_mfma_f32_32x32x16_bf16 a[112:127], a[44:47], v[168:171], a[112:127]
    ds_read_b128 a[12:15], v183 offset:35840
    s_and_b32 m0, m0, 0x1ffff
    v_cmp_lt_f32 vcc, s66, v180
    v_mfma_f32_32x32x16_bf16 a[64:79], a[48:51], v[172:175], a[64:79]
    ds_read_b128 a[16:19], v183 offset:36864
    v_mfma_f32_32x32x16_bf16 a[80:95], a[52:55], v[172:175], a[80:95]
    ds_read_b128 a[20:23], v183 offset:37888
    s_cmp_lt_u32 s63, s64
    s_cselect_b32 s63, s63, 0x40000000
    v_mfma_f32_32x32x16_bf16 a[96:111], a[56:59], v[172:175], a[96:111]
    ds_read_b128 a[24:27], v183 offset:38912
    v_mfma_f32_32x32x16_bf16 a[112:127], a[60:63], v[172:175], a[112:127]
    ds_read_b128 a[28:31], v183 offset:39936
    s_cbranch_vccnz L_k2_site_55_s
L_k2_site_55_r:
L_k2_ve_50:
    s_cmp_ge_u32 s44, 1
    s_cbranch_scc0 L_k2_vn_57
    s_waitcnt lgkmcnt(4)
    v_mfma_f32_32x32x16_bf16 v[96:111], a[0:3], v[64:67], v[128:143]
    ds_read_b128 a[32:35], v183 offset:24576
    v_exp_f32 v178, v118
    v_add_f32 v181, v181, v177
    v_cvt_pk_bf16_f32 v170, v176, v177
    v_mfma_f32_32x32x16_bf16 v[96:111], a[4:7], v[68:71], v[96:111]
    ds_read_b128 a[36:39], v183 offset:25600
    v_exp_f32 v179, v119
    v_add_f32 v181, v181, v178
    v_add_f32 v182, v182, v180
    v_mfma_f32_32x32x16_bf16 v[96:111], a[8:11], v[72:75], v[96:111]
    ds_read_b128 a[40:43], v183 offset:26624
    v_exp_f32 v176, v120
    v_add_f32 v181, v181, v179
    v_cvt_pk_bf16_f32 v171, v178, v179
    v_mfma_f32_32x32x16_bf16 v[96:111], a[12:15], v[76:79], v[96:111]
    ds_read_b128 a[44:47], v183 offset:27648
    v_exp_f32 v177, v121
    v_add_f32 v181, v181, v176
    s_waitcnt lgkmcnt(4)
    v_mfma_f32_32x32x16_bf16 v[96:111], a[16:19], v[80:83], v[96:111]
    ds_read_b128 a[48:51], v183 offset:28672
    v_exp_f32 v178, v122
    v_add_f32 v181, v181, v177
    v_cvt_pk_bf16_f32 v172, v176, v177
    v_mfma_f32_32x32x16_bf16 v[96:111], a[20:23], v[84:87], v[96:111]
    ds_read_b128 a[52:55], v183 offset:29696
    v_exp_f32 v179, v123
    v_add_f32 v181, v181, v178
    v_mfma_f32_32x32x16_bf16 v[96:111], a[24:27], v[88:91], v[96:111]
    ds_read_b128 a[56:59], v183 offset:30720
    v_exp_f32 v176, v124
    v_add_f32 v181, v181, v179
    v_cvt_pk_bf16_f32 v173, v178, v179
    v_mfma_f32_32x32x16_bf16 v[96:111], a[28:31], v[92:95], v[96:111]
    ds_read_b128 a[60:63], v183 offset:31744
    v_exp_f32 v177, v125
    v_add_f32 v181, v181, v176
    s_waitcnt vmcnt(4)
    s_barrier
    s_waitcnt lgkmcnt(4)
    v_mfma_f32_32x32x16_bf16 v[0:15], a[32:35], v[160:163], v[0:15]
    v_exp_f32 v178, v126
    v_add_f32 v181, v181, v177
    v_cvt_pk_bf16_f32 v174, v176, v177
    v_mfma_f32_32x32x16_bf16 v[16:31], a[36:39], v[160:163], v[16:31]
    buffer_load_dwordx4 v240, s[8:11], s63 offen offset:0 sc1 lds
    v_exp_f32 v179, v127
    v_add_f32 v181, v181, v178
    v_mfma_f32_32x32x16_bf16 v[32:47], a[40:43], v[160:163], v[32:47]
    v_exp_f32 v176, v96
    v_add_f32 v181, v181, v179
    v_cvt_pk_bf16_f32 v175, v178, v179
    v_mfma_f32_32x32x16_bf16 v[48:63], a[44:47], v[160:163], v[48:63]
    v_exp_f32 v177, v97
    v_cmp_lt_f32 vcc, s66, v181
    s_waitcnt lgkmcnt(0)
    v_mfma_f32_32x32x16_bf16 v[0:15], a[48:51], v[164:167], v[0:15]
    v_exp_f32 v178, v98
    v_add_f32 v180, v176, v177
    v_cvt_pk_bf16_f32 v160, v176, v177
    v_mfma_f32_32x32x16_bf16 v[16:31], a[52:55], v[164:167], v[16:31]
    buffer_load_dwordx4 v240, s[8:11], s63 offen offset:1024 sc1 lds
    v_exp_f32 v179, v99
    v_add_f32 v180, v180, v178
    v_mfma_f32_32x32x16_bf16 v[32:47], a[56:59], v[164:167], v[32:47]
    v_exp_f32 v176, v100
    v_add_f32 v180, v180, v179
    v_cvt_pk_bf16_f32 v161, v178, v179
    v_mfma_f32_32x32x16_bf16 v[48:63], a[60:63], v[164:167], v[48:63]
    v_exp_f32 v177, v101
    v_add_f32 v180, v180, v176
    s_cbranch_vccnz L_k2_site_58_s
L_k2_site_58_r:
    s_branch L_k2_ve_56
L_k2_vn_57:
    s_waitcnt lgkmcnt(4)
    v_mfma_f32_32x32x16_bf16 v[96:111], a[0:3], v[64:67], v[128:143]
    ds_read_b128 a[32:35], v183 offset:24576
    v_mfma_f32_32x32x16_bf16 v[96:111], a[4:7], v[68:71], v[96:111]
    ds_read_b128 a[36:39], v183 offset:25600
    v_add_f32 v182, v182, v180
    v_mfma_f32_32x32x16_bf16 v[96:111], a[8:11], v[72:75], v[96:111]
    ds_read_b128 a[40:43], v183 offset:26624
    v_mfma_f32_32x32x16_bf16 v[96:111], a[12:15], v[76:79], v[96:111]
    ds_read_b128 a[44:47], v183 offset:27648
    s_waitcnt lgkmcnt(4)
    v_mfma_f32_32x32x16_bf16 v[96:111], a[16:19], v[80:83], v[96:111]
    ds_read_b128 a[48:51], v183 offset:28672
    v_mfma_f32_32x32x16_bf16 v[96:111], a[20:23], v[84:87], v[96:111]
    ds_read_b128 a[52:55], v183 offset:29696
    v_mfma_f32_32x32x16_bf16 v[96:111], a[24:27], v[88:91], v[96:111]
    ds_read_b128 a[56:59], v183 offset:30720
    v_mfma_f32_32x32x16_bf16 v[96:111], a[28:31], v[92:95], v[96:111]
    ds_read_b128 a[60:63], v183 offset:31744
    s_waitcnt vmcnt(4)
    s_barrier
    s_waitcnt lgkmcnt(4)
    v_mfma_f32_32x32x16_bf16 v[0:15], a[32:35], v[160:163], v[0:15]
    v_mfma_f32_32x32x16_bf16 v[16:31], a[36:39], v[160:163], v[16:31]
    buffer_load_dwordx4 v240, s[8:11], s63 offen offset:0 sc1 lds
    v_mfma_f32_32x32x16_bf16 v[32:47], a[40:43], v[160:163], v[32:47]
    s_nop 3
    v_exp_f32 v176, v96
    v_mfma_f32_32x32x16_bf16 v[48:63], a[44:47], v[160:163], v[48:63]
    v_exp_f32 v177, v97
    s_waitcnt lgkmcnt(0)
    v_mfma_f32_32x32x16_bf16 v[0:15], a[48:51], v[164:167], v[0:15]
    v_exp_f32 v178, v98
    v_add_f32 v180, v176, v177
    v_cvt_pk_bf16_f32 v160, v176, v177
    v_mfma_f32_32x32x16_bf16 v[16:31], a[52:55], v[164:167], v[16:31]
    buffer_load_dwordx4 v240, s[8:11], s63 offen offset:1024 sc1 lds
    v_exp_f32 v179, v99
    v_add_f32 v180, v180, v178
    v_mfma_f32_32x32x16_bf16 v[32:47], a[56:59], v[164:167], v[32:47]
    v_exp_f32 v176, v100
    v_add_f32 v180, v180, v179
    v_cvt_pk_bf16_f32 v161, v178, v179
    v_mfma_f32_32x32x16_bf16 v[48:63], a[60:63], v[164:167], v[48:63]
    v_exp_f32 v177, v101
    v_add_f32 v180, v180, v176
L_k2_ve_56:
    s_cmp_ge_u32 s44, 2
    s_cbranch_scc0 L_k2_vn_60
    s_cmp_gt_u32 s44, 2
    s_cbranch_scc1 L_k2_m_61
    v_mfma_f32_32x32x16_bf16 v[112:127], a[0:3], v[192:195], v[144:159]
    s_branch L_k2_m_62
L_k2_m_61:
    v_mfma_f32_32x32x16_bf16 v[112:127], a[0:3], v[192:195], v[224:239]
L_k2_m_62:
    v_exp_f32 v178, v102
    v_add_f32 v180, v180, v177
    v_cvt_pk_bf16_f32 v162, v176, v177
    v_mfma_f32_32x32x16_bf16 v[112:127], a[4:7], v[196:199], v[112:127]
    buffer_load_dwordx4 v240, s[8:11], s63 offen offset:2048 sc1 lds
    v_exp_f32 v179, v103
    v_add_f32 v180, v180, v178
    v_add_f32 v185, v185, v181
    v_mfma_f32_32x32x16_bf16 v[112:127], a[8:11], v[200:203], v[112:127]
    v_exp_f32 v176, v104
    v_add_f32 v180, v180, v179
    v_cvt_pk_bf16_f32 v163, v178, v179
    v_mfma_f32_32x32x16_bf16 v[112:127], a[12:15], v[204:207], v[112:127]
    v_exp_f32 v177, v105
    v_add_f32 v180, v180, v176
    v_mfma_f32_32x32x16_bf16 v[112:127], a[16:19], v[208:211], v[112:127]
    v_exp_f32 v178, v106
    v_add_f32 v180, v180, v177
    v_cvt_pk_bf16_f32 v164, v176, v177
    v_mfma_f32_32x32x16_bf16 v[112:127], a[20:23], v[212:215], v[112:127]
    buffer_load_dwordx4 v240, s[8:11], s63 offen offset:3072 sc1 lds
    v_exp_f32 v179, v107
    v_add_f32 v180, v180, v178
    v_mfma_f32_32x32x16_bf16 v[112:127], a[24:27], v[216:219], v[112:127]
    v_exp_f32 v176, v108
    v_add_f32 v180, v180, v179
    v_cvt_pk_bf16_f32 v165, v178, v179
    v_mfma_f32_32x32x16_bf16 v[112:127], a[28:31], v[220:223], v[112:127]
    v_exp_f32 v177, v109
    s_add_u32 s63, s63, 16384
    v_add_f32 v180, v180, v176
    v_mfma_f32_32x32x16_bf16 a[64:79], a[32:35], v[168:171], a[64:79]
    ds_read_b128 a[0:3], v183 offset:49152
    v_exp_f32 v178, v110
    v_add_f32 v180, v180, v177
    v_cvt_pk_bf16_f32 v166, v176, v177
    v_mfma_f32_32x32x16_bf16 a[80:95], a[36:39], v[168:171], a[80:95]
    ds_read_b128 a[4:7], v183 offset:50176
    v_exp_f32 v179, v111
    s_add_u32 m0, m0, 16384
    v_add_f32 v180, v180, v178
    v_mfma_f32_32x32x16_bf16 a[96:111], a[40:43], v[168:171], a[96:111]
    ds_read_b128 a[8:11], v183 offset:51200
    v_exp_f32 v176, v112
    v_add_f32 v180, v180, v179
    v_cvt_pk_bf16_f32 v167, v178, v179
    v_mfma_f32_32x32x16_bf16 a[112:127], a[44:47], v[168:171], a[112:127]
    ds_read_b128 a[12:15], v183 offset:52224
    v_exp_f32 v177, v113
    s_and_b32 m0, m0, 0x1ffff
    v_cmp_lt_f32 vcc, s66, v180
    v_mfma_f32_32x32x16_bf16 a[64:79], a[48:51], v[172:175], a[64:79]
    ds_read_b128 a[16:19], v183 offset:53248
    v_exp_f32 v178, v114
    v_add_f32 v181, v176, v177
    v_cvt_pk_bf16_f32 v168, v176, v177
    v_mfma_f32_32x32x16_bf16 a[80:95], a[52:55], v[172:175], a[80:95]
    ds_read_b128 a[20:23], v183 offset:54272
    v_exp_f32 v179, v115
    s_cmp_lt_u32 s63, s64
    s_cselect_b32 s63, s63, 0x40000000
    v_add_f32 v181, v181, v178
    v_mfma_f32_32x32x16_bf16 a[96:111], a[56:59], v[172:175], a[96:111]
    ds_read_b128 a[24:27], v183 offset:55296
    v_exp_f32 v176, v116
    v_add_f32 v181, v181, v179
    v_cvt_pk_bf16_f32 v169, v178, v179
    v_mfma_f32_32x32x16_bf16 a[112:127], a[60:63], v[172:175], a[112:127]
    ds_read_b128 a[28:31], v183 offset:56320
    v_exp_f32 v177, v117
    v_add_f32 v181, v181, v176
    s_cbranch_vccnz L_k2_site_63_s
L_k2_site_63_r:
    s_branch L_k2_ve_59
L_k2_vn_60:
    s_cmp_ge_u32 s44, 1
    s_cbranch_scc0 L_k2_vn_64
    v_exp_f32 v178, v102
    v_add_f32 v180, v180, v177
    v_cvt_pk_bf16_f32 v162, v176, v177
    buffer_load_dwordx4 v240, s[8:11], s63 offen offset:2048 sc1 lds
    v_exp_f32 v179, v103
    v_add_f32 v180, v180, v178
    v_add_f32 v185, v185, v181
    v_exp_f32 v176, v104
    v_add_f32 v180, v180, v179
    v_cvt_pk_bf16_f32 v163, v178, v179
    v_exp_f32 v177, v105
    v_add_f32 v180, v180, v176
    v_exp_f32 v178, v106
    v_add_f32 v180, v180, v177
    v_cvt_pk_bf16_f32 v164, v176, v177
    buffer_load_dwordx4 v240, s[8:11], s63 offen offset:3072 sc1 lds
    v_exp_f32 v179, v107
    v_add_f32 v180, v180, v178
    v_exp_f32 v176, v108
    v_add_f32 v180, v180, v179
    v_cvt_pk_bf16_f32 v165, v178, v179
    v_exp_f32 v177, v109
    s_add_u32 s63, s63, 16384
    v_add_f32 v180, v180, v176
    v_mfma_f32_32x32x16_bf16 a[64:79], a[32:35], v[168:171], a[64:79]
    ds_read_b128 a[0:3], v183 offset:49152
    v_exp_f32 v178, v110
    v_add_f32 v180, v180, v177
    v_cvt_pk_bf16_f32 v166, v176, v177
    v_mfma_f32_32x32x16_bf16 a[80:95], a[36:39], v[168:171], a[80:95]
    ds_read_b128 a[4:7], v183 offset:50176
    v_exp_f32 v179, v111
    s_add_u32 m0, m0, 16384
    v_add_f32 v180, v180, v178
    v_mfma_f32_32x32x16_bf16 a[96:111], a[40:43], v[168:171], a[96:111]
    ds_read_b128 a[8:11], v183 offset:51200
    v_add_f32 v180, v180, v179
    v_cvt_pk_bf16_f32 v167, v178, v179
    v_mfma_f32_32x32x16_bf16 a[112:127], a[44:47], v[168:171], a[112:127]
    ds_read_b128 a[12:15], v183 offset:52224
    s_and_b32 m0, m0, 0x1ffff
    v_cmp_lt_f32 vcc, s66, v180
    v_mfma_f32_32x32x16_bf16 a[64:79], a[48:51], v[172:175], a[64:79]
    ds_read_b128 a[16:19], v183 offset:53248
    v_mfma_f32_32x32x16_bf16 a[80:95], a[52:55], v[172:175], a[80:95]
    ds_read_b128 a[20:23], v183 offset:54272
    s_cmp_lt_u32 s63, s64
    s_cselect_b32 s63, s63, 0x40000000
    v_mfma_f32_32x32x16_bf16 a[96:111], a[56:59], v[172:175], a[96:111]
    ds_read_b128 a[24:27], v183 offset:55296
    v_mfma_f32_32x32x16_bf16 a[112:127], a[60:63], v[172:175], a[112:127]
    ds_read_b128 a[28:31], v183 offset:56320
    s_cbranch_vccnz L_k2_site_65_s
L_k2_site_65_r:
    s_branch L_k2_ve_59
L_k2_vn_64:
    v_exp_f32 v178, v102
    v_add_f32 v180, v180, v177
    v_cvt_pk_bf16_f32 v162, v176, v177
    buffer_load_dwordx4 v240, s[8:11], s63 offen offset:2048 sc1 lds
    v_exp_f32 v179, v103
    v_add_f32 v180, v180, v178
    v_exp_f32 v176, v104
    v_add_f32 v180, v180, v179
    v_cvt_pk_bf16_f32 v163, v178, v179
    v_exp_f32 v177, v105
    v_add_f32 v180, v180, v176
    v_exp_f32 v178, v106
    v_add_f32 v180, v180, v177
    v_cvt_pk_bf16_f32 v164, v176, v177
    buffer_load_dwordx4 v240, s[8:11], s63 offen offset:3072 sc1 lds
    v_exp_f32 v179, v107
    v_add_f32 v180, v180, v178
    v_exp_f32 v176, v108
    v_add_f32 v180, v180, v179
    v_cvt_pk_bf16_f32 v165, v178, v179
    v_exp_f32 v177, v109
    s_add_u32 s63, s63, 16384
    v_add_f32 v180, v180, v176
    ds_read_b128 a[0:3], v183 offset:49152
    v_exp_f32 v178, v110
    v_add_f32 v180, v180, v177
    v_cvt_pk_bf16_f32 v166, v176, v177
    ds_read_b128 a[4:7], v183 offset:50176
    v_exp_f32 v179, v111
    s_add_u32 m0, m0, 16384
    v_add_f32 v180, v180, v178
    ds_read_b128 a[8:11], v183 offset:51200
    v_add_f32 v180, v180, v179
    v_cvt_pk_bf16_f32 v167, v178, v179
    ds_read_b128 a[12:15], v183 offset:52224
    s_and_b32 m0, m0, 0x1ffff
    v_cmp_lt_f32 vcc, s66, v180
    ds_read_b128 a[16:19], v183 offset:53248
    ds_read_b128 a[20:23], v183 offset:54272
    s_cmp_lt_u32 s63, s64
    s_cselect_b32 s63, s63, 0x40000000
    ds_read_b128 a[24:27], v183 offset:55296
    ds_read_b128 a[28:31], v183 offset:56320
    s_cbranch_vccnz L_k2_site_66_s
L_k2_site_66_r:
L_k2_ve_59:
    s_cmp_ge_u32 s44, 2
    s_cbranch_scc0 L_k2_vn_68
    s_waitcnt lgkmcnt(4)
    v_mfma_f32_32x32x16_bf16 v[96:111], a[0:3], v[64:67], v[128:143]
    ds_read_b128 a[32:35], v183 offset:40960
    v_exp_f32 v178, v118
    v_add_f32 v181, v181, v177
    v_cvt_pk_bf16_f32 v170, v176, v177
    v_mfma_f32_32x32x16_bf16 v[96:111], a[4:7], v[68:71], v[96:111]
    ds_read_b128 a[36:39], v183 offset:41984
    v_exp_f32 v179, v119
    v_add_f32 v181, v181, v178
    v_add_f32 v182, v182, v180
    v_mfma_f32_32x32x16_bf16 v[96:111], a[8:11], v[72:75], v[96:111]
    ds_read_b128 a[40:43], v183 offset:43008
    v_exp_f32 v176, v120
    v_add_f32 v181, v181, v179
    v_cvt_pk_bf16_f32 v171, v178, v179
    v_mfma_f32_32x32x16_bf16 v[96:111], a[12:15], v[76:79], v[96:111]
    ds_read_b128 a[44:47], v183 offset:44032
    v_exp_f32 v177, v121
    v_add_f32 v181, v181, v176
    s_waitcnt lgkmcnt(4)
    v_mfma_f32_32x32x16_bf16 v[96:111], a[16:19], v[80:83], v[96:111]
    ds_read_b128 a[48:51], v183 offset:45056
    v_exp_f32 v178, v122
    v_add_f32 v181, v181, v177
    v_cvt_pk_bf16_f32 v172, v176, v177
    v_mfma_f32_32x32x16_bf16 v[96:111], a[20:23], v[84:87], v[96:111]
    ds_read_b128 a[52:55], v183 offset:46080
    v_exp_f32 v179, v123
    v_add_f32 v181, v181, v178
    v_mfma_f32_32x32x16_bf16 v[96:111], a[24:27], v[88:91], v[96:111]
    ds_read_b128 a[56:59], v183 offset:47104
    v_exp_f32 v176, v124
    v_add_f32 v181, v181, v179
    v_cvt_pk_bf16_f32 v173, v178, v179
    v_mfma_f32_32x32x16_bf16 v[96:111], a[28:31], v[92:95], v[96:111]
    ds_read_b128 a[60:63], v183 offset:48128
    v_exp_f32 v177, v125
    v_add_f32 v181, v181, v176
    s_waitcnt lgkmcnt(4)
    v_mfma_f32_32x32x16_bf16 v[0:15], a[32:35], v[160:163], v[0:15]
    v_exp_f32 v178, v126
    v_add_f32 v181, v181, v177
    v_cvt_pk_bf16_f32 v174, v176, v177
    v_mfma_f32_32x32x16_bf16 v[16:31], a[36:39], v[160:163], v[16:31]
    buffer_load_dwordx4 v240, s[8:11], s63 offen offset:0 sc1 lds
    v_exp_f32 v179, v127
    v_add_f32 v181, v181, v178
    v_mfma_f32_32x32x16_bf16 v[32:47], a[40:43], v[160:163], v[32:47]
    v_exp_f32 v176, v96
    v_add_f32 v181, v181, v179
    v_cvt_pk_bf16_f32 v175, v178, v179
    v_mfma_f32_32x32x16_bf16 v[48:63], a[44:47], v[160:163], v[48:63]
    v_exp_f32 v177, v97
    v_cmp_lt_f32 vcc, s66, v181
    s_waitcnt lgkmcnt(0)
    v_mfma_f32_32x32x16_bf16 v[0:15], a[48:51], v[164:167], v[0:15]
    v_exp_f32 v178, v98
    v_add_f32 v180, v176, v177
    v_cvt_pk_bf16_f32 v160, v176, v177
    v_mfma_f32_32x32x16_bf16 v[16:31], a[52:55], v[164:167], v[16:31]
    buffer_load_dwordx4 v240, s[8:11], s63 offen offset:1024 sc1 lds
    v_exp_f32 v179, v99
    v_add_f32 v180, v180, v178
    v_mfma_f32_32x32x16_bf16 v[32:47], a[56:59], v[164:167], v[32:47]
    v_exp_f32 v176, v100
    v_add_f32 v180, v180, v179
    v_cvt_pk_bf16_f32 v161, v178, v179
    v_mfma_f32_32x32x16_bf16 v[48:63], a[60:63], v[164:167], v[48:63]
    v_exp_f32 v177, v101
    v_add_f32 v180, v180, v176
    s_cbranch_vccnz L_k2_site_69_s
L_k2_site_69_r:
    s_branch L_k2_ve_67
L_k2_vn_68:
    s_waitcnt lgkmcnt(4)
    v_mfma_f32_32x32x16_bf16 v[96:111], a[0:3], v[64:67], v[128:143]
    ds_read_b128 a[32:35], v183 offset:40960
    v_mfma_f32_32x32x16_bf16 v[96:111], a[4:7], v[68:71], v[96:111]
    ds_read_b128 a[36:39], v183 offset:41984
    v_add_f32 v182, v182, v180
    v_mfma_f32_32x32x16_bf16 v[96:111], a[8:11], v[72:75], v[96:111]
    ds_read_b128 a[40:43], v183 offset:43008
    v_mfma_f32_32x32x16_bf16 v[96:111], a[12:15], v[76:79], v[96:111]
    ds_read_b128 a[44:47], v183 offset:44032
    s_waitcnt lgkmcnt(4)
    v_mfma_f32_32x32x16_bf16 v[96:111], a[16:19], v[80:83], v[96:111]
    ds_read_b128 a[48:51], v183 offset:45056
    v_mfma_f32_32x32x16_bf16 v[96:111], a[20:23], v[84:87], v[96:111]
    ds_read_b128 a[52:55], v183 offset:46080
    v_mfma_f32_32x32x16_bf16 v[96:111], a[24:27], v[88:91], v[96:111]
    ds_read_b128 a[56:59], v183 offset:47104
    v_mfma_f32_32x32x16_bf16 v[96:111], a[28:31], v[92:95], v[96:111]
    ds_read_b128 a[60:63], v183 offset:48128
    s_waitcnt lgkmcnt(4)
    v_mfma_f32_32x32x16_bf16 v[0:15], a[32:35], v[160:163], v[0:15]
    v_mfma_f32_32x32x16_bf16 v[16:31], a[36:39], v[160:163], v[16:31]
    buffer_load_dwordx4 v240, s[8:11], s63 offen offset:0 sc1 lds
    v_mfma_f32_32x32x16_bf16 v[32:47], a[40:43], v[160:163], v[32:47]
    s_nop 5
    v_exp_f32 v176, v96
    v_mfma_f32_32x32x16_bf16 v[48:63], a[44:47], v[160:163], v[48:63]
    v_exp_f32 v177, v97
    s_waitcnt lgkmcnt(0)
    v_mfma_f32_32x32x16_bf16 v[0:15], a[48:51], v[164:167], v[0:15]
    v_exp_f32 v178, v98
    v_add_f32 v180, v176, v177
    v_cvt_pk_bf16_f32 v160, v176, v177
    v_mfma_f32_32x32x16_bf16 v[16:31], a[52:55], v[164:167], v[16:31]
    buffer_load_dwordx4 v240, s[8:11], s63 offen offset:1024 sc1 lds
    v_exp_f32 v179, v99
    v_add_f32 v180, v180, v178
    v_mfma_f32_32x32x16_bf16 v[32:47], a[56:59], v[164:167], v[32:47]
    v_exp_f32 v176, v100
    v_add_f32 v180, v180, v179
    v_cvt_pk_bf16_f32 v161, v178, v179
    v_mfma_f32_32x32x16_bf16 v[48:63], a[60:63], v[164:167], v[48:63]
    v_exp_f32 v177, v101
    v_add_f32 v180, v180, v176
L_k2_ve_67:
    s_cmp_ge_u32 s44, 3
    s_cbranch_scc0 L_k2_vn_71
    v_mfma_f32_32x32x16_bf16 v[112:127], a[0:3], v[192:195], v[144:159]
    v_exp_f32 v178, v102
    v_add_f32 v180, v180, v177
    v_cvt_pk_bf16_f32 v162, v176, v177
    v_mfma_f32_32x32x16_bf16 v[112:127], a[4:7], v[196:199], v[112:127]
    buffer_load_dwordx4 v240, s[8:11], s63 offen offset:2048 sc1 lds
    v_exp_f32 v179, v103
    v_add_f32 v180, v180, v178
    v_add_f32 v185, v185, v181
    v_mfma_f32_32x32x16_bf16 v[112:127], a[8:11], v[200:203], v[112:127]
    v_exp_f32 v176, v104
    v_add_f32 v180, v180, v179
    v_cvt_pk_bf16_f32 v163, v178, v179
    v_mfma_f32_32x32x16_bf16 v[112:127], a[12:15], v[204:207], v[112:127]
    v_exp_f32 v177, v105
    v_add_f32 v180, v180, v176
    v_mfma_f32_32x32x16_bf16 v[112:127], a[16:19], v[208:211], v[112:127]
    v_exp_f32 v178, v106
    v_add_f32 v180, v180, v177
    v_cvt_pk_bf16_f32 v164, v176, v177
    v_mfma_f32_32x32x16_bf16 v[112:127], a[20:23], v[212:215], v[112:127]
    buffer_load_dwordx4 v240, s[8:11], s63 offen offset:3072 sc1 lds
    v_exp_f32 v179, v107
    v_add_f32 v180, v180, v178
    v_mfma_f32_32x32x16_bf16 v[112:127], a[24:27], v[216:219], v[112:127]
    v_exp_f32 v176, v108
    v_add_f32 v180, v180, v179
    v_cvt_pk_bf16_f32 v165, v178, v179
    v_mfma_f32_32x32x16_bf16 v[112:127], a[28:31], v[220:223], v[112:127]
    v_exp_f32 v177, v109
    s_add_u32 s63, s63, 16384
    v_add_f32 v180, v180, v176
    v_mfma_f32_32x32x16_bf16 a[64:79], a[32:35], v[168:171], a[64:79]
    ds_read_b128 a[0:3], v184 offset:0
    v_exp_f32 v178, v110
    v_add_f32 v180, v180, v177
    v_cvt_pk_bf16_f32 v166, v176, v177
    v_mfma_f32_32x32x16_bf16 a[80:95], a[36:39], v[168:171], a[80:95]
    ds_read_b128 a[4:7], v184 offset:1024
    v_exp_f32 v179, v111
    s_add_u32 m0, m0, 16384
    v_add_f32 v180, v180, v178
    v_mfma_f32_32x32x16_bf16 a[96:111], a[40:43], v[168:171], a[96:111]
    ds_read_b128 a[8:11], v184 offset:2048
    v_exp_f32 v176, v112
    v_add_f32 v180, v180, v179
    v_cvt_pk_bf16_f32 v167, v178, v179
    v_mfma_f32_32x32x16_bf16 a[112:127], a[44:47], v[168:171], a[112:127]
    ds_read_b128 a[12:15], v184 offset:3072
    v_exp_f32 v177, v113
    s_and_b32 m0, m0, 0x1ffff
    v_cmp_lt_f32 vcc, s66, v180
    v_mfma_f32_32x32x16_bf16 a[64:79], a[48:51], v[172:175], a[64:79]
    ds_read_b128 a[16:19], v184 offset:4096
    v_exp_f32 v178, v114
    v_add_f32 v181, v176, v177
    v_cvt_pk_bf16_f32 v168, v176, v177
    v_mfma_f32_32x32x16_bf16 a[80:95], a[52:55], v[172:175], a[80:95]
    ds_read_b128 a[20:23], v184 offset:5120
    v_exp_f32 v179, v115
    s_cmp_lt_u32 s63, s64
    s_cselect_b32 s63, s63, 0x40000000
    v_add_f32 v181, v181, v178
    v_mfma_f32_32x32x16_bf16 a[96:111], a[56:59], v[172:175], a[96:111]
    ds_read_b128 a[24:27], v184 offset:6144
    v_exp_f32 v176, v116
    v_add_f32 v181, v181, v179
    v_cvt_pk_bf16_f32 v169, v178, v179
    v_mfma_f32_32x32x16_bf16 a[112:127], a[60:63], v[172:175], a[112:127]
    ds_read_b128 a[28:31], v184 offset:7168
    v_exp_f32 v177, v117
    v_add_f32 v181, v181, v176
    v_swap_b32 v183, v184
    s_cbranch_vccnz L_k2_site_72_s
L_k2_site_72_r:
    s_branch L_k2_ve_70
L_k2_vn_71:
    s_cmp_ge_u32 s44, 2
    s_cbranch_scc0 L_k2_vn_73
    v_exp_f32 v178, v102
    v_add_f32 v180, v180, v177
    v_cvt_pk_bf16_f32 v162, v176, v177
    buffer_load_dwordx4 v240, s[8:11], s63 offen offset:2048 sc1 lds
    v_exp_f32 v179, v103
    v_add_f32 v180, v180, v178
    v_add_f32 v185, v185, v181
    v_exp_f32 v176, v104
    v_add_f32 v180, v180, v179
    v_cvt_pk_bf16_f32 v163, v178, v179
    v_exp_f32 v177, v105
    v_add_f32 v180, v180, v176
    v_exp_f32 v178, v106
    v_add_f32 v180, v180, v177
    v_cvt_pk_bf16_f32 v164, v176, v177
    buffer_load_dwordx4 v240, s[8:11], s63 offen offset:3072 sc1 lds
    v_exp_f32 v179, v107
    v_add_f32 v180, v180, v178
    v_exp_f32 v176, v108
    v_add_f32 v180, v180, v179
    v_cvt_pk_bf16_f32 v165, v178, v179
    v_exp_f32 v177, v109
    s_add_u32 s63, s63, 16384
    v_add_f32 v180, v180, v176
    v_mfma_f32_32x32x16_bf16 a[64:79], a[32:35], v[168:171], a[64:79]
    ds_read_b128 a[0:3], v184 offset:0
    v_exp_f32 v178, v110
    v_add_f32 v180, v180, v177
    v_cvt_pk_bf16_f32 v166, v176, v177
    v_mfma_f32_32x32x16_bf16 a[80:95], a[36:39], v[168:171], a[80:95]
    ds_read_b128 a[4:7], v184 offset:1024
    v_exp_f32 v179, v111
    s_add_u32 m0, m0, 16384
    v_add_f32 v180, v180, v178
    v_mfma_f32_32x32x16_bf16 a[96:111], a[40:43], v[168:171], a[96:111]
    ds_read_b128 a[8:11], v184 offset:2048
    v_add_f32 v180, v180, v179
    v_cvt_pk_bf16_f32 v167, v178, v179
    v_mfma_f32_32x32x16_bf16 a[112:127], a[44:47], v[168:171], a[112:127]
    ds_read_b128 a[12:15], v184 offset:3072
    s_and_b32 m0, m0, 0x1ffff
    v_cmp_lt_f32 vcc, s66, v180
    v_mfma_f32_32x32x16_bf16 a[64:79], a[48:51], v[172:175], a[64:79]
    ds_read_b128 a[16:19], v184 offset:4096
    v_mfma_f32_32x32x16_bf16 a[80:95], a[52:55], v[172:175], a[80:95]
    ds_read_b128 a[20:23], v184 offset:5120
    s_cmp_lt_u32 s63, s64
    s_cselect_b32 s63, s63, 0x40000000
    v_mfma_f32_32x32x16_bf16 a[96:111], a[56:59], v[172:175], a[96:111]
    ds_read_b128 a[24:27], v184 offset:6144
    v_mfma_f32_32x32x16_bf16 a[112:127], a[60:63], v[172:175], a[112:127]
    ds_read_b128 a[28:31], v184 offset:7168
    v_swap_b32 v183, v184
    s_cbranch_vccnz L_k2_site_74_s
L_k2_site_74_r:
    s_branch L_k2_ve_70
L_k2_vn_73:
    v_exp_f32 v178, v102
    v_add_f32 v180, v180, v177
    v_cvt_pk_bf16_f32 v162, v176, v177
    buffer_load_dwordx4 v240, s[8:11], s63 offen offset:2048 sc1 lds
    v_exp_f32 v179, v103
    v_add_f32 v180, v180, v178
    v_exp_f32 v176, v104
    v_add_f32 v180, v180, v179
    v_cvt_pk_bf16_f32 v163, v178, v179
    v_exp_f32 v177, v105
    v_add_f32 v180, v180, v176
    v_exp_f32 v178, v106
    v_add_f32 v180, v180, v177
    v_cvt_pk_bf16_f32 v164, v176, v177
    buffer_load_dwordx4 v240, s[8:11], s63 offen offset:3072 sc1 lds
    v_exp_f32 v179, v107
    v_add_f32 v180, v180, v178
    v_exp_f32 v176, v108
    v_add_f32 v180, v180, v179
    v_cvt_pk_bf16_f32 v165, v178, v179
    v_exp_f32 v177, v109
    s_add_u32 s63, s63, 16384
    v_add_f32 v180, v180, v176
    ds_read_b128 a[0:3], v184 offset:0
    v_exp_f32 v178, v110
    v_add_f32 v180, v180, v177
    v_cvt_pk_bf16_f32 v166, v176, v177
    ds_read_b128 a[4:7], v184 offset:1024
    v_exp_f32 v179, v111
    s_add_u32 m0, m0, 16384
    v_add_f32 v180, v180, v178
    ds_read_b128 a[8:11], v184 offset:2048
    v_add_f32 v180, v180, v179
    v_cvt_pk_bf16_f32 v167, v178, v179
    ds_read_b128 a[12:15], v184 offset:3072
    s_and_b32 m0, m0, 0x1ffff
    v_cmp_lt_f32 vcc, s66, v180
    ds_read_b128 a[16:19], v184 offset:4096
    ds_read_b128 a[20:23], v184 offset:5120
    s_cmp_lt_u32 s63, s64
    s_cselect_b32 s63, s63, 0x40000000
    ds_read_b128 a[24:27], v184 offset:6144
    ds_read_b128 a[28:31], v184 offset:7168
    v_swap_b32 v183, v184
    s_cbranch_vccnz L_k2_site_75_s
L_k2_site_75_r:
L_k2_ve_70:
L_k2_trans:
    v_and_b32 v187, 31, v241
    v_lshrrev_b32 v188, 5, v241
    v_lshlrev_b32 v188, 2, v188
    v_sub_u32 v187, v187, v188
    v_mov_b32 v188, 0xff800000
    v_cmp_gt_i32 s[74:75], 0, v187
    v_cmp_gt_i32 s[76:77], 1, v187
    v_cmp_gt_i32 s[78:79], 2, v187
    v_cmp_gt_i32 vcc, 3, v187
    v_cndmask_b32 v144, v128, v188, s[74:75]
    v_cndmask_b32 v145, v128, v188, s[76:77]
    v_cndmask_b32 v146, v128, v188, s[78:79]
    v_cndmask_b32 v147, v128, v188, vcc
    v_cmp_gt_i32 s[74:75], 8, v187
    v_cmp_gt_i32 s[76:77], 9, v187
    v_cmp_gt_i32 s[78:79], 10, v187
    v_cmp_gt_i32 vcc, 11, v187
    v_cndmask_b32 v148, v128, v188, s[74:75]
    v_cndmask_b32 v149, v128, v188, s[76:77]
    v_cndmask_b32 v150, v128, v188, s[78:79]
    v_cndmask_b32 v151, v128, v188, vcc
    v_cmp_gt_i32 s[74:75], 16, v187
    v_cmp_gt_i32 s[76:77], 17, v187
    v_cmp_gt_i32 s[78:79], 18, v187
    v_cmp_gt_i32 vcc, 19, v187
    v_cndmask_b32 v152, v128, v188, s[74:75]
    v_cndmask_b32 v153, v128, v188, s[76:77]
    v_cndmask_b32 v154, v128, v188, s[78:79]
    v_cndmask_b32 v155, v128, v188, vcc
    v_cmp_gt_i32 s[74:75], 24, v187
    v_cmp_gt_i32 s[76:77], 25, v187
    v_cmp_gt_i32 s[78:79], 26, v187
    v_cmp_gt_i32 vcc, 27, v187
    v_cndmask_b32 v156, v128, v188, s[74:75]
    v_cndmask_b32 v157, v128, v188, s[76:77]
    v_cndmask_b32 v158, v128, v188, s[78:79]
    v_cndmask_b32 v159, v128, v188, vcc
    s_cmp_eq_u32 s46, 7
    s_cselect_b32 s70, s44, 99
    s_lshl_b32 s51, s46, 1
    s_sub_u32 s51, 13, s51
    s_cmp_ge_u32 s44, 3
    s_cbranch_scc0 L_k2_vn_77
    s_waitcnt lgkmcnt(4)
    s_cmp_gt_u32 s70, 0
    s_cbranch_scc1 L_k2_m_79
    v_mfma_f32_32x32x16_bf16 v[96:111], a[0:3], v[64:67], v[144:159]
    s_branch L_k2_m_80
L_k2_m_79:
    v_mfma_f32_32x32x16_bf16 v[96:111], a[0:3], v[64:67], v[128:143]
L_k2_m_80:
    ds_read_b128 a[32:35], v184 offset:57344
    v_exp_f32 v178, v118
    v_add_f32 v181, v181, v177
    v_cvt_pk_bf16_f32 v170, v176, v177
    v_mfma_f32_32x32x16_bf16 v[96:111], a[4:7], v[68:71], v[96:111]
    ds_read_b128 a[36:39], v184 offset:58368
    buffer_load_dwordx4 v240, s[8:11], s63 offen offset:0 sc1 lds
    v_exp_f32 v179, v119
    v_add_f32 v181, v181, v178
    v_add_f32 v182, v182, v180
    v_mfma_f32_32x32x16_bf16 v[96:111], a[8:11], v[72:75], v[96:111]
    ds_read_b128 a[40:43], v184 offset:59392
    v_exp_f32 v176, v120
    v_add_f32 v181, v181, v179
    v_cvt_pk_bf16_f32 v171, v178, v179
    v_mfma_f32_32x32x16_bf16 v[96:111], a[12:15], v[76:79], v[96:111]
    ds_read_b128 a[44:47], v184 offset:60416
    v_exp_f32 v177, v121
    v_add_f32 v181, v181, v176
    s_waitcnt lgkmcnt(4)
    v_mfma_f32_32x32x16_bf16 v[96:111], a[16:19], v[80:83], v[96:111]
    ds_read_b128 a[48:51], v184 offset:61440
    v_exp_f32 v178, v122
    v_add_f32 v181, v181, v177
    v_cvt_pk_bf16_f32 v172, v176, v177
    v_mfma_f32_32x32x16_bf16 v[96:111], a[20:23], v[84:87], v[96:111]
    ds_read_b128 a[52:55], v184 offset:62464
    buffer_load_dwordx4 v240, s[8:11], s63 offen offset:1024 sc1 lds
    v_exp_f32 v179, v123
    v_add_f32 v181, v181, v178
    v_mfma_f32_32x32x16_bf16 v[96:111], a[24:27], v[88:91], v[96:111]
    ds_read_b128 a[56:59], v184 offset:63488
    v_exp_f32 v176, v124
    v_add_f32 v181, v181, v179
    v_cvt_pk_bf16_f32 v173, v178, v179
    v_mfma_f32_32x32x16_bf16 v[96:111], a[28:31], v[92:95], v[96:111]
    ds_read_b128 a[60:63], v184 offset:64512
    v_exp_f32 v177, v125
    v_add_f32 v181, v181, v176
    s_waitcnt vmcnt(8)
    s_barrier
    s_waitcnt lgkmcnt(4)
    v_mfma_f32_32x32x16_bf16 v[0:15], a[32:35], v[160:163], v[0:15]
    ds_read_b128 a[0:3], v183 offset:16384
    v_exp_f32 v178, v126
    v_add_f32 v181, v181, v177
    v_cvt_pk_bf16_f32 v174, v176, v177
    v_mfma_f32_32x32x16_bf16 v[16:31], a[36:39], v[160:163], v[16:31]
    ds_read_b128 a[4:7], v183 offset:17408
    buffer_load_dwordx4 v240, s[8:11], s63 offen offset:2048 sc1 lds
    v_exp_f32 v179, v127
    v_add_f32 v181, v181, v178
    v_mfma_f32_32x32x16_bf16 v[32:47], a[40:43], v[160:163], v[32:47]
    ds_read_b128 a[8:11], v183 offset:18432
    v_exp_f32 v176, v96
    v_add_f32 v181, v181, v179
    v_cvt_pk_bf16_f32 v175, v178, v179
    v_mfma_f32_32x32x16_bf16 v[48:63], a[44:47], v[160:163], v[48:63]
    ds_read_b128 a[12:15], v183 offset:19456
    s_cmp_lt_u32 s56, s34
    s_cbranch_scc0 L_k2_pf_78
    buffer_load_dword v252, v250, s[32:35], s56 offen
    s_add_u32 s56, s56, 4096
L_k2_pf_78:
    v_exp_f32 v177, v97
    v_cmp_lt_f32 vcc, s66, v181
    s_waitcnt lgkmcnt(4)
    v_mfma_f32_32x32x16_bf16 v[0:15], a[48:51], v[164:167], v[0:15]
    ds_read_b128 a[16:19], v183 offset:20480
    v_exp_f32 v178, v98
    v_add_f32 v180, v176, v177
    v_cvt_pk_bf16_f32 v160, v176, v177
    v_mfma_f32_32x32x16_bf16 v[16:31], a[52:55], v[164:167], v[16:31]
    ds_read_b128 a[20:23], v183 offset:21504
    buffer_load_dwordx4 v240, s[8:11], s63 offen offset:3072 sc1 lds
    v_exp_f32 v179, v99
    s_add_u32 s63, s63, 16384
    v_add_f32 v180, v180, v178
    v_mfma_f32_32x32x16_bf16 v[32:47], a[56:59], v[164:167], v[32:47]
    ds_read_b128 a[24:27], v183 offset:22528
    v_exp_f32 v176, v100
    s_add_u32 m0, m0, 16384
    v_add_f32 v180, v180, v179
    v_cvt_pk_bf16_f32 v161, v178, v179
    v_mfma_f32_32x32x16_bf16 v[48:63], a[60:63], v[164:167], v[48:63]
    ds_read_b128 a[28:31], v183 offset:23552
    v_exp_f32 v177, v101
    s_and_b32 m0, m0, 0x1ffff
    s_cmp_lt_u32 s63, s64
    s_cselect_b32 s63, s63, 0x40000000
    v_add_f32 v180, v180, v176
    s_cbranch_vccnz L_k2_site_81_s
L_k2_site_81_r:
    s_branch L_k2_ve_76
L_k2_vn_77:
    s_waitcnt lgkmcnt(4)
    s_cmp_gt_u32 s70, 0
    s_cbranch_scc1 L_k2_m_83
    v_mfma_f32_32x32x16_bf16 v[96:111], a[0:3], v[64:67], v[144:159]
    s_branch L_k2_m_84
L_k2_m_83:
    v_mfma_f32_32x32x16_bf16 v[96:111], a[0:3], v[64:67], v[128:143]
L_k2_m_84:
    ds_read_b128 a[32:35], v184 offset:57344
    v_mfma_f32_32x32x16_bf16 v[96:111], a[4:7], v[68:71], v[96:111]
    ds_read_b128 a[36:39], v184 offset:58368
    buffer_load_dwordx4 v240, s[8:11], s63 offen offset:0 sc1 lds
    v_add_f32 v182, v182, v180
    v_mfma_f32_32x32x16_bf16 v[96:111], a[8:11], v[72:75], v[96:111]
    ds_read_b128 a[40:43], v184 offset:59392
    v_mfma_f32_32x32x16_bf16 v[96:111], a[12:15], v[76:79], v[96:111]
    ds_read_b128 a[44:47], v184 offset:60416
    s_waitcnt lgkmcnt(4)
    v_mfma_f32_32x32x16_bf16 v[96:111], a[16:19], v[80:83], v[96:111]
    ds_read_b128 a[48:51], v184 offset:61440
    v_mfma_f32_32x32x16_bf16 v[96:111], a[20:23], v[84:87], v[96:111]
    ds_read_b128 a[52:55], v184 offset:62464
    buffer_load_dwordx4 v240, s[8:11], s63 offen offset:1024 sc1 lds
    v_mfma_f32_32x32x16_bf16 v[96:111], a[24:27], v[88:91], v[96:111]
    ds_read_b128 a[56:59], v184 offset:63488
    v_mfma_f32_32x32x16_bf16 v[96:111], a[28:31], v[92:95], v[96:111]
    ds_read_b128 a[60:63], v184 offset:64512
    s_waitcnt vmcnt(8)
    s_barrier
    s_waitcnt lgkmcnt(4)
    v_mfma_f32_32x32x16_bf16 v[0:15], a[32:35], v[160:163], v[0:15]
    ds_read_b128 a[0:3], v183 offset:16384
    v_mfma_f32_32x32x16_bf16 v[16:31], a[36:39], v[160:163], v[16:31]
    ds_read_b128 a[4:7], v183 offset:17408
    buffer_load_dwordx4 v240, s[8:11], s63 offen offset:2048 sc1 lds
    v_mfma_f32_32x32x16_bf16 v[32:47], a[40:43], v[160:163], v[32:47]
    ds_read_b128 a[8:11], v183 offset:18432
    s_nop 0
    v_exp_f32 v176, v96
    v_mfma_f32_32x32x16_bf16 v[48:63], a[44:47], v[160:163], v[48:63]
    ds_read_b128 a[12:15], v183 offset:19456
    s_cmp_lt_u32 s56, s34
    s_cbranch_scc0 L_k2_pf_82
    buffer_load_dword v252, v250, s[32:35], s56 offen
    s_add_u32 s56, s56, 4096
L_k2_pf_82:
    v_exp_f32 v177, v97
    s_waitcnt lgkmcnt(4)
    v_mfma_f32_32x32x16_bf16 v[0:15], a[48:51], v[164:167], v[0:15]
    ds_read_b128 a[16:19], v183 offset:20480
    v_exp_f32 v178, v98
    v_add_f32 v180, v176, v177
    v_cvt_pk_bf16_f32 v160, v176, v177
    v_mfma_f32_32x32x16_bf16 v[16:31], a[52:55], v[164:167], v[16:31]
    ds_read_b128 a[20:23], v183 offset:21504
    buffer_load_dwordx4 v240, s[8:11], s63 offen offset:3072 sc1 lds
    v_exp_f32 v179, v99
    s_add_u32 s63, s63, 16384
    v_add_f32 v180, v180, v178
    v_mfma_f32_32x32x16_bf16 v[32:47], a[56:59], v[164:167], v[32:47]
    ds_read_b128 a[24:27], v183 offset:22528
    v_exp_f32 v176, v100
    s_add_u32 m0, m0, 16384
    v_add_f32 v180, v180, v179
    v_cvt_pk_bf16_f32 v161, v178, v179
    v_mfma_f32_32x32x16_bf16 v[48:63], a[60:63], v[164:167], v[48:63]
    ds_read_b128 a[28:31], v183 offset:23552
    v_exp_f32 v177, v101
    s_and_b32 m0, m0, 0x1ffff
    s_cmp_lt_u32 s63, s64
    s_cselect_b32 s63, s63, 0x40000000
    v_add_f32 v180, v180, v176
L_k2_ve_76:
    s_min_u32 s52, s70, 1
    s_cmp_eq_u32 s44, 3
    s_cselect_b32 s52, 2, s52
    s_cmp_ge_u32 s52, 2
    s_cbranch_scc0 L_k2_vn_86
    s_waitcnt lgkmcnt(4)
    s_cmp_gt_u32 s70, 1
    s_cbranch_scc1 L_k2_m_87
    v_mfma_f32_32x32x16_bf16 v[112:127], a[0:3], v[64:67], v[144:159]
    s_branch L_k2_m_88
L_k2_m_87:
    v_mfma_f32_32x32x16_bf16 v[112:127], a[0:3], v[64:67], v[128:143]
L_k2_m_88:
    v_exp_f32 v178, v102
    v_add_f32 v180, v180, v177
    v_cvt_pk_bf16_f32 v162, v176, v177
    v_mfma_f32_32x32x16_bf16 v[112:127], a[4:7], v[68:71], v[112:127]
    buffer_load_dwordx4 v240, s[8:11], s63 offen offset:0 sc1 lds
    v_exp_f32 v179, v103
    v_add_f32 v180, v180, v178
    v_add_f32 v185, v185, v181
    v_mfma_f32_32x32x16_bf16 v[112:127], a[8:11], v[72:75], v[112:127]
    v_exp_f32 v176, v104
    v_add_f32 v180, v180, v179
    v_cvt_pk_bf16_f32 v163, v178, v179
    v_mfma_f32_32x32x16_bf16 v[112:127], a[12:15], v[76:79], v[112:127]
    v_exp_f32 v177, v105
    v_add_f32 v180, v180, v176
    s_waitcnt lgkmcnt(0)
    v_mfma_f32_32x32x16_bf16 v[112:127], a[16:19], v[80:83], v[112:127]
    v_exp_f32 v178, v106
    v_add_f32 v180, v180, v177
    v_cvt_pk_bf16_f32 v164, v176, v177
    v_mfma_f32_32x32x16_bf16 v[112:127], a[20:23], v[84:87], v[112:127]
    buffer_load_dwordx4 v240, s[8:11], s63 offen offset:1024 sc1 lds
    v_exp_f32 v179, v107
    v_add_f32 v180, v180, v178
    v_mfma_f32_32x32x16_bf16 v[112:127], a[24:27], v[88:91], v[112:127]
    v_exp_f32 v176, v108
    v_add_f32 v180, v180, v179
    v_cvt_pk_bf16_f32 v165, v178, v179
    v_mfma_f32_32x32x16_bf16 v[112:127], a[28:31], v[92:95], v[112:127]
    v_exp_f32 v177, v109
    v_add_f32 v180, v180, v176
    v_mfma_f32_32x32x16_bf16 a[64:79], a[32:35], v[168:171], a[64:79]
    ds_read_b128 a[0:3], v183 offset:32768
    v_exp_f32 v178, v110
    v_add_f32 v180, v180, v177
    v_cvt_pk_bf16_f32 v166, v176, v177
    v_mfma_f32_32x32x16_bf16 a[80:95], a[36:39], v[168:171], a[80:95]
    ds_read_b128 a[4:7], v183 offset:33792
    buffer_load_dwordx4 v240, s[8:11], s63 offen offset:2048 sc1 lds
    v_exp_f32 v179, v111
    v_add_f32 v180, v180, v178
    v_mfma_f32_32x32x16_bf16 a[96:111], a[40:43], v[168:171], a[96:111]
    ds_read_b128 a[8:11], v183 offset:34816
    v_exp_f32 v176, v112
    v_add_f32 v180, v180, v179
    v_cvt_pk_bf16_f32 v167, v178, v179
    v_mfma_f32_32x32x16_bf16 a[112:127], a[44:47], v[168:171], a[112:127]
    ds_read_b128 a[12:15], v183 offset:35840
    v_exp_f32 v177, v113
    v_cmp_lt_f32 vcc, s66, v180
    v_mfma_f32_32x32x16_bf16 a[64:79], a[48:51], v[172:175], a[64:79]
    ds_read_b128 a[16:19], v183 offset:36864
    v_exp_f32 v178, v114
    v_add_f32 v181, v176, v177
    v_cvt_pk_bf16_f32 v168, v176, v177
    v_mfma_f32_32x32x16_bf16 a[80:95], a[52:55], v[172:175], a[80:95]
    ds_read_b128 a[20:23], v183 offset:37888
    buffer_load_dwordx4 v240, s[8:11], s63 offen offset:3072 sc1 lds
    v_exp_f32 v179, v115
    s_add_u32 s63, s63, 16384
    v_add_f32 v181, v181, v178
    v_mfma_f32_32x32x16_bf16 a[96:111], a[56:59], v[172:175], a[96:111]
    ds_read_b128 a[24:27], v183 offset:38912
    v_exp_f32 v176, v116
    s_add_u32 m0, m0, 16384
    v_add_f32 v181, v181, v179
    v_cvt_pk_bf16_f32 v169, v178, v179
    v_mfma_f32_32x32x16_bf16 a[112:127], a[60:63], v[172:175], a[112:127]
    ds_read_b128 a[28:31], v183 offset:39936
    v_exp_f32 v177, v117
    s_and_b32 m0, m0, 0x1ffff
    s_cmp_lt_u32 s63, s64
    s_cselect_b32 s63, s63, 0x40000000
    v_add_f32 v181, v181, v176
    s_cbranch_vccnz L_k2_site_89_s
L_k2_site_89_r:
    s_branch L_k2_ve_85
L_k2_vn_86:
    s_cmp_ge_u32 s52, 1
    s_cbranch_scc0 L_k2_vn_90
    s_waitcnt lgkmcnt(4)
    s_cmp_gt_u32 s70, 1
    s_cbranch_scc1 L_k2_m_91
    v_mfma_f32_32x32x16_bf16 v[112:127], a[0:3], v[64:67], v[144:159]
    s_branch L_k2_m_92
L_k2_m_91:
    v_mfma_f32_32x32x16_bf16 v[112:127], a[0:3], v[64:67], v[128:143]
L_k2_m_92:
    v_exp_f32 v178, v102
    v_add_f32 v180, v180, v177
    v_cvt_pk_bf16_f32 v162, v176, v177
    v_mfma_f32_32x32x16_bf16 v[112:127], a[4:7], v[68:71], v[112:127]
    buffer_load_dwordx4 v240, s[8:11], s63 offen offset:0 sc1 lds
    v_exp_f32 v179, v103
    v_add_f32 v180, v180, v178
    v_mfma_f32_32x32x16_bf16 v[112:127], a[8:11], v[72:75], v[112:127]
    v_exp_f32 v176, v104
    v_add_f32 v180, v180, v179
    v_cvt_pk_bf16_f32 v163, v178, v179
    v_mfma_f32_32x32x16_bf16 v[112:127], a[12:15], v[76:79], v[112:127]
    v_exp_f32 v177, v105
    v_add_f32 v180, v180, v176
    s_waitcnt lgkmcnt(0)
    v_mfma_f32_32x32x16_bf16 v[112:127], a[16:19], v[80:83], v[112:127]
    v_exp_f32 v178, v106
    v_add_f32 v180, v180, v177
    v_cvt_pk_bf16_f32 v164, v176, v177
    v_mfma_f32_32x32x16_bf16 v[112:127], a[20:23], v[84:87], v[112:127]
    buffer_load_dwordx4 v240, s[8:11], s63 offen offset:1024 sc1 lds
    v_exp_f32 v179, v107
    v_add_f32 v180, v180, v178
    v_mfma_f32_32x32x16_bf16 v[112:127], a[24:27], v[88:91], v[112:127]
    v_exp_f32 v176, v108
    v_add_f32 v180, v180, v179
    v_cvt_pk_bf16_f32 v165, v178, v179
    v_mfma_f32_32x32x16_bf16 v[112:127], a[28:31], v[92:95], v[112:127]
    v_exp_f32 v177, v109
    v_add_f32 v180, v180, v176
    ds_read_b128 a[0:3], v183 offset:32768
    v_exp_f32 v178, v110
    v_add_f32 v180, v180, v177
    v_cvt_pk_bf16_f32 v166, v176, v177
    ds_read_b128 a[4:7], v183 offset:33792
    buffer_load_dwordx4 v240, s[8:11], s63 offen offset:2048 sc1 lds
    v_exp_f32 v179, v111
    v_add_f32 v180, v180, v178
    ds_read_b128 a[8:11], v183 offset:34816
    s_nop 0
    v_exp_f32 v176, v112
    v_add_f32 v180, v180, v179
    v_cvt_pk_bf16_f32 v167, v178, v179
    ds_read_b128 a[12:15], v183 offset:35840
    v_exp_f32 v177, v113
    v_cmp_lt_f32 vcc, s66, v180
    ds_read_b128 a[16:19], v183 offset:36864
    v_exp_f32 v178, v114
    v_add_f32 v181, v176, v177
    v_cvt_pk_bf16_f32 v168, v176, v177
    ds_read_b128 a[20:23], v183 offset:37888
    buffer_load_dwordx4 v240, s[8:11], s63 offen offset:3072 sc1 lds
    v_exp_f32 v179, v115
    s_add_u32 s63, s63, 16384
    v_add_f32 v181, v181, v178
    ds_read_b128 a[24:27], v183 offset:38912
    v_exp_f32 v176, v116
    s_add_u32 m0, m0, 16384
    v_add_f32 v181, v181, v179
    v_cvt_pk_bf16_f32 v169, v178, v179
    ds_read_b128 a[28:31], v183 offset:39936
    v_exp_f32 v177, v117
    s_and_b32 m0, m0, 0x1ffff
    s_cmp_lt_u32 s63, s64
    s_cselect_b32 s63, s63, 0x40000000
    v_add_f32 v181, v181, v176
    s_cbranch_vccnz L_k2_site_93_s
L_k2_site_93_r:
    s_branch L_k2_ve_85
L_k2_vn_90:
    v_exp_f32 v178, v102
    v_add_f32 v180, v180, v177
    v_cvt_pk_bf16_f32 v162, v176, v177
    buffer_load_dwordx4 v240, s[8:11], s63 offen offset:0 sc1 lds
    v_exp_f32 v179, v103
    v_add_f32 v180, v180, v178
    v_exp_f32 v176, v104
    v_add_f32 v180, v180, v179
    v_cvt_pk_bf16_f32 v163, v178, v179
    v_exp_f32 v177, v105
    v_add_f32 v180, v180, v176
    v_exp_f32 v178, v106
    v_add_f32 v180, v180, v177
    v_cvt_pk_bf16_f32 v164, v176, v177
    buffer_load_dwordx4 v240, s[8:11], s63 offen offset:1024 sc1 lds
    v_exp_f32 v179, v107
    v_add_f32 v180, v180, v178
    v_exp_f32 v176, v108
    v_add_f32 v180, v180, v179
    v_cvt_pk_bf16_f32 v165, v178, v179
    v_exp_f32 v177, v109
    v_add_f32 v180, v180, v176
    v_exp_f32 v178, v110
    v_add_f32 v180, v180, v177
    v_cvt_pk_bf16_f32 v166, v176, v177
    buffer_load_dwordx4 v240, s[8:11], s63 offen offset:2048 sc1 lds
    v_exp_f32 v179, v111
    v_add_f32 v180, v180, v178
    v_add_f32 v180, v180, v179
    v_cvt_pk_bf16_f32 v167, v178, v179
    v_cmp_lt_f32 vcc, s66, v180
    buffer_load_dwordx4 v240, s[8:11], s63 offen offset:3072 sc1 lds
    s_add_u32 s63, s63, 16384
    s_add_u32 m0, m0, 16384
    s_and_b32 m0, m0, 0x1ffff
    s_cmp_lt_u32 s63, s64
    s_cselect_b32 s63, s63, 0x40000000
    s_cbranch_vccnz L_k2_site_94_s
L_k2_site_94_r:
L_k2_ve_85:
    v_mov_b32 v187, v185
    s_nop 1
    v_permlane32_swap_b32 v187, v185
    v_add_f32 v185, v185, v187
    v_rcp_f32 v185, v185
    s_lshl_b32 s52, s46, 2
    s_add_u32 s52, s52, s44
    s_lshl_b32 s52, s52, 18
    s_lshl_b32 s53, s45, 13
    s_add_u32 s52, s52, s53
    s_add_u32 s52, s52, 0x3000000
    s_add_u32 s53, s52, 4096
    v_accvgpr_read_b32 v192, a64
    v_accvgpr_read_b32 v193, a65
    v_accvgpr_read_b32 v194, a66
    v_accvgpr_read_b32 v195, a67
    v_accvgpr_read_b32 v196, a68
    v_accvgpr_read_b32 v197, a69
    v_accvgpr_read_b32 v198, a70
    v_accvgpr_read_b32 v199, a71
    v_pk_mul_f32 v[192:193], v[192:193], v[184:185] op_sel:[0,1] op_sel_hi:[1,1]
    v_pk_mul_f32 v[194:195], v[194:195], v[184:185] op_sel:[0,1] op_sel_hi:[1,1]
    v_pk_mul_f32 v[196:197], v[196:197], v[184:185] op_sel:[0,1] op_sel_hi:[1,1]
    v_pk_mul_f32 v[198:199], v[198:199], v[184:185] op_sel:[0,1] op_sel_hi:[1,1]
    v_cvt_pk_bf16_f32 v224, v192, v193
    v_cvt_pk_bf16_f32 v225, v194, v195
    v_cvt_pk_bf16_f32 v226, v196, v197
    v_cvt_pk_bf16_f32 v227, v198, v199
    buffer_store_dwordx4 v[224:227], v240, s[8:11], s52 offen offset:0 sc1
    v_accvgpr_read_b32 v200, a72
    v_accvgpr_read_b32 v201, a73
    v_accvgpr_read_b32 v202, a74
    v_accvgpr_read_b32 v203, a75
    v_accvgpr_read_b32 v204, a76
    v_accvgpr_read_b32 v205, a77
    v_accvgpr_read_b32 v206, a78
    v_accvgpr_read_b32 v207, a79
    v_pk_mul_f32 v[200:201], v[200:201], v[184:185] op_sel:[0,1] op_sel_hi:[1,1]
    v_pk_mul_f32 v[202:203], v[202:203], v[184:185] op_sel:[0,1] op_sel_hi:[1,1]
    v_pk_mul_f32 v[204:205], v[204:205], v[184:185] op_sel:[0,1] op_sel_hi:[1,1]
    v_pk_mul_f32 v[206:207], v[206:207], v[184:185] op_sel:[0,1] op_sel_hi:[1,1]
    v_cvt_pk_bf16_f32 v228, v200, v201
    v_cvt_pk_bf16_f32 v229, v202, v203
    v_cvt_pk_bf16_f32 v230, v204, v205
    v_cvt_pk_bf16_f32 v231, v206, v207
    buffer_store_dwordx4 v[228:231], v240, s[8:11], s52 offen offset:1024 sc1
    v_accvgpr_read_b32 v208, a80
    v_accvgpr_read_b32 v209, a81
    v_accvgpr_read_b32 v210, a82
    v_accvgpr_read_b32 v211, a83
    v_accvgpr_read_b32 v212, a84
    v_accvgpr_read_b32 v213, a85
    v_accvgpr_read_b32 v214, a86
    v_accvgpr_read_b32 v215, a87
    v_pk_mul_f32 v[208:209], v[208:209], v[184:185] op_sel:[0,1] op_sel_hi:[1,1]
    v_pk_mul_f32 v[210:211], v[210:211], v[184:185] op_sel:[0,1] op_sel_hi:[1,1]
    v_pk_mul_f32 v[212:213], v[212:213], v[184:185] op_sel:[0,1] op_sel_hi:[1,1]
    v_pk_mul_f32 v[214:215], v[214:215], v[184:185] op_sel:[0,1] op_sel_hi:[1,1]
    v_cvt_pk_bf16_f32 v232, v208, v209
    v_cvt_pk_bf16_f32 v233, v210, v211
    v_cvt_pk_bf16_f32 v234, v212, v213
    v_cvt_pk_bf16_f32 v235, v214, v215
    buffer_store_dwordx4 v[232:235], v240, s[8:11], s52 offen offset:2048 sc1
    v_accvgpr_read_b32 v216, a88
    v_accvgpr_read_b32 v217, a89
    v_accvgpr_read_b32 v218, a90
    v_accvgpr_read_b32 v219, a91
    v_accvgpr_read_b32 v220, a92
    v_accvgpr_read_b32 v221, a93
    v_accvgpr_read_b32 v222, a94
    v_accvgpr_read_b32 v223, a95
    v_pk_mul_f32 v[216:217], v[216:217], v[184:185] op_sel:[0,1] op_sel_hi:[1,1]
    v_pk_mul_f32 v[218:219], v[218:219], v[184:185] op_sel:[0,1] op_sel_hi:[1,1]
    v_pk_mul_f32 v[220:221], v[220:221], v[184:185] op_sel:[0,1] op_sel_hi:[1,1]
    v_pk_mul_f32 v[222:223], v[222:223], v[184:185] op_sel:[0,1] op_sel_hi:[1,1]
    v_cvt_pk_bf16_f32 v236, v216, v217
    v_cvt_pk_bf16_f32 v237, v218, v219
    v_cvt_pk_bf16_f32 v238, v220, v221
    v_cvt_pk_bf16_f32 v239, v222, v223
    buffer_store_dwordx4 v[236:239], v240, s[8:11], s52 offen offset:3072 sc1
    v_accvgpr_read_b32 v192, a96
    v_accvgpr_read_b32 v193, a97
    v_accvgpr_read_b32 v194, a98
    v_accvgpr_read_b32 v195, a99
    v_accvgpr_read_b32 v196, a100
    v_accvgpr_read_b32 v197, a101
    v_accvgpr_read_b32 v198, a102
    v_accvgpr_read_b32 v199, a103
    v_pk_mul_f32 v[192:193], v[192:193], v[184:185] op_sel:[0,1] op_sel_hi:[1,1]
    v_pk_mul_f32 v[194:195], v[194:195], v[184:185] op_sel:[0,1] op_sel_hi:[1,1]
    v_pk_mul_f32 v[196:197], v[196:197], v[184:185] op_sel:[0,1] op_sel_hi:[1,1]
    v_pk_mul_f32 v[198:199], v[198:199], v[184:185] op_sel:[0,1] op_sel_hi:[1,1]
    v_cvt_pk_bf16_f32 v224, v192, v193
    v_cvt_pk_bf16_f32 v225, v194, v195
    v_cvt_pk_bf16_f32 v226, v196, v197
    v_cvt_pk_bf16_f32 v227, v198, v199
    buffer_store_dwordx4 v[224:227], v240, s[8:11], s53 offen offset:0 sc1
    v_accvgpr_read_b32 v200, a104
    v_accvgpr_read_b32 v201, a105
    v_accvgpr_read_b32 v202, a106
    v_accvgpr_read_b32 v203, a107
    v_accvgpr_read_b32 v204, a108
    v_accvgpr_read_b32 v205, a109
    v_accvgpr_read_b32 v206, a110
    v_accvgpr_read_b32 v207, a111
    v_pk_mul_f32 v[200:201], v[200:201], v[184:185] op_sel:[0,1] op_sel_hi:[1,1]
    v_pk_mul_f32 v[202:203], v[202:203], v[184:185] op_sel:[0,1] op_sel_hi:[1,1]
    v_pk_mul_f32 v[204:205], v[204:205], v[184:185] op_sel:[0,1] op_sel_hi:[1,1]
    v_pk_mul_f32 v[206:207], v[206:207], v[184:185] op_sel:[0,1] op_sel_hi:[1,1]
    v_cvt_pk_bf16_f32 v228, v200, v201
    v_cvt_pk_bf16_f32 v229, v202, v203
    v_cvt_pk_bf16_f32 v230, v204, v205
    v_cvt_pk_bf16_f32 v231, v206, v207
    buffer_store_dwordx4 v[228:231], v240, s[8:11], s53 offen offset:1024 sc1
    v_accvgpr_read_b32 v208, a112
    v_accvgpr_read_b32 v209, a113
    v_accvgpr_read_b32 v210, a114
    v_accvgpr_read_b32 v211, a115
    v_accvgpr_read_b32 v212, a116
    v_accvgpr_read_b32 v213, a117
    v_accvgpr_read_b32 v214, a118
    v_accvgpr_read_b32 v215, a119
    v_pk_mul_f32 v[208:209], v[208:209], v[184:185] op_sel:[0,1] op_sel_hi:[1,1]
    v_pk_mul_f32 v[210:211], v[210:211], v[184:185] op_sel:[0,1] op_sel_hi:[1,1]
    v_pk_mul_f32 v[212:213], v[212:213], v[184:185] op_sel:[0,1] op_sel_hi:[1,1]
    v_pk_mul_f32 v[214:215], v[214:215], v[184:185] op_sel:[0,1] op_sel_hi:[1,1]
    v_cvt_pk_bf16_f32 v232, v208, v209
    v_cvt_pk_bf16_f32 v233, v210, v211
    v_cvt_pk_bf16_f32 v234, v212, v213
    v_cvt_pk_bf16_f32 v235, v214, v215
    buffer_store_dwordx4 v[232:235], v240, s[8:11], s53 offen offset:2048 sc1
    v_accvgpr_read_b32 v216, a120
    v_accvgpr_read_b32 v217, a121
    v_accvgpr_read_b32 v218, a122
    v_accvgpr_read_b32 v219, a123
    v_accvgpr_read_b32 v220, a124
    v_accvgpr_read_b32 v221, a125
    v_accvgpr_read_b32 v222, a126
    v_accvgpr_read_b32 v223, a127
    v_pk_mul_f32 v[216:217], v[216:217], v[184:185] op_sel:[0,1] op_sel_hi:[1,1]
    v_pk_mul_f32 v[218:219], v[218:219], v[184:185] op_sel:[0,1] op_sel_hi:[1,1]
    v_pk_mul_f32 v[220:221], v[220:221], v[184:185] op_sel:[0,1] op_sel_hi:[1,1]
    v_pk_mul_f32 v[222:223], v[222:223], v[184:185] op_sel:[0,1] op_sel_hi:[1,1]
    v_cvt_pk_bf16_f32 v236, v216, v217
    v_cvt_pk_bf16_f32 v237, v218, v219
    v_cvt_pk_bf16_f32 v238, v220, v221
    v_cvt_pk_bf16_f32 v239, v222, v223
    buffer_store_dwordx4 v[236:239], v240, s[8:11], s53 offen offset:3072 sc1
    s_cmp_lt_u32 s2, 208
    s_cbranch_scc1 L_k2_nof1
    s_load_dwordx2 s[12:13], s[0:1], 64
    s_load_dwordx2 s[28:29], s[0:1], 72
    v_and_b32 v212, 7, v241
    v_lshlrev_b32 v212, 3, v212
    s_mov_b32 s61, 0x482000
    v_add_u32 v213, 0, v241
    v_mul_u32_u24 v214, 0xaab, v213
    v_lshrrev_b32 v214, 15, v214
    v_mul_u32_u24 v215, 12, v214
    v_sub_u32 v215, v213, v215
    v_mul_u32_u24 v200, 9216, v214
    v_lshl_add_u32 v200, v215, 4, v200
    v_add_u32 v213, 64, v241
    v_mul_u32_u24 v214, 0xaab, v213
    v_lshrrev_b32 v214, 15, v214
    v_mul_u32_u24 v215, 12, v214
    v_sub_u32 v215, v213, v215
    v_mul_u32_u24 v201, 9216, v214
    v_lshl_add_u32 v201, v215, 4, v201
    v_add_u32 v213, 128, v241
    v_mul_u32_u24 v214, 0xaab, v213
    v_lshrrev_b32 v214, 15, v214
    v_mul_u32_u24 v215, 12, v214
    v_sub_u32 v215, v213, v215
    v_mul_u32_u24 v202, 9216, v214
    v_lshl_add_u32 v202, v215, 4, v202
    buffer_load_dwordx2 v[210:211], v212, s[8:11], s61 offen sc1
    s_and_b32 s52, s2, 7
    s_mul_i32 s52, s52, 6
    s_lshr_b32 s53, s2, 3
    s_add_u32 s52, s52, s53
    s_sub_u32 s52, s52, 26
    s_mul_i32 s52, s52, 192
    s_mul_i32 s60, s44, 1327104
    s_add_u32 s60, s60, s52
    s_mov_b32 s14, 0x510000
    s_mov_b32 s15, 0x00020000
    s_mov_b32 s30, 0x510000
    s_mov_b32 s31, 0x00020000
    s_waitcnt lgkmcnt(0)
L_k2_nof1:
    s_lshr_b32 s52, s2, 3
    s_sub_u32 s52, s52, 2
    s_mul_i32 s53, s52, 43
    s_lshr_b32 s53, s53, 8
    s_mul_i32 s53, s53, 6
    s_sub_u32 s53, s52, s53
    s_mul_i32 s53, s53, 3072
    s_and_b32 s54, s2, 1
    s_lshl_b32 s54, s54, 2
    s_add_u32 s54, s54, s44
    s_mul_i32 s59, s54, 589824
    s_add_u32 s59, s59, s53
    s_add_u32 s59, s59, 0x4000000
    s_cmp_lt_u32 s52, 24
    s_cselect_b32 s59, s59, 0x40000000
    s_cmp_ge_u32 s70, 2
    s_cbranch_scc0 L_k2_vn_96
    s_waitcnt lgkmcnt(4)
    s_cmp_gt_u32 s70, 2
    s_cbranch_scc1 L_k2_m_97
    v_mfma_f32_32x32x16_bf16 v[96:111], a[0:3], v[64:67], v[144:159]
    s_branch L_k2_m_98
L_k2_m_97:
    v_mfma_f32_32x32x16_bf16 v[96:111], a[0:3], v[64:67], v[128:143]
L_k2_m_98:
    ds_read_b128 a[32:35], v183 offset:8192
    v_exp_f32 v178, v118
    v_add_f32 v181, v181, v177
    v_cvt_pk_bf16_f32 v170, v176, v177
    v_mfma_f32_32x32x16_bf16 v[96:111], a[4:7], v[68:71], v[96:111]
    ds_read_b128 a[36:39], v183 offset:9216
    buffer_load_dwordx4 v240, s[8:11], s63 offen offset:0 sc1 lds
    v_exp_f32 v179, v119
    v_add_f32 v181, v181, v178
    v_add_f32 v182, v182, v180
    v_mfma_f32_32x32x16_bf16 v[96:111], a[8:11], v[72:75], v[96:111]
    ds_read_b128 a[40:43], v183 offset:10240
    v_exp_f32 v176, v120
    v_add_f32 v181, v181, v179
    v_cvt_pk_bf16_f32 v171, v178, v179
    v_mfma_f32_32x32x16_bf16 v[96:111], a[12:15], v[76:79], v[96:111]
    ds_read_b128 a[44:47], v183 offset:11264
    v_exp_f32 v177, v121
    v_add_f32 v181, v181, v176
    s_waitcnt lgkmcnt(4)
    v_mfma_f32_32x32x16_bf16 v[96:111], a[16:19], v[80:83], v[96:111]
    ds_read_b128 a[48:51], v183 offset:12288
    v_exp_f32 v178, v122
    v_add_f32 v181, v181, v177
    v_cvt_pk_bf16_f32 v172, v176, v177
    v_mfma_f32_32x32x16_bf16 v[96:111], a[20:23], v[84:87], v[96:111]
    ds_read_b128 a[52:55], v183 offset:13312
    buffer_load_dwordx4 v240, s[8:11], s63 offen offset:1024 sc1 lds
    v_exp_f32 v179, v123
    v_add_f32 v181, v181, v178
    v_mfma_f32_32x32x16_bf16 v[96:111], a[24:27], v[88:91], v[96:111]
    ds_read_b128 a[56:59], v183 offset:14336
    v_exp_f32 v176, v124
    v_add_f32 v181, v181, v179
    v_cvt_pk_bf16_f32 v173, v178, v179
    v_mfma_f32_32x32x16_bf16 v[96:111], a[28:31], v[92:95], v[96:111]
    ds_read_b128 a[60:63], v183 offset:15360
    v_exp_f32 v177, v125
    v_add_f32 v181, v181, v176
    s_waitcnt vmcnt(8)
    s_barrier
    s_waitcnt lgkmcnt(4)
    v_mfma_f32_32x32x16_bf16 v[0:15], a[32:35], v[160:163], v[0:15]
    ds_read_b128 a[0:3], v183 offset:49152
    v_exp_f32 v178, v126
    v_add_f32 v181, v181, v177
    v_cvt_pk_bf16_f32 v174, v176, v177
    v_mfma_f32_32x32x16_bf16 v[16:31], a[36:39], v[160:163], v[16:31]
    ds_read_b128 a[4:7], v183 offset:50176
    buffer_load_dwordx4 v240, s[8:11], s63 offen offset:2048 sc1 lds
    v_exp_f32 v179, v127
    v_add_f32 v181, v181, v178
    v_mfma_f32_32x32x16_bf16 v[32:47], a[40:43], v[160:163], v[32:47]
    ds_read_b128 a[8:11], v183 offset:51200
    v_exp_f32 v176, v96
    v_add_f32 v181, v181, v179
    v_cvt_pk_bf16_f32 v175, v178, v179
    v_mfma_f32_32x32x16_bf16 v[48:63], a[44:47], v[160:163], v[48:63]
    ds_read_b128 a[12:15], v183 offset:52224
    v_exp_f32 v177, v97
    v_cmp_lt_f32 vcc, s66, v181
    s_waitcnt lgkmcnt(4)
    v_mfma_f32_32x32x16_bf16 v[0:15], a[48:51], v[164:167], v[0:15]
    ds_read_b128 a[16:19], v183 offset:53248
    v_exp_f32 v178, v98
    v_add_f32 v180, v176, v177
    v_cvt_pk_bf16_f32 v160, v176, v177
    v_mfma_f32_32x32x16_bf16 v[16:31], a[52:55], v[164:167], v[16:31]
    ds_read_b128 a[20:23], v183 offset:54272
    buffer_load_dwordx4 v240, s[8:11], s63 offen offset:3072 sc1 lds
    v_exp_f32 v179, v99
    s_add_u32 s63, s63, 16384
    v_add_f32 v180, v180, v178
    v_mfma_f32_32x32x16_bf16 v[32:47], a[56:59], v[164:167], v[32:47]
    ds_read_b128 a[24:27], v183 offset:55296
    v_exp_f32 v176, v100
    s_add_u32 m0, m0, 16384
    v_add_f32 v180, v180, v179
    v_cvt_pk_bf16_f32 v161, v178, v179
    v_mfma_f32_32x32x16_bf16 v[48:63], a[60:63], v[164:167], v[48:63]
    ds_read_b128 a[28:31], v183 offset:56320
    v_exp_f32 v177, v101
    s_and_b32 m0, m0, 0x1ffff
    s_cmp_lt_u32 s63, s64
    s_cselect_b32 s63, s63, 0x40000000
    v_add_f32 v180, v180, v176
    s_cbranch_vccnz L_k2_site_99_s
L_k2_site_99_r:
    s_branch L_k2_ve_95
L_k2_vn_96:
    s_cmp_ge_u32 s70, 1
    s_cbranch_scc0 L_k2_vn_100
    ds_read_b128 a[32:35], v183 offset:8192
    v_exp_f32 v178, v118
    v_add_f32 v181, v181, v177
    v_cvt_pk_bf16_f32 v170, v176, v177
    ds_read_b128 a[36:39], v183 offset:9216
    buffer_load_dwordx4 v240, s[8:11], s63 offen offset:0 sc1 lds
    v_exp_f32 v179, v119
    v_add_f32 v181, v181, v178
    v_add_f32 v182, v182, v180
    ds_read_b128 a[40:43], v183 offset:10240
    v_exp_f32 v176, v120
    v_add_f32 v181, v181, v179
    v_cvt_pk_bf16_f32 v171, v178, v179
    ds_read_b128 a[44:47], v183 offset:11264
    v_exp_f32 v177, v121
    v_add_f32 v181, v181, v176
    ds_read_b128 a[48:51], v183 offset:12288
    v_exp_f32 v178, v122
    v_add_f32 v181, v181, v177
    v_cvt_pk_bf16_f32 v172, v176, v177
    ds_read_b128 a[52:55], v183 offset:13312
    buffer_load_dwordx4 v240, s[8:11], s63 offen offset:1024 sc1 lds
    v_exp_f32 v179, v123
    v_add_f32 v181, v181, v178
    ds_read_b128 a[56:59], v183 offset:14336
    v_exp_f32 v176, v124
    v_add_f32 v181, v181, v179
    v_cvt_pk_bf16_f32 v173, v178, v179
    ds_read_b128 a[60:63], v183 offset:15360
    v_exp_f32 v177, v125
    v_add_f32 v181, v181, v176
    s_waitcnt vmcnt(8)
    s_barrier
    s_waitcnt lgkmcnt(4)
    v_mfma_f32_32x32x16_bf16 v[0:15], a[32:35], v[160:163], v[0:15]
    v_exp_f32 v178, v126
    v_add_f32 v181, v181, v177
    v_cvt_pk_bf16_f32 v174, v176, v177
    v_mfma_f32_32x32x16_bf16 v[16:31], a[36:39], v[160:163], v[16:31]
    buffer_load_dwordx4 v240, s[8:11], s63 offen offset:2048 sc1 lds
    v_exp_f32 v179, v127
    v_add_f32 v181, v181, v178
    v_mfma_f32_32x32x16_bf16 v[32:47], a[40:43], v[160:163], v[32:47]
    v_add_f32 v181, v181, v179
    v_cvt_pk_bf16_f32 v175, v178, v179
    v_mfma_f32_32x32x16_bf16 v[48:63], a[44:47], v[160:163], v[48:63]
    v_cmp_lt_f32 vcc, s66, v181
    s_waitcnt lgkmcnt(0)
    v_mfma_f32_32x32x16_bf16 v[0:15], a[48:51], v[164:167], v[0:15]
    v_mfma_f32_32x32x16_bf16 v[16:31], a[52:55], v[164:167], v[16:31]
    buffer_load_dwordx4 v240, s[8:11], s63 offen offset:3072 sc1 lds
    s_add_u32 s63, s63, 16384
    v_mfma_f32_32x32x16_bf16 v[32:47], a[56:59], v[164:167], v[32:47]
    s_add_u32 m0, m0, 16384
    v_mfma_f32_32x32x16_bf16 v[48:63], a[60:63], v[164:167], v[48:63]
    s_and_b32 m0, m0, 0x1ffff
    s_cmp_lt_u32 s63, s64
    s_cselect_b32 s63, s63, 0x40000000
    s_cbranch_vccnz L_k2_site_101_s
L_k2_site_101_r:
    s_branch L_k2_ve_95
L_k2_vn_100:
    ds_read_b128 a[32:35], v183 offset:8192
    ds_read_b128 a[36:39], v183 offset:9216
    buffer_load_dwordx4 v240, s[8:11], s63 offen offset:0 sc1 lds
    v_add_f32 v182, v182, v180
    ds_read_b128 a[40:43], v183 offset:10240
    ds_read_b128 a[44:47], v183 offset:11264
    ds_read_b128 a[48:51], v183 offset:12288
    ds_read_b128 a[52:55], v183 offset:13312
    buffer_load_dwordx4 v240, s[8:11], s63 offen offset:1024 sc1 lds
    ds_read_b128 a[56:59], v183 offset:14336
    ds_read_b128 a[60:63], v183 offset:15360
    s_waitcnt vmcnt(8)
    s_barrier
    s_waitcnt lgkmcnt(4)
    v_mfma_f32_32x32x16_bf16 v[0:15], a[32:35], v[160:163], v[0:15]
    v_mfma_f32_32x32x16_bf16 v[16:31], a[36:39], v[160:163], v[16:31]
    buffer_load_dwordx4 v240, s[8:11], s63 offen offset:2048 sc1 lds
    v_mfma_f32_32x32x16_bf16 v[32:47], a[40:43], v[160:163], v[32:47]
    v_mfma_f32_32x32x16_bf16 v[48:63], a[44:47], v[160:163], v[48:63]
    s_waitcnt lgkmcnt(0)
    v_mfma_f32_32x32x16_bf16 v[0:15], a[48:51], v[164:167], v[0:15]
    v_mfma_f32_32x32x16_bf16 v[16:31], a[52:55], v[164:167], v[16:31]
    buffer_load_dwordx4 v240, s[8:11], s63 offen offset:3072 sc1 lds
    s_add_u32 s63, s63, 16384
    v_mfma_f32_32x32x16_bf16 v[32:47], a[56:59], v[164:167], v[32:47]
    s_add_u32 m0, m0, 16384
    v_mfma_f32_32x32x16_bf16 v[48:63], a[60:63], v[164:167], v[48:63]
    s_and_b32 m0, m0, 0x1ffff
    s_cmp_lt_u32 s63, s64
    s_cselect_b32 s63, s63, 0x40000000
L_k2_ve_95:
    v_lshlrev_b32 v253, 7, v251
    v_add_u32 v253, 12, v253
    s_nop 0
    buffer_load_dword v254, v253, s[8:11], s57 offen sc1
    s_cmp_ge_u32 s70, 3
    s_cbranch_scc0 L_k2_vn_103
    s_waitcnt lgkmcnt(4)
    s_cmp_gt_u32 s70, 3
    s_cbranch_scc1 L_k2_m_104
    v_mfma_f32_32x32x16_bf16 v[112:127], a[0:3], v[64:67], v[144:159]
    s_branch L_k2_m_105
L_k2_m_104:
    v_mfma_f32_32x32x16_bf16 v[112:127], a[0:3], v[64:67], v[128:143]
L_k2_m_105:
    ds_read_b128 a[32:35], v183 offset:24576
    v_exp_f32 v178, v102
    v_add_f32 v180, v180, v177
    v_cvt_pk_bf16_f32 v162, v176, v177
    v_mfma_f32_32x32x16_bf16 v[112:127], a[4:7], v[68:71], v[112:127]
    ds_read_b128 a[36:39], v183 offset:25600
    buffer_load_dwordx4 v240, s[8:11], s63 offen offset:0 sc1 lds
    v_exp_f32 v179, v103
    v_add_f32 v180, v180, v178
    v_add_f32 v182, v182, v181
    v_mfma_f32_32x32x16_bf16 v[112:127], a[8:11], v[72:75], v[112:127]
    ds_read_b128 a[40:43], v183 offset:26624
    v_exp_f32 v176, v104
    v_add_f32 v180, v180, v179
    v_cvt_pk_bf16_f32 v163, v178, v179
    v_mfma_f32_32x32x16_bf16 v[112:127], a[12:15], v[76:79], v[112:127]
    ds_read_b128 a[44:47], v183 offset:27648
    v_exp_f32 v177, v105
    v_add_f32 v180, v180, v176
    s_waitcnt lgkmcnt(4)
    v_mfma_f32_32x32x16_bf16 v[112:127], a[16:19], v[80:83], v[112:127]
    ds_read_b128 a[48:51], v183 offset:28672
    v_exp_f32 v178, v106
    v_add_f32 v180, v180, v177
    v_cvt_pk_bf16_f32 v164, v176, v177
    v_mfma_f32_32x32x16_bf16 v[112:127], a[20:23], v[84:87], v[112:127]
    ds_read_b128 a[52:55], v183 offset:29696
    buffer_load_dwordx4 v240, s[8:11], s63 offen offset:1024 sc1 lds
    v_exp_f32 v179, v107
    v_add_f32 v180, v180, v178
    v_mfma_f32_32x32x16_bf16 v[112:127], a[24:27], v[88:91], v[112:127]
    ds_read_b128 a[56:59], v183 offset:30720
    v_exp_f32 v176, v108
    v_add_f32 v180, v180, v179
    v_cvt_pk_bf16_f32 v165, v178, v179
    v_mfma_f32_32x32x16_bf16 v[112:127], a[28:31], v[92:95], v[112:127]
    ds_read_b128 a[60:63], v183 offset:31744
    v_exp_f32 v177, v109
    v_add_f32 v180, v180, v176
    s_waitcnt lgkmcnt(4)
    v_mfma_f32_32x32x16_bf16 v[0:15], a[32:35], v[168:171], v[0:15]
    ds_read_b128 a[0:3], v184 offset:0
    v_exp_f32 v178, v110
    v_add_f32 v180, v180, v177
    v_cvt_pk_bf16_f32 v166, v176, v177
    v_mfma_f32_32x32x16_bf16 v[16:31], a[36:39], v[168:171], v[16:31]
    ds_read_b128 a[4:7], v184 offset:1024
    buffer_load_dwordx4 v240, s[8:11], s63 offen offset:2048 sc1 lds
    v_exp_f32 v179, v111
    v_add_f32 v180, v180, v178
    v_mfma_f32_32x32x16_bf16 v[32:47], a[40:43], v[168:171], v[32:47]
    ds_read_b128 a[8:11], v184 offset:2048
    v_exp_f32 v176, v112
    v_add_f32 v180, v180, v179
    v_cvt_pk_bf16_f32 v167, v178, v179
    v_mfma_f32_32x32x16_bf16 v[48:63], a[44:47], v[168:171], v[48:63]
    ds_read_b128 a[12:15], v184 offset:3072
    v_exp_f32 v177, v113
    v_cmp_lt_f32 vcc, s66, v180
    s_waitcnt lgkmcnt(4)
    v_mfma_f32_32x32x16_bf16 v[0:15], a[48:51], v[172:175], v[0:15]
    ds_read_b128 a[16:19], v184 offset:4096
    v_exp_f32 v178, v114
    v_add_f32 v181, v176, v177
    v_cvt_pk_bf16_f32 v168, v176, v177
    v_mfma_f32_32x32x16_bf16 v[16:31], a[52:55], v[172:175], v[16:31]
    ds_read_b128 a[20:23], v184 offset:5120
    buffer_load_dwordx4 v240, s[8:11], s63 offen offset:3072 sc1 lds
    v_exp_f32 v179, v115
    s_add_u32 s63, s63, 16384
    v_add_f32 v181, v181, v178
    v_mfma_f32_32x32x16_bf16 v[32:47], a[56:59], v[172:175], v[32:47]
    ds_read_b128 a[24:27], v184 offset:6144
    v_exp_f32 v176, v116
    s_add_u32 m0, m0, 16384
    v_add_f32 v181, v181, v179
    v_cvt_pk_bf16_f32 v169, v178, v179
    v_mfma_f32_32x32x16_bf16 v[48:63], a[60:63], v[172:175], v[48:63]
    ds_read_b128 a[28:31], v184 offset:7168
    v_exp_f32 v177, v117
    s_and_b32 m0, m0, 0x1ffff
    s_cmp_lt_u32 s63, s64
    s_cselect_b32 s63, s63, 0x40000000
    v_add_f32 v181, v181, v176
    v_swap_b32 v183, v184
    s_cbranch_vccnz L_k2_site_106_s
L_k2_site_106_r:
    s_branch L_k2_ve_102
L_k2_vn_103:
    s_cmp_ge_u32 s70, 2
    s_cbranch_scc0 L_k2_vn_107
    ds_read_b128 a[32:35], v183 offset:24576
    v_exp_f32 v178, v102
    v_add_f32 v180, v180, v177
    v_cvt_pk_bf16_f32 v162, v176, v177
    ds_read_b128 a[36:39], v183 offset:25600
    buffer_load_dwordx4 v240, s[8:11], s63 offen offset:0 sc1 lds
    v_exp_f32 v179, v103
    v_add_f32 v180, v180, v178
    v_add_f32 v182, v182, v181
    ds_read_b128 a[40:43], v183 offset:26624
    v_exp_f32 v176, v104
    v_add_f32 v180, v180, v179
    v_cvt_pk_bf16_f32 v163, v178, v179
    ds_read_b128 a[44:47], v183 offset:27648
    v_exp_f32 v177, v105
    v_add_f32 v180, v180, v176
    ds_read_b128 a[48:51], v183 offset:28672
    v_exp_f32 v178, v106
    v_add_f32 v180, v180, v177
    v_cvt_pk_bf16_f32 v164, v176, v177
    ds_read_b128 a[52:55], v183 offset:29696
    buffer_load_dwordx4 v240, s[8:11], s63 offen offset:1024 sc1 lds
    v_exp_f32 v179, v107
    v_add_f32 v180, v180, v178
    ds_read_b128 a[56:59], v183 offset:30720
    v_exp_f32 v176, v108
    v_add_f32 v180, v180, v179
    v_cvt_pk_bf16_f32 v165, v178, v179
    ds_read_b128 a[60:63], v183 offset:31744
    v_exp_f32 v177, v109
    v_add_f32 v180, v180, v176
    s_waitcnt lgkmcnt(4)
    v_mfma_f32_32x32x16_bf16 v[0:15], a[32:35], v[168:171], v[0:15]
    v_exp_f32 v178, v110
    v_add_f32 v180, v180, v177
    v_cvt_pk_bf16_f32 v166, v176, v177
    v_mfma_f32_32x32x16_bf16 v[16:31], a[36:39], v[168:171], v[16:31]
    buffer_load_dwordx4 v240, s[8:11], s63 offen offset:2048 sc1 lds
    v_exp_f32 v179, v111
    v_add_f32 v180, v180, v178
    v_mfma_f32_32x32x16_bf16 v[32:47], a[40:43], v[168:171], v[32:47]
    v_add_f32 v180, v180, v179
    v_cvt_pk_bf16_f32 v167, v178, v179
    v_mfma_f32_32x32x16_bf16 v[48:63], a[44:47], v[168:171], v[48:63]
    v_cmp_lt_f32 vcc, s66, v180
    s_waitcnt lgkmcnt(0)
    v_mfma_f32_32x32x16_bf16 v[0:15], a[48:51], v[172:175], v[0:15]
    v_mfma_f32_32x32x16_bf16 v[16:31], a[52:55], v[172:175], v[16:31]
    buffer_load_dwordx4 v240, s[8:11], s63 offen offset:3072 sc1 lds
    s_add_u32 s63, s63, 16384
    v_mfma_f32_32x32x16_bf16 v[32:47], a[56:59], v[172:175], v[32:47]
    s_add_u32 m0, m0, 16384
    v_mfma_f32_32x32x16_bf16 v[48:63], a[60:63], v[172:175], v[48:63]
    s_and_b32 m0, m0, 0x1ffff
    s_cmp_lt_u32 s63, s64
    s_cselect_b32 s63, s63, 0x40000000
    v_swap_b32 v183, v184
    s_cbranch_vccnz L_k2_site_108_s
L_k2_site_108_r:
    s_branch L_k2_ve_102
L_k2_vn_107:
    s_cmp_ge_u32 s70, 1
    s_cbranch_scc0 L_k2_vn_109
    ds_read_b128 a[32:35], v183 offset:24576
    ds_read_b128 a[36:39], v183 offset:25600
    buffer_load_dwordx4 v240, s[8:11], s63 offen offset:0 sc1 lds
    v_add_f32 v182, v182, v181
    ds_read_b128 a[40:43], v183 offset:26624
    ds_read_b128 a[44:47], v183 offset:27648
    ds_read_b128 a[48:51], v183 offset:28672
    ds_read_b128 a[52:55], v183 offset:29696
    buffer_load_dwordx4 v240, s[8:11], s63 offen offset:1024 sc1 lds
    ds_read_b128 a[56:59], v183 offset:30720
    ds_read_b128 a[60:63], v183 offset:31744
    s_waitcnt lgkmcnt(4)
    v_mfma_f32_32x32x16_bf16 v[0:15], a[32:35], v[168:171], v[0:15]
    v_mfma_f32_32x32x16_bf16 v[16:31], a[36:39], v[168:171], v[16:31]
    buffer_load_dwordx4 v240, s[8:11], s63 offen offset:2048 sc1 lds
    v_mfma_f32_32x32x16_bf16 v[32:47], a[40:43], v[168:171], v[32:47]
    v_mfma_f32_32x32x16_bf16 v[48:63], a[44:47], v[168:171], v[48:63]
    s_waitcnt lgkmcnt(0)
    v_mfma_f32_32x32x16_bf16 v[0:15], a[48:51], v[172:175], v[0:15]
    v_mfma_f32_32x32x16_bf16 v[16:31], a[52:55], v[172:175], v[16:31]
    buffer_load_dwordx4 v240, s[8:11], s63 offen offset:3072 sc1 lds
    s_add_u32 s63, s63, 16384
    v_mfma_f32_32x32x16_bf16 v[32:47], a[56:59], v[172:175], v[32:47]
    s_add_u32 m0, m0, 16384
    v_mfma_f32_32x32x16_bf16 v[48:63], a[60:63], v[172:175], v[48:63]
    s_and_b32 m0, m0, 0x1ffff
    s_cmp_lt_u32 s63, s64
    s_cselect_b32 s63, s63, 0x40000000
    v_swap_b32 v183, v184
    s_branch L_k2_ve_102
L_k2_vn_109:
    buffer_load_dwordx4 v240, s[8:11], s63 offen offset:0 sc1 lds
    buffer_load_dwordx4 v240, s[8:11], s63 offen offset:1024 sc1 lds
    buffer_load_dwordx4 v240, s[8:11], s63 offen offset:2048 sc1 lds
    buffer_load_dwordx4 v240, s[8:11], s63 offen offset:3072 sc1 lds
    s_add_u32 s63, s63, 16384
    s_add_u32 m0, m0, 16384
    s_and_b32 m0, m0, 0x1ffff
    s_cmp_lt_u32 s63, s64
    s_cselect_b32 s63, s63, 0x40000000
    v_swap_b32 v183, v184
L_k2_ve_102:
    s_cmp_eq_u32 s46, 7
    s_cbranch_scc0 L_k2_peel
    s_waitcnt vmcnt(4)
    s_mov_b32 s55, 0
L_ka_fl_wof2:
    v_cmp_ne_u32 vcc, s58, v254
    s_cbranch_vccz L_ka_fl_wof2_ok
    s_sleep 8
    buffer_load_dword v254, v253, s[8:11], s57 offen sc1
    s_add_u32 s55, s55, 1
    s_cmp_lt_u32 s55, 0x40000
    s_waitcnt vmcnt(0)
    s_cbranch_scc1 L_ka_fl_wof2
L_ka_fl_wof2_ok:
    s_branch L_k2_drain2
L_k2_peel:
    s_waitcnt lgkmcnt(4)
    v_mfma_f32_32x32x16_bf16 v[96:111], a[0:3], v[64:67], v[128:143]
    ds_read_b128 a[32:35], v184 offset:40960
    v_exp_f32 v178, v118
    v_add_f32 v181, v181, v177
    v_cvt_pk_bf16_f32 v170, v176, v177
    v_mfma_f32_32x32x16_bf16 v[96:111], a[4:7], v[68:71], v[96:111]
    ds_read_b128 a[36:39], v184 offset:41984
    buffer_load_dwordx4 v240, s[8:11], s63 offen offset:0 sc1 lds
    v_exp_f32 v179, v119
    v_add_f32 v181, v181, v178
    v_add_f32 v182, v182, v180
    v_mfma_f32_32x32x16_bf16 v[96:111], a[8:11], v[72:75], v[96:111]
    ds_read_b128 a[40:43], v184 offset:43008
    v_exp_f32 v176, v120
    v_add_f32 v181, v181, v179
    v_cvt_pk_bf16_f32 v171, v178, v179
    v_mfma_f32_32x32x16_bf16 v[96:111], a[12:15], v[76:79], v[96:111]
    ds_read_b128 a[44:47], v184 offset:44032
    v_exp_f32 v177, v121
    v_add_f32 v181, v181, v176
    s_waitcnt lgkmcnt(4)
    v_mfma_f32_32x32x16_bf16 v[96:111], a[16:19], v[80:83], v[96:111]
    ds_read_b128 a[48:51], v184 offset:45056
    v_exp_f32 v178, v122
    v_add_f32 v181, v181, v177
    v_cvt_pk_bf16_f32 v172, v176, v177
    v_mfma_f32_32x32x16_bf16 v[96:111], a[20:23], v[84:87], v[96:111]
    ds_read_b128 a[52:55], v184 offset:46080
    buffer_load_dwordx4 v240, s[8:11], s63 offen offset:1024 sc1 lds
    v_exp_f32 v179, v123
    v_add_f32 v181, v181, v178
    v_mfma_f32_32x32x16_bf16 v[96:111], a[24:27], v[88:91], v[96:111]
    ds_read_b128 a[56:59], v184 offset:47104
    v_exp_f32 v176, v124
    v_add_f32 v181, v181, v179
    v_cvt_pk_bf16_f32 v173, v178, v179
    v_mfma_f32_32x32x16_bf16 v[96:111], a[28:31], v[92:95], v[96:111]
    ds_read_b128 a[60:63], v184 offset:48128
    v_exp_f32 v177, v125
    v_add_f32 v181, v181, v176
    s_waitcnt vmcnt(6)
    s_mov_b32 s55, 0
L_ka_fl_wof:
    v_cmp_ne_u32 vcc, s58, v254
    s_cbranch_vccz L_ka_fl_wof_ok
    s_sleep 8
    buffer_load_dword v254, v253, s[8:11], s57 offen sc1
    s_add_u32 s55, s55, 1
    s_cmp_lt_u32 s55, 0x40000
    s_waitcnt vmcnt(0)
    s_cbranch_scc1 L_ka_fl_wof
L_ka_fl_wof_ok:
    s_waitcnt vmcnt(8)
    s_barrier
    s_waitcnt lgkmcnt(4)
    v_mfma_f32_32x32x16_bf16 v[0:15], a[32:35], v[160:163], v[0:15]
    ds_read_b128 a[0:3], v183 offset:16384
    buffer_load_dwordx4 a[96:99], v240, s[8:11], s59 offen offset:0 sc1
    v_exp_f32 v178, v126
    v_add_f32 v181, v181, v177
    v_cvt_pk_bf16_f32 v174, v176, v177
    v_mfma_f32_32x32x16_bf16 v[16:31], a[36:39], v[160:163], v[16:31]
    ds_read_b128 a[4:7], v183 offset:17408
    buffer_load_dwordx4 v240, s[8:11], s63 offen offset:2048 sc1 lds
    v_exp_f32 v179, v127
    v_add_f32 v181, v181, v178
    v_mfma_f32_32x32x16_bf16 v[32:47], a[40:43], v[160:163], v[32:47]
    ds_read_b128 a[8:11], v183 offset:18432
    v_exp_f32 v176, v96
    v_add_f32 v181, v181, v179
    v_cvt_pk_bf16_f32 v175, v178, v179
    v_mfma_f32_32x32x16_bf16 v[48:63], a[44:47], v[160:163], v[48:63]
    ds_read_b128 a[12:15], v183 offset:19456
    buffer_load_dwordx4 a[100:103], v240, s[8:11], s59 offen offset:1024 sc1
    v_exp_f32 v177, v97
    v_cmp_lt_f32 vcc, s66, v181
    s_waitcnt lgkmcnt(4)
    v_mfma_f32_32x32x16_bf16 v[0:15], a[48:51], v[164:167], v[0:15]
    ds_read_b128 a[16:19], v183 offset:20480
    v_exp_f32 v178, v98
    v_add_f32 v180, v176, v177
    v_cvt_pk_bf16_f32 v160, v176, v177
    v_mfma_f32_32x32x16_bf16 v[16:31], a[52:55], v[164:167], v[16:31]
    ds_read_b128 a[20:23], v183 offset:21504
    buffer_load_dwordx4 v240, s[8:11], s63 offen offset:3072 sc1 lds
    v_exp_f32 v179, v99
    s_add_u32 s63, s63, 16384
    v_add_f32 v180, v180, v178
    v_mfma_f32_32x32x16_bf16 v[32:47], a[56:59], v[164:167], v[32:47]
    ds_read_b128 a[24:27], v183 offset:22528
    v_exp_f32 v176, v100
    s_add_u32 m0, m0, 16384
    v_add_f32 v180, v180, v179
    v_cvt_pk_bf16_f32 v161, v178, v179
    v_mfma_f32_32x32x16_bf16 v[48:63], a[60:63], v[164:167], v[48:63]
    ds_read_b128 a[28:31], v183 offset:23552
    buffer_load_dwordx4 a[104:107], v240, s[8:11], s59 offen offset:2048 sc1
    s_add_u32 s59, s59, 18432
    v_exp_f32 v177, v101
    s_and_b32 m0, m0, 0x1ffff
    s_cmp_lt_u32 s63, s64
    s_cselect_b32 s63, s63, 0x40000000
    v_add_f32 v180, v180, v176
    s_cbranch_vccnz L_k2_site_110_s
L_k2_site_110_r:
    s_waitcnt lgkmcnt(4)
    v_mfma_f32_32x32x16_bf16 v[112:127], a[0:3], v[64:67], v[128:143]
    ds_read_b128 a[32:35], v184 offset:57344
    v_exp_f32 v178, v102
    v_add_f32 v180, v180, v177
    v_cvt_pk_bf16_f32 v162, v176, v177
    v_mfma_f32_32x32x16_bf16 v[112:127], a[4:7], v[68:71], v[112:127]
    ds_read_b128 a[36:39], v184 offset:58368
    buffer_load_dwordx4 v240, s[8:11], s63 offen offset:0 sc1 lds
    v_exp_f32 v179, v103
    v_add_f32 v180, v180, v178
    v_add_f32 v182, v182, v181
    v_mfma_f32_32x32x16_bf16 v[112:127], a[8:11], v[72:75], v[112:127]
    ds_read_b128 a[40:43], v184 offset:59392
    v_exp_f32 v176, v104
    v_add_f32 v180, v180, v179
    v_cvt_pk_bf16_f32 v163, v178, v179
    v_mfma_f32_32x32x16_bf16 v[112:127], a[12:15], v[76:79], v[112:127]
    ds_read_b128 a[44:47], v184 offset:60416
    buffer_load_dwordx4 a[108:111], v240, s[8:11], s59 offen offset:0 sc1
    v_exp_f32 v177, v105
    v_add_f32 v180, v180, v176
    s_waitcnt lgkmcnt(4)
    v_mfma_f32_32x32x16_bf16 v[112:127], a[16:19], v[80:83], v[112:127]
    ds_read_b128 a[48:51], v184 offset:61440
    v_exp_f32 v178, v106
    v_add_f32 v180, v180, v177
    v_cvt_pk_bf16_f32 v164, v176, v177
    v_mfma_f32_32x32x16_bf16 v[112:127], a[20:23], v[84:87], v[112:127]
    ds_read_b128 a[52:55], v184 offset:62464
    buffer_load_dwordx4 v240, s[8:11], s63 offen offset:1024 sc1 lds
    v_exp_f32 v179, v107
    v_add_f32 v180, v180, v178
    v_mfma_f32_32x32x16_bf16 v[112:127], a[24:27], v[88:91], v[112:127]
    ds_read_b128 a[56:59], v184 offset:63488
    buffer_load_dwordx4 a[112:115], v240, s[8:11], s59 offen offset:1024 sc1
    v_exp_f32 v176, v108
    v_add_f32 v180, v180, v179
    v_cvt_pk_bf16_f32 v165, v178, v179
    v_mfma_f32_32x32x16_bf16 v[112:127], a[28:31], v[92:95], v[112:127]
    ds_read_b128 a[60:63], v184 offset:64512
    v_exp_f32 v177, v109
    v_add_f32 v180, v180, v176
    s_waitcnt lgkmcnt(4)
    v_mfma_f32_32x32x16_bf16 v[0:15], a[32:35], v[168:171], v[0:15]
    ds_read_b128 a[0:3], v183 offset:32768
    buffer_load_dwordx4 a[116:119], v240, s[8:11], s59 offen offset:2048 sc1
    s_add_u32 s59, s59, 18432
    v_exp_f32 v178, v110
    v_add_f32 v180, v180, v177
    v_cvt_pk_bf16_f32 v166, v176, v177
    v_mfma_f32_32x32x16_bf16 v[16:31], a[36:39], v[168:171], v[16:31]
    ds_read_b128 a[4:7], v183 offset:33792
    buffer_load_dwordx4 v240, s[8:11], s63 offen offset:2048 sc1 lds
    v_exp_f32 v179, v111
    v_add_f32 v180, v180, v178
    v_mfma_f32_32x32x16_bf16 v[32:47], a[40:43], v[168:171], v[32:47]
    ds_read_b128 a[8:11], v183 offset:34816
    v_exp_f32 v176, v112
    v_add_f32 v180, v180, v179
    v_cvt_pk_bf16_f32 v167, v178, v179
    v_mfma_f32_32x32x16_bf16 v[48:63], a[44:47], v[168:171], v[48:63]
    ds_read_b128 a[12:15], v183 offset:35840
    buffer_load_dwordx4 a[120:123], v240, s[8:11], s59 offen offset:0 sc1
    v_exp_f32 v177, v113
    v_cmp_lt_f32 vcc, s66, v180
    s_waitcnt lgkmcnt(4)
    v_mfma_f32_32x32x16_bf16 v[0:15], a[48:51], v[172:175], v[0:15]
    ds_read_b128 a[16:19], v183 offset:36864
    v_exp_f32 v178, v114
    v_add_f32 v181, v176, v177
    v_cvt_pk_bf16_f32 v168, v176, v177
    v_mfma_f32_32x32x16_bf16 v[16:31], a[52:55], v[172:175], v[16:31]
    ds_read_b128 a[20:23], v183 offset:37888
    buffer_load_dwordx4 v240, s[8:11], s63 offen offset:3072 sc1 lds
    v_exp_f32 v179, v115
    s_add_u32 s63, s63, 16384
    v_add_f32 v181, v181, v178
    v_mfma_f32_32x32x16_bf16 v[32:47], a[56:59], v[172:175], v[32:47]
    ds_read_b128 a[24:27], v183 offset:38912
    v_exp_f32 v176, v116
    s_add_u32 m0, m0, 16384
    v_add_f32 v181, v181, v179
    v_cvt_pk_bf16_f32 v169, v178, v179
    v_mfma_f32_32x32x16_bf16 v[48:63], a[60:63], v[172:175], v[48:63]
    ds_read_b128 a[28:31], v183 offset:39936
    buffer_load_dwordx4 a[124:127], v240, s[8:11], s59 offen offset:1024 sc1
    v_exp_f32 v177, v117
    s_and_b32 m0, m0, 0x1ffff
    s_cmp_lt_u32 s63, s64
    s_cselect_b32 s63, s63, 0x40000000
    v_add_f32 v181, v181, v176
    s_cbranch_vccnz L_k2_site_111_s
L_k2_site_111_r:
    s_waitcnt lgkmcnt(4)
    v_mfma_f32_32x32x16_bf16 v[96:111], a[0:3], v[64:67], v[128:143]
    ds_read_b128 a[32:35], v183 offset:8192
    v_exp_f32 v178, v118
    v_add_f32 v181, v181, v177
    v_cvt_pk_bf16_f32 v170, v176, v177
    v_mfma_f32_32x32x16_bf16 v[96:111], a[4:7], v[68:71], v[96:111]
    ds_read_b128 a[36:39], v183 offset:9216
    buffer_load_dwordx4 v240, s[8:11], s63 offen offset:0 sc1 lds
    v_exp_f32 v179, v119
    v_add_f32 v181, v181, v178
    v_add_f32 v182, v182, v180
    v_mfma_f32_32x32x16_bf16 v[96:111], a[8:11], v[72:75], v[96:111]
    ds_read_b128 a[40:43], v183 offset:10240
    v_exp_f32 v176, v120
    v_add_f32 v181, v181, v179
    v_cvt_pk_bf16_f32 v171, v178, v179
    v_mfma_f32_32x32x16_bf16 v[96:111], a[12:15], v[76:79], v[96:111]
    ds_read_b128 a[44:47], v183 offset:11264
    buffer_load_dwordx4 a[128:131], v240, s[8:11], s59 offen offset:2048 sc1
    s_add_u32 s59, s59, 18432
    v_exp_f32 v177, v121
    v_add_f32 v181, v181, v176
    s_waitcnt lgkmcnt(4)
    v_mfma_f32_32x32x16_bf16 v[96:111], a[16:19], v[80:83], v[96:111]
    ds_read_b128 a[48:51], v183 offset:12288
    v_exp_f32 v178, v122
    v_add_f32 v181, v181, v177
    v_cvt_pk_bf16_f32 v172, v176, v177
    v_mfma_f32_32x32x16_bf16 v[96:111], a[20:23], v[84:87], v[96:111]
    ds_read_b128 a[52:55], v183 offset:13312
    buffer_load_dwordx4 v240, s[8:11], s63 offen offset:1024 sc1 lds
    v_exp_f32 v179, v123
    v_add_f32 v181, v181, v178
    v_mfma_f32_32x32x16_bf16 v[96:111], a[24:27], v[88:91], v[96:111]
    ds_read_b128 a[56:59], v183 offset:14336
    buffer_load_dwordx4 a[132:135], v240, s[8:11], s59 offen offset:0 sc1
    v_exp_f32 v176, v124
    v_add_f32 v181, v181, v179
    v_cvt_pk_bf16_f32 v173, v178, v179
    v_mfma_f32_32x32x16_bf16 v[96:111], a[28:31], v[92:95], v[96:111]
    ds_read_b128 a[60:63], v183 offset:15360
    v_exp_f32 v177, v125
    v_add_f32 v181, v181, v176
    s_waitcnt vmcnt(18)
    s_barrier
    s_waitcnt lgkmcnt(4)
    v_mfma_f32_32x32x16_bf16 v[0:15], a[32:35], v[160:163], v[0:15]
    ds_read_b128 a[0:3], v183 offset:49152
    buffer_load_dwordx4 a[136:139], v240, s[8:11], s59 offen offset:1024 sc1
    v_exp_f32 v178, v126
    v_add_f32 v181, v181, v177
    v_cvt_pk_bf16_f32 v174, v176, v177
    v_mfma_f32_32x32x16_bf16 v[16:31], a[36:39], v[160:163], v[16:31]
    ds_read_b128 a[4:7], v183 offset:50176
    buffer_load_dwordx4 v240, s[8:11], s63 offen offset:2048 sc1 lds
    v_exp_f32 v179, v127
    v_add_f32 v181, v181, v178
    v_mfma_f32_32x32x16_bf16 v[32:47], a[40:43], v[160:163], v[32:47]
    ds_read_b128 a[8:11], v183 offset:51200
    v_exp_f32 v176, v96
    v_add_f32 v181, v181, v179
    v_cvt_pk_bf16_f32 v175, v178, v179
    v_mfma_f32_32x32x16_bf16 v[48:63], a[44:47], v[160:163], v[48:63]
    ds_read_b128 a[12:15], v183 offset:52224
    buffer_load_dwordx4 a[140:143], v240, s[8:11], s59 offen offset:2048 sc1
    s_add_u32 s59, s59, 18432
    v_exp_f32 v177, v97
    v_cmp_lt_f32 vcc, s66, v181
    s_waitcnt lgkmcnt(4)
    v_mfma_f32_32x32x16_bf16 v[0:15], a[48:51], v[164:167], v[0:15]
    ds_read_b128 a[16:19], v183 offset:53248
    v_exp_f32 v178, v98
    v_add_f32 v180, v176, v177
    v_cvt_pk_bf16_f32 v160, v176, v177
    v_mfma_f32_32x32x16_bf16 v[16:31], a[52:55], v[164:167], v[16:31]
    ds_read_b128 a[20:23], v183 offset:54272
    buffer_load_dwordx4 v240, s[8:11], s63 offen offset:3072 sc1 lds
    v_exp_f32 v179, v99
    s_add_u32 s63, s63, 16384
    v_add_f32 v180, v180, v178
    v_mfma_f32_32x32x16_bf16 v[32:47], a[56:59], v[164:167], v[32:47]
    ds_read_b128 a[24:27], v183 offset:55296
    v_exp_f32 v176, v100
    s_add_u32 m0, m0, 16384
    v_add_f32 v180, v180, v179
    v_cvt_pk_bf16_f32 v161, v178, v179
    v_mfma_f32_32x32x16_bf16 v[48:63], a[60:63], v[164:167], v[48:63]
    ds_read_b128 a[28:31], v183 offset:56320
    buffer_load_dwordx4 a[144:147], v240, s[8:11], s59 offen offset:0 sc1
    v_exp_f32 v177, v101
    s_and_b32 m0, m0, 0x1ffff
    s_cmp_lt_u32 s63, s64
    s_cselect_b32 s63, s63, 0x40000000
    v_add_f32 v180, v180, v176
    s_cbranch_vccnz L_k2_site_112_s
L_k2_site_112_r:
    s_waitcnt lgkmcnt(4)
    v_mfma_f32_32x32x16_bf16 v[112:127], a[0:3], v[64:67], v[128:143]
    ds_read_b128 a[32:35], v183 offset:24576
    v_exp_f32 v178, v102
    v_add_f32 v180, v180, v177
    v_cvt_pk_bf16_f32 v162, v176, v177
    v_mfma_f32_32x32x16_bf16 v[112:127], a[4:7], v[68:71], v[112:127]
    ds_read_b128 a[36:39], v183 offset:25600
    buffer_load_dwordx4 v240, s[8:11], s63 offen offset:0 sc1 lds
    v_exp_f32 v179, v103
    v_add_f32 v180, v180, v178
    v_add_f32 v182, v182, v181
    v_mfma_f32_32x32x16_bf16 v[112:127], a[8:11], v[72:75], v[112:127]
    ds_read_b128 a[40:43], v183 offset:26624
    v_exp_f32 v176, v104
    v_add_f32 v180, v180, v179
    v_cvt_pk_bf16_f32 v163, v178, v179
    v_mfma_f32_32x32x16_bf16 v[112:127], a[12:15], v[76:79], v[112:127]
    ds_read_b128 a[44:47], v183 offset:27648
    buffer_load_dwordx4 a[148:151], v240, s[8:11], s59 offen offset:1024 sc1
    v_exp_f32 v177, v105
    v_add_f32 v180, v180, v176
    s_waitcnt lgkmcnt(4)
    v_mfma_f32_32x32x16_bf16 v[112:127], a[16:19], v[80:83], v[112:127]
    ds_read_b128 a[48:51], v183 offset:28672
    v_exp_f32 v178, v106
    v_add_f32 v180, v180, v177
    v_cvt_pk_bf16_f32 v164, v176, v177
    v_mfma_f32_32x32x16_bf16 v[112:127], a[20:23], v[84:87], v[112:127]
    ds_read_b128 a[52:55], v183 offset:29696
    buffer_load_dwordx4 v240, s[8:11], s63 offen offset:1024 sc1 lds
    v_exp_f32 v179, v107
    v_add_f32 v180, v180, v178
    v_mfma_f32_32x32x16_bf16 v[112:127], a[24:27], v[88:91], v[112:127]
    ds_read_b128 a[56:59], v183 offset:30720
    buffer_load_dwordx4 a[152:155], v240, s[8:11], s59 offen offset:2048 sc1
    s_add_u32 s59, s59, 18432
    v_exp_f32 v176, v108
    v_add_f32 v180, v180, v179
    v_cvt_pk_bf16_f32 v165, v178, v179
    v_mfma_f32_32x32x16_bf16 v[112:127], a[28:31], v[92:95], v[112:127]
    ds_read_b128 a[60:63], v183 offset:31744
    v_exp_f32 v177, v109
    v_add_f32 v180, v180, v176
    s_waitcnt lgkmcnt(4)
    v_mfma_f32_32x32x16_bf16 v[0:15], a[32:35], v[168:171], v[0:15]
    ds_read_b128 a[0:3], v184 offset:0
    buffer_load_dwordx4 a[156:159], v240, s[8:11], s59 offen offset:0 sc1
    v_exp_f32 v178, v110
    v_add_f32 v180, v180, v177
    v_cvt_pk_bf16_f32 v166, v176, v177
    v_mfma_f32_32x32x16_bf16 v[16:31], a[36:39], v[168:171], v[16:31]
    ds_read_b128 a[4:7], v184 offset:1024
    buffer_load_dwordx4 v240, s[8:11], s63 offen offset:2048 sc1 lds
    v_exp_f32 v179, v111
    v_add_f32 v180, v180, v178
    v_mfma_f32_32x32x16_bf16 v[32:47], a[40:43], v[168:171], v[32:47]
    ds_read_b128 a[8:11], v184 offset:2048
    v_exp_f32 v176, v112
    v_add_f32 v180, v180, v179
    v_cvt_pk_bf16_f32 v167, v178, v179
    v_mfma_f32_32x32x16_bf16 v[48:63], a[44:47], v[168:171], v[48:63]
    ds_read_b128 a[12:15], v184 offset:3072
    buffer_load_dwordx4 a[160:163], v240, s[8:11], s59 offen offset:1024 sc1
    v_exp_f32 v177, v113
    v_cmp_lt_f32 vcc, s66, v180
    s_waitcnt lgkmcnt(4)
    v_mfma_f32_32x32x16_bf16 v[0:15], a[48:51], v[172:175], v[0:15]
    ds_read_b128 a[16:19], v184 offset:4096
    v_exp_f32 v178, v114
    v_add_f32 v181, v176, v177
    v_cvt_pk_bf16_f32 v168, v176, v177
    v_mfma_f32_32x32x16_bf16 v[16:31], a[52:55], v[172:175], v[16:31]
    ds_read_b128 a[20:23], v184 offset:5120
    buffer_load_dwordx4 v240, s[8:11], s63 offen offset:3072 sc1 lds
    v_exp_f32 v179, v115
    s_add_u32 s63, s63, 16384
    v_add_f32 v181, v181, v178
    v_mfma_f32_32x32x16_bf16 v[32:47], a[56:59], v[172:175], v[32:47]
    ds_read_b128 a[24:27], v184 offset:6144
    v_exp_f32 v176, v116
    s_add_u32 m0, m0, 16384
    v_add_f32 v181, v181, v179
    v_cvt_pk_bf16_f32 v169, v178, v179
    v_mfma_f32_32x32x16_bf16 v[48:63], a[60:63], v[172:175], v[48:63]
    ds_read_b128 a[28:31], v184 offset:7168
    buffer_load_dwordx4 a[164:167], v240, s[8:11], s59 offen offset:2048 sc1
    s_add_u32 s59, s59, 18432
    v_exp_f32 v177, v117
    s_and_b32 m0, m0, 0x1ffff
    s_cmp_lt_u32 s63, s64
    s_cselect_b32 s63, s63, 0x40000000
    v_add_f32 v181, v181, v176
    v_swap_b32 v183, v184
    s_cbranch_vccnz L_k2_site_113_s
L_k2_site_113_r:
    s_sub_u32 s51, s51, 1
    s_cmp_eq_u32 s51, 0
    s_cbranch_scc1 L_k2_stail
    .p2align 6
L_k2_loop:
    s_waitcnt lgkmcnt(4)
    v_mfma_f32_32x32x16_bf16 v[96:111], a[0:3], v[64:67], v[128:143]
    ds_read_b128 a[32:35], v184 offset:40960
    v_exp_f32 v178, v118
    v_add_f32 v181, v181, v177
    v_cvt_pk_bf16_f32 v170, v176, v177
    v_mfma_f32_32x32x16_bf16 v[96:111], a[4:7], v[68:71], v[96:111]
    ds_read_b128 a[36:39], v184 offset:41984
    buffer_load_dwordx4 v240, s[8:11], s63 offen offset:0 sc1 lds
    v_exp_f32 v179, v119
    v_add_f32 v181, v181, v178
    v_add_f32 v182, v182, v180
    v_mfma_f32_32x32x16_bf16 v[96:111], a[8:11], v[72:75], v[96:111]
    ds_read_b128 a[40:43], v184 offset:43008
    v_exp_f32 v176, v120
    v_add_f32 v181, v181, v179
    v_cvt_pk_bf16_f32 v171, v178, v179
    v_mfma_f32_32x32x16_bf16 v[96:111], a[12:15], v[76:79], v[96:111]
    ds_read_b128 a[44:47], v184 offset:44032
    v_exp_f32 v177, v121
    v_add_f32 v181, v181, v176
    s_waitcnt lgkmcnt(4)
    v_mfma_f32_32x32x16_bf16 v[96:111], a[16:19], v[80:83], v[96:111]
    ds_read_b128 a[48:51], v184 offset:45056
    v_exp_f32 v178, v122
    v_add_f32 v181, v181, v177
    v_cvt_pk_bf16_f32 v172, v176, v177
    v_mfma_f32_32x32x16_bf16 v[96:111], a[20:23], v[84:87], v[96:111]
    ds_read_b128 a[52:55], v184 offset:46080
    buffer_load_dwordx4 v240, s[8:11], s63 offen offset:1024 sc1 lds
    v_exp_f32 v179, v123
    v_add_f32 v181, v181, v178
    v_mfma_f32_32x32x16_bf16 v[96:111], a[24:27], v[88:91], v[96:111]
    ds_read_b128 a[56:59], v184 offset:47104
    v_exp_f32 v176, v124
    v_add_f32 v181, v181, v179
    v_cvt_pk_bf16_f32 v173, v178, v179
    v_mfma_f32_32x32x16_bf16 v[96:111], a[28:31], v[92:95], v[96:111]
    ds_read_b128 a[60:63], v184 offset:48128
    v_exp_f32 v177, v125
    v_add_f32 v181, v181, v176
    s_waitcnt vmcnt(8)
    s_barrier
    s_waitcnt lgkmcnt(4)
    v_mfma_f32_32x32x16_bf16 v[0:15], a[32:35], v[160:163], v[0:15]
    ds_read_b128 a[0:3], v183 offset:16384
    v_exp_f32 v178, v126
    v_add_f32 v181, v181, v177
    v_cvt_pk_bf16_f32 v174, v176, v177
    v_mfma_f32_32x32x16_bf16 v[16:31], a[36:39], v[160:163], v[16:31]
    ds_read_b128 a[4:7], v183 offset:17408
    buffer_load_dwordx4 v240, s[8:11], s63 offen offset:2048 sc1 lds
    v_exp_f32 v179, v127
    v_add_f32 v181, v181, v178
    v_mfma_f32_32x32x16_bf16 v[32:47], a[40:43], v[160:163], v[32:47]
    ds_read_b128 a[8:11], v183 offset:18432
    v_exp_f32 v176, v96
    v_add_f32 v181, v181, v179
    v_cvt_pk_bf16_f32 v175, v178, v179
    v_mfma_f32_32x32x16_bf16 v[48:63], a[44:47], v[160:163], v[48:63]
    ds_read_b128 a[12:15], v183 offset:19456
    s_cmp_lt_u32 s56, s34
    s_cbranch_scc0 L_k2_pf_114
    buffer_load_dword v252, v250, s[32:35], s56 offen
    s_add_u32 s56, s56, 4096
L_k2_pf_114:
    v_exp_f32 v177, v97
    v_cmp_lt_f32 vcc, s66, v181
    s_waitcnt lgkmcnt(4)
    v_mfma_f32_32x32x16_bf16 v[0:15], a[48:51], v[164:167], v[0:15]
    ds_read_b128 a[16:19], v183 offset:20480
    v_exp_f32 v178, v98
    v_add_f32 v180, v176, v177
    v_cvt_pk_bf16_f32 v160, v176, v177
    v_mfma_f32_32x32x16_bf16 v[16:31], a[52:55], v[164:167], v[16:31]
    ds_read_b128 a[20:23], v183 offset:21504
    buffer_load_dwordx4 v240, s[8:11], s63 offen offset:3072 sc1 lds
    v_exp_f32 v179, v99
    s_add_u32 s63, s63, 16384
    v_add_f32 v180, v180, v178
    v_mfma_f32_32x32x16_bf16 v[32:47], a[56:59], v[164:167], v[32:47]
    ds_read_b128 a[24:27], v183 offset:22528
    v_exp_f32 v176, v100
    s_add_u32 m0, m0, 16384
    v_add_f32 v180, v180, v179
    v_cvt_pk_bf16_f32 v161, v178, v179
    v_mfma_f32_32x32x16_bf16 v[48:63], a[60:63], v[164:167], v[48:63]
    ds_read_b128 a[28:31], v183 offset:23552
    v_exp_f32 v177, v101
    s_and_b32 m0, m0, 0x1ffff
    s_cmp_lt_u32 s63, s64
    s_cselect_b32 s63, s63, 0x40000000
    v_add_f32 v180, v180, v176
    s_cbranch_vccnz L_k2_site_115_s
L_k2_site_115_r:
    s_waitcnt lgkmcnt(4)
    v_mfma_f32_32x32x16_bf16 v[112:127], a[0:3], v[64:67], v[128:143]
    ds_read_b128 a[32:35], v184 offset:57344
    v_exp_f32 v178, v102
    v_add_f32 v180, v180, v177
    v_cvt_pk_bf16_f32 v162, v176, v177
    v_mfma_f32_32x32x16_bf16 v[112:127], a[4:7], v[68:71], v[112:127]
    ds_read_b128 a[36:39], v184 offset:58368
    buffer_load_dwordx4 v240, s[8:11], s63 offen offset:0 sc1 lds
    v_exp_f32 v179, v103
    v_add_f32 v180, v180, v178
    v_add_f32 v182, v182, v181
    v_mfma_f32_32x32x16_bf16 v[112:127], a[8:11], v[72:75], v[112:127]
    ds_read_b128 a[40:43], v184 offset:59392
    v_exp_f32 v176, v104
    v_add_f32 v180, v180, v179
    v_cvt_pk_bf16_f32 v163, v178, v179
    v_mfma_f32_32x32x16_bf16 v[112:127], a[12:15], v[76:79], v[112:127]
    ds_read_b128 a[44:47], v184 offset:60416
    v_exp_f32 v177, v105
    v_add_f32 v180, v180, v176
    s_waitcnt lgkmcnt(4)
    v_mfma_f32_32x32x16_bf16 v[112:127], a[16:19], v[80:83], v[112:127]
    ds_read_b128 a[48:51], v184 offset:61440
    v_exp_f32 v178, v106
    v_add_f32 v180, v180, v177
    v_cvt_pk_bf16_f32 v164, v176, v177
    v_mfma_f32_32x32x16_bf16 v[112:127], a[20:23], v[84:87], v[112:127]
    ds_read_b128 a[52:55], v184 offset:62464
    buffer_load_dwordx4 v240, s[8:11], s63 offen offset:1024 sc1 lds
    v_exp_f32 v179, v107
    v_add_f32 v180, v180, v178
    v_mfma_f32_32x32x16_bf16 v[112:127], a[24:27], v[88:91], v[112:127]
    ds_read_b128 a[56:59], v184 offset:63488
    v_exp_f32 v176, v108
    v_add_f32 v180, v180, v179
    v_cvt_pk_bf16_f32 v165, v178, v179
    v_mfma_f32_32x32x16_bf16 v[112:127], a[28:31], v[92:95], v[112:127]
    ds_read_b128 a[60:63], v184 offset:64512
    v_exp_f32 v177, v109
    v_add_f32 v180, v180, v176
    s_waitcnt lgkmcnt(4)
    v_mfma_f32_32x32x16_bf16 v[0:15], a[32:35], v[168:171], v[0:15]
    ds_read_b128 a[0:3], v183 offset:32768
    v_exp_f32 v178, v110
    v_add_f32 v180, v180, v177
    v_cvt_pk_bf16_f32 v166, v176, v177
    v_mfma_f32_32x32x16_bf16 v[16:31], a[36:39], v[168:171], v[16:31]
    ds_read_b128 a[4:7], v183 offset:33792
    buffer_load_dwordx4 v240, s[8:11], s63 offen offset:2048 sc1 lds
    v_exp_f32 v179, v111
    v_add_f32 v180, v180, v178
    v_mfma_f32_32x32x16_bf16 v[32:47], a[40:43], v[168:171], v[32:47]
    ds_read_b128 a[8:11], v183 offset:34816
    v_exp_f32 v176, v112
    v_add_f32 v180, v180, v179
    v_cvt_pk_bf16_f32 v167, v178, v179
    v_mfma_f32_32x32x16_bf16 v[48:63], a[44:47], v[168:171], v[48:63]
    ds_read_b128 a[12:15], v183 offset:35840
    v_exp_f32 v177, v113
    v_cmp_lt_f32 vcc, s66, v180
    s_waitcnt lgkmcnt(4)
    v_mfma_f32_32x32x16_bf16 v[0:15], a[48:51], v[172:175], v[0:15]
    ds_read_b128 a[16:19], v183 offset:36864
    v_exp_f32 v178, v114
    v_add_f32 v181, v176, v177
    v_cvt_pk_bf16_f32 v168, v176, v177
    v_mfma_f32_32x32x16_bf16 v[16:31], a[52:55], v[172:175], v[16:31]
    ds_read_b128 a[20:23], v183 offset:37888
    buffer_load_dwordx4 v240, s[8:11], s63 offen offset:3072 sc1 lds
    v_exp_f32 v179, v115
    s_add_u32 s63, s63, 16384
    v_add_f32 v181, v181, v178
    v_mfma_f32_32x32x16_bf16 v[32:47], a[56:59], v[172:175], v[32:47]
    ds_read_b128 a[24:27], v183 offset:38912
    v_exp_f32 v176, v116
    s_add_u32 m0, m0, 16384
    v_add_f32 v181, v181, v179
    v_cvt_pk_bf16_f32 v169, v178, v179
    v_mfma_f32_32x32x16_bf16 v[48:63], a[60:63], v[172:175], v[48:63]
    ds_read_b128 a[28:31], v183 offset:39936
    v_exp_f32 v177, v117
    s_and_b32 m0, m0, 0x1ffff
    s_cmp_lt_u32 s63, s64
    s_cselect_b32 s63, s63, 0x40000000
    v_add_f32 v181, v181, v176
    s_cbranch_vccnz L_k2_site_116_s
L_k2_site_116_r:
    s_waitcnt lgkmcnt(4)
    v_mfma_f32_32x32x16_bf16 v[96:111], a[0:3], v[64:67], v[128:143]
    ds_read_b128 a[32:35], v183 offset:8192
    v_exp_f32 v178, v118
    v_add_f32 v181, v181, v177
    v_cvt_pk_bf16_f32 v170, v176, v177
    v_mfma_f32_32x32x16_bf16 v[96:111], a[4:7], v[68:71], v[96:111]
    ds_read_b128 a[36:39], v183 offset:9216
    buffer_load_dwordx4 v240, s[8:11], s63 offen offset:0 sc1 lds
    v_exp_f32 v179, v119
    v_add_f32 v181, v181, v178
    v_add_f32 v182, v182, v180
    v_mfma_f32_32x32x16_bf16 v[96:111], a[8:11], v[72:75], v[96:111]
    ds_read_b128 a[40:43], v183 offset:10240
    v_exp_f32 v176, v120
    v_add_f32 v181, v181, v179
    v_cvt_pk_bf16_f32 v171, v178, v179
    v_mfma_f32_32x32x16_bf16 v[96:111], a[12:15], v[76:79], v[96:111]
    ds_read_b128 a[44:47], v183 offset:11264
    v_exp_f32 v177, v121
    v_add_f32 v181, v181, v176
    s_waitcnt lgkmcnt(4)
    v_mfma_f32_32x32x16_bf16 v[96:111], a[16:19], v[80:83], v[96:111]
    ds_read_b128 a[48:51], v183 offset:12288
    v_exp_f32 v178, v122
    v_add_f32 v181, v181, v177
    v_cvt_pk_bf16_f32 v172, v176, v177
    v_mfma_f32_32x32x16_bf16 v[96:111], a[20:23], v[84:87], v[96:111]
    ds_read_b128 a[52:55], v183 offset:13312
    buffer_load_dwordx4 v240, s[8:11], s63 offen offset:1024 sc1 lds
    v_exp_f32 v179, v123
    v_add_f32 v181, v181, v178
    v_mfma_f32_32x32x16_bf16 v[96:111], a[24:27], v[88:91], v[96:111]
    ds_read_b128 a[56:59], v183 offset:14336
    v_exp_f32 v176, v124
    v_add_f32 v181, v181, v179
    v_cvt_pk_bf16_f32 v173, v178, v179
    v_mfma_f32_32x32x16_bf16 v[96:111], a[28:31], v[92:95], v[96:111]
    ds_read_b128 a[60:63], v183 offset:15360
    v_exp_f32 v177, v125
    v_add_f32 v181, v181, v176
    s_waitcnt vmcnt(8)
    s_barrier
    s_waitcnt lgkmcnt(4)
    v_mfma_f32_32x32x16_bf16 v[0:15], a[32:35], v[160:163], v[0:15]
    ds_read_b128 a[0:3], v183 offset:49152
    v_exp_f32 v178, v126
    v_add_f32 v181, v181, v177
    v_cvt_pk_bf16_f32 v174, v176, v177
    v_mfma_f32_32x32x16_bf16 v[16:31], a[36:39], v[160:163], v[16:31]
    ds_read_b128 a[4:7], v183 offset:50176
    buffer_load_dwordx4 v240, s[8:11], s63 offen offset:2048 sc1 lds
    v_exp_f32 v179, v127
    v_add_f32 v181, v181, v178
    v_mfma_f32_32x32x16_bf16 v[32:47], a[40:43], v[160:163], v[32:47]
    ds_read_b128 a[8:11], v183 offset:51200
    v_exp_f32 v176, v96
    v_add_f32 v181, v181, v179
    v_cvt_pk_bf16_f32 v175, v178, v179
    v_mfma_f32_32x32x16_bf16 v[48:63], a[44:47], v[160:163], v[48:63]
    ds_read_b128 a[12:15], v183 offset:52224
    v_exp_f32 v177, v97
    v_cmp_lt_f32 vcc, s66, v181
    s_waitcnt lgkmcnt(4)
    v_mfma_f32_32x32x16_bf16 v[0:15], a[48:51], v[164:167], v[0:15]
    ds_read_b128 a[16:19], v183 offset:53248
    v_exp_f32 v178, v98
    v_add_f32 v180, v176, v177
    v_cvt_pk_bf16_f32 v160, v176, v177
    v_mfma_f32_32x32x16_bf16 v[16:31], a[52:55], v[164:167], v[16:31]
    ds_read_b128 a[20:23], v183 offset:54272
    buffer_load_dwordx4 v240, s[8:11], s63 offen offset:3072 sc1 lds
    v_exp_f32 v179, v99
    s_add_u32 s63, s63, 16384
    v_add_f32 v180, v180, v178
    v_mfma_f32_32x32x16_bf16 v[32:47], a[56:59], v[164:167], v[32:47]
    ds_read_b128 a[24:27], v183 offset:55296
    v_exp_f32 v176, v100
    s_add_u32 m0, m0, 16384
    v_add_f32 v180, v180, v179
    v_cvt_pk_bf16_f32 v161, v178, v179
    v_mfma_f32_32x32x16_bf16 v[48:63], a[60:63], v[164:167], v[48:63]
    ds_read_b128 a[28:31], v183 offset:56320
    v_exp_f32 v177, v101
    s_and_b32 m0, m0, 0x1ffff
    s_cmp_lt_u32 s63, s64
    s_cselect_b32 s63, s63, 0x40000000
    v_add_f32 v180, v180, v176
    s_cbranch_vccnz L_k2_site_117_s
L_k2_site_117_r:
    s_waitcnt lgkmcnt(4)
    v_mfma_f32_32x32x16_bf16 v[112:127], a[0:3], v[64:67], v[128:143]
    ds_read_b128 a[32:35], v183 offset:24576
    v_exp_f32 v178, v102
    v_add_f32 v180, v180, v177
    v_cvt_pk_bf16_f32 v162, v176, v177
    v_mfma_f32_32x32x16_bf16 v[112:127], a[4:7], v[68:71], v[112:127]
    ds_read_b128 a[36:39], v183 offset:25600
    buffer_load_dwordx4 v240, s[8:11], s63 offen offset:0 sc1 lds
    v_exp_f32 v179, v103
    v_add_f32 v180, v180, v178
    v_add_f32 v182, v182, v181
    v_mfma_f32_32x32x16_bf16 v[112:127], a[8:11], v[72:75], v[112:127]
    ds_read_b128 a[40:43], v183 offset:26624
    v_exp_f32 v176, v104
    v_add_f32 v180, v180, v179
    v_cvt_pk_bf16_f32 v163, v178, v179
    v_mfma_f32_32x32x16_bf16 v[112:127], a[12:15], v[76:79], v[112:127]
    ds_read_b128 a[44:47], v183 offset:27648
    v_exp_f32 v177, v105
    v_add_f32 v180, v180, v176
    s_waitcnt lgkmcnt(4)
    v_mfma_f32_32x32x16_bf16 v[112:127], a[16:19], v[80:83], v[112:127]
    ds_read_b128 a[48:51], v183 offset:28672
    v_exp_f32 v178, v106
    v_add_f32 v180, v180, v177
    v_cvt_pk_bf16_f32 v164, v176, v177
    v_mfma_f32_32x32x16_bf16 v[112:127], a[20:23], v[84:87], v[112:127]
    ds_read_b128 a[52:55], v183 offset:29696
    buffer_load_dwordx4 v240, s[8:11], s63 offen offset:1024 sc1 lds
    v_exp_f32 v179, v107
    v_add_f32 v180, v180, v178
    v_mfma_f32_32x32x16_bf16 v[112:127], a[24:27], v[88:91], v[112:127]
    ds_read_b128 a[56:59], v183 offset:30720
    v_exp_f32 v176, v108
    v_add_f32 v180, v180, v179
    v_cvt_pk_bf16_f32 v165, v178, v179
    v_mfma_f32_32x32x16_bf16 v[112:127], a[28:31], v[92:95], v[112:127]
    ds_read_b128 a[60:63], v183 offset:31744
    v_exp_f32 v177, v109
    v_add_f32 v180, v180, v176
    s_waitcnt lgkmcnt(4)
    v_mfma_f32_32x32x16_bf16 v[0:15], a[32:35], v[168:171], v[0:15]
    ds_read_b128 a[0:3], v184 offset:0
    v_exp_f32 v178, v110
    v_add_f32 v180, v180, v177
    v_cvt_pk_bf16_f32 v166, v176, v177
    v_mfma_f32_32x32x16_bf16 v[16:31], a[36:39], v[168:171], v[16:31]
    ds_read_b128 a[4:7], v184 offset:1024
    buffer_load_dwordx4 v240, s[8:11], s63 offen offset:2048 sc1 lds
    v_exp_f32 v179, v111
    v_add_f32 v180, v180, v178
    v_mfma_f32_32x32x16_bf16 v[32:47], a[40:43], v[168:171], v[32:47]
    ds_read_b128 a[8:11], v184 offset:2048
    v_exp_f32 v176, v112
    v_add_f32 v180, v180, v179
    v_cvt_pk_bf16_f32 v167, v178, v179
    v_mfma_f32_32x32x16_bf16 v[48:63], a[44:47], v[168:171], v[48:63]
    ds_read_b128 a[12:15], v184 offset:3072
    v_exp_f32 v177, v113
    v_cmp_lt_f32 vcc, s66, v180
    s_waitcnt lgkmcnt(4)
    v_mfma_f32_32x32x16_bf16 v[0:15], a[48:51], v[172:175], v[0:15]
    ds_read_b128 a[16:19], v184 offset:4096
    v_exp_f32 v178, v114
    v_add_f32 v181, v176, v177
    v_cvt_pk_bf16_f32 v168, v176, v177
    v_mfma_f32_32x32x16_bf16 v[16:31], a[52:55], v[172:175], v[16:31]
    ds_read_b128 a[20:23], v184 offset:5120
    buffer_load_dwordx4 v240, s[8:11], s63 offen offset:3072 sc1 lds
    v_exp_f32 v179, v115
    s_add_u32 s63, s63, 16384
    v_add_f32 v181, v181, v178
    v_mfma_f32_32x32x16_bf16 v[32:47], a[56:59], v[172:175], v[32:47]
    ds_read_b128 a[24:27], v184 offset:6144
    v_exp_f32 v176, v116
    s_add_u32 m0, m0, 16384
    v_add_f32 v181, v181, v179
    v_cvt_pk_bf16_f32 v169, v178, v179
    v_mfma_f32_32x32x16_bf16 v[48:63], a[60:63], v[172:175], v[48:63]
    ds_read_b128 a[28:31], v184 offset:7168
    v_exp_f32 v177, v117
    s_and_b32 m0, m0, 0x1ffff
    s_cmp_lt_u32 s63, s64
    s_cselect_b32 s63, s63, 0x40000000
    v_add_f32 v181, v181, v176
    v_swap_b32 v183, v184
    s_cbranch_vccnz L_k2_site_118_s
L_k2_site_118_r:
    s_sub_u32 s51, s51, 1
    s_cmp_lg_u32 s51, 0
    s_cbranch_scc1 L_k2_loop
L_k2_stail:
    s_cmp_lg_u32 s44, 0
    s_cbranch_scc1 L_ka_sf_ctx1
    s_lshl_b32 s55, s2, 7
    s_add_u32 s55, s55, 0x490000
    v_mov_b32 v254, s58
    s_mov_b64 exec, 1
    buffer_store_dword v254, v255, s[8:11], s55 offen offset:16 sc1
    s_mov_b64 exec, -1
L_ka_sf_ctx1:
    s_waitcnt lgkmcnt(4)
    s_cmp_gt_u32 s44, 0
    s_cbranch_scc1 L_k2_m_119
    v_mfma_f32_32x32x16_bf16 v[96:111], a[0:3], v[64:67], v[144:159]
    s_branch L_k2_m_120
L_k2_m_119:
    v_mfma_f32_32x32x16_bf16 v[96:111], a[0:3], v[64:67], v[128:143]
L_k2_m_120:
    ds_read_b128 a[32:35], v184 offset:40960
    v_exp_f32 v178, v118
    v_add_f32 v181, v181, v177
    v_cvt_pk_bf16_f32 v170, v176, v177
    v_mfma_f32_32x32x16_bf16 v[96:111], a[4:7], v[68:71], v[96:111]
    ds_read_b128 a[36:39], v184 offset:41984
    buffer_load_dwordx4 v240, s[8:11], s63 offen offset:0 sc1 lds
    v_exp_f32 v179, v119
    v_add_f32 v181, v181, v178
    v_add_f32 v182, v182, v180
    v_mfma_f32_32x32x16_bf16 v[96:111], a[8:11], v[72:75], v[96:111]
    ds_read_b128 a[40:43], v184 offset:43008
    buffer_load_dwordx4 a[168:171], v240, s[8:11], s59 offen offset:0 sc1
    v_exp_f32 v176, v120
    v_add_f32 v181, v181, v179
    v_cvt_pk_bf16_f32 v171, v178, v179
    v_mfma_f32_32x32x16_bf16 v[96:111], a[12:15], v[76:79], v[96:111]
    ds_read_b128 a[44:47], v184 offset:44032
    buffer_load_dwordx4 a[172:175], v240, s[8:11], s59 offen offset:1024 sc1
    v_exp_f32 v177, v121
    v_add_f32 v181, v181, v176
    s_waitcnt lgkmcnt(4)
    v_mfma_f32_32x32x16_bf16 v[96:111], a[16:19], v[80:83], v[96:111]
    ds_read_b128 a[48:51], v184 offset:45056
    v_exp_f32 v178, v122
    v_add_f32 v181, v181, v177
    v_cvt_pk_bf16_f32 v172, v176, v177
    v_mfma_f32_32x32x16_bf16 v[96:111], a[20:23], v[84:87], v[96:111]
    ds_read_b128 a[52:55], v184 offset:46080
    buffer_load_dwordx4 v240, s[8:11], s63 offen offset:1024 sc1 lds
    v_exp_f32 v179, v123
    v_add_f32 v181, v181, v178
    v_mfma_f32_32x32x16_bf16 v[96:111], a[24:27], v[88:91], v[96:111]
    ds_read_b128 a[56:59], v184 offset:47104
    buffer_load_dwordx4 a[176:179], v240, s[8:11], s59 offen offset:2048 sc1
    s_add_u32 s59, s59, 18432
    v_exp_f32 v176, v124
    v_add_f32 v181, v181, v179
    v_cvt_pk_bf16_f32 v173, v178, v179
    v_mfma_f32_32x32x16_bf16 v[96:111], a[28:31], v[92:95], v[96:111]
    ds_read_b128 a[60:63], v184 offset:48128
    v_exp_f32 v177, v125
    v_add_f32 v181, v181, v176
    s_waitcnt vmcnt(11)
    s_barrier
    s_waitcnt lgkmcnt(4)
    v_mfma_f32_32x32x16_bf16 v[0:15], a[32:35], v[160:163], v[0:15]
    ds_read_b128 a[0:3], v183 offset:16384
    buffer_load_dwordx4 a[180:183], v240, s[8:11], s59 offen offset:0 sc1
    v_exp_f32 v178, v126
    v_add_f32 v181, v181, v177
    v_cvt_pk_bf16_f32 v174, v176, v177
    v_mfma_f32_32x32x16_bf16 v[16:31], a[36:39], v[160:163], v[16:31]
    ds_read_b128 a[4:7], v183 offset:17408
    buffer_load_dwordx4 v240, s[8:11], s63 offen offset:2048 sc1 lds
    v_exp_f32 v179, v127
    v_add_f32 v181, v181, v178
    v_mfma_f32_32x32x16_bf16 v[32:47], a[40:43], v[160:163], v[32:47]
    ds_read_b128 a[8:11], v183 offset:18432
    v_exp_f32 v176, v96
    v_add_f32 v181, v181, v179
    v_cvt_pk_bf16_f32 v175, v178, v179
    v_mfma_f32_32x32x16_bf16 v[48:63], a[44:47], v[160:163], v[48:63]
    ds_read_b128 a[12:15], v183 offset:19456
    buffer_load_dwordx4 a[184:187], v240, s[8:11], s59 offen offset:1024 sc1
    v_exp_f32 v177, v97
    v_cmp_lt_f32 vcc, s66, v181
    s_waitcnt lgkmcnt(4)
    v_mfma_f32_32x32x16_bf16 v[0:15], a[48:51], v[164:167], v[0:15]
    ds_read_b128 a[16:19], v183 offset:20480
    v_exp_f32 v178, v98
    v_add_f32 v180, v176, v177
    v_cvt_pk_bf16_f32 v160, v176, v177
    v_mfma_f32_32x32x16_bf16 v[16:31], a[52:55], v[164:167], v[16:31]
    ds_read_b128 a[20:23], v183 offset:21504
    buffer_load_dwordx4 v240, s[8:11], s63 offen offset:3072 sc1 lds
    v_exp_f32 v179, v99
    s_add_u32 s63, s63, 16384
    v_add_f32 v180, v180, v178
    v_mfma_f32_32x32x16_bf16 v[32:47], a[56:59], v[164:167], v[32:47]
    ds_read_b128 a[24:27], v183 offset:22528
    v_exp_f32 v176, v100
    s_add_u32 m0, m0, 16384
    v_add_f32 v180, v180, v179
    v_cvt_pk_bf16_f32 v161, v178, v179
    v_mfma_f32_32x32x16_bf16 v[48:63], a[60:63], v[164:167], v[48:63]
    ds_read_b128 a[28:31], v183 offset:23552
    buffer_load_dwordx4 a[188:191], v240, s[8:11], s59 offen offset:2048 sc1
    s_add_u32 s59, s59, 18432
    v_exp_f32 v177, v101
    s_and_b32 m0, m0, 0x1ffff
    s_cmp_lt_u32 s63, s64
    s_cselect_b32 s63, s63, 0x40000000
    v_add_f32 v180, v180, v176
    s_cbranch_vccnz L_k2_site_121_s
L_k2_site_121_r:
    s_cmp_ge_u32 s44, 1
    s_cbranch_scc0 L_k2_vn_123
    s_waitcnt lgkmcnt(4)
    s_cmp_gt_u32 s44, 1
    s_cbranch_scc1 L_k2_m_124
    v_mfma_f32_32x32x16_bf16 v[112:127], a[0:3], v[64:67], v[144:159]
    s_branch L_k2_m_125
L_k2_m_124:
    v_mfma_f32_32x32x16_bf16 v[112:127], a[0:3], v[64:67], v[128:143]
L_k2_m_125:
    ds_read_b128 a[32:35], v184 offset:57344
    v_exp_f32 v178, v102
    v_add_f32 v180, v180, v177
    v_cvt_pk_bf16_f32 v162, v176, v177
    v_mfma_f32_32x32x16_bf16 v[112:127], a[4:7], v[68:71], v[112:127]
    ds_read_b128 a[36:39], v184 offset:58368
    buffer_load_dwordx4 v240, s[8:11], s63 offen offset:0 sc1 lds
    v_exp_f32 v179, v103
    v_add_f32 v180, v180, v178
    v_add_f32 v182, v182, v181
    v_mfma_f32_32x32x16_bf16 v[112:127], a[8:11], v[72:75], v[112:127]
    ds_read_b128 a[40:43], v184 offset:59392
    buffer_load_dwordx4 a[192:195], v240, s[8:11], s59 offen offset:0 sc1
    v_exp_f32 v176, v104
    v_add_f32 v180, v180, v179
    v_cvt_pk_bf16_f32 v163, v178, v179
    v_mfma_f32_32x32x16_bf16 v[112:127], a[12:15], v[76:79], v[112:127]
    ds_read_b128 a[44:47], v184 offset:60416
    buffer_load_dwordx4 a[196:199], v240, s[8:11], s59 offen offset:1024 sc1
    v_exp_f32 v177, v105
    v_add_f32 v180, v180, v176
    s_waitcnt lgkmcnt(4)
    v_mfma_f32_32x32x16_bf16 v[112:127], a[16:19], v[80:83], v[112:127]
    ds_read_b128 a[48:51], v184 offset:61440
    v_exp_f32 v178, v106
    v_add_f32 v180, v180, v177
    v_cvt_pk_bf16_f32 v164, v176, v177
    v_mfma_f32_32x32x16_bf16 v[112:127], a[20:23], v[84:87], v[112:127]
    ds_read_b128 a[52:55], v184 offset:62464
    buffer_load_dwordx4 v240, s[8:11], s63 offen offset:1024 sc1 lds
    v_exp_f32 v179, v107
    v_add_f32 v180, v180, v178
    v_mfma_f32_32x32x16_bf16 v[112:127], a[24:27], v[88:91], v[112:127]
    ds_read_b128 a[56:59], v184 offset:63488
    buffer_load_dwordx4 a[200:203], v240, s[8:11], s59 offen offset:2048 sc1
    s_add_u32 s59, s59, 18432
    v_exp_f32 v176, v108
    v_add_f32 v180, v180, v179
    v_cvt_pk_bf16_f32 v165, v178, v179
    v_mfma_f32_32x32x16_bf16 v[112:127], a[28:31], v[92:95], v[112:127]
    ds_read_b128 a[60:63], v184 offset:64512
    v_exp_f32 v177, v109
    v_add_f32 v180, v180, v176
    s_waitcnt lgkmcnt(4)
    v_mfma_f32_32x32x16_bf16 v[0:15], a[32:35], v[168:171], v[0:15]
    ds_read_b128 a[0:3], v183 offset:32768
    buffer_load_dwordx4 a[204:207], v240, s[8:11], s59 offen offset:0 sc1
    v_exp_f32 v178, v110
    v_add_f32 v180, v180, v177
    v_cvt_pk_bf16_f32 v166, v176, v177
    v_mfma_f32_32x32x16_bf16 v[16:31], a[36:39], v[168:171], v[16:31]
    ds_read_b128 a[4:7], v183 offset:33792
    buffer_load_dwordx4 v240, s[8:11], s63 offen offset:2048 sc1 lds
    v_exp_f32 v179, v111
    v_add_f32 v180, v180, v178
    v_mfma_f32_32x32x16_bf16 v[32:47], a[40:43], v[168:171], v[32:47]
    ds_read_b128 a[8:11], v183 offset:34816
    v_exp_f32 v176, v112
    v_add_f32 v180, v180, v179
    v_cvt_pk_bf16_f32 v167, v178, v179
    v_mfma_f32_32x32x16_bf16 v[48:63], a[44:47], v[168:171], v[48:63]
    ds_read_b128 a[12:15], v183 offset:35840
    buffer_load_dwordx4 a[208:211], v240, s[8:11], s59 offen offset:1024 sc1
    v_exp_f32 v177, v113
    v_cmp_lt_f32 vcc, s66, v180
    s_waitcnt lgkmcnt(4)
    v_mfma_f32_32x32x16_bf16 v[0:15], a[48:51], v[172:175], v[0:15]
    ds_read_b128 a[16:19], v183 offset:36864
    v_exp_f32 v178, v114
    v_add_f32 v181, v176, v177
    v_cvt_pk_bf16_f32 v168, v176, v177
    v_mfma_f32_32x32x16_bf16 v[16:31], a[52:55], v[172:175], v[16:31]
    ds_read_b128 a[20:23], v183 offset:37888
    buffer_load_dwordx4 v240, s[8:11], s63 offen offset:3072 sc1 lds
    v_exp_f32 v179, v115
    s_add_u32 s63, s63, 16384
    v_add_f32 v181, v181, v178
    v_mfma_f32_32x32x16_bf16 v[32:47], a[56:59], v[172:175], v[32:47]
    ds_read_b128 a[24:27], v183 offset:38912
    v_exp_f32 v176, v116
    s_add_u32 m0, m0, 16384
    v_add_f32 v181, v181, v179
    v_cvt_pk_bf16_f32 v169, v178, v179
    v_mfma_f32_32x32x16_bf16 v[48:63], a[60:63], v[172:175], v[48:63]
    ds_read_b128 a[28:31], v183 offset:39936
    buffer_load_dwordx4 a[212:215], v240, s[8:11], s59 offen offset:2048 sc1
    s_add_u32 s59, s59, 18432
    v_exp_f32 v177, v117
    s_and_b32 m0, m0, 0x1ffff
    s_cmp_lt_u32 s63, s64
    s_cselect_b32 s63, s63, 0x40000000
    v_add_f32 v181, v181, v176
    s_cbranch_vccnz L_k2_site_126_s
L_k2_site_126_r:
    s_branch L_k2_ve_122
L_k2_vn_123:
    ds_read_b128 a[32:35], v184 offset:57344
    v_exp_f32 v178, v102
    v_add_f32 v180, v180, v177
    v_cvt_pk_bf16_f32 v162, v176, v177
    ds_read_b128 a[36:39], v184 offset:58368
    buffer_load_dwordx4 v240, s[8:11], s63 offen offset:0 sc1 lds
    v_exp_f32 v179, v103
    v_add_f32 v180, v180, v178
    v_add_f32 v182, v182, v181
    ds_read_b128 a[40:43], v184 offset:59392
    buffer_load_dwordx4 a[192:195], v240, s[8:11], s59 offen offset:0 sc1
    v_exp_f32 v176, v104
    v_add_f32 v180, v180, v179
    v_cvt_pk_bf16_f32 v163, v178, v179
    ds_read_b128 a[44:47], v184 offset:60416
    buffer_load_dwordx4 a[196:199], v240, s[8:11], s59 offen offset:1024 sc1
    v_exp_f32 v177, v105
    v_add_f32 v180, v180, v176
    ds_read_b128 a[48:51], v184 offset:61440
    v_exp_f32 v178, v106
    v_add_f32 v180, v180, v177
    v_cvt_pk_bf16_f32 v164, v176, v177
    ds_read_b128 a[52:55], v184 offset:62464
    buffer_load_dwordx4 v240, s[8:11], s63 offen offset:1024 sc1 lds
    v_exp_f32 v179, v107
    v_add_f32 v180, v180, v178
    ds_read_b128 a[56:59], v184 offset:63488
    buffer_load_dwordx4 a[200:203], v240, s[8:11], s59 offen offset:2048 sc1
    s_add_u32 s59, s59, 18432
    v_exp_f32 v176, v108
    v_add_f32 v180, v180, v179
    v_cvt_pk_bf16_f32 v165, v178, v179
    ds_read_b128 a[60:63], v184 offset:64512
    v_exp_f32 v177, v109
    v_add_f32 v180, v180, v176
    s_waitcnt lgkmcnt(4)
    v_mfma_f32_32x32x16_bf16 v[0:15], a[32:35], v[168:171], v[0:15]
    buffer_load_dwordx4 a[204:207], v240, s[8:11], s59 offen offset:0 sc1
    v_exp_f32 v178, v110
    v_add_f32 v180, v180, v177
    v_cvt_pk_bf16_f32 v166, v176, v177
    v_mfma_f32_32x32x16_bf16 v[16:31], a[36:39], v[168:171], v[16:31]
    buffer_load_dwordx4 v240, s[8:11], s63 offen offset:2048 sc1 lds
    v_exp_f32 v179, v111
    v_add_f32 v180, v180, v178
    v_mfma_f32_32x32x16_bf16 v[32:47], a[40:43], v[168:171], v[32:47]
    v_add_f32 v180, v180, v179
    v_cvt_pk_bf16_f32 v167, v178, v179
    v_mfma_f32_32x32x16_bf16 v[48:63], a[44:47], v[168:171], v[48:63]
    buffer_load_dwordx4 a[208:211], v240, s[8:11], s59 offen offset:1024 sc1
    v_cmp_lt_f32 vcc, s66, v180
    s_waitcnt lgkmcnt(0)
    v_mfma_f32_32x32x16_bf16 v[0:15], a[48:51], v[172:175], v[0:15]
    v_mfma_f32_32x32x16_bf16 v[16:31], a[52:55], v[172:175], v[16:31]
    buffer_load_dwordx4 v240, s[8:11], s63 offen offset:3072 sc1 lds
    s_add_u32 s63, s63, 16384
    v_mfma_f32_32x32x16_bf16 v[32:47], a[56:59], v[172:175], v[32:47]
    s_add_u32 m0, m0, 16384
    v_mfma_f32_32x32x16_bf16 v[48:63], a[60:63], v[172:175], v[48:63]
    buffer_load_dwordx4 a[212:215], v240, s[8:11], s59 offen offset:2048 sc1
    s_add_u32 s59, s59, 18432
    s_and_b32 m0, m0, 0x1ffff
    s_cmp_lt_u32 s63, s64
    s_cselect_b32 s63, s63, 0x40000000
    s_cbranch_vccnz L_k2_site_127_s
L_k2_site_127_r:
L_k2_ve_122:
    s_cmp_ge_u32 s44, 2
    s_cbranch_scc0 L_k2_vn_129
    s_waitcnt lgkmcnt(4)
    s_cmp_gt_u32 s44, 2
    s_cbranch_scc1 L_k2_m_130
    v_mfma_f32_32x32x16_bf16 v[96:111], a[0:3], v[64:67], v[144:159]
    s_branch L_k2_m_131
L_k2_m_130:
    v_mfma_f32_32x32x16_bf16 v[96:111], a[0:3], v[64:67], v[128:143]
L_k2_m_131:
    ds_read_b128 a[32:35], v183 offset:8192
    v_exp_f32 v178, v118
    v_add_f32 v181, v181, v177
    v_cvt_pk_bf16_f32 v170, v176, v177
    v_mfma_f32_32x32x16_bf16 v[96:111], a[4:7], v[68:71], v[96:111]
    ds_read_b128 a[36:39], v183 offset:9216
    buffer_load_dwordx4 v240, s[8:11], s63 offen offset:0 sc1 lds
    v_exp_f32 v179, v119
    v_add_f32 v181, v181, v178
    v_add_f32 v182, v182, v180
    v_mfma_f32_32x32x16_bf16 v[96:111], a[8:11], v[72:75], v[96:111]
    ds_read_b128 a[40:43], v183 offset:10240
    buffer_load_dwordx4 a[216:219], v240, s[8:11], s59 offen offset:0 sc1
    v_exp_f32 v176, v120
    v_add_f32 v181, v181, v179
    v_cvt_pk_bf16_f32 v171, v178, v179
    v_mfma_f32_32x32x16_bf16 v[96:111], a[12:15], v[76:79], v[96:111]
    ds_read_b128 a[44:47], v183 offset:11264
    buffer_load_dwordx4 a[220:223], v240, s[8:11], s59 offen offset:1024 sc1
    v_exp_f32 v177, v121
    v_add_f32 v181, v181, v176
    s_waitcnt lgkmcnt(4)
    v_mfma_f32_32x32x16_bf16 v[96:111], a[16:19], v[80:83], v[96:111]
    ds_read_b128 a[48:51], v183 offset:12288
    v_exp_f32 v178, v122
    v_add_f32 v181, v181, v177
    v_cvt_pk_bf16_f32 v172, v176, v177
    v_mfma_f32_32x32x16_bf16 v[96:111], a[20:23], v[84:87], v[96:111]
    ds_read_b128 a[52:55], v183 offset:13312
    buffer_load_dwordx4 v240, s[8:11], s63 offen offset:1024 sc1 lds
    v_exp_f32 v179, v123
    v_add_f32 v181, v181, v178
    v_mfma_f32_32x32x16_bf16 v[96:111], a[24:27], v[88:91], v[96:111]
    ds_read_b128 a[56:59], v183 offset:14336
    buffer_load_dwordx4 a[224:227], v240, s[8:11], s59 offen offset:2048 sc1
    s_add_u32 s59, s59, 18432
    v_exp_f32 v176, v124
    v_add_f32 v181, v181, v179
    v_cvt_pk_bf16_f32 v173, v178, v179
    v_mfma_f32_32x32x16_bf16 v[96:111], a[28:31], v[92:95], v[96:111]
    ds_read_b128 a[60:63], v183 offset:15360
    v_exp_f32 v177, v125
    v_add_f32 v181, v181, v176
    s_waitcnt vmcnt(20)
    s_barrier
    s_waitcnt lgkmcnt(4)
    v_mfma_f32_32x32x16_bf16 v[0:15], a[32:35], v[160:163], v[0:15]
    ds_read_b128 a[0:3], v183 offset:49152
    buffer_load_dwordx4 a[228:231], v240, s[8:11], s59 offen offset:0 sc1
    v_exp_f32 v178, v126
    v_add_f32 v181, v181, v177
    v_cvt_pk_bf16_f32 v174, v176, v177
    v_mfma_f32_32x32x16_bf16 v[16:31], a[36:39], v[160:163], v[16:31]
    ds_read_b128 a[4:7], v183 offset:50176
    buffer_load_dwordx4 v240, s[8:11], s63 offen offset:2048 sc1 lds
    v_exp_f32 v179, v127
    v_add_f32 v181, v181, v178
    v_mfma_f32_32x32x16_bf16 v[32:47], a[40:43], v[160:163], v[32:47]
    ds_read_b128 a[8:11], v183 offset:51200
    v_exp_f32 v176, v96
    v_add_f32 v181, v181, v179
    v_cvt_pk_bf16_f32 v175, v178, v179
    v_mfma_f32_32x32x16_bf16 v[48:63], a[44:47], v[160:163], v[48:63]
    ds_read_b128 a[12:15], v183 offset:52224
    buffer_load_dwordx4 a[232:235], v240, s[8:11], s59 offen offset:1024 sc1
    v_exp_f32 v177, v97
    v_cmp_lt_f32 vcc, s66, v181
    s_waitcnt lgkmcnt(4)
    v_mfma_f32_32x32x16_bf16 v[0:15], a[48:51], v[164:167], v[0:15]
    ds_read_b128 a[16:19], v183 offset:53248
    v_exp_f32 v178, v98
    v_add_f32 v180, v176, v177
    v_cvt_pk_bf16_f32 v160, v176, v177
    v_mfma_f32_32x32x16_bf16 v[16:31], a[52:55], v[164:167], v[16:31]
    ds_read_b128 a[20:23], v183 offset:54272
    buffer_load_dwordx4 v240, s[8:11], s63 offen offset:3072 sc1 lds
    v_exp_f32 v179, v99
    s_add_u32 s63, s63, 16384
    v_add_f32 v180, v180, v178
    v_mfma_f32_32x32x16_bf16 v[32:47], a[56:59], v[164:167], v[32:47]
    ds_read_b128 a[24:27], v183 offset:55296
    v_exp_f32 v176, v100
    s_add_u32 m0, m0, 16384
    v_add_f32 v180, v180, v179
    v_cvt_pk_bf16_f32 v161, v178, v179
    v_mfma_f32_32x32x16_bf16 v[48:63], a[60:63], v[164:167], v[48:63]
    ds_read_b128 a[28:31], v183 offset:56320
    buffer_load_dwordx4 a[236:239], v240, s[8:11], s59 offen offset:2048 sc1
    s_add_u32 s59, s59, 18432
    v_exp_f32 v177, v101
    s_and_b32 m0, m0, 0x1ffff
    s_cmp_lt_u32 s63, s64
    s_cselect_b32 s63, s63, 0x40000000
    v_add_f32 v180, v180, v176
    s_cbranch_vccnz L_k2_site_132_s
L_k2_site_132_r:
    s_branch L_k2_ve_128
L_k2_vn_129:
    s_cmp_ge_u32 s44, 1
    s_cbranch_scc0 L_k2_vn_133
    ds_read_b128 a[32:35], v183 offset:8192
    v_exp_f32 v178, v118
    v_add_f32 v181, v181, v177
    v_cvt_pk_bf16_f32 v170, v176, v177
    ds_read_b128 a[36:39], v183 offset:9216
    buffer_load_dwordx4 v240, s[8:11], s63 offen offset:0 sc1 lds
    v_exp_f32 v179, v119
    v_add_f32 v181, v181, v178
    v_add_f32 v182, v182, v180
    ds_read_b128 a[40:43], v183 offset:10240
    buffer_load_dwordx4 a[216:219], v240, s[8:11], s59 offen offset:0 sc1
    v_exp_f32 v176, v120
    v_add_f32 v181, v181, v179
    v_cvt_pk_bf16_f32 v171, v178, v179
    ds_read_b128 a[44:47], v183 offset:11264
    buffer_load_dwordx4 a[220:223], v240, s[8:11], s59 offen offset:1024 sc1
    v_exp_f32 v177, v121
    v_add_f32 v181, v181, v176
    ds_read_b128 a[48:51], v183 offset:12288
    v_exp_f32 v178, v122
    v_add_f32 v181, v181, v177
    v_cvt_pk_bf16_f32 v172, v176, v177
    ds_read_b128 a[52:55], v183 offset:13312
    buffer_load_dwordx4 v240, s[8:11], s63 offen offset:1024 sc1 lds
    v_exp_f32 v179, v123
    v_add_f32 v181, v181, v178
    ds_read_b128 a[56:59], v183 offset:14336
    buffer_load_dwordx4 a[224:227], v240, s[8:11], s59 offen offset:2048 sc1
    s_add_u32 s59, s59, 18432
    v_exp_f32 v176, v124
    v_add_f32 v181, v181, v179
    v_cvt_pk_bf16_f32 v173, v178, v179
    ds_read_b128 a[60:63], v183 offset:15360
    v_exp_f32 v177, v125
    v_add_f32 v181, v181, v176
    s_waitcnt vmcnt(20)
    s_barrier
    s_waitcnt lgkmcnt(4)
    v_mfma_f32_32x32x16_bf16 v[0:15], a[32:35], v[160:163], v[0:15]
    buffer_load_dwordx4 a[228:231], v240, s[8:11], s59 offen offset:0 sc1
    v_exp_f32 v178, v126
    v_add_f32 v181, v181, v177
    v_cvt_pk_bf16_f32 v174, v176, v177
    v_mfma_f32_32x32x16_bf16 v[16:31], a[36:39], v[160:163], v[16:31]
    buffer_load_dwordx4 v240, s[8:11], s63 offen offset:2048 sc1 lds
    v_exp_f32 v179, v127
    v_add_f32 v181, v181, v178
    v_mfma_f32_32x32x16_bf16 v[32:47], a[40:43], v[160:163], v[32:47]
    v_add_f32 v181, v181, v179
    v_cvt_pk_bf16_f32 v175, v178, v179
    v_mfma_f32_32x32x16_bf16 v[48:63], a[44:47], v[160:163], v[48:63]
    buffer_load_dwordx4 a[232:235], v240, s[8:11], s59 offen offset:1024 sc1
    v_cmp_lt_f32 vcc, s66, v181
    s_waitcnt lgkmcnt(0)
    v_mfma_f32_32x32x16_bf16 v[0:15], a[48:51], v[164:167], v[0:15]
    v_mfma_f32_32x32x16_bf16 v[16:31], a[52:55], v[164:167], v[16:31]
    buffer_load_dwordx4 v240, s[8:11], s63 offen offset:3072 sc1 lds
    s_add_u32 s63, s63, 16384
    v_mfma_f32_32x32x16_bf16 v[32:47], a[56:59], v[164:167], v[32:47]
    s_add_u32 m0, m0, 16384
    v_mfma_f32_32x32x16_bf16 v[48:63], a[60:63], v[164:167], v[48:63]
    buffer_load_dwordx4 a[236:239], v240, s[8:11], s59 offen offset:2048 sc1
    s_add_u32 s59, s59, 18432
    s_and_b32 m0, m0, 0x1ffff
    s_cmp_lt_u32 s63, s64
    s_cselect_b32 s63, s63, 0x40000000
    s_cbranch_vccnz L_k2_site_134_s
L_k2_site_134_r:
    s_branch L_k2_ve_128
L_k2_vn_133:
    ds_read_b128 a[32:35], v183 offset:8192
    ds_read_b128 a[36:39], v183 offset:9216
    buffer_load_dwordx4 v240, s[8:11], s63 offen offset:0 sc1 lds
    v_add_f32 v182, v182, v180
    ds_read_b128 a[40:43], v183 offset:10240
    buffer_load_dwordx4 a[216:219], v240, s[8:11], s59 offen offset:0 sc1
    ds_read_b128 a[44:47], v183 offset:11264
    buffer_load_dwordx4 a[220:223], v240, s[8:11], s59 offen offset:1024 sc1
    ds_read_b128 a[48:51], v183 offset:12288
    ds_read_b128 a[52:55], v183 offset:13312
    buffer_load_dwordx4 v240, s[8:11], s63 offen offset:1024 sc1 lds
    ds_read_b128 a[56:59], v183 offset:14336
    buffer_load_dwordx4 a[224:227], v240, s[8:11], s59 offen offset:2048 sc1
    s_add_u32 s59, s59, 18432
    ds_read_b128 a[60:63], v183 offset:15360
    s_waitcnt vmcnt(20)
    s_barrier
    s_waitcnt lgkmcnt(4)
    v_mfma_f32_32x32x16_bf16 v[0:15], a[32:35], v[160:163], v[0:15]
    buffer_load_dwordx4 a[228:231], v240, s[8:11], s59 offen offset:0 sc1
    v_mfma_f32_32x32x16_bf16 v[16:31], a[36:39], v[160:163], v[16:31]
    buffer_load_dwordx4 v240, s[8:11], s63 offen offset:2048 sc1 lds
    v_mfma_f32_32x32x16_bf16 v[32:47], a[40:43], v[160:163], v[32:47]
    v_mfma_f32_32x32x16_bf16 v[48:63], a[44:47], v[160:163], v[48:63]
    buffer_load_dwordx4 a[232:235], v240, s[8:11], s59 offen offset:1024 sc1
    s_waitcnt lgkmcnt(0)
    v_mfma_f32_32x32x16_bf16 v[0:15], a[48:51], v[164:167], v[0:15]
    v_mfma_f32_32x32x16_bf16 v[16:31], a[52:55], v[164:167], v[16:31]
    buffer_load_dwordx4 v240, s[8:11], s63 offen offset:3072 sc1 lds
    s_add_u32 s63, s63, 16384
    v_mfma_f32_32x32x16_bf16 v[32:47], a[56:59], v[164:167], v[32:47]
    s_add_u32 m0, m0, 16384
    v_mfma_f32_32x32x16_bf16 v[48:63], a[60:63], v[164:167], v[48:63]
    buffer_load_dwordx4 a[236:239], v240, s[8:11], s59 offen offset:2048 sc1
    s_add_u32 s59, s59, 18432
    s_and_b32 m0, m0, 0x1ffff
    s_cmp_lt_u32 s63, s64
    s_cselect_b32 s63, s63, 0x40000000
L_k2_ve_128:
    s_cmp_ge_u32 s44, 3
    s_cbranch_scc0 L_k2_vn_136
    s_waitcnt lgkmcnt(4)
    v_mfma_f32_32x32x16_bf16 v[112:127], a[0:3], v[64:67], v[144:159]
    ds_read_b128 a[32:35], v183 offset:24576
    v_exp_f32 v178, v102
    v_add_f32 v180, v180, v177
    v_cvt_pk_bf16_f32 v162, v176, v177
    v_mfma_f32_32x32x16_bf16 v[112:127], a[4:7], v[68:71], v[112:127]
    ds_read_b128 a[36:39], v183 offset:25600
    buffer_load_dwordx4 v240, s[8:11], s63 offen offset:0 sc1 lds
    v_exp_f32 v179, v103
    v_add_f32 v180, v180, v178
    v_add_f32 v182, v182, v181
    v_mfma_f32_32x32x16_bf16 v[112:127], a[8:11], v[72:75], v[112:127]
    ds_read_b128 a[40:43], v183 offset:26624
    buffer_load_dwordx4 a[240:243], v240, s[8:11], s59 offen offset:0 sc1
    v_exp_f32 v176, v104
    v_add_f32 v180, v180, v179
    v_cvt_pk_bf16_f32 v163, v178, v179
    v_mfma_f32_32x32x16_bf16 v[112:127], a[12:15], v[76:79], v[112:127]
    ds_read_b128 a[44:47], v183 offset:27648
    buffer_load_dwordx4 a[244:247], v240, s[8:11], s59 offen offset:1024 sc1
    v_exp_f32 v177, v105
    v_add_f32 v180, v180, v176
    s_waitcnt lgkmcnt(4)
    v_mfma_f32_32x32x16_bf16 v[112:127], a[16:19], v[80:83], v[112:127]
    ds_read_b128 a[48:51], v183 offset:28672
    v_exp_f32 v178, v106
    v_add_f32 v180, v180, v177
    v_cvt_pk_bf16_f32 v164, v176, v177
    v_mfma_f32_32x32x16_bf16 v[112:127], a[20:23], v[84:87], v[112:127]
    ds_read_b128 a[52:55], v183 offset:29696
    buffer_load_dwordx4 v240, s[8:11], s63 offen offset:1024 sc1 lds
    v_exp_f32 v179, v107
    v_add_f32 v180, v180, v178
    v_mfma_f32_32x32x16_bf16 v[112:127], a[24:27], v[88:91], v[112:127]
    ds_read_b128 a[56:59], v183 offset:30720
    buffer_load_dwordx4 a[248:251], v240, s[8:11], s59 offen offset:2048 sc1
    s_add_u32 s59, s59, 18432
    v_exp_f32 v176, v108
    v_add_f32 v180, v180, v179
    v_cvt_pk_bf16_f32 v165, v178, v179
    v_mfma_f32_32x32x16_bf16 v[112:127], a[28:31], v[92:95], v[112:127]
    ds_read_b128 a[60:63], v183 offset:31744
    v_exp_f32 v177, v109
    v_add_f32 v180, v180, v176
    s_waitcnt lgkmcnt(4)
    v_mfma_f32_32x32x16_bf16 v[0:15], a[32:35], v[168:171], v[0:15]
    ds_read_b128 a[0:3], v184 offset:0
    v_exp_f32 v178, v110
    v_add_f32 v180, v180, v177
    v_cvt_pk_bf16_f32 v166, v176, v177
    v_mfma_f32_32x32x16_bf16 v[16:31], a[36:39], v[168:171], v[16:31]
    ds_read_b128 a[4:7], v184 offset:1024
    buffer_load_dwordx4 v240, s[8:11], s63 offen offset:2048 sc1 lds
    v_exp_f32 v179, v111
    v_add_f32 v180, v180, v178
    v_mfma_f32_32x32x16_bf16 v[32:47], a[40:43], v[168:171], v[32:47]
    ds_read_b128 a[8:11], v184 offset:2048
    v_exp_f32 v176, v112
    v_add_f32 v180, v180, v179
    v_cvt_pk_bf16_f32 v167, v178, v179
    v_mfma_f32_32x32x16_bf16 v[48:63], a[44:47], v[168:171], v[48:63]
    ds_read_b128 a[12:15], v184 offset:3072
    v_exp_f32 v177, v113
    v_cmp_lt_f32 vcc, s66, v180
    s_waitcnt lgkmcnt(4)
    v_mfma_f32_32x32x16_bf16 v[0:15], a[48:51], v[172:175], v[0:15]
    ds_read_b128 a[16:19], v184 offset:4096
    v_exp_f32 v178, v114
    v_add_f32 v181, v176, v177
    v_cvt_pk_bf16_f32 v168, v176, v177
    v_mfma_f32_32x32x16_bf16 v[16:31], a[52:55], v[172:175], v[16:31]
    ds_read_b128 a[20:23], v184 offset:5120
    buffer_load_dwordx4 v240, s[8:11], s63 offen offset:3072 sc1 lds
    v_exp_f32 v179, v115
    s_add_u32 s63, s63, 16384
    v_add_f32 v181, v181, v178
    v_mfma_f32_32x32x16_bf16 v[32:47], a[56:59], v[172:175], v[32:47]
    ds_read_b128 a[24:27], v184 offset:6144
    v_exp_f32 v176, v116
    s_add_u32 m0, m0, 16384
    v_add_f32 v181, v181, v179
    v_cvt_pk_bf16_f32 v169, v178, v179
    v_mfma_f32_32x32x16_bf16 v[48:63], a[60:63], v[172:175], v[48:63]
    ds_read_b128 a[28:31], v184 offset:7168
    v_exp_f32 v177, v117
    s_and_b32 m0, m0, 0x1ffff
    s_cmp_lt_u32 s63, s64
    s_cselect_b32 s63, s63, 0x40000000
    v_add_f32 v181, v181, v176
    v_swap_b32 v183, v184
    s_cbranch_vccnz L_k2_site_137_s
L_k2_site_137_r:
    s_branch L_k2_ve_135
L_k2_vn_136:
    s_cmp_ge_u32 s44, 2
    s_cbranch_scc0 L_k2_vn_138
    ds_read_b128 a[32:35], v183 offset:24576
    v_exp_f32 v178, v102
    v_add_f32 v180, v180, v177
    v_cvt_pk_bf16_f32 v162, v176, v177
    ds_read_b128 a[36:39], v183 offset:25600
    buffer_load_dwordx4 v240, s[8:11], s63 offen offset:0 sc1 lds
    v_exp_f32 v179, v103
    v_add_f32 v180, v180, v178
    v_add_f32 v182, v182, v181
    ds_read_b128 a[40:43], v183 offset:26624
    buffer_load_dwordx4 a[240:243], v240, s[8:11], s59 offen offset:0 sc1
    v_exp_f32 v176, v104
    v_add_f32 v180, v180, v179
    v_cvt_pk_bf16_f32 v163, v178, v179
    ds_read_b128 a[44:47], v183 offset:27648
    buffer_load_dwordx4 a[244:247], v240, s[8:11], s59 offen offset:1024 sc1
    v_exp_f32 v177, v105
    v_add_f32 v180, v180, v176
    ds_read_b128 a[48:51], v183 offset:28672
    v_exp_f32 v178, v106
    v_add_f32 v180, v180, v177
    v_cvt_pk_bf16_f32 v164, v176, v177
    ds_read_b128 a[52:55], v183 offset:29696
    buffer_load_dwordx4 v240, s[8:11], s63 offen offset:1024 sc1 lds
    v_exp_f32 v179, v107
    v_add_f32 v180, v180, v178
    ds_read_b128 a[56:59], v183 offset:30720
    buffer_load_dwordx4 a[248:251], v240, s[8:11], s59 offen offset:2048 sc1
    s_add_u32 s59, s59, 18432
    v_exp_f32 v176, v108
    v_add_f32 v180, v180, v179
    v_cvt_pk_bf16_f32 v165, v178, v179
    ds_read_b128 a[60:63], v183 offset:31744
    v_exp_f32 v177, v109
    v_add_f32 v180, v180, v176
    s_waitcnt lgkmcnt(4)
    v_mfma_f32_32x32x16_bf16 v[0:15], a[32:35], v[168:171], v[0:15]
    v_exp_f32 v178, v110
    v_add_f32 v180, v180, v177
    v_cvt_pk_bf16_f32 v166, v176, v177
    v_mfma_f32_32x32x16_bf16 v[16:31], a[36:39], v[168:171], v[16:31]
    buffer_load_dwordx4 v240, s[8:11], s63 offen offset:2048 sc1 lds
    v_exp_f32 v179, v111
    v_add_f32 v180, v180, v178
    v_mfma_f32_32x32x16_bf16 v[32:47], a[40:43], v[168:171], v[32:47]
    v_add_f32 v180, v180, v179
    v_cvt_pk_bf16_f32 v167, v178, v179
    v_mfma_f32_32x32x16_bf16 v[48:63], a[44:47], v[168:171], v[48:63]
    v_cmp_lt_f32 vcc, s66, v180
    s_waitcnt lgkmcnt(0)
    v_mfma_f32_32x32x16_bf16 v[0:15], a[48:51], v[172:175], v[0:15]
    v_mfma_f32_32x32x16_bf16 v[16:31], a[52:55], v[172:175], v[16:31]
    buffer_load_dwordx4 v240, s[8:11], s63 offen offset:3072 sc1 lds
    s_add_u32 s63, s63, 16384
    v_mfma_f32_32x32x16_bf16 v[32:47], a[56:59], v[172:175], v[32:47]
    s_add_u32 m0, m0, 16384
    v_mfma_f32_32x32x16_bf16 v[48:63], a[60:63], v[172:175], v[48:63]
    s_and_b32 m0, m0, 0x1ffff
    s_cmp_lt_u32 s63, s64
    s_cselect_b32 s63, s63, 0x40000000
    v_swap_b32 v183, v184
    s_cbranch_vccnz L_k2_site_139_s
L_k2_site_139_r:
    s_branch L_k2_ve_135
L_k2_vn_138:
    s_cmp_ge_u32 s44, 1
    s_cbranch_scc0 L_k2_vn_140
    ds_read_b128 a[32:35], v183 offset:24576
    ds_read_b128 a[36:39], v183 offset:25600
    buffer_load_dwordx4 v240, s[8:11], s63 offen offset:0 sc1 lds
    v_add_f32 v182, v182, v181
    ds_read_b128 a[40:43], v183 offset:26624
    buffer_load_dwordx4 a[240:243], v240, s[8:11], s59 offen offset:0 sc1
    ds_read_b128 a[44:47], v183 offset:27648
    buffer_load_dwordx4 a[244:247], v240, s[8:11], s59 offen offset:1024 sc1
    ds_read_b128 a[48:51], v183 offset:28672
    ds_read_b128 a[52:55], v183 offset:29696
    buffer_load_dwordx4 v240, s[8:11], s63 offen offset:1024 sc1 lds
    ds_read_b128 a[56:59], v183 offset:30720
    buffer_load_dwordx4 a[248:251], v240, s[8:11], s59 offen offset:2048 sc1
    s_add_u32 s59, s59, 18432
    ds_read_b128 a[60:63], v183 offset:31744
    s_waitcnt lgkmcnt(4)
    v_mfma_f32_32x32x16_bf16 v[0:15], a[32:35], v[168:171], v[0:15]
    v_mfma_f32_32x32x16_bf16 v[16:31], a[36:39], v[168:171], v[16:31]
    buffer_load_dwordx4 v240, s[8:11], s63 offen offset:2048 sc1 lds
    v_mfma_f32_32x32x16_bf16 v[32:47], a[40:43], v[168:171], v[32:47]
    v_mfma_f32_32x32x16_bf16 v[48:63], a[44:47], v[168:171], v[48:63]
    s_waitcnt lgkmcnt(0)
    v_mfma_f32_32x32x16_bf16 v[0:15], a[48:51], v[172:175], v[0:15]
    v_mfma_f32_32x32x16_bf16 v[16:31], a[52:55], v[172:175], v[16:31]
    buffer_load_dwordx4 v240, s[8:11], s63 offen offset:3072 sc1 lds
    s_add_u32 s63, s63, 16384
    v_mfma_f32_32x32x16_bf16 v[32:47], a[56:59], v[172:175], v[32:47]
    s_add_u32 m0, m0, 16384
    v_mfma_f32_32x32x16_bf16 v[48:63], a[60:63], v[172:175], v[48:63]
    s_and_b32 m0, m0, 0x1ffff
    s_cmp_lt_u32 s63, s64
    s_cselect_b32 s63, s63, 0x40000000
    v_swap_b32 v183, v184
    s_branch L_k2_ve_135
L_k2_vn_140:
    buffer_load_dwordx4 v240, s[8:11], s63 offen offset:0 sc1 lds
    buffer_load_dwordx4 a[240:243], v240, s[8:11], s59 offen offset:0 sc1
    buffer_load_dwordx4 a[244:247], v240, s[8:11], s59 offen offset:1024 sc1
    buffer_load_dwordx4 v240, s[8:11], s63 offen offset:1024 sc1 lds
    buffer_load_dwordx4 a[248:251], v240, s[8:11], s59 offen offset:2048 sc1
    s_add_u32 s59, s59, 18432
    buffer_load_dwordx4 v240, s[8:11], s63 offen offset:2048 sc1 lds
    buffer_load_dwordx4 v240, s[8:11], s63 offen offset:3072 sc1 lds
    s_add_u32 s63, s63, 16384
    s_add_u32 m0, m0, 16384
    s_and_b32 m0, m0, 0x1ffff
    s_cmp_lt_u32 s63, s64
    s_cselect_b32 s63, s63, 0x40000000
    v_swap_b32 v183, v184
L_k2_ve_135:
L_k2_drain2:
    s_cmp_lt_u32 s44, 2
    s_cbranch_scc1 L_k2_epi
    s_cmp_eq_u32 s44, 3
    s_cbranch_scc1 L_k2_dr3
    ds_read_b128 a[32:35], v184 offset:40960
    ds_read_b128 a[36:39], v184 offset:41984
    v_add_f32 v182, v182, v180
    ds_read_b128 a[40:43], v184 offset:43008
    ds_read_b128 a[44:47], v184 offset:44032
    ds_read_b128 a[48:51], v184 offset:45056
    ds_read_b128 a[52:55], v184 offset:46080
    ds_read_b128 a[56:59], v184 offset:47104
    ds_read_b128 a[60:63], v184 offset:48128
    s_waitcnt lgkmcnt(4)
    v_mfma_f32_32x32x16_bf16 v[0:15], a[32:35], v[160:163], v[0:15]
    v_mfma_f32_32x32x16_bf16 v[16:31], a[36:39], v[160:163], v[16:31]
    v_mfma_f32_32x32x16_bf16 v[32:47], a[40:43], v[160:163], v[32:47]
    v_mfma_f32_32x32x16_bf16 v[48:63], a[44:47], v[160:163], v[48:63]
    s_waitcnt lgkmcnt(0)
    v_mfma_f32_32x32x16_bf16 v[0:15], a[48:51], v[164:167], v[0:15]
    v_mfma_f32_32x32x16_bf16 v[16:31], a[52:55], v[164:167], v[16:31]
    v_mfma_f32_32x32x16_bf16 v[32:47], a[56:59], v[164:167], v[32:47]
    v_mfma_f32_32x32x16_bf16 v[48:63], a[60:63], v[164:167], v[48:63]
    s_branch L_k2_epi
L_k2_dr3:
    ds_read_b128 a[32:35], v184 offset:40960
    v_exp_f32 v178, v118
    v_add_f32 v181, v181, v177
    v_cvt_pk_bf16_f32 v170, v176, v177
    ds_read_b128 a[36:39], v184 offset:41984
    v_exp_f32 v179, v119
    v_add_f32 v181, v181, v178
    v_add_f32 v182, v182, v180
    ds_read_b128 a[40:43], v184 offset:43008
    v_exp_f32 v176, v120
    v_add_f32 v181, v181, v179
    v_cvt_pk_bf16_f32 v171, v178, v179
    ds_read_b128 a[44:47], v184 offset:44032
    v_exp_f32 v177, v121
    v_add_f32 v181, v181, v176
    ds_read_b128 a[48:51], v184 offset:45056
    v_exp_f32 v178, v122
    v_add_f32 v181, v181, v177
    v_cvt_pk_bf16_f32 v172, v176, v177
    ds_read_b128 a[52:55], v184 offset:46080
    v_exp_f32 v179, v123
    v_add_f32 v181, v181, v178
    ds_read_b128 a[56:59], v184 offset:47104
    v_exp_f32 v176, v124
    v_add_f32 v181, v181, v179
    v_cvt_pk_bf16_f32 v173, v178, v179
    ds_read_b128 a[60:63], v184 offset:48128
    v_exp_f32 v177, v125
    v_add_f32 v181, v181, v176
    s_waitcnt lgkmcnt(4)
    v_mfma_f32_32x32x16_bf16 v[0:15], a[32:35], v[160:163], v[0:15]
    ds_read_b128 a[32:35], v184 offset:57344
    v_exp_f32 v178, v126
    v_add_f32 v181, v181, v177
    v_cvt_pk_bf16_f32 v174, v176, v177
    v_mfma_f32_32x32x16_bf16 v[16:31], a[36:39], v[160:163], v[16:31]
    ds_read_b128 a[36:39], v184 offset:58368
    v_exp_f32 v179, v127
    v_add_f32 v181, v181, v178
    v_mfma_f32_32x32x16_bf16 v[32:47], a[40:43], v[160:163], v[32:47]
    ds_read_b128 a[40:43], v184 offset:59392
    v_add_f32 v181, v181, v179
    v_cvt_pk_bf16_f32 v175, v178, v179
    v_mfma_f32_32x32x16_bf16 v[48:63], a[44:47], v[160:163], v[48:63]
    ds_read_b128 a[44:47], v184 offset:60416
    v_cmp_lt_f32 vcc, s66, v181
    s_waitcnt lgkmcnt(4)
    v_mfma_f32_32x32x16_bf16 v[0:15], a[48:51], v[164:167], v[0:15]
    ds_read_b128 a[48:51], v184 offset:61440
    v_mfma_f32_32x32x16_bf16 v[16:31], a[52:55], v[164:167], v[16:31]
    ds_read_b128 a[52:55], v184 offset:62464
    v_mfma_f32_32x32x16_bf16 v[32:47], a[56:59], v[164:167], v[32:47]
    ds_read_b128 a[56:59], v184 offset:63488
    v_mfma_f32_32x32x16_bf16 v[48:63], a[60:63], v[164:167], v[48:63]
    ds_read_b128 a[60:63], v184 offset:64512
    s_cbranch_vccnz L_k2_site_141_s
L_k2_site_141_r:
    v_add_f32 v182, v182, v181
    s_waitcnt lgkmcnt(4)
    v_mfma_f32_32x32x16_bf16 v[0:15], a[32:35], v[168:171], v[0:15]
    v_mfma_f32_32x32x16_bf16 v[16:31], a[36:39], v[168:171], v[16:31]
    v_mfma_f32_32x32x16_bf16 v[32:47], a[40:43], v[168:171], v[32:47]
    v_mfma_f32_32x32x16_bf16 v[48:63], a[44:47], v[168:171], v[48:63]
    s_waitcnt lgkmcnt(0)
    v_mfma_f32_32x32x16_bf16 v[0:15], a[48:51], v[172:175], v[0:15]
    v_mfma_f32_32x32x16_bf16 v[16:31], a[52:55], v[172:175], v[16:31]
    v_mfma_f32_32x32x16_bf16 v[32:47], a[56:59], v[172:175], v[32:47]
    v_mfma_f32_32x32x16_bf16 v[48:63], a[60:63], v[172:175], v[48:63]
L_k2_epi:
    s_nop 7
    s_nop 3
    v_mov_b32 v187, v182
    s_nop 1
    v_permlane32_swap_b32 v187, v182
    v_add_f32 v182, v182, v187
    v_rcp_f32 v182, v182
    s_lshl_b32 s52, s62, 2
    s_add_u32 s52, s52, s44
    s_lshl_b32 s52, s52, 18
    s_lshl_b32 s53, s45, 13
    s_add_u32 s52, s52, s53
    s_add_u32 s52, s52, 0x3000000
    s_add_u32 s53, s52, 4096
    v_pk_mul_f32 v[0:1], v[0:1], v[182:183] op_sel_hi:[1,0]
    v_pk_mul_f32 v[2:3], v[2:3], v[182:183] op_sel_hi:[1,0]
    v_pk_mul_f32 v[4:5], v[4:5], v[182:183] op_sel_hi:[1,0]
    v_pk_mul_f32 v[6:7], v[6:7], v[182:183] op_sel_hi:[1,0]
    v_cvt_pk_bf16_f32 v96, v0, v1
    v_cvt_pk_bf16_f32 v97, v2, v3
    v_cvt_pk_bf16_f32 v98, v4, v5
    v_cvt_pk_bf16_f32 v99, v6, v7
    buffer_store_dwordx4 v[96:99], v240, s[8:11], s52 offen offset:0 sc1
    v_pk_mul_f32 v[8:9], v[8:9], v[182:183] op_sel_hi:[1,0]
    v_pk_mul_f32 v[10:11], v[10:11], v[182:183] op_sel_hi:[1,0]
    v_pk_mul_f32 v[12:13], v[12:13], v[182:183] op_sel_hi:[1,0]
    v_pk_mul_f32 v[14:15], v[14:15], v[182:183] op_sel_hi:[1,0]
    v_cvt_pk_bf16_f32 v100, v8, v9
    v_cvt_pk_bf16_f32 v101, v10, v11
    v_cvt_pk_bf16_f32 v102, v12, v13
    v_cvt_pk_bf16_f32 v103, v14, v15
    buffer_store_dwordx4 v[100:103], v240, s[8:11], s52 offen offset:1024 sc1
    v_pk_mul_f32 v[16:17], v[16:17], v[182:183] op_sel_hi:[1,0]
    v_pk_mul_f32 v[18:19], v[18:19], v[182:183] op_sel_hi:[1,0]
    v_pk_mul_f32 v[20:21], v[20:21], v[182:183] op_sel_hi:[1,0]
    v_pk_mul_f32 v[22:23], v[22:23], v[182:183] op_sel_hi:[1,0]
    v_cvt_pk_bf16_f32 v104, v16, v17
    v_cvt_pk_bf16_f32 v105, v18, v19
    v_cvt_pk_bf16_f32 v106, v20, v21
    v_cvt_pk_bf16_f32 v107, v22, v23
    buffer_store_dwordx4 v[104:107], v240, s[8:11], s52 offen offset:2048 sc1
    v_pk_mul_f32 v[24:25], v[24:25], v[182:183] op_sel_hi:[1,0]
    v_pk_mul_f32 v[26:27], v[26:27], v[182:183] op_sel_hi:[1,0]
    v_pk_mul_f32 v[28:29], v[28:29], v[182:183] op_sel_hi:[1,0]
    v_pk_mul_f32 v[30:31], v[30:31], v[182:183] op_sel_hi:[1,0]
    v_cvt_pk_bf16_f32 v108, v24, v25
    v_cvt_pk_bf16_f32 v109, v26, v27
    v_cvt_pk_bf16_f32 v110, v28, v29
    v_cvt_pk_bf16_f32 v111, v30, v31
    buffer_store_dwordx4 v[108:111], v240, s[8:11], s52 offen offset:3072 sc1
    v_pk_mul_f32 v[32:33], v[32:33], v[182:183] op_sel_hi:[1,0]
    v_pk_mul_f32 v[34:35], v[34:35], v[182:183] op_sel_hi:[1,0]
    v_pk_mul_f32 v[36:37], v[36:37], v[182:183] op_sel_hi:[1,0]
    v_pk_mul_f32 v[38:39], v[38:39], v[182:183] op_sel_hi:[1,0]
    v_cvt_pk_bf16_f32 v112, v32, v33
    v_cvt_pk_bf16_f32 v113, v34, v35
    v_cvt_pk_bf16_f32 v114, v36, v37
    v_cvt_pk_bf16_f32 v115, v38, v39
    buffer_store_dwordx4 v[112:115], v240, s[8:11], s53 offen offset:0 sc1
    v_pk_mul_f32 v[40:41], v[40:41], v[182:183] op_sel_hi:[1,0]
    v_pk_mul_f32 v[42:43], v[42:43], v[182:183] op_sel_hi:[1,0]
    v_pk_mul_f32 v[44:45], v[44:45], v[182:183] op_sel_hi:[1,0]
    v_pk_mul_f32 v[46:47], v[46:47], v[182:183] op_sel_hi:[1,0]
    v_cvt_pk_bf16_f32 v116, v40, v41
    v_cvt_pk_bf16_f32 v117, v42, v43
    v_cvt_pk_bf16_f32 v118, v44, v45
    v_cvt_pk_bf16_f32 v119, v46, v47
    buffer_store_dwordx4 v[116:119], v240, s[8:11], s53 offen offset:1024 sc1
    v_pk_mul_f32 v[48:49], v[48:49], v[182:183] op_sel_hi:[1,0]
    v_pk_mul_f32 v[50:51], v[50:51], v[182:183] op_sel_hi:[1,0]
    v_pk_mul_f32 v[52:53], v[52:53], v[182:183] op_sel_hi:[1,0]
    v_pk_mul_f32 v[54:55], v[54:55], v[182:183] op_sel_hi:[1,0]
    v_cvt_pk_bf16_f32 v120, v48, v49
    v_cvt_pk_bf16_f32 v121, v50, v51
    v_cvt_pk_bf16_f32 v122, v52, v53
    v_cvt_pk_bf16_f32 v123, v54, v55
    buffer_store_dwordx4 v[120:123], v240, s[8:11], s53 offen offset:2048 sc1
    v_pk_mul_f32 v[56:57], v[56:57], v[182:183] op_sel_hi:[1,0]
    v_pk_mul_f32 v[58:59], v[58:59], v[182:183] op_sel_hi:[1,0]
    v_pk_mul_f32 v[60:61], v[60:61], v[182:183] op_sel_hi:[1,0]
    v_pk_mul_f32 v[62:63], v[62:63], v[182:183] op_sel_hi:[1,0]
    v_cvt_pk_bf16_f32 v124, v56, v57
    v_cvt_pk_bf16_f32 v125, v58, v59
    v_cvt_pk_bf16_f32 v126, v60, v61
    v_cvt_pk_bf16_f32 v127, v62, v63
    buffer_store_dwordx4 v[124:127], v240, s[8:11], s53 offen offset:3072 sc1
L_k2_fin:
    s_and_b32 s36, s2, 7
    s_lshr_b32 s37, s2, 3
    s_sub_u32 s61, s37, 2
    s_cmp_lt_u32 s61, 24
    s_cbranch_scc1 L_k3_oproj
    s_cmp_ge_u32 s37, 26
    s_cbranch_scc1 L_k3_ffn
    s_waitcnt vmcnt(0)
    s_barrier
    s_cmp_lg_u32 s44, 3
    s_cbranch_scc1 L_ka_pc_a
    s_lshl_b32 s63, s2, 7
    s_add_u32 s63, s63, 0x490000
    v_mov_b32 v254, s58
    s_mov_b64 exec, 1
    buffer_store_dword v254, v255, s[8:11], s63 offen offset:8 sc1
    buffer_store_dword v254, v255, s[8:11], s63 offen offset:16 sc1
    s_mov_b64 exec, -1
L_ka_pc_a:
    s_endpgm
L_k3_oproj:
    s_sub_u32 s37, s37, 2
    s_mul_i32 s60, s37, 43
    s_lshr_b32 s60, s60, 8
    s_mul_i32 s61, s60, 6
    s_sub_u32 s50, s37, s61
    s_lshr_b32 s49, s36, 1
    s_lshl_b32 s49, s49, 2
    s_add_u32 s49, s49, s60
    s_and_b32 s51, s36, 1
    s_sub_u32 s61, 15, s49
    s_cmp_ge_u32 s49, 8
    s_cselect_b32 s60, s61, s49
    s_cselect_b32 s61, 8, 16
    s_lshl_b32 s60, s60, 12
    s_add_u32 s60, s60, s61
    s_lshl_b32 s61, s51, 2
    s_add_u32 s61, s61, s44
    s_lshl_b32 s62, s61, 7
    s_add_u32 s60, s60, s62
    v_and_b32 v253, 3, v241
    v_lshlrev_b32 v253, 10, v253
    v_add_u32 v253, s60, v253
    v_lshrrev_b32 v244, 7, v253
    buffer_load_dword v250, v253, s[8:11], s57 offen sc1
    v_cmp_eq_u32 s[52:53], s2, v244
    v_mov_b32 v245, s58
    s_lshl_b32 s45, s49, 20
    s_lshl_b32 s61, s61, 15
    s_add_u32 s45, s45, s61
    s_add_u32 s45, s45, 0x3000000
    s_lshl_b32 s60, s51, 19
    v_add_u32 v120, s60, v240
    v_add_u32 v121, 0x40000, v120
    v_xor_b32 v122, 0x80000, v120
    v_xor_b32 v123, 0x80000, v121
    s_waitcnt vmcnt(0)
    s_barrier
    s_cmp_lg_u32 s44, 3
    s_cbranch_scc1 L_ka_pc_b
    s_lshl_b32 s63, s2, 7
    s_add_u32 s63, s63, 0x490000
    v_mov_b32 v254, s58
    s_mov_b64 exec, 1
    buffer_store_dword v254, v255, s[8:11], s63 offen offset:8 sc1
    buffer_store_dword v254, v255, s[8:11], s63 offen offset:16 sc1
    s_mov_b64 exec, -1
L_ka_pc_b:
    v_cndmask_b32 v254, v250, v245, s[52:53]
    s_mov_b32 s63, 0
L_ka_fl_ctx:
    v_cmp_ne_u32 vcc, s58, v254
    s_cbranch_vccz L_ka_fl_ctx_ok
    s_sleep 8
    buffer_load_dword v254, v253, s[8:11], s57 offen sc1
    s_add_u32 s63, s63, 1
    s_cmp_lt_u32 s63, 0x40000
    s_waitcnt vmcnt(0)
    s_cbranch_scc1 L_ka_fl_ctx
L_ka_fl_ctx_ok:
    buffer_load_dwordx4 v[140:143], v120, s[8:11], s45 offen offset:0 sc1
    buffer_load_dwordx4 v[144:147], v121, s[8:11], s45 offen offset:0 sc1
    buffer_load_dwordx4 v[148:151], v122, s[8:11], s45 offen offset:0 sc1
    buffer_load_dwordx4 v[152:155], v123, s[8:11], s45 offen offset:0 sc1
    buffer_load_dwordx4 v[156:159], v120, s[8:11], s45 offen offset:1024 sc1
    buffer_load_dwordx4 v[160:163], v121, s[8:11], s45 offen offset:1024 sc1
    buffer_load_dwordx4 v[164:167], v122, s[8:11], s45 offen offset:1024 sc1
    buffer_load_dwordx4 v[168:171], v123, s[8:11], s45 offen offset:1024 sc1
    buffer_load_dwordx4 v[172:175], v120, s[8:11], s45 offen offset:2048 sc1
    buffer_load_dwordx4 v[176:179], v121, s[8:11], s45 offen offset:2048 sc1
    buffer_load_dwordx4 v[180:183], v122, s[8:11], s45 offen offset:2048 sc1
    buffer_load_dwordx4 v[184:187], v123, s[8:11], s45 offen offset:2048 sc1
    buffer_load_dwordx4 v[96:99], v120, s[8:11], s45 offen offset:3072 sc1
    buffer_load_dwordx4 v[100:103], v121, s[8:11], s45 offen offset:3072 sc1
    buffer_load_dwordx4 v[104:107], v122, s[8:11], s45 offen offset:3072 sc1
    buffer_load_dwordx4 v[108:111], v123, s[8:11], s45 offen offset:3072 sc1
    s_add_u32 s45, s45, 4096
    buffer_load_dwordx4 v[112:115], v120, s[8:11], s45 offen offset:0 sc1
    buffer_load_dwordx4 v[116:119], v121, s[8:11], s45 offen offset:0 sc1
    buffer_load_dwordx4 v[192:195], v122, s[8:11], s45 offen offset:0 sc1
    buffer_load_dwordx4 v[196:199], v123, s[8:11], s45 offen offset:0 sc1
    buffer_load_dwordx4 v[200:203], v120, s[8:11], s45 offen offset:1024 sc1
    buffer_load_dwordx4 v[204:207], v121, s[8:11], s45 offen offset:1024 sc1
    buffer_load_dwordx4 v[208:211], v122, s[8:11], s45 offen offset:1024 sc1
    buffer_load_dwordx4 v[212:215], v123, s[8:11], s45 offen offset:1024 sc1
    buffer_load_dwordx4 v[216:219], v120, s[8:11], s45 offen offset:2048 sc1
    buffer_load_dwordx4 v[220:223], v121, s[8:11], s45 offen offset:2048 sc1
    buffer_load_dwordx4 v[224:227], v122, s[8:11], s45 offen offset:2048 sc1
    buffer_load_dwordx4 v[228:231], v123, s[8:11], s45 offen offset:2048 sc1
    buffer_load_dwordx4 v[232:235], v120, s[8:11], s45 offen offset:3072 sc1
    buffer_load_dwordx4 v[236:239], v121, s[8:11], s45 offen offset:3072 sc1
    s_load_dwordx2 s[16:17], s[0:1], 0
    s_load_dwordx2 s[20:21], s[0:1], 88
    v_lshrrev_b32 v244, 5, v241
    v_and_b32 v245, 31, v241
    s_lshl_b32 s49, s49, 1
    s_add_u32 s49, s49, s51
    s_lshl_b32 s60, s49, 6
    v_add_u32 v128, s60, v245
    v_add_u32 v129, 32, v128
    s_mul_i32 s60, s50, 192
    s_lshl_b32 s61, s44, 4
    s_add_u32 s60, s60, s61
    v_lshl_add_u32 v139, v244, 3, s60
    v_mul_u32_u24 v126, 1152, v128
    v_add_u32 v126, v126, v139
    v_add_u32 v127, 36864, v126
    v_lshlrev_b32 v133, 4, v245
    v_lshl_add_u32 v133, v244, 3, v133
    v_add_u32 v138, 4096, v133
    s_mul_i32 s62, s49, 73728
    s_mul_i32 s63, s50, 6144
    s_add_u32 s62, s62, s63
    s_lshl_b32 s63, s44, 9
    s_add_u32 s62, s62, s63
    s_add_u32 s63, s62, 36864
    s_mul_i32 s60, s44, 6144
    s_mul_i32 s47, s44, 24576
    v_add_u32 v130, s60, v240
    v_add_u32 v131, 49152, v130
    v_add_u32 v132, s47, v240
    s_mov_b32 s18, 0x240000
    s_mov_b32 s19, 0x00020000
    s_mov_b32 s22, 0x240000
    s_mov_b32 s23, 0x00020000
    v_and_b32 v190, 15, v241
    v_lshlrev_b32 v190, 3, v190
    s_mov_b32 s55, 0x482000
    s_waitcnt vmcnt(26)
    v_mfma_f32_32x32x16_bf16 a[0:15], a[96:99], v[148:151], 0
    v_mfma_f32_32x32x16_bf16 a[32:47], a[100:103], v[148:151], 0
    v_mfma_f32_32x32x16_bf16 a[64:79], a[104:107], v[148:151], 0
    buffer_load_dwordx4 v[148:151], v122, s[8:11], s45 offen offset:3072 sc1
    v_mfma_f32_32x32x16_bf16 a[16:31], a[96:99], v[152:155], 0
    v_mfma_f32_32x32x16_bf16 a[48:63], a[100:103], v[152:155], 0
    v_mfma_f32_32x32x16_bf16 a[80:95], a[104:107], v[152:155], 0
    buffer_load_dwordx4 v[152:155], v123, s[8:11], s45 offen offset:3072 sc1
    v_mfma_f32_32x32x16_bf16 v[0:15], a[96:99], v[140:143], 0
    v_mfma_f32_32x32x16_bf16 v[32:47], a[100:103], v[140:143], 0
    v_mfma_f32_32x32x16_bf16 v[64:79], a[104:107], v[140:143], 0
    s_add_u32 s45, s45, 4096
    buffer_load_dwordx4 v[140:143], v120, s[8:11], s45 offen offset:0 sc1
    v_mfma_f32_32x32x16_bf16 v[16:31], a[96:99], v[144:147], 0
    buffer_load_dwordx4 a[96:99], v121, s[8:11], s45 offen offset:0 sc1
    v_mfma_f32_32x32x16_bf16 v[48:63], a[100:103], v[144:147], 0
    buffer_load_dwordx4 a[100:103], v122, s[8:11], s45 offen offset:0 sc1
    v_mfma_f32_32x32x16_bf16 v[80:95], a[104:107], v[144:147], 0
    buffer_load_dwordx4 v[144:147], v123, s[8:11], s45 offen offset:0 sc1
    buffer_load_dwordx4 a[104:107], v120, s[8:11], s45 offen offset:1024 sc1
    s_waitcnt vmcnt(29)
    v_mfma_f32_32x32x16_bf16 a[0:15], a[108:111], v[164:167], a[0:15]
    v_mfma_f32_32x32x16_bf16 a[32:47], a[112:115], v[164:167], a[32:47]
    v_mfma_f32_32x32x16_bf16 a[64:79], a[116:119], v[164:167], a[64:79]
    buffer_load_dwordx4 v[164:167], v121, s[8:11], s45 offen offset:1024 sc1
    v_mfma_f32_32x32x16_bf16 a[16:31], a[108:111], v[168:171], a[16:31]
    v_mfma_f32_32x32x16_bf16 a[48:63], a[112:115], v[168:171], a[48:63]
    v_mfma_f32_32x32x16_bf16 a[80:95], a[116:119], v[168:171], a[80:95]
    buffer_load_dwordx4 v[168:171], v122, s[8:11], s45 offen offset:1024 sc1
    v_mfma_f32_32x32x16_bf16 v[0:15], a[108:111], v[156:159], v[0:15]
    v_mfma_f32_32x32x16_bf16 v[32:47], a[112:115], v[156:159], v[32:47]
    v_mfma_f32_32x32x16_bf16 v[64:79], a[116:119], v[156:159], v[64:79]
    buffer_load_dwordx4 v[156:159], v123, s[8:11], s45 offen offset:1024 sc1
    v_mfma_f32_32x32x16_bf16 v[16:31], a[108:111], v[160:163], v[16:31]
    buffer_load_dwordx4 a[108:111], v120, s[8:11], s45 offen offset:2048 sc1
    v_mfma_f32_32x32x16_bf16 v[48:63], a[112:115], v[160:163], v[48:63]
    buffer_load_dwordx4 a[112:115], v121, s[8:11], s45 offen offset:2048 sc1
    v_mfma_f32_32x32x16_bf16 v[80:95], a[116:119], v[160:163], v[80:95]
    buffer_load_dwordx4 v[160:163], v122, s[8:11], s45 offen offset:2048 sc1
    buffer_load_dwordx4 a[116:119], v123, s[8:11], s45 offen offset:2048 sc1
    s_waitcnt vmcnt(32)
    v_mfma_f32_32x32x16_bf16 a[0:15], a[120:123], v[180:183], a[0:15]
    v_mfma_f32_32x32x16_bf16 a[32:47], a[124:127], v[180:183], a[32:47]
    v_mfma_f32_32x32x16_bf16 a[64:79], a[128:131], v[180:183], a[64:79]
    buffer_load_dwordx4 v[180:183], v120, s[8:11], s45 offen offset:3072 sc1
    v_mfma_f32_32x32x16_bf16 a[16:31], a[120:123], v[184:187], a[16:31]
    v_mfma_f32_32x32x16_bf16 a[48:63], a[124:127], v[184:187], a[48:63]
    v_mfma_f32_32x32x16_bf16 a[80:95], a[128:131], v[184:187], a[80:95]
    buffer_load_dwordx4 v[184:187], v121, s[8:11], s45 offen offset:3072 sc1
    v_mfma_f32_32x32x16_bf16 v[0:15], a[120:123], v[172:175], v[0:15]
    v_mfma_f32_32x32x16_bf16 v[32:47], a[124:127], v[172:175], v[32:47]
    v_mfma_f32_32x32x16_bf16 v[64:79], a[128:131], v[172:175], v[64:79]
    buffer_load_dwordx4 v[172:175], v122, s[8:11], s45 offen offset:3072 sc1
    v_mfma_f32_32x32x16_bf16 v[16:31], a[120:123], v[176:179], v[16:31]
    buffer_load_dwordx4 a[120:123], v123, s[8:11], s45 offen offset:3072 sc1
    v_mfma_f32_32x32x16_bf16 v[48:63], a[124:127], v[176:179], v[48:63]
    s_add_u32 s45, s45, 4096
    buffer_load_dwordx4 a[124:127], v120, s[8:11], s45 offen offset:0 sc1
    v_mfma_f32_32x32x16_bf16 v[80:95], a[128:131], v[176:179], v[80:95]
    buffer_load_dwordx4 v[176:179], v121, s[8:11], s45 offen offset:0 sc1
    buffer_load_dwordx4 a[128:131], v122, s[8:11], s45 offen offset:0 sc1
    s_waitcnt vmcnt(35)
    v_mfma_f32_32x32x16_bf16 a[0:15], a[132:135], v[104:107], a[0:15]
    v_mfma_f32_32x32x16_bf16 a[32:47], a[136:139], v[104:107], a[32:47]
    v_mfma_f32_32x32x16_bf16 a[64:79], a[140:143], v[104:107], a[64:79]
    buffer_load_dwordx4 v[104:107], v123, s[8:11], s45 offen offset:0 sc1
    v_mfma_f32_32x32x16_bf16 a[16:31], a[132:135], v[108:111], a[16:31]
    v_mfma_f32_32x32x16_bf16 a[48:63], a[136:139], v[108:111], a[48:63]
    v_mfma_f32_32x32x16_bf16 a[80:95], a[140:143], v[108:111], a[80:95]
    buffer_load_dwordx4 v[108:111], v120, s[8:11], s45 offen offset:1024 sc1
    v_mfma_f32_32x32x16_bf16 v[0:15], a[132:135], v[96:99], v[0:15]
    v_mfma_f32_32x32x16_bf16 v[32:47], a[136:139], v[96:99], v[32:47]
    v_mfma_f32_32x32x16_bf16 v[64:79], a[140:143], v[96:99], v[64:79]
    buffer_load_dwordx4 v[96:99], v121, s[8:11], s45 offen offset:1024 sc1
    v_mfma_f32_32x32x16_bf16 v[16:31], a[132:135], v[100:103], v[16:31]
    buffer_load_dwordx4 a[132:135], v122, s[8:11], s45 offen offset:1024 sc1
    v_mfma_f32_32x32x16_bf16 v[48:63], a[136:139], v[100:103], v[48:63]
    buffer_load_dwordx4 a[136:139], v123, s[8:11], s45 offen offset:1024 sc1
    v_mfma_f32_32x32x16_bf16 v[80:95], a[140:143], v[100:103], v[80:95]
    buffer_load_dwordx4 v[100:103], v240, s[8:11], s59 offen offset:0 sc1
    buffer_load_dwordx4 a[140:143], v240, s[8:11], s59 offen offset:1024 sc1
    s_waitcnt vmcnt(38)
    v_mfma_f32_32x32x16_bf16 a[0:15], a[144:147], v[192:195], a[0:15]
    v_mfma_f32_32x32x16_bf16 a[32:47], a[148:151], v[192:195], a[32:47]
    v_mfma_f32_32x32x16_bf16 a[64:79], a[152:155], v[192:195], a[64:79]
    buffer_load_dwordx4 v[192:195], v240, s[8:11], s59 offen offset:2048 sc1
    v_mfma_f32_32x32x16_bf16 a[16:31], a[144:147], v[196:199], a[16:31]
    v_mfma_f32_32x32x16_bf16 a[48:63], a[148:151], v[196:199], a[48:63]
    v_mfma_f32_32x32x16_bf16 a[80:95], a[152:155], v[196:199], a[80:95]
    buffer_load_dwordx4 v[196:199], v120, s[8:11], s45 offen offset:2048 sc1
    v_mfma_f32_32x32x16_bf16 v[0:15], a[144:147], v[112:115], v[0:15]
    v_mfma_f32_32x32x16_bf16 v[32:47], a[148:151], v[112:115], v[32:47]
    v_mfma_f32_32x32x16_bf16 v[64:79], a[152:155], v[112:115], v[64:79]
    buffer_load_dwordx4 v[112:115], v121, s[8:11], s45 offen offset:2048 sc1
    v_mfma_f32_32x32x16_bf16 v[16:31], a[144:147], v[116:119], v[16:31]
    buffer_load_dwordx4 a[144:147], v122, s[8:11], s45 offen offset:2048 sc1
    v_mfma_f32_32x32x16_bf16 v[48:63], a[148:151], v[116:119], v[48:63]
    buffer_load_dwordx4 a[148:151], v123, s[8:11], s45 offen offset:2048 sc1
    v_mfma_f32_32x32x16_bf16 v[80:95], a[152:155], v[116:119], v[80:95]
    s_add_u32 s59, s59, 18432
    buffer_load_dwordx4 v[116:119], v240, s[8:11], s59 offen offset:0 sc1
    buffer_load_dwordx4 a[152:155], v240, s[8:11], s59 offen offset:1024 sc1
    s_waitcnt vmcnt(41)
    v_mfma_f32_32x32x16_bf16 a[0:15], a[156:159], v[208:211], a[0:15]
    v_mfma_f32_32x32x16_bf16 a[32:47], a[160:163], v[208:211], a[32:47]
    v_mfma_f32_32x32x16_bf16 a[64:79], a[164:167], v[208:211], a[64:79]
    buffer_load_dwordx4 v[208:211], v240, s[8:11], s59 offen offset:2048 sc1
    v_mfma_f32_32x32x16_bf16 a[16:31], a[156:159], v[212:215], a[16:31]
    v_mfma_f32_32x32x16_bf16 a[48:63], a[160:163], v[212:215], a[48:63]
    v_mfma_f32_32x32x16_bf16 a[80:95], a[164:167], v[212:215], a[80:95]
    buffer_load_dwordx4 v[212:215], v120, s[8:11], s45 offen offset:3072 sc1
    v_mfma_f32_32x32x16_bf16 v[0:15], a[156:159], v[200:203], v[0:15]
    v_mfma_f32_32x32x16_bf16 v[32:47], a[160:163], v[200:203], v[32:47]
    v_mfma_f32_32x32x16_bf16 v[64:79], a[164:167], v[200:203], v[64:79]
    buffer_load_dwordx4 v[200:203], v121, s[8:11], s45 offen offset:3072 sc1
    v_mfma_f32_32x32x16_bf16 v[16:31], a[156:159], v[204:207], v[16:31]
    buffer_load_dwordx4 a[156:159], v122, s[8:11], s45 offen offset:3072 sc1
    v_mfma_f32_32x32x16_bf16 v[48:63], a[160:163], v[204:207], v[48:63]
    buffer_load_dwordx4 a[160:163], v123, s[8:11], s45 offen offset:3072 sc1
    v_mfma_f32_32x32x16_bf16 v[80:95], a[164:167], v[204:207], v[80:95]
    s_add_u32 s59, s59, 18432
    buffer_load_dwordx4 v[204:207], v240, s[8:11], s59 offen offset:0 sc1
    buffer_load_dwordx4 a[164:167], v240, s[8:11], s59 offen offset:1024 sc1
    s_waitcnt vmcnt(44)
    v_mfma_f32_32x32x16_bf16 a[0:15], a[168:171], v[224:227], a[0:15]
    v_mfma_f32_32x32x16_bf16 a[32:47], a[172:175], v[224:227], a[32:47]
    v_mfma_f32_32x32x16_bf16 a[64:79], a[176:179], v[224:227], a[64:79]
    buffer_load_dwordx4 v[224:227], v240, s[8:11], s59 offen offset:2048 sc1
    v_mfma_f32_32x32x16_bf16 a[16:31], a[168:171], v[228:231], a[16:31]
    v_mfma_f32_32x32x16_bf16 a[48:63], a[172:175], v[228:231], a[48:63]
    v_mfma_f32_32x32x16_bf16 a[80:95], a[176:179], v[228:231], a[80:95]
    s_add_u32 s45, s45, 4096
    buffer_load_dwordx4 v[228:231], v120, s[8:11], s45 offen offset:0 sc1
    v_mfma_f32_32x32x16_bf16 v[0:15], a[168:171], v[216:219], v[0:15]
    v_mfma_f32_32x32x16_bf16 v[32:47], a[172:175], v[216:219], v[32:47]
    v_mfma_f32_32x32x16_bf16 v[64:79], a[176:179], v[216:219], v[64:79]
    buffer_load_dwordx4 v[216:219], v121, s[8:11], s45 offen offset:0 sc1
    v_mfma_f32_32x32x16_bf16 v[16:31], a[168:171], v[220:223], v[16:31]
    buffer_load_dwordx4 a[168:171], v122, s[8:11], s45 offen offset:0 sc1
    v_mfma_f32_32x32x16_bf16 v[48:63], a[172:175], v[220:223], v[48:63]
    buffer_load_dwordx4 a[172:175], v123, s[8:11], s45 offen offset:0 sc1
    v_mfma_f32_32x32x16_bf16 v[80:95], a[176:179], v[220:223], v[80:95]
    s_add_u32 s59, s59, 18432
    buffer_load_dwordx4 v[220:223], v240, s[8:11], s59 offen offset:0 sc1
    buffer_load_dwordx4 a[176:179], v240, s[8:11], s59 offen offset:1024 sc1
    s_waitcnt vmcnt(47)
    v_mfma_f32_32x32x16_bf16 a[0:15], a[180:183], v[148:151], a[0:15]
    v_mfma_f32_32x32x16_bf16 a[32:47], a[184:187], v[148:151], a[32:47]
    v_mfma_f32_32x32x16_bf16 a[64:79], a[188:191], v[148:151], a[64:79]
    buffer_load_dwordx4 v[148:151], v240, s[8:11], s59 offen offset:2048 sc1
    v_mfma_f32_32x32x16_bf16 a[16:31], a[180:183], v[152:155], a[16:31]
    v_mfma_f32_32x32x16_bf16 a[48:63], a[184:187], v[152:155], a[48:63]
    v_mfma_f32_32x32x16_bf16 a[80:95], a[188:191], v[152:155], a[80:95]
    buffer_load_dwordx4 v[152:155], v120, s[8:11], s45 offen offset:1024 sc1
    v_mfma_f32_32x32x16_bf16 v[0:15], a[180:183], v[232:235], v[0:15]
    v_mfma_f32_32x32x16_bf16 v[32:47], a[184:187], v[232:235], v[32:47]
    v_mfma_f32_32x32x16_bf16 v[64:79], a[188:191], v[232:235], v[64:79]
    buffer_load_dwordx4 v[232:235], v121, s[8:11], s45 offen offset:1024 sc1
    v_mfma_f32_32x32x16_bf16 v[16:31], a[180:183], v[236:239], v[16:31]
    buffer_load_dwordx4 a[180:183], v122, s[8:11], s45 offen offset:1024 sc1
    v_mfma_f32_32x32x16_bf16 v[48:63], a[184:187], v[236:239], v[48:63]
    buffer_load_dwordx4 a[184:187], v123, s[8:11], s45 offen offset:1024 sc1
    v_mfma_f32_32x32x16_bf16 v[80:95], a[188:191], v[236:239], v[80:95]
    s_add_u32 s59, s59, 18432
    buffer_load_dwordx4 v[236:239], v240, s[8:11], s59 offen offset:0 sc1
    buffer_load_dwordx4 a[188:191], v240, s[8:11], s59 offen offset:1024 sc1
    s_waitcnt vmcnt(50)
    v_mfma_f32_32x32x16_bf16 a[0:15], a[192:195], a[100:103], a[0:15]
    v_mfma_f32_32x32x16_bf16 a[32:47], a[196:199], a[100:103], a[32:47]
    v_mfma_f32_32x32x16_bf16 a[64:79], a[200:203], a[100:103], a[64:79]
    buffer_load_dwordx4 a[100:103], v240, s[8:11], s59 offen offset:2048 sc1
    v_mfma_f32_32x32x16_bf16 a[16:31], a[192:195], v[144:147], a[16:31]
    v_mfma_f32_32x32x16_bf16 a[48:63], a[196:199], v[144:147], a[48:63]
    v_mfma_f32_32x32x16_bf16 a[80:95], a[200:203], v[144:147], a[80:95]
    buffer_load_dwordx4 v[144:147], v120, s[8:11], s45 offen offset:2048 sc1
    v_mfma_f32_32x32x16_bf16 v[0:15], a[192:195], v[140:143], v[0:15]
    v_mfma_f32_32x32x16_bf16 v[32:47], a[196:199], v[140:143], v[32:47]
    v_mfma_f32_32x32x16_bf16 v[64:79], a[200:203], v[140:143], v[64:79]
    buffer_load_dwordx4 v[140:143], v121, s[8:11], s45 offen offset:2048 sc1
    v_mfma_f32_32x32x16_bf16 v[16:31], a[192:195], a[96:99], v[16:31]
    buffer_load_dwordx4 a[192:195], v122, s[8:11], s45 offen offset:2048 sc1
    v_mfma_f32_32x32x16_bf16 v[48:63], a[196:199], a[96:99], v[48:63]
    buffer_load_dwordx4 a[196:199], v123, s[8:11], s45 offen offset:2048 sc1
    v_mfma_f32_32x32x16_bf16 v[80:95], a[200:203], a[96:99], v[80:95]
    s_add_u32 s59, s59, 18432
    buffer_load_dwordx4 a[96:99], v240, s[8:11], s59 offen offset:0 sc1
    buffer_load_dwordx4 a[200:203], v240, s[8:11], s59 offen offset:1024 sc1
    s_waitcnt vmcnt(53)
    v_mfma_f32_32x32x16_bf16 a[0:15], a[204:207], v[168:171], a[0:15]
    v_mfma_f32_32x32x16_bf16 a[32:47], a[208:211], v[168:171], a[32:47]
    v_mfma_f32_32x32x16_bf16 a[64:79], a[212:215], v[168:171], a[64:79]
    buffer_load_dwordx4 v[168:171], v240, s[8:11], s59 offen offset:2048 sc1
    v_mfma_f32_32x32x16_bf16 a[16:31], a[204:207], v[156:159], a[16:31]
    v_mfma_f32_32x32x16_bf16 a[48:63], a[208:211], v[156:159], a[48:63]
    v_mfma_f32_32x32x16_bf16 a[80:95], a[212:215], v[156:159], a[80:95]
    buffer_load_dwordx4 v[156:159], v120, s[8:11], s45 offen offset:3072 sc1
    v_mfma_f32_32x32x16_bf16 v[0:15], a[204:207], a[104:107], v[0:15]
    v_mfma_f32_32x32x16_bf16 v[32:47], a[208:211], a[104:107], v[32:47]
    v_mfma_f32_32x32x16_bf16 v[64:79], a[212:215], a[104:107], v[64:79]
    buffer_load_dwordx4 a[104:107], v121, s[8:11], s45 offen offset:3072 sc1
    v_mfma_f32_32x32x16_bf16 v[16:31], a[204:207], v[164:167], v[16:31]
    buffer_load_dwordx4 a[204:207], v122, s[8:11], s45 offen offset:3072 sc1
    v_mfma_f32_32x32x16_bf16 v[48:63], a[208:211], v[164:167], v[48:63]
    buffer_load_dwordx4 a[208:211], v123, s[8:11], s45 offen offset:3072 sc1
    v_mfma_f32_32x32x16_bf16 v[80:95], a[212:215], v[164:167], v[80:95]
    s_add_u32 s59, s59, 18432
    buffer_load_dwordx4 v[164:167], v240, s[8:11], s59 offen offset:0 sc1
    buffer_load_dwordx4 a[212:215], v240, s[8:11], s59 offen offset:1024 sc1
    s_waitcnt vmcnt(56)
    v_mfma_f32_32x32x16_bf16 a[0:15], a[216:219], v[160:163], a[0:15]
    v_mfma_f32_32x32x16_bf16 a[32:47], a[220:223], v[160:163], a[32:47]
    v_mfma_f32_32x32x16_bf16 a[64:79], a[224:227], v[160:163], a[64:79]
    buffer_load_dwordx4 v[160:163], v240, s[8:11], s59 offen offset:2048 sc1
    v_mfma_f32_32x32x16_bf16 a[16:31], a[216:219], a[116:119], a[16:31]
    v_mfma_f32_32x32x16_bf16 a[48:63], a[220:223], a[116:119], a[48:63]
    v_mfma_f32_32x32x16_bf16 a[80:95], a[224:227], a[116:119], a[80:95]
    s_add_u32 s45, s45, 4096
    buffer_load_dwordx4 a[116:119], v120, s[8:11], s45 offen offset:0 sc1
    v_mfma_f32_32x32x16_bf16 v[0:15], a[216:219], a[108:111], v[0:15]
    v_mfma_f32_32x32x16_bf16 v[32:47], a[220:223], a[108:111], v[32:47]
    v_mfma_f32_32x32x16_bf16 v[64:79], a[224:227], a[108:111], v[64:79]
    buffer_load_dwordx4 a[108:111], v121, s[8:11], s45 offen offset:0 sc1
    v_mfma_f32_32x32x16_bf16 v[16:31], a[216:219], a[112:115], v[16:31]
    buffer_load_dwordx4 a[216:219], v122, s[8:11], s45 offen offset:0 sc1
    v_mfma_f32_32x32x16_bf16 v[48:63], a[220:223], a[112:115], v[48:63]
    v_mfma_f32_32x32x16_bf16 v[80:95], a[224:227], a[112:115], v[80:95]
    s_waitcnt vmcnt(56)
    v_mfma_f32_32x32x16_bf16 a[0:15], a[228:231], v[172:175], a[0:15]
    v_mfma_f32_32x32x16_bf16 a[32:47], a[232:235], v[172:175], a[32:47]
    v_mfma_f32_32x32x16_bf16 a[64:79], a[236:239], v[172:175], a[64:79]
    buffer_load_dwordx4 v[172:175], v123, s[8:11], s45 offen offset:0 sc1
    v_mfma_f32_32x32x16_bf16 a[16:31], a[228:231], a[120:123], a[16:31]
    s_add_u32 s59, s59, 18432
    buffer_load_dwordx4 a[220:223], v240, s[8:11], s59 offen offset:0 sc1
    v_mfma_f32_32x32x16_bf16 a[48:63], a[232:235], a[120:123], a[48:63]
    buffer_load_dwordx4 a[112:115], v240, s[8:11], s59 offen offset:1024 sc1
    v_mfma_f32_32x32x16_bf16 a[80:95], a[236:239], a[120:123], a[80:95]
    buffer_load_dwordx4 a[224:227], v240, s[8:11], s59 offen offset:2048 sc1
    v_mfma_f32_32x32x16_bf16 v[0:15], a[228:231], v[180:183], v[0:15]
    v_mfma_f32_32x32x16_bf16 v[32:47], a[232:235], v[180:183], v[32:47]
    v_mfma_f32_32x32x16_bf16 v[64:79], a[236:239], v[180:183], v[64:79]
    v_mfma_f32_32x32x16_bf16 v[16:31], a[228:231], v[184:187], v[16:31]
    v_mfma_f32_32x32x16_bf16 v[48:63], a[232:235], v[184:187], v[48:63]
    v_mfma_f32_32x32x16_bf16 v[80:95], a[236:239], v[184:187], v[80:95]
    s_waitcnt vmcnt(56)
    buffer_load_dwordx2 v[188:189], v190, s[8:11], s55 offen sc1
    v_mfma_f32_32x32x16_bf16 a[0:15], a[240:243], a[128:131], a[0:15]
    v_mfma_f32_32x32x16_bf16 a[32:47], a[244:247], a[128:131], a[32:47]
    v_mfma_f32_32x32x16_bf16 a[64:79], a[248:251], a[128:131], a[64:79]
    buffer_load_dwordx4 v[180:183], v120, s[8:11], s45 offen offset:1024 sc1
    v_mfma_f32_32x32x16_bf16 a[16:31], a[240:243], v[104:107], a[16:31]
    buffer_load_dwordx4 v[184:187], v121, s[8:11], s45 offen offset:1024 sc1
    v_mfma_f32_32x32x16_bf16 a[48:63], a[244:247], v[104:107], a[48:63]
    buffer_load_dwordx4 a[120:123], v122, s[8:11], s45 offen offset:1024 sc1
    v_mfma_f32_32x32x16_bf16 a[80:95], a[248:251], v[104:107], a[80:95]
    v_mfma_f32_32x32x16_bf16 v[0:15], a[240:243], a[124:127], v[0:15]
    v_mfma_f32_32x32x16_bf16 v[32:47], a[244:247], a[124:127], v[32:47]
    v_mfma_f32_32x32x16_bf16 v[64:79], a[248:251], a[124:127], v[64:79]
    v_mfma_f32_32x32x16_bf16 v[16:31], a[240:243], v[176:179], v[16:31]
    v_mfma_f32_32x32x16_bf16 v[48:63], a[244:247], v[176:179], v[48:63]
    v_mfma_f32_32x32x16_bf16 v[80:95], a[248:251], v[176:179], v[80:95]
    s_waitcnt vmcnt(53)
    v_mfma_f32_32x32x16_bf16 a[0:15], v[100:103], a[132:135], a[0:15]
    v_mfma_f32_32x32x16_bf16 a[32:47], a[140:143], a[132:135], a[32:47]
    v_mfma_f32_32x32x16_bf16 a[64:79], v[192:195], a[132:135], a[64:79]
    buffer_load_dwordx4 v[176:179], v123, s[8:11], s45 offen offset:1024 sc1
    v_mfma_f32_32x32x16_bf16 a[16:31], v[100:103], a[136:139], a[16:31]
    s_add_u32 s59, s59, 18432
    buffer_load_dwordx4 a[228:231], v240, s[8:11], s59 offen offset:0 sc1
    v_mfma_f32_32x32x16_bf16 a[48:63], a[140:143], a[136:139], a[48:63]
    buffer_load_dwordx4 a[232:235], v240, s[8:11], s59 offen offset:1024 sc1
    v_mfma_f32_32x32x16_bf16 a[80:95], v[192:195], a[136:139], a[80:95]
    buffer_load_dwordx4 a[236:239], v240, s[8:11], s59 offen offset:2048 sc1
    v_mfma_f32_32x32x16_bf16 v[0:15], v[100:103], v[108:111], v[0:15]
    buffer_load_dwordx4 a[128:131], v120, s[8:11], s45 offen offset:2048 sc1
    v_mfma_f32_32x32x16_bf16 v[32:47], a[140:143], v[108:111], v[32:47]
    buffer_load_dwordx4 v[104:107], v121, s[8:11], s45 offen offset:2048 sc1
    v_mfma_f32_32x32x16_bf16 v[64:79], v[192:195], v[108:111], v[64:79]
    buffer_load_dwordx4 a[124:127], v122, s[8:11], s45 offen offset:2048 sc1
    v_mfma_f32_32x32x16_bf16 v[16:31], v[100:103], v[96:99], v[16:31]
    v_mfma_f32_32x32x16_bf16 v[48:63], a[140:143], v[96:99], v[48:63]
    v_mfma_f32_32x32x16_bf16 v[80:95], v[192:195], v[96:99], v[80:95]
    s_waitcnt vmcnt(53)
    v_mfma_f32_32x32x16_bf16 a[0:15], v[116:119], a[144:147], a[0:15]
    v_mfma_f32_32x32x16_bf16 a[32:47], a[152:155], a[144:147], a[32:47]
    v_mfma_f32_32x32x16_bf16 a[64:79], v[208:211], a[144:147], a[64:79]
    buffer_load_dwordx4 a[240:243], v123, s[8:11], s45 offen offset:2048 sc1
    v_mfma_f32_32x32x16_bf16 a[16:31], v[116:119], a[148:151], a[16:31]
    s_add_u32 s59, s59, 18432
    buffer_load_dwordx4 a[244:247], v240, s[8:11], s59 offen offset:0 sc1
    v_mfma_f32_32x32x16_bf16 a[48:63], a[152:155], a[148:151], a[48:63]
    buffer_load_dwordx4 a[248:251], v240, s[8:11], s59 offen offset:1024 sc1
    v_mfma_f32_32x32x16_bf16 a[80:95], v[208:211], a[148:151], a[80:95]
    buffer_load_dwordx4 a[132:135], v240, s[8:11], s59 offen offset:2048 sc1
    v_mfma_f32_32x32x16_bf16 v[0:15], v[116:119], v[196:199], v[0:15]
    buffer_load_dwordx4 a[136:139], v120, s[8:11], s45 offen offset:3072 sc1
    v_mfma_f32_32x32x16_bf16 v[32:47], a[152:155], v[196:199], v[32:47]
    buffer_load_dwordx4 v[108:111], v121, s[8:11], s45 offen offset:3072 sc1
    v_mfma_f32_32x32x16_bf16 v[64:79], v[208:211], v[196:199], v[64:79]
    buffer_load_dwordx4 v[100:103], v122, s[8:11], s45 offen offset:3072 sc1
    v_mfma_f32_32x32x16_bf16 v[16:31], v[116:119], v[112:115], v[16:31]
    v_mfma_f32_32x32x16_bf16 v[48:63], a[152:155], v[112:115], v[48:63]
    v_mfma_f32_32x32x16_bf16 v[80:95], v[208:211], v[112:115], v[80:95]
    s_waitcnt vmcnt(53)
    v_mfma_f32_32x32x16_bf16 a[0:15], v[204:207], a[156:159], a[0:15]
    v_mfma_f32_32x32x16_bf16 a[32:47], a[164:167], a[156:159], a[32:47]
    v_mfma_f32_32x32x16_bf16 a[64:79], v[224:227], a[156:159], a[64:79]
    buffer_load_dwordx4 a[140:143], v123, s[8:11], s45 offen offset:3072 sc1
    v_mfma_f32_32x32x16_bf16 a[16:31], v[204:207], a[160:163], a[16:31]
    s_add_u32 s59, s59, 18432
    buffer_load_dwordx4 v[96:99], v240, s[8:11], s59 offen offset:0 sc1
    v_mfma_f32_32x32x16_bf16 a[48:63], a[164:167], a[160:163], a[48:63]
    buffer_load_dwordx4 v[192:195], v240, s[8:11], s59 offen offset:1024 sc1
    v_mfma_f32_32x32x16_bf16 a[80:95], v[224:227], a[160:163], a[80:95]
    buffer_load_dwordx4 a[144:147], v240, s[8:11], s59 offen offset:2048 sc1
    v_mfma_f32_32x32x16_bf16 v[0:15], v[204:207], v[212:215], v[0:15]
    s_add_u32 s45, s45, 4096
    buffer_load_dwordx4 a[148:151], v120, s[8:11], s45 offen offset:0 sc1
    v_mfma_f32_32x32x16_bf16 v[32:47], a[164:167], v[212:215], v[32:47]
    buffer_load_dwordx4 v[196:199], v121, s[8:11], s45 offen offset:0 sc1
    v_mfma_f32_32x32x16_bf16 v[64:79], v[224:227], v[212:215], v[64:79]
    buffer_load_dwordx4 v[116:119], v122, s[8:11], s45 offen offset:0 sc1
    v_mfma_f32_32x32x16_bf16 v[16:31], v[204:207], v[200:203], v[16:31]
    v_mfma_f32_32x32x16_bf16 v[48:63], a[164:167], v[200:203], v[48:63]
    v_mfma_f32_32x32x16_bf16 v[80:95], v[224:227], v[200:203], v[80:95]
    s_waitcnt vmcnt(53)
    v_mfma_f32_32x32x16_bf16 a[0:15], v[220:223], a[168:171], a[0:15]
    v_mfma_f32_32x32x16_bf16 a[32:47], a[176:179], a[168:171], a[32:47]
    v_mfma_f32_32x32x16_bf16 a[64:79], v[148:151], a[168:171], a[64:79]
    buffer_load_dwordx4 a[152:155], v123, s[8:11], s45 offen offset:0 sc1
    v_mfma_f32_32x32x16_bf16 a[16:31], v[220:223], a[172:175], a[16:31]
    s_add_u32 s59, s59, 18432
    buffer_load_dwordx4 v[112:115], v240, s[8:11], s59 offen offset:0 sc1
    v_mfma_f32_32x32x16_bf16 a[48:63], a[176:179], a[172:175], a[48:63]
    buffer_load_dwordx4 v[208:211], v240, s[8:11], s59 offen offset:1024 sc1
    v_mfma_f32_32x32x16_bf16 a[80:95], v[148:151], a[172:175], a[80:95]
    buffer_load_dwordx4 a[156:159], v240, s[8:11], s59 offen offset:2048 sc1
    v_mfma_f32_32x32x16_bf16 v[0:15], v[220:223], v[228:231], v[0:15]
    buffer_load_dwordx4 a[160:163], v120, s[8:11], s45 offen offset:1024 sc1
    v_mfma_f32_32x32x16_bf16 v[32:47], a[176:179], v[228:231], v[32:47]
    buffer_load_dwordx4 v[212:215], v121, s[8:11], s45 offen offset:1024 sc1
    v_mfma_f32_32x32x16_bf16 v[64:79], v[148:151], v[228:231], v[64:79]
    buffer_load_dwordx4 v[204:207], v122, s[8:11], s45 offen offset:1024 sc1
    v_mfma_f32_32x32x16_bf16 v[16:31], v[220:223], v[216:219], v[16:31]
    v_mfma_f32_32x32x16_bf16 v[48:63], a[176:179], v[216:219], v[48:63]
    v_mfma_f32_32x32x16_bf16 v[80:95], v[148:151], v[216:219], v[80:95]
    s_waitcnt vmcnt(53)
    v_mfma_f32_32x32x16_bf16 a[0:15], v[236:239], a[180:183], a[0:15]
    v_mfma_f32_32x32x16_bf16 a[32:47], a[188:191], a[180:183], a[32:47]
    v_mfma_f32_32x32x16_bf16 a[64:79], a[100:103], a[180:183], a[64:79]
    buffer_load_dwordx4 a[164:167], v123, s[8:11], s45 offen offset:1024 sc1
    v_mfma_f32_32x32x16_bf16 a[16:31], v[236:239], a[184:187], a[16:31]
    s_add_u32 s59, s59, 18432
    buffer_load_dwordx4 v[200:203], v240, s[8:11], s59 offen offset:0 sc1
    v_mfma_f32_32x32x16_bf16 a[48:63], a[188:191], a[184:187], a[48:63]
    buffer_load_dwordx4 v[224:227], v240, s[8:11], s59 offen offset:1024 sc1
    v_mfma_f32_32x32x16_bf16 a[80:95], a[100:103], a[184:187], a[80:95]
    buffer_load_dwordx4 a[168:171], v240, s[8:11], s59 offen offset:2048 sc1
    v_mfma_f32_32x32x16_bf16 v[0:15], v[236:239], v[152:155], v[0:15]
    buffer_load_dwordx4 a[172:175], v120, s[8:11], s45 offen offset:2048 sc1
    v_mfma_f32_32x32x16_bf16 v[32:47], a[188:191], v[152:155], v[32:47]
    buffer_load_dwordx4 v[228:231], v121, s[8:11], s45 offen offset:2048 sc1
    v_mfma_f32_32x32x16_bf16 v[64:79], a[100:103], v[152:155], v[64:79]
    buffer_load_dwordx4 v[220:223], v122, s[8:11], s45 offen offset:2048 sc1
    v_mfma_f32_32x32x16_bf16 v[16:31], v[236:239], v[232:235], v[16:31]
    v_mfma_f32_32x32x16_bf16 v[48:63], a[188:191], v[232:235], v[48:63]
    v_mfma_f32_32x32x16_bf16 v[80:95], a[100:103], v[232:235], v[80:95]
    s_waitcnt vmcnt(53)
    v_mfma_f32_32x32x16_bf16 a[0:15], a[96:99], a[192:195], a[0:15]
    v_mfma_f32_32x32x16_bf16 a[32:47], a[200:203], a[192:195], a[32:47]
    v_mfma_f32_32x32x16_bf16 a[64:79], v[168:171], a[192:195], a[64:79]
    buffer_load_dwordx4 a[176:179], v123, s[8:11], s45 offen offset:2048 sc1
    v_mfma_f32_32x32x16_bf16 a[16:31], a[96:99], a[196:199], a[16:31]
    s_add_u32 s59, s59, 18432
    buffer_load_dwordx4 v[216:219], v240, s[8:11], s59 offen offset:0 sc1
    v_mfma_f32_32x32x16_bf16 a[48:63], a[200:203], a[196:199], a[48:63]
    buffer_load_dwordx4 a[180:183], v240, s[8:11], s59 offen offset:1024 sc1
    v_mfma_f32_32x32x16_bf16 a[80:95], v[168:171], a[196:199], a[80:95]
    buffer_load_dwordx4 a[184:187], v240, s[8:11], s59 offen offset:2048 sc1
    v_mfma_f32_32x32x16_bf16 v[0:15], a[96:99], v[144:147], v[0:15]
    buffer_load_dwordx4 v[236:239], v120, s[8:11], s45 offen offset:3072 sc1
    v_mfma_f32_32x32x16_bf16 v[32:47], a[200:203], v[144:147], v[32:47]
    buffer_load_dwordx4 a[188:191], v121, s[8:11], s45 offen offset:3072 sc1
    v_mfma_f32_32x32x16_bf16 v[64:79], v[168:171], v[144:147], v[64:79]
    buffer_load_dwordx4 v[232:235], v122, s[8:11], s45 offen offset:3072 sc1
    v_mfma_f32_32x32x16_bf16 v[16:31], a[96:99], v[140:143], v[16:31]
    v_mfma_f32_32x32x16_bf16 v[48:63], a[200:203], v[140:143], v[48:63]
    v_mfma_f32_32x32x16_bf16 v[80:95], v[168:171], v[140:143], v[80:95]
    s_waitcnt vmcnt(53)
    v_mfma_f32_32x32x16_bf16 a[0:15], v[164:167], a[204:207], a[0:15]
    v_mfma_f32_32x32x16_bf16 a[32:47], a[212:215], a[204:207], a[32:47]
    v_mfma_f32_32x32x16_bf16 a[64:79], v[160:163], a[204:207], a[64:79]
    buffer_load_dwordx4 a[100:103], v123, s[8:11], s45 offen offset:3072 sc1
    v_mfma_f32_32x32x16_bf16 a[16:31], v[164:167], a[208:211], a[16:31]
    s_add_u32 s59, s59, 18432
    buffer_load_dwordx4 a[192:195], v240, s[8:11], s59 offen offset:0 sc1
    v_mfma_f32_32x32x16_bf16 a[48:63], a[212:215], a[208:211], a[48:63]
    buffer_load_dwordx4 a[196:199], v240, s[8:11], s59 offen offset:1024 sc1
    v_mfma_f32_32x32x16_bf16 a[80:95], v[160:163], a[208:211], a[80:95]
    buffer_load_dwordx4 a[96:99], v240, s[8:11], s59 offen offset:2048 sc1
    v_mfma_f32_32x32x16_bf16 v[0:15], v[164:167], v[156:159], v[0:15]
    s_add_u32 s45, s45, 4096
    buffer_load_dwordx4 a[200:203], v120, s[8:11], s45 offen offset:0 sc1
    v_mfma_f32_32x32x16_bf16 v[32:47], a[212:215], v[156:159], v[32:47]
    buffer_load_dwordx4 a[204:207], v121, s[8:11], s45 offen offset:0 sc1
    v_mfma_f32_32x32x16_bf16 v[64:79], v[160:163], v[156:159], v[64:79]
    buffer_load_dwordx4 a[208:211], v122, s[8:11], s45 offen offset:0 sc1
    v_mfma_f32_32x32x16_bf16 v[16:31], v[164:167], a[104:107], v[16:31]
    v_mfma_f32_32x32x16_bf16 v[48:63], a[212:215], a[104:107], v[48:63]
    v_mfma_f32_32x32x16_bf16 v[80:95], v[160:163], a[104:107], v[80:95]
    s_waitcnt vmcnt(53)
    v_mfma_f32_32x32x16_bf16 a[0:15], a[220:223], a[216:219], a[0:15]
    v_mfma_f32_32x32x16_bf16 a[32:47], a[112:115], a[216:219], a[32:47]
    v_mfma_f32_32x32x16_bf16 a[64:79], a[224:227], a[216:219], a[64:79]
    buffer_load_dwordx4 a[212:215], v123, s[8:11], s45 offen offset:0 sc1
    v_mfma_f32_32x32x16_bf16 a[16:31], a[220:223], v[172:175], a[16:31]
    s_add_u32 s59, s59, 18432
    buffer_load_dwordx4 a[104:107], v240, s[8:11], s59 offen offset:0 sc1
    v_mfma_f32_32x32x16_bf16 a[48:63], a[112:115], v[172:175], a[48:63]
    buffer_load_dwordx4 a[216:219], v240, s[8:11], s59 offen offset:1024 sc1
    v_mfma_f32_32x32x16_bf16 a[80:95], a[224:227], v[172:175], a[80:95]
    v_mfma_f32_32x32x16_bf16 v[0:15], a[220:223], a[116:119], v[0:15]
    v_mfma_f32_32x32x16_bf16 v[32:47], a[112:115], a[116:119], v[32:47]
    v_mfma_f32_32x32x16_bf16 v[64:79], a[224:227], a[116:119], v[64:79]
    buffer_load_dwordx4 a[116:119], v240, s[8:11], s59 offen offset:2048 sc1
    v_mfma_f32_32x32x16_bf16 v[16:31], a[220:223], a[108:111], v[16:31]
    buffer_load_dwordx4 a[220:223], v120, s[8:11], s45 offen offset:1024 sc1
    v_mfma_f32_32x32x16_bf16 v[48:63], a[112:115], a[108:111], v[48:63]
    buffer_load_dwordx4 a[112:115], v121, s[8:11], s45 offen offset:1024 sc1
    v_mfma_f32_32x32x16_bf16 v[80:95], a[224:227], a[108:111], v[80:95]
    buffer_load_dwordx4 a[108:111], v122, s[8:11], s45 offen offset:1024 sc1
    s_waitcnt vmcnt(52)
    v_mfma_f32_32x32x16_bf16 a[0:15], a[228:231], a[120:123], a[0:15]
    v_mfma_f32_32x32x16_bf16 a[32:47], a[232:235], a[120:123], a[32:47]
    v_mfma_f32_32x32x16_bf16 a[64:79], a[236:239], a[120:123], a[64:79]
    buffer_load_dwordx4 a[224:227], v123, s[8:11], s45 offen offset:1024 sc1
    v_mfma_f32_32x32x16_bf16 a[16:31], a[228:231], v[176:179], a[16:31]
    s_add_u32 s59, s59, 18432
    buffer_load_dwordx4 a[120:123], v240, s[8:11], s59 offen offset:0 sc1
    v_mfma_f32_32x32x16_bf16 a[48:63], a[232:235], v[176:179], a[48:63]
    v_mfma_f32_32x32x16_bf16 a[80:95], a[236:239], v[176:179], a[80:95]
    v_mfma_f32_32x32x16_bf16 v[0:15], a[228:231], v[180:183], v[0:15]
    v_mfma_f32_32x32x16_bf16 v[32:47], a[232:235], v[180:183], v[32:47]
    v_mfma_f32_32x32x16_bf16 v[64:79], a[236:239], v[180:183], v[64:79]
    v_mfma_f32_32x32x16_bf16 v[16:31], a[228:231], v[184:187], v[16:31]
    buffer_load_dwordx4 a[228:231], v240, s[8:11], s59 offen offset:1024 sc1
    v_mfma_f32_32x32x16_bf16 v[48:63], a[232:235], v[184:187], v[48:63]
    buffer_load_dwordx4 a[232:235], v240, s[8:11], s59 offen offset:2048 sc1
    v_mfma_f32_32x32x16_bf16 v[80:95], a[236:239], v[184:187], v[80:95]
    buffer_load_dwordx4 a[236:239], v120, s[8:11], s45 offen offset:2048 sc1
    s_waitcnt vmcnt(50)
    s_waitcnt vmcnt(63)
    s_mov_b32 s54, 0
    s_waitcnt lgkmcnt(0)
L_k3_selp:
    v_cmp_ne_u32 vcc, s58, v189
    s_cbranch_vccz L_k3_selok
    s_sleep 8
    buffer_load_dwordx2 v[188:189], v190, s[8:11], s55 offen sc1
    s_add_u32 s54, s54, 1
    s_cmp_lt_u32 s54, 0x40000
    s_waitcnt vmcnt(0)
    s_cbranch_scc1 L_k3_selp
L_k3_selok:
    v_readlane_b32 s64, v188, 0
    v_readlane_b32 s65, v188, 1
    v_readlane_b32 s66, v188, 2
    v_readlane_b32 s67, v188, 3
    v_readlane_b32 s68, v188, 4
    v_readlane_b32 s69, v188, 5
    v_readlane_b32 s70, v188, 6
    v_readlane_b32 s71, v188, 7
    v_readlane_b32 s72, v188, 8
    v_readlane_b32 s73, v188, 9
    v_readlane_b32 s74, v188, 10
    v_readlane_b32 s75, v188, 11
    v_readlane_b32 s76, v188, 12
    v_readlane_b32 s77, v188, 13
    v_readlane_b32 s78, v188, 14
    v_readlane_b32 s79, v188, 15
    buffer_load_dwordx2 v[164:165], v126, s[16:19], 0 offen offset:0
    buffer_load_dwordx2 v[176:177], v133, s[8:11], s62 offen offset:0 sc1
    buffer_load_dwordx2 v[166:167], v127, s[16:19], 0 offen offset:0
    buffer_load_dwordx2 v[178:179], v133, s[8:11], s63 offen offset:0 sc1
    buffer_load_dwordx2 v[168:169], v126, s[16:19], 0 offen offset:64
    buffer_load_dwordx2 v[180:181], v133, s[8:11], s62 offen offset:2048 sc1
    buffer_load_dwordx2 v[170:171], v127, s[16:19], 0 offen offset:64
    buffer_load_dwordx2 v[182:183], v133, s[8:11], s63 offen offset:2048 sc1
    buffer_load_dwordx2 v[172:173], v126, s[16:19], 0 offen offset:128
    buffer_load_dwordx2 v[184:185], v138, s[8:11], s62 offen offset:0 sc1
    buffer_load_dwordx2 v[174:175], v127, s[16:19], 0 offen offset:128
    buffer_load_dwordx2 v[186:187], v138, s[8:11], s63 offen offset:0 sc1
    v_mov_b32 v134, -1
    v_mov_b32 v136, 0
    v_cmp_eq_u32 vcc, s64, v128
    v_mov_b32 v246, 0
    v_mov_b32 v247, s72
    v_cndmask_b32 v134, v134, v246, vcc
    v_cndmask_b32 v136, v136, v247, vcc
    v_cmp_eq_u32 vcc, s65, v128
    v_mov_b32 v246, 2304
    v_mov_b32 v247, s73
    v_cndmask_b32 v134, v134, v246, vcc
    v_cndmask_b32 v136, v136, v247, vcc
    v_cmp_eq_u32 vcc, s66, v128
    v_mov_b32 v246, 4608
    v_mov_b32 v247, s74
    v_cndmask_b32 v134, v134, v246, vcc
    v_cndmask_b32 v136, v136, v247, vcc
    v_cmp_eq_u32 vcc, s67, v128
    v_mov_b32 v246, 6912
    v_mov_b32 v247, s75
    v_cndmask_b32 v134, v134, v246, vcc
    v_cndmask_b32 v136, v136, v247, vcc
    v_cmp_eq_u32 vcc, s68, v128
    v_mov_b32 v246, 9216
    v_mov_b32 v247, s76
    v_cndmask_b32 v134, v134, v246, vcc
    v_cndmask_b32 v136, v136, v247, vcc
    v_cmp_eq_u32 vcc, s69, v128
    v_mov_b32 v246, 11520
    v_mov_b32 v247, s77
    v_cndmask_b32 v134, v134, v246, vcc
    v_cndmask_b32 v136, v136, v247, vcc
    v_cmp_eq_u32 vcc, s70, v128
    v_mov_b32 v246, 13824
    v_mov_b32 v247, s78
    v_cndmask_b32 v134, v134, v246, vcc
    v_cndmask_b32 v136, v136, v247, vcc
    v_cmp_eq_u32 vcc, s71, v128
    v_mov_b32 v246, 16128
    v_mov_b32 v247, s79
    v_cndmask_b32 v134, v134, v246, vcc
    v_cndmask_b32 v136, v136, v247, vcc
    v_mov_b32 v135, -1
    v_mov_b32 v137, 0
    v_cmp_eq_u32 vcc, s64, v129
    v_mov_b32 v246, 0
    v_mov_b32 v247, s72
    v_cndmask_b32 v135, v135, v246, vcc
    v_cndmask_b32 v137, v137, v247, vcc
    v_cmp_eq_u32 vcc, s65, v129
    v_mov_b32 v246, 2304
    v_mov_b32 v247, s73
    v_cndmask_b32 v135, v135, v246, vcc
    v_cndmask_b32 v137, v137, v247, vcc
    v_cmp_eq_u32 vcc, s66, v129
    v_mov_b32 v246, 4608
    v_mov_b32 v247, s74
    v_cndmask_b32 v135, v135, v246, vcc
    v_cndmask_b32 v137, v137, v247, vcc
    v_cmp_eq_u32 vcc, s67, v129
    v_mov_b32 v246, 6912
    v_mov_b32 v247, s75
    v_cndmask_b32 v135, v135, v246, vcc
    v_cndmask_b32 v137, v137, v247, vcc
    v_cmp_eq_u32 vcc, s68, v129
    v_mov_b32 v246, 9216
    v_mov_b32 v247, s76
    v_cndmask_b32 v135, v135, v246, vcc
    v_cndmask_b32 v137, v137, v247, vcc
    v_cmp_eq_u32 vcc, s69, v129
    v_mov_b32 v246, 11520
    v_mov_b32 v247, s77
    v_cndmask_b32 v135, v135, v246, vcc
    v_cndmask_b32 v137, v137, v247, vcc
    v_cmp_eq_u32 vcc, s70, v129
    v_mov_b32 v246, 13824
    v_mov_b32 v247, s78
    v_cndmask_b32 v135, v135, v246, vcc
    v_cndmask_b32 v137, v137, v247, vcc
    v_cmp_eq_u32 vcc, s71, v129
    v_mov_b32 v246, 16128
    v_mov_b32 v247, s79
    v_cndmask_b32 v135, v135, v246, vcc
    v_cndmask_b32 v137, v137, v247, vcc
    v_mfma_f32_32x32x16_bf16 a[0:15], a[244:247], a[124:127], a[0:15]
    v_mfma_f32_32x32x16_bf16 a[32:47], a[248:251], a[124:127], a[32:47]
    v_mfma_f32_32x32x16_bf16 a[64:79], a[132:135], a[124:127], a[64:79]
    v_mfma_f32_32x32x16_bf16 a[16:31], a[244:247], a[240:243], a[16:31]
    v_mfma_f32_32x32x16_bf16 a[48:63], a[248:251], a[240:243], a[48:63]
    v_mfma_f32_32x32x16_bf16 a[80:95], a[132:135], a[240:243], a[80:95]
    v_mfma_f32_32x32x16_bf16 v[0:15], a[244:247], a[128:131], v[0:15]
    v_mfma_f32_32x32x16_bf16 v[32:47], a[248:251], a[128:131], v[32:47]
    v_mfma_f32_32x32x16_bf16 v[64:79], a[132:135], a[128:131], v[64:79]
    v_mfma_f32_32x32x16_bf16 v[16:31], a[244:247], v[104:107], v[16:31]
    v_mfma_f32_32x32x16_bf16 v[48:63], a[248:251], v[104:107], v[48:63]
    v_mfma_f32_32x32x16_bf16 v[80:95], a[132:135], v[104:107], v[80:95]
    s_waitcnt vmcnt(55)
    v_mfma_f32_32x32x16_bf16 a[0:15], v[96:99], v[100:103], a[0:15]
    v_mfma_f32_32x32x16_bf16 a[32:47], v[192:195], v[100:103], a[32:47]
    v_mfma_f32_32x32x16_bf16 a[64:79], a[144:147], v[100:103], a[64:79]
    buffer_load_dwordx4 a[124:127], v121, s[8:11], s45 offen offset:2048 sc1
    v_mfma_f32_32x32x16_bf16 a[16:31], v[96:99], a[140:143], a[16:31]
    buffer_load_dwordx4 a[240:243], v122, s[8:11], s45 offen offset:2048 sc1
    v_mfma_f32_32x32x16_bf16 a[48:63], v[192:195], a[140:143], a[48:63]
    buffer_load_dwordx4 a[128:131], v123, s[8:11], s45 offen offset:2048 sc1
    v_mfma_f32_32x32x16_bf16 a[80:95], a[144:147], a[140:143], a[80:95]
    s_add_u32 s59, s59, 18432
    buffer_load_dwordx4 a[244:247], v240, s[8:11], s59 offen offset:0 sc1
    v_mfma_f32_32x32x16_bf16 v[0:15], v[96:99], a[136:139], v[0:15]
    buffer_load_dwordx4 a[248:251], v240, s[8:11], s59 offen offset:1024 sc1
    v_mfma_f32_32x32x16_bf16 v[32:47], v[192:195], a[136:139], v[32:47]
    v_mfma_f32_32x32x16_bf16 v[64:79], a[144:147], a[136:139], v[64:79]
    v_mfma_f32_32x32x16_bf16 v[16:31], v[96:99], v[108:111], v[16:31]
    v_mfma_f32_32x32x16_bf16 v[48:63], v[192:195], v[108:111], v[48:63]
    v_mfma_f32_32x32x16_bf16 v[80:95], a[144:147], v[108:111], v[80:95]
    s_waitcnt vmcnt(53)
    v_mfma_f32_32x32x16_bf16 a[0:15], v[112:115], v[116:119], a[0:15]
    v_mfma_f32_32x32x16_bf16 a[32:47], v[208:211], v[116:119], a[32:47]
    v_mfma_f32_32x32x16_bf16 a[64:79], a[156:159], v[116:119], a[64:79]
    buffer_load_dwordx4 v[104:107], v240, s[8:11], s59 offen offset:2048 sc1
    v_mfma_f32_32x32x16_bf16 a[16:31], v[112:115], a[152:155], a[16:31]
    buffer_load_dwordx4 a[132:135], v120, s[8:11], s45 offen offset:3072 sc1
    v_mfma_f32_32x32x16_bf16 a[48:63], v[208:211], a[152:155], a[48:63]
    buffer_load_dwordx4 v[100:103], v121, s[8:11], s45 offen offset:3072 sc1
    v_mfma_f32_32x32x16_bf16 a[80:95], a[156:159], a[152:155], a[80:95]
    buffer_load_dwordx4 a[140:143], v122, s[8:11], s45 offen offset:3072 sc1
    v_mfma_f32_32x32x16_bf16 v[0:15], v[112:115], a[148:151], v[0:15]
    buffer_load_dwordx4 a[136:139], v123, s[8:11], s45 offen offset:3072 sc1
    v_mfma_f32_32x32x16_bf16 v[32:47], v[208:211], a[148:151], v[32:47]
    s_add_u32 s59, s59, 18432
    buffer_load_dwordx4 v[96:99], v240, s[8:11], s59 offen offset:0 sc1
    v_mfma_f32_32x32x16_bf16 v[64:79], a[156:159], a[148:151], v[64:79]
    buffer_load_dwordx4 v[192:195], v240, s[8:11], s59 offen offset:1024 sc1
    v_mfma_f32_32x32x16_bf16 v[16:31], v[112:115], v[196:199], v[16:31]
    v_mfma_f32_32x32x16_bf16 v[48:63], v[208:211], v[196:199], v[48:63]
    v_mfma_f32_32x32x16_bf16 v[80:95], a[156:159], v[196:199], v[80:95]
    s_waitcnt vmcnt(53)
    v_mfma_f32_32x32x16_bf16 a[0:15], v[200:203], v[204:207], a[0:15]
    v_mfma_f32_32x32x16_bf16 a[32:47], v[224:227], v[204:207], a[32:47]
    v_mfma_f32_32x32x16_bf16 a[64:79], a[168:171], v[204:207], a[64:79]
    buffer_load_dwordx4 v[108:111], v240, s[8:11], s59 offen offset:2048 sc1
    v_mfma_f32_32x32x16_bf16 a[16:31], v[200:203], a[164:167], a[16:31]
    v_mfma_f32_32x32x16_bf16 a[48:63], v[224:227], a[164:167], a[48:63]
    v_mfma_f32_32x32x16_bf16 a[80:95], a[168:171], a[164:167], a[80:95]
    v_mfma_f32_32x32x16_bf16 v[0:15], v[200:203], a[160:163], v[0:15]
    v_mfma_f32_32x32x16_bf16 v[32:47], v[224:227], a[160:163], v[32:47]
    v_mfma_f32_32x32x16_bf16 v[64:79], a[168:171], a[160:163], v[64:79]
    v_mfma_f32_32x32x16_bf16 v[16:31], v[200:203], v[212:215], v[16:31]
    v_mfma_f32_32x32x16_bf16 v[48:63], v[224:227], v[212:215], v[48:63]
    v_mfma_f32_32x32x16_bf16 v[80:95], a[168:171], v[212:215], v[80:95]
    s_waitcnt vmcnt(47)
    v_mfma_f32_32x32x16_bf16 a[0:15], v[216:219], v[220:223], a[0:15]
    v_mfma_f32_32x32x16_bf16 a[32:47], a[180:183], v[220:223], a[32:47]
    v_mfma_f32_32x32x16_bf16 a[64:79], a[184:187], v[220:223], a[64:79]
    v_mfma_f32_32x32x16_bf16 a[16:31], v[216:219], a[176:179], a[16:31]
    v_mfma_f32_32x32x16_bf16 a[48:63], a[180:183], a[176:179], a[48:63]
    v_mfma_f32_32x32x16_bf16 a[80:95], a[184:187], a[176:179], a[80:95]
    v_mfma_f32_32x32x16_bf16 v[0:15], v[216:219], a[172:175], v[0:15]
    v_mfma_f32_32x32x16_bf16 v[32:47], a[180:183], a[172:175], v[32:47]
    v_mfma_f32_32x32x16_bf16 v[64:79], a[184:187], a[172:175], v[64:79]
    v_mfma_f32_32x32x16_bf16 v[16:31], v[216:219], v[228:231], v[16:31]
    v_mfma_f32_32x32x16_bf16 v[48:63], a[180:183], v[228:231], v[48:63]
    v_mfma_f32_32x32x16_bf16 v[80:95], a[184:187], v[228:231], v[80:95]
    s_waitcnt vmcnt(40)
    v_mfma_f32_32x32x16_bf16 a[0:15], a[192:195], v[232:235], a[0:15]
    v_mfma_f32_32x32x16_bf16 a[32:47], a[196:199], v[232:235], a[32:47]
    v_mfma_f32_32x32x16_bf16 a[64:79], a[96:99], v[232:235], a[64:79]
    v_mfma_f32_32x32x16_bf16 a[16:31], a[192:195], a[100:103], a[16:31]
    v_mfma_f32_32x32x16_bf16 a[48:63], a[196:199], a[100:103], a[48:63]
    v_mfma_f32_32x32x16_bf16 a[80:95], a[96:99], a[100:103], a[80:95]
    v_mfma_f32_32x32x16_bf16 v[0:15], a[192:195], v[236:239], v[0:15]
    v_mfma_f32_32x32x16_bf16 v[32:47], a[196:199], v[236:239], v[32:47]
    v_mfma_f32_32x32x16_bf16 v[64:79], a[96:99], v[236:239], v[64:79]
    v_mfma_f32_32x32x16_bf16 v[16:31], a[192:195], a[188:191], v[16:31]
    v_mfma_f32_32x32x16_bf16 v[48:63], a[196:199], a[188:191], v[48:63]
    v_mfma_f32_32x32x16_bf16 v[80:95], a[96:99], a[188:191], v[80:95]
    s_waitcnt vmcnt(33)
    v_mfma_f32_32x32x16_bf16 a[0:15], a[104:107], a[208:211], a[0:15]
    v_mfma_f32_32x32x16_bf16 a[32:47], a[216:219], a[208:211], a[32:47]
    v_mfma_f32_32x32x16_bf16 a[64:79], a[116:119], a[208:211], a[64:79]
    v_mfma_f32_32x32x16_bf16 a[16:31], a[104:107], a[212:215], a[16:31]
    v_mfma_f32_32x32x16_bf16 a[48:63], a[216:219], a[212:215], a[48:63]
    v_mfma_f32_32x32x16_bf16 a[80:95], a[116:119], a[212:215], a[80:95]
    v_mfma_f32_32x32x16_bf16 v[0:15], a[104:107], a[200:203], v[0:15]
    v_mfma_f32_32x32x16_bf16 v[32:47], a[216:219], a[200:203], v[32:47]
    v_mfma_f32_32x32x16_bf16 v[64:79], a[116:119], a[200:203], v[64:79]
    v_mfma_f32_32x32x16_bf16 v[16:31], a[104:107], a[204:207], v[16:31]
    v_mfma_f32_32x32x16_bf16 v[48:63], a[216:219], a[204:207], v[48:63]
    v_mfma_f32_32x32x16_bf16 v[80:95], a[116:119], a[204:207], v[80:95]
    s_waitcnt vmcnt(26)
    v_mfma_f32_32x32x16_bf16 a[0:15], a[120:123], a[108:111], a[0:15]
    v_mfma_f32_32x32x16_bf16 a[32:47], a[228:231], a[108:111], a[32:47]
    v_mfma_f32_32x32x16_bf16 a[64:79], a[232:235], a[108:111], a[64:79]
    v_mfma_f32_32x32x16_bf16 a[16:31], a[120:123], a[224:227], a[16:31]
    v_mfma_f32_32x32x16_bf16 a[48:63], a[228:231], a[224:227], a[48:63]
    v_mfma_f32_32x32x16_bf16 a[80:95], a[232:235], a[224:227], a[80:95]
    v_mfma_f32_32x32x16_bf16 v[0:15], a[120:123], a[220:223], v[0:15]
    v_mfma_f32_32x32x16_bf16 v[32:47], a[228:231], a[220:223], v[32:47]
    v_mfma_f32_32x32x16_bf16 v[64:79], a[232:235], a[220:223], v[64:79]
    v_mfma_f32_32x32x16_bf16 v[16:31], a[120:123], a[112:115], v[16:31]
    v_mfma_f32_32x32x16_bf16 v[48:63], a[228:231], a[112:115], v[48:63]
    v_mfma_f32_32x32x16_bf16 v[80:95], a[232:235], a[112:115], v[80:95]
    s_waitcnt vmcnt(7)
    v_mfma_f32_32x32x16_bf16 a[0:15], a[244:247], a[240:243], a[0:15]
    v_mfma_f32_32x32x16_bf16 a[32:47], a[248:251], a[240:243], a[32:47]
    v_mfma_f32_32x32x16_bf16 a[64:79], v[104:107], a[240:243], a[64:79]
    v_mfma_f32_32x32x16_bf16 a[16:31], a[244:247], a[128:131], a[16:31]
    v_mfma_f32_32x32x16_bf16 a[48:63], a[248:251], a[128:131], a[48:63]
    v_mfma_f32_32x32x16_bf16 a[80:95], v[104:107], a[128:131], a[80:95]
    v_mfma_f32_32x32x16_bf16 v[0:15], a[244:247], a[236:239], v[0:15]
    v_mfma_f32_32x32x16_bf16 v[32:47], a[248:251], a[236:239], v[32:47]
    v_mfma_f32_32x32x16_bf16 v[64:79], v[104:107], a[236:239], v[64:79]
    v_mfma_f32_32x32x16_bf16 v[16:31], a[244:247], a[124:127], v[16:31]
    v_mfma_f32_32x32x16_bf16 v[48:63], a[248:251], a[124:127], v[48:63]
    v_mfma_f32_32x32x16_bf16 v[80:95], v[104:107], a[124:127], v[80:95]
    s_waitcnt vmcnt(0)
    v_mfma_f32_32x32x16_bf16 a[0:15], v[96:99], a[140:143], a[0:15]
    v_mfma_f32_32x32x16_bf16 a[32:47], v[192:195], a[140:143], a[32:47]
    v_mfma_f32_32x32x16_bf16 a[64:79], v[108:111], a[140:143], a[64:79]
    v_mfma_f32_32x32x16_bf16 a[16:31], v[96:99], a[136:139], a[16:31]
    v_mfma_f32_32x32x16_bf16 a[48:63], v[192:195], a[136:139], a[48:63]
    v_mfma_f32_32x32x16_bf16 a[80:95], v[108:111], a[136:139], a[80:95]
    v_mfma_f32_32x32x16_bf16 v[0:15], v[96:99], a[132:135], v[0:15]
    v_mfma_f32_32x32x16_bf16 v[32:47], v[192:195], a[132:135], v[32:47]
    v_mfma_f32_32x32x16_bf16 v[64:79], v[108:111], a[132:135], v[64:79]
    v_mfma_f32_32x32x16_bf16 v[16:31], v[96:99], v[100:103], v[16:31]
    v_mfma_f32_32x32x16_bf16 v[48:63], v[192:195], v[100:103], v[48:63]
    v_mfma_f32_32x32x16_bf16 v[80:95], v[108:111], v[100:103], v[80:95]
    s_waitcnt vmcnt(13)
    v_add_u32 v130, 36864, v240
    v_add_u32 v131, 73728, v240
    v_add_u32 v132, 110592, v240
    s_cmp_eq_u32 s44, 0
    s_cbranch_scc0 L_k3_x1
    ds_write_b128 v130, a[4:7] offset:30720
    ds_write_b128 v130, a[20:23] offset:31744
    ds_write_b128 v130, a[36:39] offset:32768
    ds_write_b128 v130, a[52:55] offset:33792
    ds_write_b128 v130, a[68:71] offset:34816
    ds_write_b128 v130, a[84:87] offset:35840
    ds_write_b128 v131, a[8:11] offset:18432
    ds_write_b128 v131, a[24:27] offset:19456
    ds_write_b128 v131, a[40:43] offset:20480
    ds_write_b128 v131, a[56:59] offset:21504
    ds_write_b128 v131, a[72:75] offset:22528
    ds_write_b128 v131, a[88:91] offset:23552
    ds_write_b128 v132, a[12:15] offset:6144
    ds_write_b128 v132, a[28:31] offset:7168
    ds_write_b128 v132, a[44:47] offset:8192
    ds_write_b128 v132, a[60:63] offset:9216
    ds_write_b128 v132, a[76:79] offset:10240
    ds_write_b128 v132, a[92:95] offset:11264
    ds_write_b128 v130, v[4:7] offset:24576
    ds_write_b128 v130, v[20:23] offset:25600
    ds_write_b128 v130, v[36:39] offset:26624
    ds_write_b128 v130, v[52:55] offset:27648
    ds_write_b128 v130, v[68:71] offset:28672
    ds_write_b128 v130, v[84:87] offset:29696
    ds_write_b128 v131, v[8:11] offset:12288
    ds_write_b128 v131, v[24:27] offset:13312
    ds_write_b128 v131, v[40:43] offset:14336
    ds_write_b128 v131, v[56:59] offset:15360
    ds_write_b128 v131, v[72:75] offset:16384
    ds_write_b128 v131, v[88:91] offset:17408
    ds_write_b128 v132, v[12:15] offset:0
    ds_write_b128 v132, v[28:31] offset:1024
    ds_write_b128 v132, v[44:47] offset:2048
    ds_write_b128 v132, v[60:63] offset:3072
    ds_write_b128 v132, v[76:79] offset:4096
    ds_write_b128 v132, v[92:95] offset:5120
    v_accvgpr_read_b32 v96, a0
    v_accvgpr_read_b32 v97, a1
    v_accvgpr_read_b32 v98, a2
    v_accvgpr_read_b32 v99, a3
    v_accvgpr_read_b32 v100, a16
    v_accvgpr_read_b32 v101, a17
    v_accvgpr_read_b32 v102, a18
    v_accvgpr_read_b32 v103, a19
    v_accvgpr_read_b32 v104, a32
    v_accvgpr_read_b32 v105, a33
    v_accvgpr_read_b32 v106, a34
    v_accvgpr_read_b32 v107, a35
    v_accvgpr_read_b32 v108, a48
    v_accvgpr_read_b32 v109, a49
    v_accvgpr_read_b32 v110, a50
    v_accvgpr_read_b32 v111, a51
    v_accvgpr_read_b32 v112, a64
    v_accvgpr_read_b32 v113, a65
    v_accvgpr_read_b32 v114, a66
    v_accvgpr_read_b32 v115, a67
    v_accvgpr_read_b32 v116, a80
    v_accvgpr_read_b32 v117, a81
    v_accvgpr_read_b32 v118, a82
    v_accvgpr_read_b32 v119, a83
    v_mov_b32 v133, v240
    s_branch L_k3_x4
L_k3_x1:
    s_cmp_eq_u32 s44, 1
    s_cbranch_scc0 L_k3_x2
    ds_write_b128 v240, a[0:3] offset:6144
    ds_write_b128 v240, a[16:19] offset:7168
    ds_write_b128 v240, a[32:35] offset:8192
    ds_write_b128 v240, a[48:51] offset:9216
    ds_write_b128 v240, a[64:67] offset:10240
    ds_write_b128 v240, a[80:83] offset:11264
    ds_write_b128 v131, a[8:11] offset:30720
    ds_write_b128 v131, a[24:27] offset:31744
    ds_write_b128 v131, a[40:43] offset:32768
    ds_write_b128 v131, a[56:59] offset:33792
    ds_write_b128 v131, a[72:75] offset:34816
    ds_write_b128 v131, a[88:91] offset:35840
    ds_write_b128 v132, a[12:15] offset:18432
    ds_write_b128 v132, a[28:31] offset:19456
    ds_write_b128 v132, a[44:47] offset:20480
    ds_write_b128 v132, a[60:63] offset:21504
    ds_write_b128 v132, a[76:79] offset:22528
    ds_write_b128 v132, a[92:95] offset:23552
    ds_write_b128 v240, v[0:3] offset:0
    ds_write_b128 v240, v[16:19] offset:1024
    ds_write_b128 v240, v[32:35] offset:2048
    ds_write_b128 v240, v[48:51] offset:3072
    ds_write_b128 v240, v[64:67] offset:4096
    ds_write_b128 v240, v[80:83] offset:5120
    ds_write_b128 v131, v[8:11] offset:24576
    ds_write_b128 v131, v[24:27] offset:25600
    ds_write_b128 v131, v[40:43] offset:26624
    ds_write_b128 v131, v[56:59] offset:27648
    ds_write_b128 v131, v[72:75] offset:28672
    ds_write_b128 v131, v[88:91] offset:29696
    ds_write_b128 v132, v[12:15] offset:12288
    ds_write_b128 v132, v[28:31] offset:13312
    ds_write_b128 v132, v[44:47] offset:14336
    ds_write_b128 v132, v[60:63] offset:15360
    ds_write_b128 v132, v[76:79] offset:16384
    ds_write_b128 v132, v[92:95] offset:17408
    v_accvgpr_read_b32 v96, a4
    v_accvgpr_read_b32 v97, a5
    v_accvgpr_read_b32 v98, a6
    v_accvgpr_read_b32 v99, a7
    v_accvgpr_read_b32 v100, a20
    v_accvgpr_read_b32 v101, a21
    v_accvgpr_read_b32 v102, a22
    v_accvgpr_read_b32 v103, a23
    v_accvgpr_read_b32 v104, a36
    v_accvgpr_read_b32 v105, a37
    v_accvgpr_read_b32 v106, a38
    v_accvgpr_read_b32 v107, a39
    v_accvgpr_read_b32 v108, a52
    v_accvgpr_read_b32 v109, a53
    v_accvgpr_read_b32 v110, a54
    v_accvgpr_read_b32 v111, a55
    v_accvgpr_read_b32 v112, a68
    v_accvgpr_read_b32 v113, a69
    v_accvgpr_read_b32 v114, a70
    v_accvgpr_read_b32 v115, a71
    v_accvgpr_read_b32 v116, a84
    v_accvgpr_read_b32 v117, a85
    v_accvgpr_read_b32 v118, a86
    v_accvgpr_read_b32 v119, a87
    v_pk_add_f32 v[0:1], v[4:5], 0 op_sel_hi:[1,0]
    v_pk_add_f32 v[2:3], v[6:7], 0 op_sel_hi:[1,0]
    v_pk_add_f32 v[16:17], v[20:21], 0 op_sel_hi:[1,0]
    v_pk_add_f32 v[18:19], v[22:23], 0 op_sel_hi:[1,0]
    v_pk_add_f32 v[32:33], v[36:37], 0 op_sel_hi:[1,0]
    v_pk_add_f32 v[34:35], v[38:39], 0 op_sel_hi:[1,0]
    v_pk_add_f32 v[48:49], v[52:53], 0 op_sel_hi:[1,0]
    v_pk_add_f32 v[50:51], v[54:55], 0 op_sel_hi:[1,0]
    v_pk_add_f32 v[64:65], v[68:69], 0 op_sel_hi:[1,0]
    v_pk_add_f32 v[66:67], v[70:71], 0 op_sel_hi:[1,0]
    v_pk_add_f32 v[80:81], v[84:85], 0 op_sel_hi:[1,0]
    v_pk_add_f32 v[82:83], v[86:87], 0 op_sel_hi:[1,0]
    v_mov_b32 v133, v130
    s_branch L_k3_x4
L_k3_x2:
    s_cmp_eq_u32 s44, 2
    s_cbranch_scc0 L_k3_x3
    ds_write_b128 v240, a[0:3] offset:18432
    ds_write_b128 v240, a[16:19] offset:19456
    ds_write_b128 v240, a[32:35] offset:20480
    ds_write_b128 v240, a[48:51] offset:21504
    ds_write_b128 v240, a[64:67] offset:22528
    ds_write_b128 v240, a[80:83] offset:23552
    ds_write_b128 v130, a[4:7] offset:6144
    ds_write_b128 v130, a[20:23] offset:7168
    ds_write_b128 v130, a[36:39] offset:8192
    ds_write_b128 v130, a[52:55] offset:9216
    ds_write_b128 v130, a[68:71] offset:10240
    ds_write_b128 v130, a[84:87] offset:11264
    ds_write_b128 v132, a[12:15] offset:30720
    ds_write_b128 v132, a[28:31] offset:31744
    ds_write_b128 v132, a[44:47] offset:32768
    ds_write_b128 v132, a[60:63] offset:33792
    ds_write_b128 v132, a[76:79] offset:34816
    ds_write_b128 v132, a[92:95] offset:35840
    ds_write_b128 v240, v[0:3] offset:12288
    ds_write_b128 v240, v[16:19] offset:13312
    ds_write_b128 v240, v[32:35] offset:14336
    ds_write_b128 v240, v[48:51] offset:15360
    ds_write_b128 v240, v[64:67] offset:16384
    ds_write_b128 v240, v[80:83] offset:17408
    ds_write_b128 v130, v[4:7] offset:0
    ds_write_b128 v130, v[20:23] offset:1024
    ds_write_b128 v130, v[36:39] offset:2048
    ds_write_b128 v130, v[52:55] offset:3072
    ds_write_b128 v130, v[68:71] offset:4096
    ds_write_b128 v130, v[84:87] offset:5120
    ds_write_b128 v132, v[12:15] offset:24576
    ds_write_b128 v132, v[28:31] offset:25600
    ds_write_b128 v132, v[44:47] offset:26624
    ds_write_b128 v132, v[60:63] offset:27648
    ds_write_b128 v132, v[76:79] offset:28672
    ds_write_b128 v132, v[92:95] offset:29696
    v_accvgpr_read_b32 v96, a8
    v_accvgpr_read_b32 v97, a9
    v_accvgpr_read_b32 v98, a10
    v_accvgpr_read_b32 v99, a11
    v_accvgpr_read_b32 v100, a24
    v_accvgpr_read_b32 v101, a25
    v_accvgpr_read_b32 v102, a26
    v_accvgpr_read_b32 v103, a27
    v_accvgpr_read_b32 v104, a40
    v_accvgpr_read_b32 v105, a41
    v_accvgpr_read_b32 v106, a42
    v_accvgpr_read_b32 v107, a43
    v_accvgpr_read_b32 v108, a56
    v_accvgpr_read_b32 v109, a57
    v_accvgpr_read_b32 v110, a58
    v_accvgpr_read_b32 v111, a59
    v_accvgpr_read_b32 v112, a72
    v_accvgpr_read_b32 v113, a73
    v_accvgpr_read_b32 v114, a74
    v_accvgpr_read_b32 v115, a75
    v_accvgpr_read_b32 v116, a88
    v_accvgpr_read_b32 v117, a89
    v_accvgpr_read_b32 v118, a90
    v_accvgpr_read_b32 v119, a91
    v_pk_add_f32 v[0:1], v[8:9], 0 op_sel_hi:[1,0]
    v_pk_add_f32 v[2:3], v[10:11], 0 op_sel_hi:[1,0]
    v_pk_add_f32 v[16:17], v[24:25], 0 op_sel_hi:[1,0]
    v_pk_add_f32 v[18:19], v[26:27], 0 op_sel_hi:[1,0]
    v_pk_add_f32 v[32:33], v[40:41], 0 op_sel_hi:[1,0]
    v_pk_add_f32 v[34:35], v[42:43], 0 op_sel_hi:[1,0]
    v_pk_add_f32 v[48:49], v[56:57], 0 op_sel_hi:[1,0]
    v_pk_add_f32 v[50:51], v[58:59], 0 op_sel_hi:[1,0]
    v_pk_add_f32 v[64:65], v[72:73], 0 op_sel_hi:[1,0]
    v_pk_add_f32 v[66:67], v[74:75], 0 op_sel_hi:[1,0]
    v_pk_add_f32 v[80:81], v[88:89], 0 op_sel_hi:[1,0]
    v_pk_add_f32 v[82:83], v[90:91], 0 op_sel_hi:[1,0]
    v_mov_b32 v133, v131
    s_branch L_k3_x4
L_k3_x3:
    ds_write_b128 v240, a[0:3] offset:30720
    ds_write_b128 v240, a[16:19] offset:31744
    ds_write_b128 v240, a[32:35] offset:32768
    ds_write_b128 v240, a[48:51] offset:33792
    ds_write_b128 v240, a[64:67] offset:34816
    ds_write_b128 v240, a[80:83] offset:35840
    ds_write_b128 v130, a[4:7] offset:18432
    ds_write_b128 v130, a[20:23] offset:19456
    ds_write_b128 v130, a[36:39] offset:20480
    ds_write_b128 v130, a[52:55] offset:21504
    ds_write_b128 v130, a[68:71] offset:22528
    ds_write_b128 v130, a[84:87] offset:23552
    ds_write_b128 v131, a[8:11] offset:6144
    ds_write_b128 v131, a[24:27] offset:7168
    ds_write_b128 v131, a[40:43] offset:8192
    ds_write_b128 v131, a[56:59] offset:9216
    ds_write_b128 v131, a[72:75] offset:10240
    ds_write_b128 v131, a[88:91] offset:11264
    ds_write_b128 v240, v[0:3] offset:24576
    ds_write_b128 v240, v[16:19] offset:25600
    ds_write_b128 v240, v[32:35] offset:26624
    ds_write_b128 v240, v[48:51] offset:27648
    ds_write_b128 v240, v[64:67] offset:28672
    ds_write_b128 v240, v[80:83] offset:29696
    ds_write_b128 v130, v[4:7] offset:12288
    ds_write_b128 v130, v[20:23] offset:13312
    ds_write_b128 v130, v[36:39] offset:14336
    ds_write_b128 v130, v[52:55] offset:15360
    ds_write_b128 v130, v[68:71] offset:16384
    ds_write_b128 v130, v[84:87] offset:17408
    ds_write_b128 v131, v[8:11] offset:0
    ds_write_b128 v131, v[24:27] offset:1024
    ds_write_b128 v131, v[40:43] offset:2048
    ds_write_b128 v131, v[56:59] offset:3072
    ds_write_b128 v131, v[72:75] offset:4096
    ds_write_b128 v131, v[88:91] offset:5120
    v_accvgpr_read_b32 v96, a12
    v_accvgpr_read_b32 v97, a13
    v_accvgpr_read_b32 v98, a14
    v_accvgpr_read_b32 v99, a15
    v_accvgpr_read_b32 v100, a28
    v_accvgpr_read_b32 v101, a29
    v_accvgpr_read_b32 v102, a30
    v_accvgpr_read_b32 v103, a31
    v_accvgpr_read_b32 v104, a44
    v_accvgpr_read_b32 v105, a45
    v_accvgpr_read_b32 v106, a46
    v_accvgpr_read_b32 v107, a47
    v_accvgpr_read_b32 v108, a60
    v_accvgpr_read_b32 v109, a61
    v_accvgpr_read_b32 v110, a62
    v_accvgpr_read_b32 v111, a63
    v_accvgpr_read_b32 v112, a76
    v_accvgpr_read_b32 v113, a77
    v_accvgpr_read_b32 v114, a78
    v_accvgpr_read_b32 v115, a79
    v_accvgpr_read_b32 v116, a92
    v_accvgpr_read_b32 v117, a93
    v_accvgpr_read_b32 v118, a94
    v_accvgpr_read_b32 v119, a95
    v_pk_add_f32 v[0:1], v[12:13], 0 op_sel_hi:[1,0]
    v_pk_add_f32 v[2:3], v[14:15], 0 op_sel_hi:[1,0]
    v_pk_add_f32 v[16:17], v[28:29], 0 op_sel_hi:[1,0]
    v_pk_add_f32 v[18:19], v[30:31], 0 op_sel_hi:[1,0]
    v_pk_add_f32 v[32:33], v[44:45], 0 op_sel_hi:[1,0]
    v_pk_add_f32 v[34:35], v[46:47], 0 op_sel_hi:[1,0]
    v_pk_add_f32 v[48:49], v[60:61], 0 op_sel_hi:[1,0]
    v_pk_add_f32 v[50:51], v[62:63], 0 op_sel_hi:[1,0]
    v_pk_add_f32 v[64:65], v[76:77], 0 op_sel_hi:[1,0]
    v_pk_add_f32 v[66:67], v[78:79], 0 op_sel_hi:[1,0]
    v_pk_add_f32 v[80:81], v[92:93], 0 op_sel_hi:[1,0]
    v_pk_add_f32 v[82:83], v[94:95], 0 op_sel_hi:[1,0]
    v_mov_b32 v133, v132
L_k3_x4:
    v_lshlrev_b32 v140, 16, v164
    v_lshlrev_b32 v248, 16, v176
    v_and_b32 v141, 0xffff0000, v164
    v_and_b32 v247, 0xffff0000, v176
    v_add_f32 v140, v140, v248
    v_add_f32 v141, v141, v247
    v_lshlrev_b32 v142, 16, v165
    v_lshlrev_b32 v248, 16, v177
    v_and_b32 v143, 0xffff0000, v165
    v_and_b32 v247, 0xffff0000, v177
    v_add_f32 v142, v142, v248
    v_add_f32 v143, v143, v247
    v_lshlrev_b32 v144, 16, v166
    v_lshlrev_b32 v248, 16, v178
    v_and_b32 v145, 0xffff0000, v166
    v_and_b32 v247, 0xffff0000, v178
    v_add_f32 v144, v144, v248
    v_add_f32 v145, v145, v247
    v_lshlrev_b32 v146, 16, v167
    v_lshlrev_b32 v248, 16, v179
    v_and_b32 v147, 0xffff0000, v167
    v_and_b32 v247, 0xffff0000, v179
    v_add_f32 v146, v146, v248
    v_add_f32 v147, v147, v247
    v_lshlrev_b32 v148, 16, v168
    v_lshlrev_b32 v248, 16, v180
    v_and_b32 v149, 0xffff0000, v168
    v_and_b32 v247, 0xffff0000, v180
    v_add_f32 v148, v148, v248
    v_add_f32 v149, v149, v247
    v_lshlrev_b32 v150, 16, v169
    v_lshlrev_b32 v248, 16, v181
    v_and_b32 v151, 0xffff0000, v169
    v_and_b32 v247, 0xffff0000, v181
    v_add_f32 v150, v150, v248
    v_add_f32 v151, v151, v247
    v_lshlrev_b32 v152, 16, v170
    v_lshlrev_b32 v248, 16, v182
    v_and_b32 v153, 0xffff0000, v170
    v_and_b32 v247, 0xffff0000, v182
    v_add_f32 v152, v152, v248
    v_add_f32 v153, v153, v247
    v_lshlrev_b32 v154, 16, v171
    v_lshlrev_b32 v248, 16, v183
    v_and_b32 v155, 0xffff0000, v171
    v_and_b32 v247, 0xffff0000, v183
    v_add_f32 v154, v154, v248
    v_add_f32 v155, v155, v247
    v_lshlrev_b32 v156, 16, v172
    v_lshlrev_b32 v248, 16, v184
    v_and_b32 v157, 0xffff0000, v172
    v_and_b32 v247, 0xffff0000, v184
    v_add_f32 v156, v156, v248
    v_add_f32 v157, v157, v247
    v_lshlrev_b32 v158, 16, v173
    v_lshlrev_b32 v248, 16, v185
    v_and_b32 v159, 0xffff0000, v173
    v_and_b32 v247, 0xffff0000, v185
    v_add_f32 v158, v158, v248
    v_add_f32 v159, v159, v247
    v_lshlrev_b32 v160, 16, v174
    v_lshlrev_b32 v248, 16, v186
    v_and_b32 v161, 0xffff0000, v174
    v_and_b32 v247, 0xffff0000, v186
    v_add_f32 v160, v160, v248
    v_add_f32 v161, v161, v247
    v_lshlrev_b32 v162, 16, v175
    v_lshlrev_b32 v248, 16, v187
    v_and_b32 v163, 0xffff0000, v175
    v_and_b32 v247, 0xffff0000, v187
    v_add_f32 v162, v162, v248
    v_add_f32 v163, v163, v247
    s_lshl_b32 s60, s2, 2
    s_add_u32 s60, s60, s44
    s_mul_i32 s62, s60, 6144
    s_add_u32 s62, s62, 0x4800000
    s_xor_b32 s60, s60, 4
    s_mul_i32 s60, s60, 6144
    s_add_u32 s60, s60, 0x4800000
    s_add_u32 s61, s60, 3072
    s_lshl_b32 s48, s2, 7
    s_lshl_b32 s63, s44, 2
    s_add_u32 s48, s48, s63
    s_add_u32 s48, s48, 32
    s_xor_b32 s63, s48, 128
    v_mov_b32 v253, s63
    s_add_u32 s48, s48, 0x490000
    v_mov_b32 v254, s58
    s_waitcnt lgkmcnt(0)
    s_barrier
    ds_read_b128 v[192:195], v133 offset:6144
    ds_read_b128 v[196:199], v133 offset:18432
    ds_read_b128 v[200:203], v133 offset:30720
    ds_read_b128 v[204:207], v133 offset:7168
    ds_read_b128 v[208:211], v133 offset:19456
    ds_read_b128 v[212:215], v133 offset:31744
    ds_read_b128 v[216:219], v133 offset:8192
    ds_read_b128 v[220:223], v133 offset:20480
    ds_read_b128 v[224:227], v133 offset:32768
    s_waitcnt lgkmcnt(6)
    v_pk_add_f32 v[192:193], v[192:193], v[196:197]
    v_pk_add_f32 v[96:97], v[96:97], v[200:201]
    v_pk_add_f32 v[194:195], v[194:195], v[198:199]
    v_pk_add_f32 v[98:99], v[98:99], v[202:203]
    v_pk_add_f32 v[96:97], v[96:97], v[192:193]
    v_pk_add_f32 v[98:99], v[98:99], v[194:195]
    buffer_store_dwordx4 v[96:99], v240, s[8:11], s62 offen offset:0 sc1
    s_waitcnt lgkmcnt(3)
    v_pk_add_f32 v[204:205], v[204:205], v[208:209]
    v_pk_add_f32 v[100:101], v[100:101], v[212:213]
    v_pk_add_f32 v[206:207], v[206:207], v[210:211]
    v_pk_add_f32 v[102:103], v[102:103], v[214:215]
    v_pk_add_f32 v[100:101], v[100:101], v[204:205]
    v_pk_add_f32 v[102:103], v[102:103], v[206:207]
    buffer_store_dwordx4 v[100:103], v240, s[8:11], s62 offen offset:1024 sc1
    s_waitcnt lgkmcnt(0)
    v_pk_add_f32 v[216:217], v[216:217], v[220:221]
    v_pk_add_f32 v[104:105], v[104:105], v[224:225]
    v_pk_add_f32 v[218:219], v[218:219], v[222:223]
    v_pk_add_f32 v[106:107], v[106:107], v[226:227]
    v_pk_add_f32 v[104:105], v[104:105], v[216:217]
    v_pk_add_f32 v[106:107], v[106:107], v[218:219]
    buffer_store_dwordx4 v[104:107], v240, s[8:11], s62 offen offset:2048 sc1
    s_add_u32 s62, s62, 3072
    ds_read_b128 v[192:195], v133 offset:9216
    ds_read_b128 v[196:199], v133 offset:21504
    ds_read_b128 v[200:203], v133 offset:33792
    ds_read_b128 v[204:207], v133 offset:10240
    ds_read_b128 v[208:211], v133 offset:22528
    ds_read_b128 v[212:215], v133 offset:34816
    ds_read_b128 v[216:219], v133 offset:11264
    ds_read_b128 v[220:223], v133 offset:23552
    ds_read_b128 v[224:227], v133 offset:35840
    s_waitcnt lgkmcnt(6)
    v_pk_add_f32 v[192:193], v[192:193], v[196:197]
    v_pk_add_f32 v[108:109], v[108:109], v[200:201]
    v_pk_add_f32 v[194:195], v[194:195], v[198:199]
    v_pk_add_f32 v[110:111], v[110:111], v[202:203]
    v_pk_add_f32 v[108:109], v[108:109], v[192:193]
    v_pk_add_f32 v[110:111], v[110:111], v[194:195]
    buffer_store_dwordx4 v[108:111], v240, s[8:11], s62 offen offset:0 sc1
    s_waitcnt lgkmcnt(3)
    v_pk_add_f32 v[204:205], v[204:205], v[208:209]
    v_pk_add_f32 v[112:113], v[112:113], v[212:213]
    v_pk_add_f32 v[206:207], v[206:207], v[210:211]
    v_pk_add_f32 v[114:115], v[114:115], v[214:215]
    v_pk_add_f32 v[112:113], v[112:113], v[204:205]
    v_pk_add_f32 v[114:115], v[114:115], v[206:207]
    buffer_store_dwordx4 v[112:115], v240, s[8:11], s62 offen offset:1024 sc1
    s_waitcnt lgkmcnt(0)
    v_pk_add_f32 v[216:217], v[216:217], v[220:221]
    v_pk_add_f32 v[116:117], v[116:117], v[224:225]
    v_pk_add_f32 v[218:219], v[218:219], v[222:223]
    v_pk_add_f32 v[118:119], v[118:119], v[226:227]
    v_pk_add_f32 v[116:117], v[116:117], v[216:217]
    v_pk_add_f32 v[118:119], v[118:119], v[218:219]
    buffer_store_dwordx4 v[116:119], v240, s[8:11], s62 offen offset:2048 sc1
    ds_read_b128 v[4:7], v133 offset:0
    ds_read_b128 v[8:11], v133 offset:12288
    ds_read_b128 v[12:15], v133 offset:24576
    ds_read_b128 v[20:23], v133 offset:1024
    ds_read_b128 v[24:27], v133 offset:13312
    ds_read_b128 v[28:31], v133 offset:25600
    ds_read_b128 v[36:39], v133 offset:2048
    ds_read_b128 v[40:43], v133 offset:14336
    ds_read_b128 v[44:47], v133 offset:26624
    ds_read_b128 v[52:55], v133 offset:3072
    ds_read_b128 v[56:59], v133 offset:15360
    ds_read_b128 v[60:63], v133 offset:27648
    ds_read_b128 v[68:71], v133 offset:4096
    ds_read_b128 v[72:75], v133 offset:16384
    ds_read_b128 v[76:79], v133 offset:28672
    ds_read_b128 v[84:87], v133 offset:5120
    ds_read_b128 v[88:91], v133 offset:17408
    ds_read_b128 v[92:95], v133 offset:29696
    s_waitcnt vmcnt(0)
    s_mov_b64 exec, 1
    buffer_store_dword v254, v255, s[8:11], s48 offen sc1
    s_mov_b64 exec, -1
    buffer_load_dword v250, v253, s[8:11], s57 offen sc1
    v_mov_b32 v96, 0
    v_mov_b32 v97, 0
    v_mov_b32 v98, 0
    v_mov_b32 v99, 0
    v_mov_b32 v100, 0
    v_mov_b32 v101, 0
    v_mov_b32 v102, 0
    v_mov_b32 v103, 0
    v_mov_b32 v104, 0
    v_mov_b32 v105, 0
    v_mov_b32 v106, 0
    v_mov_b32 v107, 0
    v_mov_b32 v108, 0
    v_mov_b32 v109, 0
    v_mov_b32 v110, 0
    v_mov_b32 v111, 0
    v_mov_b32 v112, 0
    v_mov_b32 v113, 0
    v_mov_b32 v114, 0
    v_mov_b32 v115, 0
    v_mov_b32 v116, 0
    v_mov_b32 v117, 0
    v_mov_b32 v118, 0
    v_mov_b32 v119, 0
    v_max_i32 v246, v134, v135
    v_cmp_le_i32 vcc, 0, v246
    s_cbranch_vccz L_k3_nosel
    s_mov_b32 s54, 0
L_k3_poll:
    buffer_load_dword v246, v255, s[40:43], 0 offen offset:128 sc1
    s_waitcnt vmcnt(0)
    v_readfirstlane_b32 s55, v246
    s_add_u32 s54, s54, 1
    s_cmp_ge_u32 s55, 48
    s_cbranch_scc1 L_k3_polled
    s_sleep 8
    s_cmp_lt_u32 s54, 0x40000
    s_cbranch_scc1 L_k3_poll
L_k3_polled:
    s_mov_b32 s54, 0x483000
    v_lshl_add_u32 v246, v139, 1, v134
    v_cmp_le_i32 vcc, 0, v134
    s_and_saveexec_b64 s[52:53], vcc
    s_cbranch_execz L_k3_sel_142
    buffer_load_dwordx4 v[96:99], v246, s[8:11], s54 offen offset:0 sc1
    buffer_load_dwordx4 v[104:107], v246, s[8:11], s54 offen offset:128 sc1
    buffer_load_dwordx4 v[112:115], v246, s[8:11], s54 offen offset:256 sc1
L_k3_sel_142:
    s_mov_b64 exec, s[52:53]
    v_lshl_add_u32 v246, v139, 1, v135
    v_cmp_le_i32 vcc, 0, v135
    s_and_saveexec_b64 s[52:53], vcc
    s_cbranch_execz L_k3_sel_143
    buffer_load_dwordx4 v[100:103], v246, s[8:11], s54 offen offset:0 sc1
    buffer_load_dwordx4 v[108:111], v246, s[8:11], s54 offen offset:128 sc1
    buffer_load_dwordx4 v[116:119], v246, s[8:11], s54 offen offset:256 sc1
L_k3_sel_143:
    s_mov_b64 exec, s[52:53]
L_k3_nosel:
    s_waitcnt lgkmcnt(15)
    v_pk_add_f32 v[0:1], v[0:1], v[4:5]
    v_pk_add_f32 v[8:9], v[8:9], v[12:13]
    v_pk_add_f32 v[2:3], v[2:3], v[6:7]
    v_pk_add_f32 v[10:11], v[10:11], v[14:15]
    v_pk_add_f32 v[0:1], v[0:1], v[140:141]
    v_pk_add_f32 v[2:3], v[2:3], v[142:143]
    v_pk_add_f32 v[0:1], v[0:1], v[8:9]
    v_pk_add_f32 v[2:3], v[2:3], v[10:11]
    s_waitcnt lgkmcnt(12)
    v_pk_add_f32 v[16:17], v[16:17], v[20:21]
    v_pk_add_f32 v[24:25], v[24:25], v[28:29]
    v_pk_add_f32 v[18:19], v[18:19], v[22:23]
    v_pk_add_f32 v[26:27], v[26:27], v[30:31]
    v_pk_add_f32 v[16:17], v[16:17], v[144:145]
    v_pk_add_f32 v[18:19], v[18:19], v[146:147]
    v_pk_add_f32 v[16:17], v[16:17], v[24:25]
    v_pk_add_f32 v[18:19], v[18:19], v[26:27]
    s_waitcnt lgkmcnt(9)
    v_pk_add_f32 v[32:33], v[32:33], v[36:37]
    v_pk_add_f32 v[40:41], v[40:41], v[44:45]
    v_pk_add_f32 v[34:35], v[34:35], v[38:39]
    v_pk_add_f32 v[42:43], v[42:43], v[46:47]
    v_pk_add_f32 v[32:33], v[32:33], v[148:149]
    v_pk_add_f32 v[34:35], v[34:35], v[150:151]
    v_pk_add_f32 v[32:33], v[32:33], v[40:41]
    v_pk_add_f32 v[34:35], v[34:35], v[42:43]
    s_waitcnt lgkmcnt(6)
    v_pk_add_f32 v[48:49], v[48:49], v[52:53]
    v_pk_add_f32 v[56:57], v[56:57], v[60:61]
    v_pk_add_f32 v[50:51], v[50:51], v[54:55]
    v_pk_add_f32 v[58:59], v[58:59], v[62:63]
    v_pk_add_f32 v[48:49], v[48:49], v[152:153]
    v_pk_add_f32 v[50:51], v[50:51], v[154:155]
    v_pk_add_f32 v[48:49], v[48:49], v[56:57]
    v_pk_add_f32 v[50:51], v[50:51], v[58:59]
    s_waitcnt lgkmcnt(3)
    v_pk_add_f32 v[64:65], v[64:65], v[68:69]
    v_pk_add_f32 v[72:73], v[72:73], v[76:77]
    v_pk_add_f32 v[66:67], v[66:67], v[70:71]
    v_pk_add_f32 v[74:75], v[74:75], v[78:79]
    v_pk_add_f32 v[64:65], v[64:65], v[156:157]
    v_pk_add_f32 v[66:67], v[66:67], v[158:159]
    v_pk_add_f32 v[64:65], v[64:65], v[72:73]
    v_pk_add_f32 v[66:67], v[66:67], v[74:75]
    s_waitcnt lgkmcnt(0)
    v_pk_add_f32 v[80:81], v[80:81], v[84:85]
    v_pk_add_f32 v[88:89], v[88:89], v[92:93]
    v_pk_add_f32 v[82:83], v[82:83], v[86:87]
    v_pk_add_f32 v[90:91], v[90:91], v[94:95]
    v_pk_add_f32 v[80:81], v[80:81], v[160:161]
    v_pk_add_f32 v[82:83], v[82:83], v[162:163]
    v_pk_add_f32 v[80:81], v[80:81], v[88:89]
    v_pk_add_f32 v[82:83], v[82:83], v[90:91]
    s_waitcnt vmcnt(0)
    v_mov_b32 v254, v250
    s_mov_b32 s63, 0
L_ka_fl_part:
    v_cmp_ne_u32 vcc, s58, v254
    s_cbranch_vccz L_ka_fl_part_ok
    s_sleep 8
    buffer_load_dword v254, v253, s[8:11], s57 offen sc1
    s_add_u32 s63, s63, 1
    s_cmp_lt_u32 s63, 0x40000
    s_waitcnt vmcnt(0)
    s_cbranch_scc1 L_ka_fl_part
L_ka_fl_part_ok:
    buffer_load_dwordx4 v[192:195], v240, s[8:11], s60 offen offset:0 sc1
    buffer_load_dwordx4 v[196:199], v240, s[8:11], s60 offen offset:1024 sc1
    buffer_load_dwordx4 v[200:203], v240, s[8:11], s60 offen offset:2048 sc1
    buffer_load_dwordx4 v[204:207], v240, s[8:11], s61 offen offset:0 sc1
    buffer_load_dwordx4 v[208:211], v240, s[8:11], s61 offen offset:1024 sc1
    buffer_load_dwordx4 v[212:215], v240, s[8:11], s61 offen offset:2048 sc1
    v_fmac_f32 v0, v96, v136
    v_fmac_f32 v1, v97, v136
    v_fmac_f32 v2, v98, v136
    v_fmac_f32 v3, v99, v136
    v_fmac_f32 v16, v100, v137
    v_fmac_f32 v17, v101, v137
    v_fmac_f32 v18, v102, v137
    v_fmac_f32 v19, v103, v137
    v_fmac_f32 v32, v104, v136
    v_fmac_f32 v33, v105, v136
    v_fmac_f32 v34, v106, v136
    v_fmac_f32 v35, v107, v136
    v_fmac_f32 v48, v108, v137
    v_fmac_f32 v49, v109, v137
    v_fmac_f32 v50, v110, v137
    v_fmac_f32 v51, v111, v137
    v_fmac_f32 v64, v112, v136
    v_fmac_f32 v65, v113, v136
    v_fmac_f32 v66, v114, v136
    v_fmac_f32 v67, v115, v136
    v_fmac_f32 v80, v116, v137
    v_fmac_f32 v81, v117, v137
    v_fmac_f32 v82, v118, v137
    v_fmac_f32 v83, v119, v137
    s_waitcnt vmcnt(5)
    v_pk_add_f32 v[0:1], v[0:1], v[192:193]
    v_pk_add_f32 v[2:3], v[2:3], v[194:195]
    v_cvt_pk_bf16_f32 v4, v0, v1
    v_cvt_pk_bf16_f32 v5, v2, v3
    buffer_store_dwordx2 v[4:5], v126, s[20:23], 0 offen offset:0
    s_waitcnt vmcnt(5)
    v_pk_add_f32 v[16:17], v[16:17], v[196:197]
    v_pk_add_f32 v[18:19], v[18:19], v[198:199]
    v_cvt_pk_bf16_f32 v20, v16, v17
    v_cvt_pk_bf16_f32 v21, v18, v19
    buffer_store_dwordx2 v[20:21], v127, s[20:23], 0 offen offset:0
    s_waitcnt vmcnt(5)
    v_pk_add_f32 v[32:33], v[32:33], v[200:201]
    v_pk_add_f32 v[34:35], v[34:35], v[202:203]
    v_cvt_pk_bf16_f32 v36, v32, v33
    v_cvt_pk_bf16_f32 v37, v34, v35
    buffer_store_dwordx2 v[36:37], v126, s[20:23], 0 offen offset:64
    s_waitcnt vmcnt(5)
    v_pk_add_f32 v[48:49], v[48:49], v[204:205]
    v_pk_add_f32 v[50:51], v[50:51], v[206:207]
    v_cvt_pk_bf16_f32 v52, v48, v49
    v_cvt_pk_bf16_f32 v53, v50, v51
    buffer_store_dwordx2 v[52:53], v127, s[20:23], 0 offen offset:64
    s_waitcnt vmcnt(5)
    v_pk_add_f32 v[64:65], v[64:65], v[208:209]
    v_pk_add_f32 v[66:67], v[66:67], v[210:211]
    v_cvt_pk_bf16_f32 v68, v64, v65
    v_cvt_pk_bf16_f32 v69, v66, v67
    buffer_store_dwordx2 v[68:69], v126, s[20:23], 0 offen offset:128
    s_waitcnt vmcnt(5)
    v_pk_add_f32 v[80:81], v[80:81], v[212:213]
    v_pk_add_f32 v[82:83], v[82:83], v[214:215]
    v_cvt_pk_bf16_f32 v84, v80, v81
    v_cvt_pk_bf16_f32 v85, v82, v83
    buffer_store_dwordx2 v[84:85], v127, s[20:23], 0 offen offset:128
    s_endpgm
L_k3_ffn:
    s_cmp_lt_u32 s2, 208
    s_cbranch_scc1 L_k2_nof2
    s_mov_b32 s62, 0
    s_mov_b32 s61, 0x482000
    s_waitcnt vmcnt(16)
L_k2_fsel:
    v_cmp_ne_u32 vcc, s58, v211
    s_cbranch_vccz L_k2_fselok
    s_sleep 8
    buffer_load_dwordx2 v[210:211], v212, s[8:11], s61 offen sc1
    s_add_u32 s62, s62, 1
    s_cmp_lt_u32 s62, 0x40000
    s_waitcnt vmcnt(0)
    s_cbranch_scc1 L_k2_fsel
L_k2_fselok:
    v_lshrrev_b32 v213, 5, v210
    v_mul_u32_u24 v213, 36864, v213
    v_and_b32 v214, 31, v210
    v_lshl_add_u32 v213, v214, 4, v213
    v_lshrrev_b32 v214, 5, v241
    v_lshl_add_u32 v213, v214, 9, v213
    v_and_b32 v214, 31, v241
    v_cmp_gt_u32 vcc, 8, v214
    v_mov_b32 v205, 0x40000000
    s_mul_i32 s61, s44, 9216
    v_cndmask_b32 v205, v205, v213, vcc
    buffer_load_dwordx4 a[216:219], v205, s[8:11], s61 offen offset:0 sc1
    buffer_load_dwordx4 a[220:223], v205, s[8:11], s61 offen offset:1024 sc1
    buffer_load_dwordx4 a[224:227], v205, s[8:11], s61 offen offset:2048 sc1
    buffer_load_dwordx4 a[228:231], v205, s[8:11], s61 offen offset:3072 sc1
    s_add_u32 s61, s61, 4096
    buffer_load_dwordx4 a[232:235], v205, s[8:11], s61 offen offset:0 sc1
    buffer_load_dwordx4 a[236:239], v205, s[8:11], s61 offen offset:1024 sc1
    buffer_load_dwordx4 a[240:243], v205, s[8:11], s61 offen offset:2048 sc1
    buffer_load_dwordx4 a[244:247], v205, s[8:11], s61 offen offset:3072 sc1
    s_add_u32 s61, s61, 4096
    buffer_load_dwordx4 a[248:251], v205, s[8:11], s61 offen offset:0 sc1
    buffer_load_dwordx4 a[96:99], v200, s[12:15], s60 offen
    buffer_load_dwordx4 a[100:103], v201, s[12:15], s60 offen
    buffer_load_dwordx4 a[104:107], v202, s[12:15], s60 offen
    buffer_load_dwordx4 a[108:111], v200, s[28:31], s60 offen
    buffer_load_dwordx4 a[112:115], v201, s[28:31], s60 offen
    buffer_load_dwordx4 a[116:119], v202, s[28:31], s60 offen
    s_add_u32 s60, s60, 147456
    buffer_load_dwordx4 a[120:123], v200, s[12:15], s60 offen
    buffer_load_dwordx4 a[124:127], v201, s[12:15], s60 offen
    buffer_load_dwordx4 a[128:131], v202, s[12:15], s60 offen
    buffer_load_dwordx4 a[132:135], v200, s[28:31], s60 offen
    buffer_load_dwordx4 a[136:139], v201, s[28:31], s60 offen
    buffer_load_dwordx4 a[140:143], v202, s[28:31], s60 offen
    s_add_u32 s60, s60, 147456
    buffer_load_dwordx4 a[144:147], v200, s[12:15], s60 offen
    buffer_load_dwordx4 a[148:151], v201, s[12:15], s60 offen
    buffer_load_dwordx4 a[152:155], v202, s[12:15], s60 offen
    buffer_load_dwordx4 a[156:159], v200, s[28:31], s60 offen
    buffer_load_dwordx4 a[160:163], v201, s[28:31], s60 offen
    buffer_load_dwordx4 a[164:167], v202, s[28:31], s60 offen
    s_add_u32 s60, s60, 147456
L_k2_nof2:
    s_mov_b32 s54, s60
    s_waitcnt vmcnt(27)
    s_barrier
    s_cmp_lg_u32 s44, 3
    s_cbranch_scc1 L_ka_pc_f
    s_lshl_b32 s63, s2, 7
    s_add_u32 s63, s63, 0x490000
    v_mov_b32 v254, s58
    s_mov_b64 exec, 1
    buffer_store_dword v254, v255, s[8:11], s63 offen offset:8 sc1
    buffer_store_dword v254, v255, s[8:11], s63 offen offset:16 sc1
    s_mov_b64 exec, -1
L_ka_pc_f:
    s_load_dwordx2 s[32:33], s[0:1], 80
    s_mul_i32 s49, s36, 6
    s_add_u32 s49, s49, s37
    s_sub_u32 s49, s49, 26
    buffer_load_dwordx4 a[168:171], v200, s[12:15], s54 offen
    buffer_load_dwordx4 a[172:175], v201, s[12:15], s54 offen
    buffer_load_dwordx4 a[176:179], v202, s[12:15], s54 offen
    buffer_load_dwordx4 a[180:183], v200, s[28:31], s54 offen
    buffer_load_dwordx4 a[184:187], v201, s[28:31], s54 offen
    buffer_load_dwordx4 a[188:191], v202, s[28:31], s54 offen
    s_add_u32 s54, s54, 147456
    buffer_load_dwordx4 a[192:195], v200, s[12:15], s54 offen
    buffer_load_dwordx4 a[196:199], v201, s[12:15], s54 offen
    buffer_load_dwordx4 a[200:203], v202, s[12:15], s54 offen
    buffer_load_dwordx4 a[204:207], v200, s[28:31], s54 offen
    buffer_load_dwordx4 a[208:211], v201, s[28:31], s54 offen
    buffer_load_dwordx4 a[212:215], v202, s[28:31], s54 offen
    s_add_u32 s54, s54, 147456
    buffer_load_dwordx4 a[0:3], v200, s[12:15], s54 offen
    buffer_load_dwordx4 a[4:7], v201, s[12:15], s54 offen
    buffer_load_dwordx4 a[8:11], v202, s[12:15], s54 offen
    buffer_load_dwordx4 a[12:15], v200, s[28:31], s54 offen
    buffer_load_dwordx4 a[16:19], v201, s[28:31], s54 offen
    buffer_load_dwordx4 a[20:23], v202, s[28:31], s54 offen
    s_add_u32 s54, s54, 147456
    buffer_load_dwordx4 a[24:27], v200, s[12:15], s54 offen
    buffer_load_dwordx4 a[28:31], v201, s[12:15], s54 offen
    buffer_load_dwordx4 a[32:35], v202, s[12:15], s54 offen
    buffer_load_dwordx4 a[36:39], v200, s[28:31], s54 offen
    buffer_load_dwordx4 a[40:43], v201, s[28:31], s54 offen
    buffer_load_dwordx4 a[44:47], v202, s[28:31], s54 offen
    s_add_u32 s54, s54, 147456
    v_lshlrev_b32 v206, 4, v241
    s_mul_i32 s47, s44, 12288
    s_add_u32 s47, s47, 110592
    v_add_u32 v203, s47, v206
    v_bfe_u32 v245, v241, 4, 1
    v_lshlrev_b32 v245, 5, v245
    v_and_b32 v246, 3, v241
    v_lshl_add_u32 v245, v246, 3, v245
    v_lshrrev_b32 v244, 5, v241
    v_bfe_u32 v246, v241, 2, 2
    v_lshl_add_u32 v247, v244, 3, v246
    v_mul_u32_u24 v247, 192, v247
    v_add_u32 v247, v247, v245
    v_add_u32 v204, s47, v247
    v_lshl_add_u32 v247, v244, 2, v246
    v_mul_u32_u24 v247, 1152, v247
    v_add_u32 v247, v247, v245
    s_lshl_b32 s61, s44, 6
    v_add_u32 v207, s61, v247
    v_add_u32 v208, 55296, v207
    s_mov_b32 s34, 0x510000
    s_mov_b32 s35, 0x00020000
    s_waitcnt lgkmcnt(0)
    s_mul_i32 s63, s44, 27648
    s_mul_i32 s61, s49, 110592
    s_add_u32 s61, s61, s63
    s_waitcnt vmcnt(39)
    ds_write_b128 v203, a[96:99] offset:0
    ds_write_b128 v203, a[100:103] offset:1024
    ds_write_b128 v203, a[104:107] offset:2048
    ds_read_b64_tr_b16 v[132:133], v204 offset:0
    ds_read_b64_tr_b16 v[134:135], v204 offset:768
    ds_read_b64_tr_b16 v[136:137], v204 offset:64
    ds_read_b64_tr_b16 v[138:139], v204 offset:832
    ds_read_b64_tr_b16 v[140:141], v204 offset:128
    ds_read_b64_tr_b16 v[142:143], v204 offset:896
    buffer_load_dwordx4 a[48:51], v200, s[12:15], s54 offen
    buffer_load_dwordx4 a[52:55], v201, s[12:15], s54 offen
    buffer_load_dwordx4 a[56:59], v202, s[12:15], s54 offen
    buffer_load_dwordx4 a[60:63], v200, s[28:31], s54 offen
    buffer_load_dwordx4 a[64:67], v201, s[28:31], s54 offen
    buffer_load_dwordx4 a[68:71], v202, s[28:31], s54 offen
    s_add_u32 s54, s54, 147456
    s_waitcnt vmcnt(42)
    ds_write_b128 v203, a[108:111] offset:3072
    ds_write_b128 v203, a[112:115] offset:4096
    ds_write_b128 v203, a[116:119] offset:5120
    ds_read_b64_tr_b16 v[144:145], v204 offset:3072
    ds_read_b64_tr_b16 v[146:147], v204 offset:3840
    ds_read_b64_tr_b16 v[148:149], v204 offset:3136
    ds_read_b64_tr_b16 v[150:151], v204 offset:3904
    ds_read_b64_tr_b16 v[152:153], v204 offset:3200
    ds_read_b64_tr_b16 v[154:155], v204 offset:3968
    s_waitcnt lgkmcnt(9)
    v_mfma_f32_32x32x16_bf16 v[0:15], v[132:135], a[216:219], 0
    v_mfma_f32_32x32x16_bf16 v[16:31], v[136:139], a[216:219], 0
    v_mfma_f32_32x32x16_bf16 v[32:47], v[140:143], a[216:219], 0
    s_waitcnt vmcnt(39)
    ds_write_b128 v203, a[120:123] offset:6144
    ds_write_b128 v203, a[124:127] offset:7168
    ds_write_b128 v203, a[128:131] offset:8192
    ds_read_b64_tr_b16 v[132:133], v204 offset:6144
    ds_read_b64_tr_b16 v[134:135], v204 offset:6912
    ds_read_b64_tr_b16 v[136:137], v204 offset:6208
    ds_read_b64_tr_b16 v[138:139], v204 offset:6976
    ds_read_b64_tr_b16 v[140:141], v204 offset:6272
    ds_read_b64_tr_b16 v[142:143], v204 offset:7040
    s_waitcnt lgkmcnt(9)
    v_mfma_f32_32x32x16_bf16 v[48:63], v[144:147], a[216:219], 0
    v_mfma_f32_32x32x16_bf16 v[64:79], v[148:151], a[216:219], 0
    v_mfma_f32_32x32x16_bf16 v[80:95], v[152:155], a[216:219], 0
    buffer_load_dwordx4 a[72:75], v200, s[12:15], s54 offen
    buffer_load_dwordx4 a[76:79], v201, s[12:15], s54 offen
    buffer_load_dwordx4 a[80:83], v202, s[12:15], s54 offen
    buffer_load_dwordx4 a[84:87], v200, s[28:31], s54 offen
    buffer_load_dwordx4 a[88:91], v201, s[28:31], s54 offen
    buffer_load_dwordx4 a[92:95], v202, s[28:31], s54 offen
    s_add_u32 s54, s54, 147456
    s_waitcnt vmcnt(42)
    ds_write_b128 v203, a[132:135] offset:9216
    ds_write_b128 v203, a[136:139] offset:10240
    ds_write_b128 v203, a[140:143] offset:11264
    ds_read_b64_tr_b16 v[144:145], v204 offset:9216
    ds_read_b64_tr_b16 v[146:147], v204 offset:9984
    ds_read_b64_tr_b16 v[148:149], v204 offset:9280
    ds_read_b64_tr_b16 v[150:151], v204 offset:10048
    ds_read_b64_tr_b16 v[152:153], v204 offset:9344
    ds_read_b64_tr_b16 v[154:155], v204 offset:10112
    s_waitcnt lgkmcnt(9)
    v_mfma_f32_32x32x16_bf16 v[0:15], v[132:135], a[220:223], v[0:15]
    v_mfma_f32_32x32x16_bf16 v[16:31], v[136:139], a[220:223], v[16:31]
    v_mfma_f32_32x32x16_bf16 v[32:47], v[140:143], a[220:223], v[32:47]
    s_waitcnt vmcnt(39)
    ds_write_b128 v203, a[144:147] offset:0
    ds_write_b128 v203, a[148:151] offset:1024
    ds_write_b128 v203, a[152:155] offset:2048
    ds_read_b64_tr_b16 v[132:133], v204 offset:0
    ds_read_b64_tr_b16 v[134:135], v204 offset:768
    ds_read_b64_tr_b16 v[136:137], v204 offset:64
    ds_read_b64_tr_b16 v[138:139], v204 offset:832
    ds_read_b64_tr_b16 v[140:141], v204 offset:128
    ds_read_b64_tr_b16 v[142:143], v204 offset:896
    s_waitcnt lgkmcnt(9)
    v_mfma_f32_32x32x16_bf16 v[48:63], v[144:147], a[220:223], v[48:63]
    v_mfma_f32_32x32x16_bf16 v[64:79], v[148:151], a[220:223], v[64:79]
    v_mfma_f32_32x32x16_bf16 v[80:95], v[152:155], a[220:223], v[80:95]
    s_add_u32 m0, s63, 0
    s_add_u32 s62, s61, 0
    buffer_load_dwordx4 v206, s[32:35], s62 offen offset:0 lds
    buffer_load_dwordx4 v206, s[32:35], s62 offen offset:1024 lds
    s_waitcnt vmcnt(38)
    ds_write_b128 v203, a[156:159] offset:3072
    ds_write_b128 v203, a[160:163] offset:4096
    ds_write_b128 v203, a[164:167] offset:5120
    ds_read_b64_tr_b16 v[144:145], v204 offset:3072
    ds_read_b64_tr_b16 v[146:147], v204 offset:3840
    ds_read_b64_tr_b16 v[148:149], v204 offset:3136
    ds_read_b64_tr_b16 v[150:151], v204 offset:3904
    ds_read_b64_tr_b16 v[152:153], v204 offset:3200
    ds_read_b64_tr_b16 v[154:155], v204 offset:3968
    s_waitcnt lgkmcnt(9)
    v_mfma_f32_32x32x16_bf16 v[0:15], v[132:135], a[224:227], v[0:15]
    v_mfma_f32_32x32x16_bf16 v[16:31], v[136:139], a[224:227], v[16:31]
    v_mfma_f32_32x32x16_bf16 v[32:47], v[140:143], a[224:227], v[32:47]
    buffer_load_dwordx4 v206, s[32:35], s62 offen offset:2048 lds
    buffer_load_dwordx4 v206, s[32:35], s62 offen offset:3072 lds
    s_waitcnt vmcnt(37)
    ds_write_b128 v203, a[168:171] offset:6144
    ds_write_b128 v203, a[172:175] offset:7168
    ds_write_b128 v203, a[176:179] offset:8192
    ds_read_b64_tr_b16 v[132:133], v204 offset:6144
    ds_read_b64_tr_b16 v[134:135], v204 offset:6912
    ds_read_b64_tr_b16 v[136:137], v204 offset:6208
    ds_read_b64_tr_b16 v[138:139], v204 offset:6976
    ds_read_b64_tr_b16 v[140:141], v204 offset:6272
    ds_read_b64_tr_b16 v[142:143], v204 offset:7040
    s_waitcnt lgkmcnt(9)
    v_mfma_f32_32x32x16_bf16 v[48:63], v[144:147], a[224:227], v[48:63]
    v_mfma_f32_32x32x16_bf16 v[64:79], v[148:151], a[224:227], v[64:79]
    v_mfma_f32_32x32x16_bf16 v[80:95], v[152:155], a[224:227], v[80:95]
    s_add_u32 m0, s63, 4096
    s_add_u32 s62, s61, 4096
    buffer_load_dwordx4 v206, s[32:35], s62 offen offset:0 lds
    buffer_load_dwordx4 v206, s[32:35], s62 offen offset:1024 lds
    s_waitcnt vmcnt(36)
    ds_write_b128 v203, a[180:183] offset:9216
    ds_write_b128 v203, a[184:187] offset:10240
    ds_write_b128 v203, a[188:191] offset:11264
    ds_read_b64_tr_b16 v[144:145], v204 offset:9216
    ds_read_b64_tr_b16 v[146:147], v204 offset:9984
    ds_read_b64_tr_b16 v[148:149], v204 offset:9280
    ds_read_b64_tr_b16 v[150:151], v204 offset:10048
    ds_read_b64_tr_b16 v[152:153], v204 offset:9344
    ds_read_b64_tr_b16 v[154:155], v204 offset:10112
    s_waitcnt lgkmcnt(9)
    v_mfma_f32_32x32x16_bf16 v[0:15], v[132:135], a[228:231], v[0:15]
    v_mfma_f32_32x32x16_bf16 v[16:31], v[136:139], a[228:231], v[16:31]
    v_mfma_f32_32x32x16_bf16 v[32:47], v[140:143], a[228:231], v[32:47]
    buffer_load_dwordx4 v206, s[32:35], s62 offen offset:2048 lds
    buffer_load_dwordx4 v206, s[32:35], s62 offen offset:3072 lds
    s_waitcnt vmcnt(35)
    ds_write_b128 v203, a[192:195] offset:0
    ds_write_b128 v203, a[196:199] offset:1024
    ds_write_b128 v203, a[200:203] offset:2048
    ds_read_b64_tr_b16 v[132:133], v204 offset:0
    ds_read_b64_tr_b16 v[134:135], v204 offset:768
    ds_read_b64_tr_b16 v[136:137], v204 offset:64
    ds_read_b64_tr_b16 v[138:139], v204 offset:832
    ds_read_b64_tr_b16 v[140:141], v204 offset:128
    ds_read_b64_tr_b16 v[142:143], v204 offset:896
    s_waitcnt lgkmcnt(9)
    v_mfma_f32_32x32x16_bf16 v[48:63], v[144:147], a[228:231], v[48:63]
    v_mfma_f32_32x32x16_bf16 v[64:79], v[148:151], a[228:231], v[64:79]
    v_mfma_f32_32x32x16_bf16 v[80:95], v[152:155], a[228:231], v[80:95]
    s_add_u32 m0, s63, 8192
    s_add_u32 s62, s61, 8192
    buffer_load_dwordx4 v206, s[32:35], s62 offen offset:0 lds
    buffer_load_dwordx4 v206, s[32:35], s62 offen offset:1024 lds
    s_waitcnt vmcnt(34)
    ds_write_b128 v203, a[204:207] offset:3072
    ds_write_b128 v203, a[208:211] offset:4096
    ds_write_b128 v203, a[212:215] offset:5120
    ds_read_b64_tr_b16 v[144:145], v204 offset:3072
    ds_read_b64_tr_b16 v[146:147], v204 offset:3840
    ds_read_b64_tr_b16 v[148:149], v204 offset:3136
    ds_read_b64_tr_b16 v[150:151], v204 offset:3904
    ds_read_b64_tr_b16 v[152:153], v204 offset:3200
    ds_read_b64_tr_b16 v[154:155], v204 offset:3968
    s_waitcnt lgkmcnt(9)
    v_mfma_f32_32x32x16_bf16 v[0:15], v[132:135], a[232:235], v[0:15]
    v_mfma_f32_32x32x16_bf16 v[16:31], v[136:139], a[232:235], v[16:31]
    v_mfma_f32_32x32x16_bf16 v[32:47], v[140:143], a[232:235], v[32:47]
    buffer_load_dwordx4 v206, s[32:35], s62 offen offset:2048 lds
    buffer_load_dwordx4 v206, s[32:35], s62 offen offset:3072 lds
    s_waitcnt vmcnt(33)
    ds_write_b128 v203, a[0:3] offset:6144
    ds_write_b128 v203, a[4:7] offset:7168
    ds_write_b128 v203, a[8:11] offset:8192
    ds_read_b64_tr_b16 v[132:133], v204 offset:6144
    ds_read_b64_tr_b16 v[134:135], v204 offset:6912
    ds_read_b64_tr_b16 v[136:137], v204 offset:6208
    ds_read_b64_tr_b16 v[138:139], v204 offset:6976
    ds_read_b64_tr_b16 v[140:141], v204 offset:6272
    ds_read_b64_tr_b16 v[142:143], v204 offset:7040
    s_waitcnt lgkmcnt(9)
    v_mfma_f32_32x32x16_bf16 v[48:63], v[144:147], a[232:235], v[48:63]
    v_mfma_f32_32x32x16_bf16 v[64:79], v[148:151], a[232:235], v[64:79]
    v_mfma_f32_32x32x16_bf16 v[80:95], v[152:155], a[232:235], v[80:95]
    s_add_u32 m0, s63, 12288
    s_add_u32 s62, s61, 12288
    buffer_load_dwordx4 v206, s[32:35], s62 offen offset:0 lds
    buffer_load_dwordx4 v206, s[32:35], s62 offen offset:1024 lds
    s_waitcnt vmcnt(32)
    ds_write_b128 v203, a[12:15] offset:9216
    ds_write_b128 v203, a[16:19] offset:10240
    ds_write_b128 v203, a[20:23] offset:11264
    ds_read_b64_tr_b16 v[144:145], v204 offset:9216
    ds_read_b64_tr_b16 v[146:147], v204 offset:9984
    ds_read_b64_tr_b16 v[148:149], v204 offset:9280
    ds_read_b64_tr_b16 v[150:151], v204 offset:10048
    ds_read_b64_tr_b16 v[152:153], v204 offset:9344
    ds_read_b64_tr_b16 v[154:155], v204 offset:10112
    s_waitcnt lgkmcnt(9)
    v_mfma_f32_32x32x16_bf16 v[0:15], v[132:135], a[236:239], v[0:15]
    v_mfma_f32_32x32x16_bf16 v[16:31], v[136:139], a[236:239], v[16:31]
    v_mfma_f32_32x32x16_bf16 v[32:47], v[140:143], a[236:239], v[32:47]
    buffer_load_dwordx4 v206, s[32:35], s62 offen offset:2048 lds
    buffer_load_dwordx4 v206, s[32:35], s62 offen offset:3072 lds
    s_waitcnt vmcnt(31)
    ds_write_b128 v203, a[24:27] offset:0
    ds_write_b128 v203, a[28:31] offset:1024
    ds_write_b128 v203, a[32:35] offset:2048
    ds_read_b64_tr_b16 v[132:133], v204 offset:0
    ds_read_b64_tr_b16 v[134:135], v204 offset:768
    ds_read_b64_tr_b16 v[136:137], v204 offset:64
    ds_read_b64_tr_b16 v[138:139], v204 offset:832
    ds_read_b64_tr_b16 v[140:141], v204 offset:128
    ds_read_b64_tr_b16 v[142:143], v204 offset:896
    s_waitcnt lgkmcnt(9)
    v_mfma_f32_32x32x16_bf16 v[48:63], v[144:147], a[236:239], v[48:63]
    v_mfma_f32_32x32x16_bf16 v[64:79], v[148:151], a[236:239], v[64:79]
    v_mfma_f32_32x32x16_bf16 v[80:95], v[152:155], a[236:239], v[80:95]
    s_add_u32 m0, s63, 16384
    s_add_u32 s62, s61, 16384
    buffer_load_dwordx4 v206, s[32:35], s62 offen offset:0 lds
    buffer_load_dwordx4 v206, s[32:35], s62 offen offset:1024 lds
    s_waitcnt vmcnt(30)
    ds_write_b128 v203, a[36:39] offset:3072
    ds_write_b128 v203, a[40:43] offset:4096
    ds_write_b128 v203, a[44:47] offset:5120
    ds_read_b64_tr_b16 v[144:145], v204 offset:3072
    ds_read_b64_tr_b16 v[146:147], v204 offset:3840
    ds_read_b64_tr_b16 v[148:149], v204 offset:3136
    ds_read_b64_tr_b16 v[150:151], v204 offset:3904
    ds_read_b64_tr_b16 v[152:153], v204 offset:3200
    ds_read_b64_tr_b16 v[154:155], v204 offset:3968
    s_waitcnt lgkmcnt(9)
    v_mfma_f32_32x32x16_bf16 v[0:15], v[132:135], a[240:243], v[0:15]
    v_mfma_f32_32x32x16_bf16 v[16:31], v[136:139], a[240:243], v[16:31]
    v_mfma_f32_32x32x16_bf16 v[32:47], v[140:143], a[240:243], v[32:47]
    buffer_load_dwordx4 v206, s[32:35], s62 offen offset:2048 lds
    buffer_load_dwordx4 v206, s[32:35], s62 offen offset:3072 lds
    s_waitcnt vmcnt(29)
    ds_write_b128 v203, a[48:51] offset:6144
    ds_write_b128 v203, a[52:55] offset:7168
    ds_write_b128 v203, a[56:59] offset:8192
    ds_read_b64_tr_b16 v[132:133], v204 offset:6144
    ds_read_b64_tr_b16 v[134:135], v204 offset:6912
    ds_read_b64_tr_b16 v[136:137], v204 offset:6208
    ds_read_b64_tr_b16 v[138:139], v204 offset:6976
    ds_read_b64_tr_b16 v[140:141], v204 offset:6272
    ds_read_b64_tr_b16 v[142:143], v204 offset:7040
    s_waitcnt lgkmcnt(9)
    v_mfma_f32_32x32x16_bf16 v[48:63], v[144:147], a[240:243], v[48:63]
    v_mfma_f32_32x32x16_bf16 v[64:79], v[148:151], a[240:243], v[64:79]
    v_mfma_f32_32x32x16_bf16 v[80:95], v[152:155], a[240:243], v[80:95]
    s_add_u32 m0, s63, 20480
    s_add_u32 s62, s61, 20480
    buffer_load_dwordx4 v206, s[32:35], s62 offen offset:0 lds
    buffer_load_dwordx4 v206, s[32:35], s62 offen offset:1024 lds
    s_waitcnt vmcnt(28)
    ds_write_b128 v203, a[60:63] offset:9216
    ds_write_b128 v203, a[64:67] offset:10240
    ds_write_b128 v203, a[68:71] offset:11264
    ds_read_b64_tr_b16 v[144:145], v204 offset:9216
    ds_read_b64_tr_b16 v[146:147], v204 offset:9984
    ds_read_b64_tr_b16 v[148:149], v204 offset:9280
    ds_read_b64_tr_b16 v[150:151], v204 offset:10048
    ds_read_b64_tr_b16 v[152:153], v204 offset:9344
    ds_read_b64_tr_b16 v[154:155], v204 offset:10112
    s_waitcnt lgkmcnt(9)
    v_mfma_f32_32x32x16_bf16 v[0:15], v[132:135], a[244:247], v[0:15]
    v_mfma_f32_32x32x16_bf16 v[16:31], v[136:139], a[244:247], v[16:31]
    v_mfma_f32_32x32x16_bf16 v[32:47], v[140:143], a[244:247], v[32:47]
    buffer_load_dwordx4 v206, s[32:35], s62 offen offset:2048 lds
    buffer_load_dwordx4 v206, s[32:35], s62 offen offset:3072 lds
    s_waitcnt vmcnt(27)
    ds_write_b128 v203, a[72:75] offset:0
    ds_write_b128 v203, a[76:79] offset:1024
    ds_write_b128 v203, a[80:83] offset:2048
    ds_read_b64_tr_b16 v[132:133], v204 offset:0
    ds_read_b64_tr_b16 v[134:135], v204 offset:768
    ds_read_b64_tr_b16 v[136:137], v204 offset:64
    ds_read_b64_tr_b16 v[138:139], v204 offset:832
    ds_read_b64_tr_b16 v[140:141], v204 offset:128
    ds_read_b64_tr_b16 v[142:143], v204 offset:896
    s_waitcnt lgkmcnt(9)
    v_mfma_f32_32x32x16_bf16 v[48:63], v[144:147], a[244:247], v[48:63]
    v_mfma_f32_32x32x16_bf16 v[64:79], v[148:151], a[244:247], v[64:79]
    v_mfma_f32_32x32x16_bf16 v[80:95], v[152:155], a[244:247], v[80:95]
    s_add_u32 m0, s63, 24576
    s_add_u32 s62, s61, 24576
    buffer_load_dwordx4 v206, s[32:35], s62 offen offset:0 lds
    buffer_load_dwordx4 v206, s[32:35], s62 offen offset:1024 lds
    s_waitcnt vmcnt(26)
    ds_write_b128 v203, a[84:87] offset:3072
    ds_write_b128 v203, a[88:91] offset:4096
    ds_write_b128 v203, a[92:95] offset:5120
    ds_read_b64_tr_b16 v[144:145], v204 offset:3072
    ds_read_b64_tr_b16 v[146:147], v204 offset:3840
    ds_read_b64_tr_b16 v[148:149], v204 offset:3136
    ds_read_b64_tr_b16 v[150:151], v204 offset:3904
    ds_read_b64_tr_b16 v[152:153], v204 offset:3200
    ds_read_b64_tr_b16 v[154:155], v204 offset:3968
    s_waitcnt lgkmcnt(9)
    v_mfma_f32_32x32x16_bf16 v[0:15], v[132:135], a[248:251], v[0:15]
    v_mfma_f32_32x32x16_bf16 v[16:31], v[136:139], a[248:251], v[16:31]
    v_mfma_f32_32x32x16_bf16 v[32:47], v[140:143], a[248:251], v[32:47]
    buffer_load_dwordx4 v206, s[32:35], s62 offen offset:2048 lds
    s_waitcnt lgkmcnt(0)
    v_mfma_f32_32x32x16_bf16 v[48:63], v[144:147], a[248:251], v[48:63]
    v_mfma_f32_32x32x16_bf16 v[64:79], v[148:151], a[248:251], v[64:79]
    v_mfma_f32_32x32x16_bf16 v[80:95], v[152:155], a[248:251], v[80:95]
    v_and_b32 v244, 31, v241
    v_lshrrev_b32 v245, 5, v241
    v_lshl_add_u32 v246, v245, 3, v244
    v_lshlrev_b32 v246, 4, v246
    v_add_u32 v209, s47, v246
    v_cmp_gt_u32 s[52:53], 8, v244
    s_lshl_b32 s60, s44, 8
    s_add_u32 s60, s60, 110592
    v_add_u32 v210, s60, v246
    s_mov_b64 exec, s[52:53]
    ds_write_b128 v209, v[0:3] offset:0
    ds_write_b128 v209, v[4:7] offset:256
    ds_write_b128 v209, v[8:11] offset:512
    ds_write_b128 v209, v[12:15] offset:768
    ds_write_b128 v209, v[16:19] offset:1024
    ds_write_b128 v209, v[20:23] offset:1280
    ds_write_b128 v209, v[24:27] offset:1536
    ds_write_b128 v209, v[28:31] offset:1792
    ds_write_b128 v209, v[32:35] offset:2048
    ds_write_b128 v209, v[36:39] offset:2304
    ds_write_b128 v209, v[40:43] offset:2560
    ds_write_b128 v209, v[44:47] offset:2816
    ds_write_b128 v209, v[48:51] offset:3072
    ds_write_b128 v209, v[52:55] offset:3328
    ds_write_b128 v209, v[56:59] offset:3584
    ds_write_b128 v209, v[60:63] offset:3840
    ds_write_b128 v209, v[64:67] offset:4096
    ds_write_b128 v209, v[68:71] offset:4352
    ds_write_b128 v209, v[72:75] offset:4608
    ds_write_b128 v209, v[76:79] offset:4864
    ds_write_b128 v209, v[80:83] offset:5120
    ds_write_b128 v209, v[84:87] offset:5376
    ds_write_b128 v209, v[88:91] offset:5632
    ds_write_b128 v209, v[92:95] offset:5888
    s_waitcnt lgkmcnt(0)
    s_barrier
    ds_read_b128 v[0:3], v210 offset:0
    ds_read_b128 v[4:7], v210 offset:1024
    ds_read_b128 v[8:11], v210 offset:2048
    ds_read_b128 v[12:15], v210 offset:3072
    ds_read_b128 v[16:19], v210 offset:4096
    ds_read_b128 v[20:23], v210 offset:5120
    ds_read_b128 v[24:27], v210 offset:12288
    ds_read_b128 v[28:31], v210 offset:13312
    ds_read_b128 v[32:35], v210 offset:14336
    ds_read_b128 v[36:39], v210 offset:15360
    ds_read_b128 v[40:43], v210 offset:16384
    ds_read_b128 v[44:47], v210 offset:17408
    ds_read_b128 v[48:51], v210 offset:24576
    ds_read_b128 v[52:55], v210 offset:25600
    ds_read_b128 v[56:59], v210 offset:26624
    ds_read_b128 v[60:63], v210 offset:27648
    ds_read_b128 v[64:67], v210 offset:28672
    ds_read_b128 v[68:71], v210 offset:29696
    ds_read_b128 v[72:75], v210 offset:36864
    ds_read_b128 v[76:79], v210 offset:37888
    ds_read_b128 v[80:83], v210 offset:38912
    ds_read_b128 v[84:87], v210 offset:39936
    ds_read_b128 v[88:91], v210 offset:40960
    ds_read_b128 v[92:95], v210 offset:41984
    s_waitcnt lgkmcnt(0)
    v_add_f32 v0, v0, v24
    v_add_f32 v48, v48, v72
    v_add_f32 v1, v1, v25
    v_add_f32 v49, v49, v73
    v_add_f32 v2, v2, v26
    v_add_f32 v50, v50, v74
    v_add_f32 v3, v3, v27
    v_add_f32 v51, v51, v75
    v_add_f32 v4, v4, v28
    v_add_f32 v52, v52, v76
    v_add_f32 v5, v5, v29
    v_add_f32 v53, v53, v77
    v_add_f32 v6, v6, v30
    v_add_f32 v54, v54, v78
    v_add_f32 v7, v7, v31
    v_add_f32 v55, v55, v79
    v_add_f32 v8, v8, v32
    v_add_f32 v56, v56, v80
    v_add_f32 v9, v9, v33
    v_add_f32 v57, v57, v81
    v_add_f32 v10, v10, v34
    v_add_f32 v58, v58, v82
    v_add_f32 v11, v11, v35
    v_add_f32 v59, v59, v83
    v_add_f32 v12, v12, v36
    v_add_f32 v60, v60, v84
    v_add_f32 v13, v13, v37
    v_add_f32 v61, v61, v85
    v_add_f32 v14, v14, v38
    v_add_f32 v62, v62, v86
    v_add_f32 v15, v15, v39
    v_add_f32 v63, v63, v87
    v_add_f32 v16, v16, v40
    v_add_f32 v64, v64, v88
    v_add_f32 v17, v17, v41
    v_add_f32 v65, v65, v89
    v_add_f32 v18, v18, v42
    v_add_f32 v66, v66, v90
    v_add_f32 v19, v19, v43
    v_add_f32 v67, v67, v91
    v_add_f32 v20, v20, v44
    v_add_f32 v68, v68, v92
    v_add_f32 v21, v21, v45
    v_add_f32 v69, v69, v93
    v_add_f32 v22, v22, v46
    v_add_f32 v70, v70, v94
    v_add_f32 v23, v23, v47
    v_add_f32 v71, v71, v95
    v_add_f32 v0, v0, v48
    v_add_f32 v1, v1, v49
    v_add_f32 v2, v2, v50
    v_add_f32 v3, v3, v51
    v_add_f32 v4, v4, v52
    v_add_f32 v5, v5, v53
    v_add_f32 v6, v6, v54
    v_add_f32 v7, v7, v55
    v_add_f32 v8, v8, v56
    v_add_f32 v9, v9, v57
    v_add_f32 v10, v10, v58
    v_add_f32 v11, v11, v59
    v_add_f32 v12, v12, v60
    v_add_f32 v13, v13, v61
    v_add_f32 v14, v14, v62
    v_add_f32 v15, v15, v63
    v_add_f32 v16, v16, v64
    v_add_f32 v17, v17, v65
    v_add_f32 v18, v18, v66
    v_add_f32 v19, v19, v67
    v_add_f32 v20, v20, v68
    v_add_f32 v21, v21, v69
    v_add_f32 v22, v22, v70
    v_add_f32 v23, v23, v71
    v_cvt_pk_bf16_f32 v48, v0, v1
    v_lshlrev_b32 v0, 16, v48
    v_and_b32 v1, 0xffff0000, v48
    v_cvt_pk_bf16_f32 v50, v2, v3
    v_lshlrev_b32 v2, 16, v50
    v_and_b32 v3, 0xffff0000, v50
    v_cvt_pk_bf16_f32 v52, v4, v5
    v_lshlrev_b32 v4, 16, v52
    v_and_b32 v5, 0xffff0000, v52
    v_cvt_pk_bf16_f32 v54, v6, v7
    v_lshlrev_b32 v6, 16, v54
    v_and_b32 v7, 0xffff0000, v54
    v_cvt_pk_bf16_f32 v56, v8, v9
    v_lshlrev_b32 v8, 16, v56
    v_and_b32 v9, 0xffff0000, v56
    v_cvt_pk_bf16_f32 v58, v10, v11
    v_lshlrev_b32 v10, 16, v58
    v_and_b32 v11, 0xffff0000, v58
    v_cvt_pk_bf16_f32 v60, v12, v13
    v_lshlrev_b32 v12, 16, v60
    v_and_b32 v13, 0xffff0000, v60
    v_cvt_pk_bf16_f32 v62, v14, v15
    v_lshlrev_b32 v14, 16, v62
    v_and_b32 v15, 0xffff0000, v62
    v_cvt_pk_bf16_f32 v64, v16, v17
    v_lshlrev_b32 v16, 16, v64
    v_and_b32 v17, 0xffff0000, v64
    v_cvt_pk_bf16_f32 v66, v18, v19
    v_lshlrev_b32 v18, 16, v66
    v_and_b32 v19, 0xffff0000, v66
    v_cvt_pk_bf16_f32 v68, v20, v21
    v_lshlrev_b32 v20, 16, v68
    v_and_b32 v21, 0xffff0000, v68
    v_cvt_pk_bf16_f32 v70, v22, v23
    v_lshlrev_b32 v22, 16, v70
    v_and_b32 v23, 0xffff0000, v70
    v_mul_f32 v24, 0xbfb8aa3b, v0
    v_mul_f32 v25, 0xbfb8aa3b, v1
    v_mul_f32 v26, 0xbfb8aa3b, v2
    v_mul_f32 v27, 0xbfb8aa3b, v3
    v_mul_f32 v28, 0xbfb8aa3b, v4
    v_mul_f32 v29, 0xbfb8aa3b, v5
    v_mul_f32 v30, 0xbfb8aa3b, v6
    v_mul_f32 v31, 0xbfb8aa3b, v7
    v_mul_f32 v32, 0xbfb8aa3b, v8
    v_mul_f32 v33, 0xbfb8aa3b, v9
    v_mul_f32 v34, 0xbfb8aa3b, v10
    v_mul_f32 v35, 0xbfb8aa3b, v11
    v_exp_f32 v24, v24
    v_exp_f32 v25, v25
    v_exp_f32 v26, v26
    v_exp_f32 v27, v27
    v_exp_f32 v28, v28
    v_exp_f32 v29, v29
    v_exp_f32 v30, v30
    v_exp_f32 v31, v31
    v_exp_f32 v32, v32
    v_exp_f32 v33, v33
    v_exp_f32 v34, v34
    v_exp_f32 v35, v35
    v_add_f32 v24, 1.0, v24
    v_add_f32 v25, 1.0, v25
    v_add_f32 v26, 1.0, v26
    v_add_f32 v27, 1.0, v27
    v_add_f32 v28, 1.0, v28
    v_add_f32 v29, 1.0, v29
    v_add_f32 v30, 1.0, v30
    v_add_f32 v31, 1.0, v31
    v_add_f32 v32, 1.0, v32
    v_add_f32 v33, 1.0, v33
    v_add_f32 v34, 1.0, v34
    v_add_f32 v35, 1.0, v35
    v_rcp_f32 v24, v24
    v_rcp_f32 v25, v25
    v_rcp_f32 v26, v26
    v_rcp_f32 v27, v27
    v_rcp_f32 v28, v28
    v_rcp_f32 v29, v29
    v_rcp_f32 v30, v30
    v_rcp_f32 v31, v31
    v_rcp_f32 v32, v32
    v_rcp_f32 v33, v33
    v_rcp_f32 v34, v34
    v_rcp_f32 v35, v35
    v_mul_f32 v0, v0, v24
    v_mul_f32 v1, v1, v25
    v_mul_f32 v2, v2, v26
    v_mul_f32 v3, v3, v27
    v_mul_f32 v4, v4, v28
    v_mul_f32 v5, v5, v29
    v_mul_f32 v6, v6, v30
    v_mul_f32 v7, v7, v31
    v_mul_f32 v8, v8, v32
    v_mul_f32 v9, v9, v33
    v_mul_f32 v10, v10, v34
    v_mul_f32 v11, v11, v35
    v_cvt_pk_bf16_f32 v48, v0, v1
    v_lshlrev_b32 v0, 16, v48
    v_and_b32 v1, 0xffff0000, v48
    v_cvt_pk_bf16_f32 v50, v2, v3
    v_lshlrev_b32 v2, 16, v50
    v_and_b32 v3, 0xffff0000, v50
    v_cvt_pk_bf16_f32 v52, v4, v5
    v_lshlrev_b32 v4, 16, v52
    v_and_b32 v5, 0xffff0000, v52
    v_cvt_pk_bf16_f32 v54, v6, v7
    v_lshlrev_b32 v6, 16, v54
    v_and_b32 v7, 0xffff0000, v54
    v_cvt_pk_bf16_f32 v56, v8, v9
    v_lshlrev_b32 v8, 16, v56
    v_and_b32 v9, 0xffff0000, v56
    v_cvt_pk_bf16_f32 v58, v10, v11
    v_lshlrev_b32 v10, 16, v58
    v_and_b32 v11, 0xffff0000, v58
    v_mul_f32 v0, v0, v12
    v_mul_f32 v1, v1, v13
    v_mul_f32 v2, v2, v14
    v_mul_f32 v3, v3, v15
    v_mul_f32 v4, v4, v16
    v_mul_f32 v5, v5, v17
    v_mul_f32 v6, v6, v18
    v_mul_f32 v7, v7, v19
    v_mul_f32 v8, v8, v20
    v_mul_f32 v9, v9, v21
    v_mul_f32 v10, v10, v22
    v_mul_f32 v11, v11, v23
    v_cvt_pk_bf16_f32 v24, v0, v1
    v_cvt_pk_bf16_f32 v25, v2, v3
    v_cvt_pk_bf16_f32 v26, v4, v5
    v_cvt_pk_bf16_f32 v27, v6, v7
    v_cvt_pk_bf16_f32 v28, v8, v9
    v_cvt_pk_bf16_f32 v29, v10, v11
    s_lshr_b32 s60, s44, 1
    s_lshl_b32 s60, s60, 10
    s_and_b32 s61, s44, 1
    s_lshl_b32 s61, s61, 3
    s_add_u32 s60, s60, s61
    s_add_u32 s60, s60, 116736
    v_add_u32 v244, s60, v206
    ds_write_b64 v244, v[24:25] offset:0
    ds_write_b64 v244, v[26:27] offset:2048
    ds_write_b64 v244, v[28:29] offset:4096
    s_mov_b64 exec, -1
    v_add_u32 v244, 116736, v206
    v_and_b32 v245, 31, v241
    v_mul_u32_u24 v245, 2304, v245
    v_lshrrev_b32 v246, 5, v241
    v_lshl_add_u32 v245, v246, 4, v245
    s_lshl_b32 s60, s44, 7
    s_add_u32 s60, s60, 122880
    v_add_u32 v209, s60, v245
    s_waitcnt vmcnt(0) lgkmcnt(0)
    s_barrier
    ds_read_b128 v[96:99], v244 offset:0
    ds_read_b128 v[100:103], v244 offset:1024
    ds_read_b128 v[104:107], v244 offset:2048
    ds_read_b128 v[108:111], v244 offset:3072
    ds_read_b128 v[112:115], v244 offset:4096
    ds_read_b128 v[116:119], v244 offset:5120
    ds_read_b64_tr_b16 v[132:133], v207 offset:0
    ds_read_b64_tr_b16 v[134:135], v207 offset:9216
    ds_read_b64_tr_b16 v[136:137], v207 offset:18432
    ds_read_b64_tr_b16 v[138:139], v207 offset:27648
    ds_read_b64_tr_b16 v[140:141], v207 offset:36864
    ds_read_b64_tr_b16 v[142:143], v207 offset:46080
    ds_read_b64_tr_b16 v[144:145], v208 offset:0
    ds_read_b64_tr_b16 v[146:147], v208 offset:9216
    ds_read_b64_tr_b16 v[148:149], v208 offset:18432
    ds_read_b64_tr_b16 v[150:151], v208 offset:27648
    ds_read_b64_tr_b16 v[152:153], v208 offset:36864
    ds_read_b64_tr_b16 v[154:155], v208 offset:46080
    ds_read_b64_tr_b16 v[156:157], v207 offset:256
    ds_read_b64_tr_b16 v[158:159], v207 offset:9472
    ds_read_b64_tr_b16 v[160:161], v207 offset:18688
    ds_read_b64_tr_b16 v[162:163], v207 offset:27904
    ds_read_b64_tr_b16 v[164:165], v207 offset:37120
    ds_read_b64_tr_b16 v[166:167], v207 offset:46336
    ds_read_b64_tr_b16 v[168:169], v208 offset:256
    ds_read_b64_tr_b16 v[170:171], v208 offset:9472
    ds_read_b64_tr_b16 v[172:173], v208 offset:18688
    ds_read_b64_tr_b16 v[174:175], v208 offset:27904
    ds_read_b64_tr_b16 v[176:177], v208 offset:37120
    ds_read_b64_tr_b16 v[178:179], v208 offset:46336
    s_waitcnt lgkmcnt(12)
    v_mfma_f32_32x32x16_bf16 v[0:15], v[132:135], v[96:99], 0
    v_mfma_f32_32x32x16_bf16 v[0:15], v[136:139], v[100:103], v[0:15]
    v_mfma_f32_32x32x16_bf16 v[0:15], v[140:143], v[104:107], v[0:15]
    v_mfma_f32_32x32x16_bf16 v[0:15], v[144:147], v[108:111], v[0:15]
    v_mfma_f32_32x32x16_bf16 v[0:15], v[148:151], v[112:115], v[0:15]
    v_mfma_f32_32x32x16_bf16 v[0:15], v[152:155], v[116:119], v[0:15]
    ds_read_b64_tr_b16 v[132:133], v207 offset:512
    ds_read_b64_tr_b16 v[134:135], v207 offset:9728
    ds_read_b64_tr_b16 v[136:137], v207 offset:18944
    ds_read_b64_tr_b16 v[138:139], v207 offset:28160
    ds_read_b64_tr_b16 v[140:141], v207 offset:37376
    ds_read_b64_tr_b16 v[142:143], v207 offset:46592
    ds_read_b64_tr_b16 v[144:145], v208 offset:512
    ds_read_b64_tr_b16 v[146:147], v208 offset:9728
    ds_read_b64_tr_b16 v[148:149], v208 offset:18944
    ds_read_b64_tr_b16 v[150:151], v208 offset:28160
    ds_read_b64_tr_b16 v[152:153], v208 offset:37376
    ds_read_b64_tr_b16 v[154:155], v208 offset:46592
    s_waitcnt lgkmcnt(12)
    v_mfma_f32_32x32x16_bf16 v[16:31], v[156:159], v[96:99], 0
    v_mfma_f32_32x32x16_bf16 v[16:31], v[160:163], v[100:103], v[16:31]
    v_mfma_f32_32x32x16_bf16 v[16:31], v[164:167], v[104:107], v[16:31]
    v_mfma_f32_32x32x16_bf16 v[16:31], v[168:171], v[108:111], v[16:31]
    v_mfma_f32_32x32x16_bf16 v[16:31], v[172:175], v[112:115], v[16:31]
    v_mfma_f32_32x32x16_bf16 v[16:31], v[176:179], v[116:119], v[16:31]
    ds_read_b64_tr_b16 v[156:157], v207 offset:768
    ds_read_b64_tr_b16 v[158:159], v207 offset:9984
    ds_read_b64_tr_b16 v[160:161], v207 offset:19200
    ds_read_b64_tr_b16 v[162:163], v207 offset:28416
    ds_read_b64_tr_b16 v[164:165], v207 offset:37632
    ds_read_b64_tr_b16 v[166:167], v207 offset:46848
    ds_read_b64_tr_b16 v[168:169], v208 offset:768
    ds_read_b64_tr_b16 v[170:171], v208 offset:9984
    ds_read_b64_tr_b16 v[172:173], v208 offset:19200
    ds_read_b64_tr_b16 v[174:175], v208 offset:28416
    ds_read_b64_tr_b16 v[176:177], v208 offset:37632
    ds_read_b64_tr_b16 v[178:179], v208 offset:46848
    s_waitcnt lgkmcnt(12)
    v_mfma_f32_32x32x16_bf16 v[32:47], v[132:135], v[96:99], 0
    v_mfma_f32_32x32x16_bf16 v[32:47], v[136:139], v[100:103], v[32:47]
    v_mfma_f32_32x32x16_bf16 v[32:47], v[140:143], v[104:107], v[32:47]
    v_mfma_f32_32x32x16_bf16 v[32:47], v[144:147], v[108:111], v[32:47]
    v_mfma_f32_32x32x16_bf16 v[32:47], v[148:151], v[112:115], v[32:47]
    v_mfma_f32_32x32x16_bf16 v[32:47], v[152:155], v[116:119], v[32:47]
    ds_read_b64_tr_b16 v[132:133], v207 offset:1024
    ds_read_b64_tr_b16 v[134:135], v207 offset:10240
    ds_read_b64_tr_b16 v[136:137], v207 offset:19456
    ds_read_b64_tr_b16 v[138:139], v207 offset:28672
    ds_read_b64_tr_b16 v[140:141], v207 offset:37888
    ds_read_b64_tr_b16 v[142:143], v207 offset:47104
    ds_read_b64_tr_b16 v[144:145], v208 offset:1024
    ds_read_b64_tr_b16 v[146:147], v208 offset:10240
    ds_read_b64_tr_b16 v[148:149], v208 offset:19456
    ds_read_b64_tr_b16 v[150:151], v208 offset:28672
    ds_read_b64_tr_b16 v[152:153], v208 offset:37888
    ds_read_b64_tr_b16 v[154:155], v208 offset:47104
    s_waitcnt lgkmcnt(12)
    v_mfma_f32_32x32x16_bf16 v[48:63], v[156:159], v[96:99], 0
    v_mfma_f32_32x32x16_bf16 v[48:63], v[160:163], v[100:103], v[48:63]
    v_mfma_f32_32x32x16_bf16 v[48:63], v[164:167], v[104:107], v[48:63]
    v_mfma_f32_32x32x16_bf16 v[48:63], v[168:171], v[108:111], v[48:63]
    v_mfma_f32_32x32x16_bf16 v[48:63], v[172:175], v[112:115], v[48:63]
    v_mfma_f32_32x32x16_bf16 v[48:63], v[176:179], v[116:119], v[48:63]
    s_waitcnt lgkmcnt(0)
    v_mfma_f32_32x32x16_bf16 v[64:79], v[132:135], v[96:99], 0
    v_mfma_f32_32x32x16_bf16 v[64:79], v[136:139], v[100:103], v[64:79]
    v_mfma_f32_32x32x16_bf16 v[64:79], v[140:143], v[104:107], v[64:79]
    v_mfma_f32_32x32x16_bf16 v[64:79], v[144:147], v[108:111], v[64:79]
    v_mfma_f32_32x32x16_bf16 v[64:79], v[148:151], v[112:115], v[64:79]
    v_mfma_f32_32x32x16_bf16 v[64:79], v[152:155], v[116:119], v[64:79]
    s_mov_b64 exec, s[52:53]
    ds_write_b128 v209, v[0:3] offset:0
    ds_write_b128 v209, v[4:7] offset:32
    ds_write_b128 v209, v[8:11] offset:64
    ds_write_b128 v209, v[12:15] offset:96
    ds_write_b128 v209, v[16:19] offset:512
    ds_write_b128 v209, v[20:23] offset:544
    ds_write_b128 v209, v[24:27] offset:576
    ds_write_b128 v209, v[28:31] offset:608
    ds_write_b128 v209, v[32:35] offset:1024
    ds_write_b128 v209, v[36:39] offset:1056
    ds_write_b128 v209, v[40:43] offset:1088
    ds_write_b128 v209, v[44:47] offset:1120
    ds_write_b128 v209, v[48:51] offset:1536
    ds_write_b128 v209, v[52:55] offset:1568
    ds_write_b128 v209, v[56:59] offset:1600
    ds_write_b128 v209, v[60:63] offset:1632
    s_cmp_ge_u32 s44, 2
    s_cbranch_scc1 L_k3_ffn_y
    s_nop 7
    ds_write_b128 v209, v[64:67] offset:2048
    ds_write_b128 v209, v[68:71] offset:2080
    ds_write_b128 v209, v[72:75] offset:2112
    ds_write_b128 v209, v[76:79] offset:2144
L_k3_ffn_y:
    s_mov_b64 exec, -1
    v_lshlrev_b32 v244, 2, v241
    s_mul_i32 s60, s44, 4608
    v_add_u32 v244, s60, v244
    v_add_u32 v245, 122880, v244
    s_waitcnt lgkmcnt(0)
    s_barrier
    ds_read_b32 v0, v245 offset:0
    ds_read_b32 v1, v245 offset:256
    ds_read_b32 v2, v245 offset:512
    ds_read_b32 v3, v245 offset:768
    ds_read_b32 v4, v245 offset:1024
    ds_read_b32 v5, v245 offset:1280
    ds_read_b32 v6, v245 offset:1536
    ds_read_b32 v7, v245 offset:1792
    ds_read_b32 v8, v245 offset:2048
    ds_read_b32 v9, v245 offset:2304
    ds_read_b32 v10, v245 offset:2560
    ds_read_b32 v11, v245 offset:2816
    ds_read_b32 v12, v245 offset:3072
    ds_read_b32 v13, v245 offset:3328
    ds_read_b32 v14, v245 offset:3584
    ds_read_b32 v15, v245 offset:3840
    ds_read_b32 v16, v245 offset:4096
    ds_read_b32 v17, v245 offset:4352
    s_mov_b32 s60, 0x483000
    s_add_u32 s61, s60, 4096
    s_waitcnt lgkmcnt(0)
    buffer_atomic_add_f32 v0, v244, s[8:11], s60 offen offset:0 sc0
    buffer_atomic_add_f32 v1, v244, s[8:11], s60 offen offset:256 sc0
    buffer_atomic_add_f32 v2, v244, s[8:11], s60 offen offset:512 sc0
    buffer_atomic_add_f32 v3, v244, s[8:11], s60 offen offset:768 sc0
    buffer_atomic_add_f32 v4, v244, s[8:11], s60 offen offset:1024 sc0
    buffer_atomic_add_f32 v5, v244, s[8:11], s60 offen offset:1280 sc0
    buffer_atomic_add_f32 v6, v244, s[8:11], s60 offen offset:1536 sc0
    buffer_atomic_add_f32 v7, v244, s[8:11], s60 offen offset:1792 sc0
    buffer_atomic_add_f32 v8, v244, s[8:11], s60 offen offset:2048 sc0
    buffer_atomic_add_f32 v9, v244, s[8:11], s60 offen offset:2304 sc0
    buffer_atomic_add_f32 v10, v244, s[8:11], s60 offen offset:2560 sc0
    buffer_atomic_add_f32 v11, v244, s[8:11], s60 offen offset:2816 sc0
    buffer_atomic_add_f32 v12, v244, s[8:11], s60 offen offset:3072 sc0
    buffer_atomic_add_f32 v13, v244, s[8:11], s60 offen offset:3328 sc0
    buffer_atomic_add_f32 v14, v244, s[8:11], s60 offen offset:3584 sc0
    buffer_atomic_add_f32 v15, v244, s[8:11], s60 offen offset:3840 sc0
    buffer_atomic_add_f32 v16, v244, s[8:11], s61 offen offset:0 sc0
    buffer_atomic_add_f32 v17, v244, s[8:11], s61 offen offset:256 sc0
    s_waitcnt vmcnt(0)
    s_barrier
    s_cmp_lg_u32 s44, 0
    s_cbranch_scc1 L_k3_ffn_end
    v_mov_b32 v0, 1
    v_mov_b32 v1, 0
    s_mov_b64 exec, 1
    buffer_atomic_add v0, v1, s[40:43], 0 offen offset:128 sc1
    s_mov_b64 exec, -1
L_k3_ffn_end:
    s_endpgm
L_ka_done:
    s_endpgm
L_k2_site_5_s:
    s_mov_b64 s[74:75], -1
    s_call_b64 s[76:77], L_k2_slowD1
    s_branch L_k2_site_5_r
L_k2_site_6_s:
    s_mov_b64 s[74:75], -1
    s_call_b64 s[76:77], L_k2_slowD0
    s_branch L_k2_site_6_r
L_k2_site_11_s:
    s_mov_b64 s[74:75], 0
    s_call_b64 s[76:77], L_k2_slowD1
    s_branch L_k2_site_11_r
L_k2_site_12_s:
    s_mov_b64 s[74:75], 0
    s_call_b64 s[76:77], L_k2_slowD1
    s_branch L_k2_site_12_r
L_k2_site_15_s:
    s_mov_b64 s[74:75], 0
    s_call_b64 s[76:77], L_k2_slowD0
    s_branch L_k2_site_15_r
L_k2_site_20_s:
    s_mov_b64 s[74:75], 0
    s_call_b64 s[76:77], L_k2_slowD1
    s_branch L_k2_site_20_r
L_k2_site_22_s:
    s_mov_b64 s[74:75], 0
    s_call_b64 s[76:77], L_k2_slowD1
    s_branch L_k2_site_22_r
L_k2_site_23_s:
    s_mov_b64 s[74:75], 0
    s_call_b64 s[76:77], L_k2_slowD1
    s_branch L_k2_site_23_r
L_k2_site_26_s:
    s_mov_b64 s[74:75], 0
    s_call_b64 s[76:77], L_k2_slowD0
    s_branch L_k2_site_26_r
L_k2_site_31_s:
    s_mov_b64 s[74:75], 0
    s_call_b64 s[76:77], L_k2_slowD1
    s_branch L_k2_site_31_r
L_k2_site_33_s:
    s_mov_b64 s[74:75], 0
    s_call_b64 s[76:77], L_k2_slowD1
    s_branch L_k2_site_33_r
L_k2_site_34_s:
    s_mov_b64 s[74:75], 0
    s_call_b64 s[76:77], L_k2_slowD1
    s_branch L_k2_site_34_r
L_k2_site_36_s:
    s_mov_b64 s[74:75], 0
    s_call_b64 s[76:77], L_k2_slowD0
    s_branch L_k2_site_36_r
L_k2_site_37_s:
    s_mov_b64 s[74:75], 0
    s_call_b64 s[76:77], L_k2_slowD1
    s_branch L_k2_site_37_r
L_k2_site_38_s:
    s_mov_b64 s[74:75], 0
    s_call_b64 s[76:77], L_k2_slowD0
    s_branch L_k2_site_38_r
L_k2_site_39_s:
    s_mov_b64 s[74:75], 0
    s_call_b64 s[76:77], L_k2_slowD1
    s_branch L_k2_site_39_r
L_k2_site_40_s:
    s_mov_b64 s[74:75], 0
    s_call_b64 s[76:77], L_k2_slowD0
    s_branch L_k2_site_40_r
L_k2_site_41_s:
    s_mov_b64 s[74:75], 0
    s_call_b64 s[76:77], L_k2_slowD1
    s_branch L_k2_site_41_r
L_k2_site_42_s:
    s_mov_b64 s[74:75], 0
    s_call_b64 s[76:77], L_k2_slowD0
    s_branch L_k2_site_42_r
L_k2_site_43_s:
    s_mov_b64 s[74:75], 0
    s_call_b64 s[76:77], L_k2_slowD1
    s_branch L_k2_site_43_r
L_k2_site_45_s:
    s_mov_b64 s[74:75], 0
    s_call_b64 s[76:77], L_k2_slowD0
    s_branch L_k2_site_45_r
L_k2_site_48_s:
    s_mov_b64 s[74:75], 0
    s_call_b64 s[76:77], L_k2_slowD1
    s_branch L_k2_site_48_r
L_k2_site_49_s:
    s_mov_b64 s[74:75], 0
    s_call_b64 s[76:77], L_k2_slowD0
    s_branch L_k2_site_49_r
L_k2_site_54_s:
    s_mov_b64 s[74:75], 0
    s_call_b64 s[76:77], L_k2_slowD1
    s_branch L_k2_site_54_r
L_k2_site_55_s:
    s_mov_b64 s[74:75], 0
    s_call_b64 s[76:77], L_k2_slowD1
    s_branch L_k2_site_55_r
L_k2_site_58_s:
    s_mov_b64 s[74:75], 0
    s_call_b64 s[76:77], L_k2_slowD0
    s_branch L_k2_site_58_r
L_k2_site_63_s:
    s_mov_b64 s[74:75], 0
    s_call_b64 s[76:77], L_k2_slowD1
    s_branch L_k2_site_63_r
L_k2_site_65_s:
    s_mov_b64 s[74:75], 0
    s_call_b64 s[76:77], L_k2_slowD1
    s_branch L_k2_site_65_r
L_k2_site_66_s:
    s_mov_b64 s[74:75], 0
    s_call_b64 s[76:77], L_k2_slowD1
    s_branch L_k2_site_66_r
L_k2_site_69_s:
    s_mov_b64 s[74:75], 0
    s_call_b64 s[76:77], L_k2_slowD0
    s_branch L_k2_site_69_r
L_k2_site_72_s:
    s_mov_b64 s[74:75], 0
    s_call_b64 s[76:77], L_k2_slowD1
    s_branch L_k2_site_72_r
L_k2_site_74_s:
    s_mov_b64 s[74:75], 0
    s_call_b64 s[76:77], L_k2_slowD1
    s_branch L_k2_site_74_r
L_k2_site_75_s:
    s_mov_b64 s[74:75], 0
    s_call_b64 s[76:77], L_k2_slowD1
    s_branch L_k2_site_75_r
L_k2_site_81_s:
    s_mov_b64 s[74:75], 0
    s_call_b64 s[76:77], L_k2_slowD0n
    s_branch L_k2_site_81_r
L_k2_site_89_s:
    s_mov_b64 s[74:75], 0
    s_call_b64 s[76:77], L_k2_slowS1
    s_branch L_k2_site_89_r
L_k2_site_93_s:
    s_mov_b64 s[74:75], 0
    s_call_b64 s[76:77], L_k2_slowS1
    s_branch L_k2_site_93_r
L_k2_site_94_s:
    s_mov_b64 s[74:75], 0
    s_call_b64 s[76:77], L_k2_slowS1
    s_branch L_k2_site_94_r
L_k2_site_99_s:
    s_mov_b64 s[74:75], 0
    s_call_b64 s[76:77], L_k2_slowS0
    s_branch L_k2_site_99_r
L_k2_site_101_s:
    s_mov_b64 s[74:75], 0
    s_call_b64 s[76:77], L_k2_slowS0
    s_branch L_k2_site_101_r
L_k2_site_106_s:
    s_mov_b64 s[74:75], 0
    s_call_b64 s[76:77], L_k2_slowS1
    s_branch L_k2_site_106_r
L_k2_site_108_s:
    s_mov_b64 s[74:75], 0
    s_call_b64 s[76:77], L_k2_slowS1
    s_branch L_k2_site_108_r
L_k2_site_110_s:
    s_mov_b64 s[74:75], 0
    s_call_b64 s[76:77], L_k2_slowS0
    s_branch L_k2_site_110_r
L_k2_site_111_s:
    s_mov_b64 s[74:75], 0
    s_call_b64 s[76:77], L_k2_slowS1
    s_branch L_k2_site_111_r
L_k2_site_112_s:
    s_mov_b64 s[74:75], 0
    s_call_b64 s[76:77], L_k2_slowS0
    s_branch L_k2_site_112_r
L_k2_site_113_s:
    s_mov_b64 s[74:75], 0
    s_call_b64 s[76:77], L_k2_slowS1
    s_branch L_k2_site_113_r
L_k2_site_115_s:
    s_mov_b64 s[74:75], 0
    s_call_b64 s[76:77], L_k2_slowS0
    s_branch L_k2_site_115_r
L_k2_site_116_s:
    s_mov_b64 s[74:75], 0
    s_call_b64 s[76:77], L_k2_slowS1
    s_branch L_k2_site_116_r
L_k2_site_117_s:
    s_mov_b64 s[74:75], 0
    s_call_b64 s[76:77], L_k2_slowS0
    s_branch L_k2_site_117_r
L_k2_site_118_s:
    s_mov_b64 s[74:75], 0
    s_call_b64 s[76:77], L_k2_slowS1
    s_branch L_k2_site_118_r
L_k2_site_121_s:
    s_mov_b64 s[74:75], 0
    s_call_b64 s[76:77], L_k2_slowS0
    s_branch L_k2_site_121_r
L_k2_site_126_s:
    s_mov_b64 s[74:75], 0
    s_call_b64 s[76:77], L_k2_slowS1
    s_branch L_k2_site_126_r
L_k2_site_127_s:
    s_mov_b64 s[74:75], 0
    s_call_b64 s[76:77], L_k2_slowS1
    s_branch L_k2_site_127_r
L_k2_site_132_s:
    s_mov_b64 s[74:75], 0
    s_call_b64 s[76:77], L_k2_slowS0
    s_branch L_k2_site_132_r
L_k2_site_134_s:
    s_mov_b64 s[74:75], 0
    s_call_b64 s[76:77], L_k2_slowS0
    s_branch L_k2_site_134_r
L_k2_site_137_s:
    s_mov_b64 s[74:75], 0
    s_call_b64 s[76:77], L_k2_slowS1
    s_branch L_k2_site_137_r
L_k2_site_139_s:
    s_mov_b64 s[74:75], 0
    s_call_b64 s[76:77], L_k2_slowS1
    s_branch L_k2_site_139_r
L_k2_site_141_s:
    s_mov_b64 s[74:75], 0
    s_call_b64 s[76:77], L_k2_slowS0
    s_branch L_k2_site_141_r
L_k2_slowS0:
    s_nop 15
    s_nop 15
    v_max3_f32 v187, v112, v113, v114
    v_max3_f32 v187, v187, v115, v116
    v_max3_f32 v187, v187, v117, v118
    v_max3_f32 v187, v187, v119, v120
    v_max3_f32 v187, v187, v121, v122
    v_max3_f32 v187, v187, v123, v124
    v_max3_f32 v187, v187, v125, v126
    v_max_f32 v187, v187, v127
    v_mov_b32 v188, v187
    s_nop 1
    v_permlane32_swap_b32 v187, v188
    v_max_f32 v187, v187, v188
    v_max_f32 v189, 0, v187
    v_cndmask_b32 v188, v189, v187, s[74:75]
    v_exp_f32 v189, -v189
    v_sub_f32 v128, v128, v188
    v_sub_f32 v112, v112, v188
    v_sub_f32 v144, v144, v188
    v_sub_f32 v96, v96, v188
    v_sub_f32 v129, v129, v188
    v_sub_f32 v113, v113, v188
    v_sub_f32 v145, v145, v188
    v_sub_f32 v97, v97, v188
    v_sub_f32 v130, v130, v188
    v_sub_f32 v114, v114, v188
    v_sub_f32 v146, v146, v188
    v_sub_f32 v98, v98, v188
    v_sub_f32 v131, v131, v188
    v_sub_f32 v115, v115, v188
    v_sub_f32 v147, v147, v188
    v_sub_f32 v99, v99, v188
    v_sub_f32 v132, v132, v188
    v_sub_f32 v116, v116, v188
    v_sub_f32 v148, v148, v188
    v_sub_f32 v100, v100, v188
    v_sub_f32 v133, v133, v188
    v_sub_f32 v117, v117, v188
    v_sub_f32 v149, v149, v188
    v_sub_f32 v101, v101, v188
    v_sub_f32 v134, v134, v188
    v_sub_f32 v118, v118, v188
    v_sub_f32 v150, v150, v188
    v_sub_f32 v102, v102, v188
    v_sub_f32 v135, v135, v188
    v_sub_f32 v119, v119, v188
    v_sub_f32 v151, v151, v188
    v_sub_f32 v103, v103, v188
    v_sub_f32 v136, v136, v188
    v_sub_f32 v120, v120, v188
    v_sub_f32 v152, v152, v188
    v_sub_f32 v104, v104, v188
    v_sub_f32 v137, v137, v188
    v_sub_f32 v121, v121, v188
    v_sub_f32 v153, v153, v188
    v_sub_f32 v105, v105, v188
    v_sub_f32 v138, v138, v188
    v_sub_f32 v122, v122, v188
    v_sub_f32 v154, v154, v188
    v_sub_f32 v106, v106, v188
    v_sub_f32 v139, v139, v188
    v_sub_f32 v123, v123, v188
    v_sub_f32 v155, v155, v188
    v_sub_f32 v107, v107, v188
    v_sub_f32 v140, v140, v188
    v_sub_f32 v124, v124, v188
    v_sub_f32 v156, v156, v188
    v_sub_f32 v108, v108, v188
    v_sub_f32 v141, v141, v188
    v_sub_f32 v125, v125, v188
    v_sub_f32 v157, v157, v188
    v_sub_f32 v109, v109, v188
    v_sub_f32 v142, v142, v188
    v_sub_f32 v126, v126, v188
    v_sub_f32 v158, v158, v188
    v_sub_f32 v110, v110, v188
    v_sub_f32 v143, v143, v188
    v_sub_f32 v127, v127, v188
    v_sub_f32 v159, v159, v188
    v_sub_f32 v111, v111, v188
    v_mul_f32 v0, v0, v189
    v_mul_f32 v1, v1, v189
    v_mul_f32 v2, v2, v189
    v_mul_f32 v3, v3, v189
    v_mul_f32 v4, v4, v189
    v_mul_f32 v5, v5, v189
    v_mul_f32 v6, v6, v189
    v_mul_f32 v7, v7, v189
    v_mul_f32 v8, v8, v189
    v_mul_f32 v9, v9, v189
    v_mul_f32 v10, v10, v189
    v_mul_f32 v11, v11, v189
    v_mul_f32 v12, v12, v189
    v_mul_f32 v13, v13, v189
    v_mul_f32 v14, v14, v189
    v_mul_f32 v15, v15, v189
    v_mul_f32 v16, v16, v189
    v_mul_f32 v17, v17, v189
    v_mul_f32 v18, v18, v189
    v_mul_f32 v19, v19, v189
    v_mul_f32 v20, v20, v189
    v_mul_f32 v21, v21, v189
    v_mul_f32 v22, v22, v189
    v_mul_f32 v23, v23, v189
    v_mul_f32 v24, v24, v189
    v_mul_f32 v25, v25, v189
    v_mul_f32 v26, v26, v189
    v_mul_f32 v27, v27, v189
    v_mul_f32 v28, v28, v189
    v_mul_f32 v29, v29, v189
    v_mul_f32 v30, v30, v189
    v_mul_f32 v31, v31, v189
    v_mul_f32 v32, v32, v189
    v_mul_f32 v33, v33, v189
    v_mul_f32 v34, v34, v189
    v_mul_f32 v35, v35, v189
    v_mul_f32 v36, v36, v189
    v_mul_f32 v37, v37, v189
    v_mul_f32 v38, v38, v189
    v_mul_f32 v39, v39, v189
    v_mul_f32 v40, v40, v189
    v_mul_f32 v41, v41, v189
    v_mul_f32 v42, v42, v189
    v_mul_f32 v43, v43, v189
    v_mul_f32 v44, v44, v189
    v_mul_f32 v45, v45, v189
    v_mul_f32 v46, v46, v189
    v_mul_f32 v47, v47, v189
    v_mul_f32 v48, v48, v189
    v_mul_f32 v49, v49, v189
    v_mul_f32 v50, v50, v189
    v_mul_f32 v51, v51, v189
    v_mul_f32 v52, v52, v189
    v_mul_f32 v53, v53, v189
    v_mul_f32 v54, v54, v189
    v_mul_f32 v55, v55, v189
    v_mul_f32 v56, v56, v189
    v_mul_f32 v57, v57, v189
    v_mul_f32 v58, v58, v189
    v_mul_f32 v59, v59, v189
    v_mul_f32 v60, v60, v189
    v_mul_f32 v61, v61, v189
    v_mul_f32 v62, v62, v189
    v_mul_f32 v63, v63, v189
    v_mul_f32 v182, v182, v189
    v_exp_f32 v187, v112
    v_exp_f32 v190, v113
    s_nop 0
    v_add_f32 v181, v187, v190
    v_cvt_pk_bf16_f32 v168, v187, v190
    v_exp_f32 v187, v114
    v_exp_f32 v190, v115
    v_add_f32 v181, v181, v187
    v_add_f32 v181, v181, v190
    v_cvt_pk_bf16_f32 v169, v187, v190
    v_exp_f32 v187, v116
    v_exp_f32 v190, v117
    v_add_f32 v181, v181, v187
    v_add_f32 v181, v181, v190
    v_cvt_pk_bf16_f32 v170, v187, v190
    v_exp_f32 v187, v118
    v_exp_f32 v190, v119
    v_add_f32 v181, v181, v187
    v_add_f32 v181, v181, v190
    v_cvt_pk_bf16_f32 v171, v187, v190
    v_exp_f32 v187, v120
    v_exp_f32 v190, v121
    v_add_f32 v181, v181, v187
    v_add_f32 v181, v181, v190
    v_cvt_pk_bf16_f32 v172, v187, v190
    v_exp_f32 v187, v122
    v_exp_f32 v190, v123
    v_add_f32 v181, v181, v187
    v_add_f32 v181, v181, v190
    v_cvt_pk_bf16_f32 v173, v187, v190
    v_exp_f32 v187, v124
    v_exp_f32 v190, v125
    v_add_f32 v181, v181, v187
    v_add_f32 v181, v181, v190
    v_cvt_pk_bf16_f32 v174, v187, v190
    v_exp_f32 v187, v126
    v_exp_f32 v190, v127
    v_add_f32 v181, v181, v187
    v_add_f32 v181, v181, v190
    v_cvt_pk_bf16_f32 v175, v187, v190
    v_exp_f32 v176, v96
    v_exp_f32 v177, v97
    s_nop 0
    v_add_f32 v180, v176, v177
    v_cvt_pk_bf16_f32 v160, v176, v177
    v_exp_f32 v178, v98
    s_nop 0
    v_add_f32 v180, v180, v178
    v_exp_f32 v179, v99
    s_nop 0
    v_add_f32 v180, v180, v179
    v_cvt_pk_bf16_f32 v161, v178, v179
    v_exp_f32 v176, v100
    s_nop 0
    v_add_f32 v180, v180, v176
    v_exp_f32 v177, v101
    s_nop 3
    s_setpc_b64 s[76:77]
L_k2_slowS1:
    s_nop 15
    s_nop 15
    v_max3_f32 v187, v96, v97, v98
    v_max3_f32 v187, v187, v99, v100
    v_max3_f32 v187, v187, v101, v102
    v_max3_f32 v187, v187, v103, v104
    v_max3_f32 v187, v187, v105, v106
    v_max3_f32 v187, v187, v107, v108
    v_max3_f32 v187, v187, v109, v110
    v_max_f32 v187, v187, v111
    v_mov_b32 v188, v187
    s_nop 1
    v_permlane32_swap_b32 v187, v188
    v_max_f32 v187, v187, v188
    v_max_f32 v189, 0, v187
    v_cndmask_b32 v188, v189, v187, s[74:75]
    v_exp_f32 v189, -v189
    v_sub_f32 v128, v128, v188
    v_sub_f32 v96, v96, v188
    v_sub_f32 v144, v144, v188
    v_sub_f32 v112, v112, v188
    v_sub_f32 v129, v129, v188
    v_sub_f32 v97, v97, v188
    v_sub_f32 v145, v145, v188
    v_sub_f32 v113, v113, v188
    v_sub_f32 v130, v130, v188
    v_sub_f32 v98, v98, v188
    v_sub_f32 v146, v146, v188
    v_sub_f32 v114, v114, v188
    v_sub_f32 v131, v131, v188
    v_sub_f32 v99, v99, v188
    v_sub_f32 v147, v147, v188
    v_sub_f32 v115, v115, v188
    v_sub_f32 v132, v132, v188
    v_sub_f32 v100, v100, v188
    v_sub_f32 v148, v148, v188
    v_sub_f32 v116, v116, v188
    v_sub_f32 v133, v133, v188
    v_sub_f32 v101, v101, v188
    v_sub_f32 v149, v149, v188
    v_sub_f32 v117, v117, v188
    v_sub_f32 v134, v134, v188
    v_sub_f32 v102, v102, v188
    v_sub_f32 v150, v150, v188
    v_sub_f32 v118, v118, v188
    v_sub_f32 v135, v135, v188
    v_sub_f32 v103, v103, v188
    v_sub_f32 v151, v151, v188
    v_sub_f32 v119, v119, v188
    v_sub_f32 v136, v136, v188
    v_sub_f32 v104, v104, v188
    v_sub_f32 v152, v152, v188
    v_sub_f32 v120, v120, v188
    v_sub_f32 v137, v137, v188
    v_sub_f32 v105, v105, v188
    v_sub_f32 v153, v153, v188
    v_sub_f32 v121, v121, v188
    v_sub_f32 v138, v138, v188
    v_sub_f32 v106, v106, v188
    v_sub_f32 v154, v154, v188
    v_sub_f32 v122, v122, v188
    v_sub_f32 v139, v139, v188
    v_sub_f32 v107, v107, v188
    v_sub_f32 v155, v155, v188
    v_sub_f32 v123, v123, v188
    v_sub_f32 v140, v140, v188
    v_sub_f32 v108, v108, v188
    v_sub_f32 v156, v156, v188
    v_sub_f32 v124, v124, v188
    v_sub_f32 v141, v141, v188
    v_sub_f32 v109, v109, v188
    v_sub_f32 v157, v157, v188
    v_sub_f32 v125, v125, v188
    v_sub_f32 v142, v142, v188
    v_sub_f32 v110, v110, v188
    v_sub_f32 v158, v158, v188
    v_sub_f32 v126, v126, v188
    v_sub_f32 v143, v143, v188
    v_sub_f32 v111, v111, v188
    v_sub_f32 v159, v159, v188
    v_sub_f32 v127, v127, v188
    v_mul_f32 v0, v0, v189
    v_mul_f32 v1, v1, v189
    v_mul_f32 v2, v2, v189
    v_mul_f32 v3, v3, v189
    v_mul_f32 v4, v4, v189
    v_mul_f32 v5, v5, v189
    v_mul_f32 v6, v6, v189
    v_mul_f32 v7, v7, v189
    v_mul_f32 v8, v8, v189
    v_mul_f32 v9, v9, v189
    v_mul_f32 v10, v10, v189
    v_mul_f32 v11, v11, v189
    v_mul_f32 v12, v12, v189
    v_mul_f32 v13, v13, v189
    v_mul_f32 v14, v14, v189
    v_mul_f32 v15, v15, v189
    v_mul_f32 v16, v16, v189
    v_mul_f32 v17, v17, v189
    v_mul_f32 v18, v18, v189
    v_mul_f32 v19, v19, v189
    v_mul_f32 v20, v20, v189
    v_mul_f32 v21, v21, v189
    v_mul_f32 v22, v22, v189
    v_mul_f32 v23, v23, v189
    v_mul_f32 v24, v24, v189
    v_mul_f32 v25, v25, v189
    v_mul_f32 v26, v26, v189
    v_mul_f32 v27, v27, v189
    v_mul_f32 v28, v28, v189
    v_mul_f32 v29, v29, v189
    v_mul_f32 v30, v30, v189
    v_mul_f32 v31, v31, v189
    v_mul_f32 v32, v32, v189
    v_mul_f32 v33, v33, v189
    v_mul_f32 v34, v34, v189
    v_mul_f32 v35, v35, v189
    v_mul_f32 v36, v36, v189
    v_mul_f32 v37, v37, v189
    v_mul_f32 v38, v38, v189
    v_mul_f32 v39, v39, v189
    v_mul_f32 v40, v40, v189
    v_mul_f32 v41, v41, v189
    v_mul_f32 v42, v42, v189
    v_mul_f32 v43, v43, v189
    v_mul_f32 v44, v44, v189
    v_mul_f32 v45, v45, v189
    v_mul_f32 v46, v46, v189
    v_mul_f32 v47, v47, v189
    v_mul_f32 v48, v48, v189
    v_mul_f32 v49, v49, v189
    v_mul_f32 v50, v50, v189
    v_mul_f32 v51, v51, v189
    v_mul_f32 v52, v52, v189
    v_mul_f32 v53, v53, v189
    v_mul_f32 v54, v54, v189
    v_mul_f32 v55, v55, v189
    v_mul_f32 v56, v56, v189
    v_mul_f32 v57, v57, v189
    v_mul_f32 v58, v58, v189
    v_mul_f32 v59, v59, v189
    v_mul_f32 v60, v60, v189
    v_mul_f32 v61, v61, v189
    v_mul_f32 v62, v62, v189
    v_mul_f32 v63, v63, v189
    v_mul_f32 v182, v182, v189
    v_exp_f32 v187, v96
    v_exp_f32 v190, v97
    s_nop 0
    v_add_f32 v180, v187, v190
    v_cvt_pk_bf16_f32 v160, v187, v190
    v_exp_f32 v187, v98
    v_exp_f32 v190, v99
    v_add_f32 v180, v180, v187
    v_add_f32 v180, v180, v190
    v_cvt_pk_bf16_f32 v161, v187, v190
    v_exp_f32 v187, v100
    v_exp_f32 v190, v101
    v_add_f32 v180, v180, v187
    v_add_f32 v180, v180, v190
    v_cvt_pk_bf16_f32 v162, v187, v190
    v_exp_f32 v187, v102
    v_exp_f32 v190, v103
    v_add_f32 v180, v180, v187
    v_add_f32 v180, v180, v190
    v_cvt_pk_bf16_f32 v163, v187, v190
    v_exp_f32 v187, v104
    v_exp_f32 v190, v105
    v_add_f32 v180, v180, v187
    v_add_f32 v180, v180, v190
    v_cvt_pk_bf16_f32 v164, v187, v190
    v_exp_f32 v187, v106
    v_exp_f32 v190, v107
    v_add_f32 v180, v180, v187
    v_add_f32 v180, v180, v190
    v_cvt_pk_bf16_f32 v165, v187, v190
    v_exp_f32 v187, v108
    v_exp_f32 v190, v109
    v_add_f32 v180, v180, v187
    v_add_f32 v180, v180, v190
    v_cvt_pk_bf16_f32 v166, v187, v190
    v_exp_f32 v187, v110
    v_exp_f32 v190, v111
    v_add_f32 v180, v180, v187
    v_add_f32 v180, v180, v190
    v_cvt_pk_bf16_f32 v167, v187, v190
    v_exp_f32 v176, v112
    v_exp_f32 v177, v113
    s_nop 0
    v_add_f32 v181, v176, v177
    v_cvt_pk_bf16_f32 v168, v176, v177
    v_exp_f32 v178, v114
    s_nop 0
    v_add_f32 v181, v181, v178
    v_exp_f32 v179, v115
    s_nop 0
    v_add_f32 v181, v181, v179
    v_cvt_pk_bf16_f32 v169, v178, v179
    v_exp_f32 v176, v116
    s_nop 0
    v_add_f32 v181, v181, v176
    v_exp_f32 v177, v117
    s_nop 3
    s_setpc_b64 s[76:77]
L_k2_slowD0:
    s_nop 15
    s_nop 15
    v_max3_f32 v187, v112, v113, v114
    v_max3_f32 v187, v187, v115, v116
    v_max3_f32 v187, v187, v117, v118
    v_max3_f32 v187, v187, v119, v120
    v_max3_f32 v187, v187, v121, v122
    v_max3_f32 v187, v187, v123, v124
    v_max3_f32 v187, v187, v125, v126
    v_max_f32 v187, v187, v127
    v_mov_b32 v188, v187
    s_nop 1
    v_permlane32_swap_b32 v187, v188
    v_max_f32 v187, v187, v188
    v_max_f32 v189, 0, v187
    v_cndmask_b32 v188, v189, v187, s[74:75]
    v_exp_f32 v189, -v189
    v_sub_f32 v224, v224, v188
    v_sub_f32 v112, v112, v188
    v_sub_f32 v144, v144, v188
    v_sub_f32 v225, v225, v188
    v_sub_f32 v113, v113, v188
    v_sub_f32 v145, v145, v188
    v_sub_f32 v226, v226, v188
    v_sub_f32 v114, v114, v188
    v_sub_f32 v146, v146, v188
    v_sub_f32 v227, v227, v188
    v_sub_f32 v115, v115, v188
    v_sub_f32 v147, v147, v188
    v_sub_f32 v228, v228, v188
    v_sub_f32 v116, v116, v188
    v_sub_f32 v148, v148, v188
    v_sub_f32 v229, v229, v188
    v_sub_f32 v117, v117, v188
    v_sub_f32 v149, v149, v188
    v_sub_f32 v230, v230, v188
    v_sub_f32 v118, v118, v188
    v_sub_f32 v150, v150, v188
    v_sub_f32 v231, v231, v188
    v_sub_f32 v119, v119, v188
    v_sub_f32 v151, v151, v188
    v_sub_f32 v232, v232, v188
    v_sub_f32 v120, v120, v188
    v_sub_f32 v152, v152, v188
    v_sub_f32 v233, v233, v188
    v_sub_f32 v121, v121, v188
    v_sub_f32 v153, v153, v188
    v_sub_f32 v234, v234, v188
    v_sub_f32 v122, v122, v188
    v_sub_f32 v154, v154, v188
    v_sub_f32 v235, v235, v188
    v_sub_f32 v123, v123, v188
    v_sub_f32 v155, v155, v188
    v_sub_f32 v236, v236, v188
    v_sub_f32 v124, v124, v188
    v_sub_f32 v156, v156, v188
    v_sub_f32 v237, v237, v188
    v_sub_f32 v125, v125, v188
    v_sub_f32 v157, v157, v188
    v_sub_f32 v238, v238, v188
    v_sub_f32 v126, v126, v188
    v_sub_f32 v158, v158, v188
    v_sub_f32 v239, v239, v188
    v_sub_f32 v127, v127, v188
    v_sub_f32 v159, v159, v188
    v_accvgpr_read_b32 v190, a64
    v_mul_f32 v190, v190, v189
    v_accvgpr_write_b32 a64, v190
    v_accvgpr_read_b32 v190, a65
    v_mul_f32 v190, v190, v189
    v_accvgpr_write_b32 a65, v190
    v_accvgpr_read_b32 v190, a66
    v_mul_f32 v190, v190, v189
    v_accvgpr_write_b32 a66, v190
    v_accvgpr_read_b32 v190, a67
    v_mul_f32 v190, v190, v189
    v_accvgpr_write_b32 a67, v190
    v_accvgpr_read_b32 v190, a68
    v_mul_f32 v190, v190, v189
    v_accvgpr_write_b32 a68, v190
    v_accvgpr_read_b32 v190, a69
    v_mul_f32 v190, v190, v189
    v_accvgpr_write_b32 a69, v190
    v_accvgpr_read_b32 v190, a70
    v_mul_f32 v190, v190, v189
    v_accvgpr_write_b32 a70, v190
    v_accvgpr_read_b32 v190, a71
    v_mul_f32 v190, v190, v189
    v_accvgpr_write_b32 a71, v190
    v_accvgpr_read_b32 v190, a72
    v_mul_f32 v190, v190, v189
    v_accvgpr_write_b32 a72, v190
    v_accvgpr_read_b32 v190, a73
    v_mul_f32 v190, v190, v189
    v_accvgpr_write_b32 a73, v190
    v_accvgpr_read_b32 v190, a74
    v_mul_f32 v190, v190, v189
    v_accvgpr_write_b32 a74, v190
    v_accvgpr_read_b32 v190, a75
    v_mul_f32 v190, v190, v189
    v_accvgpr_write_b32 a75, v190
    v_accvgpr_read_b32 v190, a76
    v_mul_f32 v190, v190, v189
    v_accvgpr_write_b32 a76, v190
    v_accvgpr_read_b32 v190, a77
    v_mul_f32 v190, v190, v189
    v_accvgpr_write_b32 a77, v190
    v_accvgpr_read_b32 v190, a78
    v_mul_f32 v190, v190, v189
    v_accvgpr_write_b32 a78, v190
    v_accvgpr_read_b32 v190, a79
    v_mul_f32 v190, v190, v189
    v_accvgpr_write_b32 a79, v190
    v_accvgpr_read_b32 v190, a80
    v_mul_f32 v190, v190, v189
    v_accvgpr_write_b32 a80, v190
    v_accvgpr_read_b32 v190, a81
    v_mul_f32 v190, v190, v189
    v_accvgpr_write_b32 a81, v190
    v_accvgpr_read_b32 v190, a82
    v_mul_f32 v190, v190, v189
    v_accvgpr_write_b32 a82, v190
    v_accvgpr_read_b32 v190, a83
    v_mul_f32 v190, v190, v189
    v_accvgpr_write_b32 a83, v190
    v_accvgpr_read_b32 v190, a84
    v_mul_f32 v190, v190, v189
    v_accvgpr_write_b32 a84, v190
    v_accvgpr_read_b32 v190, a85
    v_mul_f32 v190, v190, v189
    v_accvgpr_write_b32 a85, v190
    v_accvgpr_read_b32 v190, a86
    v_mul_f32 v190, v190, v189
    v_accvgpr_write_b32 a86, v190
    v_accvgpr_read_b32 v190, a87
    v_mul_f32 v190, v190, v189
    v_accvgpr_write_b32 a87, v190
    v_accvgpr_read_b32 v190, a88
    v_mul_f32 v190, v190, v189
    v_accvgpr_write_b32 a88, v190
    v_accvgpr_read_b32 v190, a89
    v_mul_f32 v190, v190, v189
    v_accvgpr_write_b32 a89, v190
    v_accvgpr_read_b32 v190, a90
    v_mul_f32 v190, v190, v189
    v_accvgpr_write_b32 a90, v190
    v_accvgpr_read_b32 v190, a91
    v_mul_f32 v190, v190, v189
    v_accvgpr_write_b32 a91, v190
    v_accvgpr_read_b32 v190, a92
    v_mul_f32 v190, v190, v189
    v_accvgpr_write_b32 a92, v190
    v_accvgpr_read_b32 v190, a93
    v_mul_f32 v190, v190, v189
    v_accvgpr_write_b32 a93, v190
    v_accvgpr_read_b32 v190, a94
    v_mul_f32 v190, v190, v189
    v_accvgpr_write_b32 a94, v190
    v_accvgpr_read_b32 v190, a95
    v_mul_f32 v190, v190, v189
    v_accvgpr_write_b32 a95, v190
    v_accvgpr_read_b32 v190, a96
    v_mul_f32 v190, v190, v189
    v_accvgpr_write_b32 a96, v190
    v_accvgpr_read_b32 v190, a97
    v_mul_f32 v190, v190, v189
    v_accvgpr_write_b32 a97, v190
    v_accvgpr_read_b32 v190, a98
    v_mul_f32 v190, v190, v189
    v_accvgpr_write_b32 a98, v190
    v_accvgpr_read_b32 v190, a99
    v_mul_f32 v190, v190, v189
    v_accvgpr_write_b32 a99, v190
    v_accvgpr_read_b32 v190, a100
    v_mul_f32 v190, v190, v189
    v_accvgpr_write_b32 a100, v190
    v_accvgpr_read_b32 v190, a101
    v_mul_f32 v190, v190, v189
    v_accvgpr_write_b32 a101, v190
    v_accvgpr_read_b32 v190, a102
    v_mul_f32 v190, v190, v189
    v_accvgpr_write_b32 a102, v190
    v_accvgpr_read_b32 v190, a103
    v_mul_f32 v190, v190, v189
    v_accvgpr_write_b32 a103, v190
    v_accvgpr_read_b32 v190, a104
    v_mul_f32 v190, v190, v189
    v_accvgpr_write_b32 a104, v190
    v_accvgpr_read_b32 v190, a105
    v_mul_f32 v190, v190, v189
    v_accvgpr_write_b32 a105, v190
    v_accvgpr_read_b32 v190, a106
    v_mul_f32 v190, v190, v189
    v_accvgpr_write_b32 a106, v190
    v_accvgpr_read_b32 v190, a107
    v_mul_f32 v190, v190, v189
    v_accvgpr_write_b32 a107, v190
    v_accvgpr_read_b32 v190, a108
    v_mul_f32 v190, v190, v189
    v_accvgpr_write_b32 a108, v190
    v_accvgpr_read_b32 v190, a109
    v_mul_f32 v190, v190, v189
    v_accvgpr_write_b32 a109, v190
    v_accvgpr_read_b32 v190, a110
    v_mul_f32 v190, v190, v189
    v_accvgpr_write_b32 a110, v190
    v_accvgpr_read_b32 v190, a111
    v_mul_f32 v190, v190, v189
    v_accvgpr_write_b32 a111, v190
    v_accvgpr_read_b32 v190, a112
    v_mul_f32 v190, v190, v189
    v_accvgpr_write_b32 a112, v190
    v_accvgpr_read_b32 v190, a113
    v_mul_f32 v190, v190, v189
    v_accvgpr_write_b32 a113, v190
    v_accvgpr_read_b32 v190, a114
    v_mul_f32 v190, v190, v189
    v_accvgpr_write_b32 a114, v190
    v_accvgpr_read_b32 v190, a115
    v_mul_f32 v190, v190, v189
    v_accvgpr_write_b32 a115, v190
    v_accvgpr_read_b32 v190, a116
    v_mul_f32 v190, v190, v189
    v_accvgpr_write_b32 a116, v190
    v_accvgpr_read_b32 v190, a117
    v_mul_f32 v190, v190, v189
    v_accvgpr_write_b32 a117, v190
    v_accvgpr_read_b32 v190, a118
    v_mul_f32 v190, v190, v189
    v_accvgpr_write_b32 a118, v190
    v_accvgpr_read_b32 v190, a119
    v_mul_f32 v190, v190, v189
    v_accvgpr_write_b32 a119, v190
    v_accvgpr_read_b32 v190, a120
    v_mul_f32 v190, v190, v189
    v_accvgpr_write_b32 a120, v190
    v_accvgpr_read_b32 v190, a121
    v_mul_f32 v190, v190, v189
    v_accvgpr_write_b32 a121, v190
    v_accvgpr_read_b32 v190, a122
    v_mul_f32 v190, v190, v189
    v_accvgpr_write_b32 a122, v190
    v_accvgpr_read_b32 v190, a123
    v_mul_f32 v190, v190, v189
    v_accvgpr_write_b32 a123, v190
    v_accvgpr_read_b32 v190, a124
    v_mul_f32 v190, v190, v189
    v_accvgpr_write_b32 a124, v190
    v_accvgpr_read_b32 v190, a125
    v_mul_f32 v190, v190, v189
    v_accvgpr_write_b32 a125, v190
    v_accvgpr_read_b32 v190, a126
    v_mul_f32 v190, v190, v189
    v_accvgpr_write_b32 a126, v190
    v_accvgpr_read_b32 v190, a127
    v_mul_f32 v190, v190, v189
    v_accvgpr_write_b32 a127, v190
    v_mul_f32 v185, v185, v189
    v_exp_f32 v187, v112
    v_exp_f32 v190, v113
    s_nop 0
    v_add_f32 v181, v187, v190
    v_cvt_pk_bf16_f32 v168, v187, v190
    v_exp_f32 v187, v114
    v_exp_f32 v190, v115
    v_add_f32 v181, v181, v187
    v_add_f32 v181, v181, v190
    v_cvt_pk_bf16_f32 v169, v187, v190
    v_exp_f32 v187, v116
    v_exp_f32 v190, v117
    v_add_f32 v181, v181, v187
    v_add_f32 v181, v181, v190
    v_cvt_pk_bf16_f32 v170, v187, v190
    v_exp_f32 v187, v118
    v_exp_f32 v190, v119
    v_add_f32 v181, v181, v187
    v_add_f32 v181, v181, v190
    v_cvt_pk_bf16_f32 v171, v187, v190
    v_exp_f32 v187, v120
    v_exp_f32 v190, v121
    v_add_f32 v181, v181, v187
    v_add_f32 v181, v181, v190
    v_cvt_pk_bf16_f32 v172, v187, v190
    v_exp_f32 v187, v122
    v_exp_f32 v190, v123
    v_add_f32 v181, v181, v187
    v_add_f32 v181, v181, v190
    v_cvt_pk_bf16_f32 v173, v187, v190
    v_exp_f32 v187, v124
    v_exp_f32 v190, v125
    v_add_f32 v181, v181, v187
    v_add_f32 v181, v181, v190
    v_cvt_pk_bf16_f32 v174, v187, v190
    v_exp_f32 v187, v126
    v_exp_f32 v190, v127
    v_add_f32 v181, v181, v187
    v_add_f32 v181, v181, v190
    v_cvt_pk_bf16_f32 v175, v187, v190
    s_nop 3
    s_setpc_b64 s[76:77]
L_k2_slowD0n:
    s_nop 15
    s_nop 15
    v_max3_f32 v187, v112, v113, v114
    v_max3_f32 v187, v187, v115, v116
    v_max3_f32 v187, v187, v117, v118
    v_max3_f32 v187, v187, v119, v120
    v_max3_f32 v187, v187, v121, v122
    v_max3_f32 v187, v187, v123, v124
    v_max3_f32 v187, v187, v125, v126
    v_max_f32 v187, v187, v127
    v_mov_b32 v188, v187
    s_nop 1
    v_permlane32_swap_b32 v187, v188
    v_max_f32 v187, v187, v188
    v_max_f32 v189, 0, v187
    v_cndmask_b32 v188, v189, v187, s[74:75]
    v_exp_f32 v189, -v189
    v_sub_f32 v224, v224, v188
    v_sub_f32 v112, v112, v188
    v_sub_f32 v225, v225, v188
    v_sub_f32 v113, v113, v188
    v_sub_f32 v226, v226, v188
    v_sub_f32 v114, v114, v188
    v_sub_f32 v227, v227, v188
    v_sub_f32 v115, v115, v188
    v_sub_f32 v228, v228, v188
    v_sub_f32 v116, v116, v188
    v_sub_f32 v229, v229, v188
    v_sub_f32 v117, v117, v188
    v_sub_f32 v230, v230, v188
    v_sub_f32 v118, v118, v188
    v_sub_f32 v231, v231, v188
    v_sub_f32 v119, v119, v188
    v_sub_f32 v232, v232, v188
    v_sub_f32 v120, v120, v188
    v_sub_f32 v233, v233, v188
    v_sub_f32 v121, v121, v188
    v_sub_f32 v234, v234, v188
    v_sub_f32 v122, v122, v188
    v_sub_f32 v235, v235, v188
    v_sub_f32 v123, v123, v188
    v_sub_f32 v236, v236, v188
    v_sub_f32 v124, v124, v188
    v_sub_f32 v237, v237, v188
    v_sub_f32 v125, v125, v188
    v_sub_f32 v238, v238, v188
    v_sub_f32 v126, v126, v188
    v_sub_f32 v239, v239, v188
    v_sub_f32 v127, v127, v188
    v_accvgpr_read_b32 v190, a64
    v_mul_f32 v190, v190, v189
    v_accvgpr_write_b32 a64, v190
    v_accvgpr_read_b32 v190, a65
    v_mul_f32 v190, v190, v189
    v_accvgpr_write_b32 a65, v190
    v_accvgpr_read_b32 v190, a66
    v_mul_f32 v190, v190, v189
    v_accvgpr_write_b32 a66, v190
    v_accvgpr_read_b32 v190, a67
    v_mul_f32 v190, v190, v189
    v_accvgpr_write_b32 a67, v190
    v_accvgpr_read_b32 v190, a68
    v_mul_f32 v190, v190, v189
    v_accvgpr_write_b32 a68, v190
    v_accvgpr_read_b32 v190, a69
    v_mul_f32 v190, v190, v189
    v_accvgpr_write_b32 a69, v190
    v_accvgpr_read_b32 v190, a70
    v_mul_f32 v190, v190, v189
    v_accvgpr_write_b32 a70, v190
    v_accvgpr_read_b32 v190, a71
    v_mul_f32 v190, v190, v189
    v_accvgpr_write_b32 a71, v190
    v_accvgpr_read_b32 v190, a72
    v_mul_f32 v190, v190, v189
    v_accvgpr_write_b32 a72, v190
    v_accvgpr_read_b32 v190, a73
    v_mul_f32 v190, v190, v189
    v_accvgpr_write_b32 a73, v190
    v_accvgpr_read_b32 v190, a74
    v_mul_f32 v190, v190, v189
    v_accvgpr_write_b32 a74, v190
    v_accvgpr_read_b32 v190, a75
    v_mul_f32 v190, v190, v189
    v_accvgpr_write_b32 a75, v190
    v_accvgpr_read_b32 v190, a76
    v_mul_f32 v190, v190, v189
    v_accvgpr_write_b32 a76, v190
    v_accvgpr_read_b32 v190, a77
    v_mul_f32 v190, v190, v189
    v_accvgpr_write_b32 a77, v190
    v_accvgpr_read_b32 v190, a78
    v_mul_f32 v190, v190, v189
    v_accvgpr_write_b32 a78, v190
    v_accvgpr_read_b32 v190, a79
    v_mul_f32 v190, v190, v189
    v_accvgpr_write_b32 a79, v190
    v_accvgpr_read_b32 v190, a80
    v_mul_f32 v190, v190, v189
    v_accvgpr_write_b32 a80, v190
    v_accvgpr_read_b32 v190, a81
    v_mul_f32 v190, v190, v189
    v_accvgpr_write_b32 a81, v190
    v_accvgpr_read_b32 v190, a82
    v_mul_f32 v190, v190, v189
    v_accvgpr_write_b32 a82, v190
    v_accvgpr_read_b32 v190, a83
    v_mul_f32 v190, v190, v189
    v_accvgpr_write_b32 a83, v190
    v_accvgpr_read_b32 v190, a84
    v_mul_f32 v190, v190, v189
    v_accvgpr_write_b32 a84, v190
    v_accvgpr_read_b32 v190, a85
    v_mul_f32 v190, v190, v189
    v_accvgpr_write_b32 a85, v190
    v_accvgpr_read_b32 v190, a86
    v_mul_f32 v190, v190, v189
    v_accvgpr_write_b32 a86, v190
    v_accvgpr_read_b32 v190, a87
    v_mul_f32 v190, v190, v189
    v_accvgpr_write_b32 a87, v190
    v_accvgpr_read_b32 v190, a88
    v_mul_f32 v190, v190, v189
    v_accvgpr_write_b32 a88, v190
    v_accvgpr_read_b32 v190, a89
    v_mul_f32 v190, v190, v189
    v_accvgpr_write_b32 a89, v190
    v_accvgpr_read_b32 v190, a90
    v_mul_f32 v190, v190, v189
    v_accvgpr_write_b32 a90, v190
    v_accvgpr_read_b32 v190, a91
    v_mul_f32 v190, v190, v189
    v_accvgpr_write_b32 a91, v190
    v_accvgpr_read_b32 v190, a92
    v_mul_f32 v190, v190, v189
    v_accvgpr_write_b32 a92, v190
    v_accvgpr_read_b32 v190, a93
    v_mul_f32 v190, v190, v189
    v_accvgpr_write_b32 a93, v190
    v_accvgpr_read_b32 v190, a94
    v_mul_f32 v190, v190, v189
    v_accvgpr_write_b32 a94, v190
    v_accvgpr_read_b32 v190, a95
    v_mul_f32 v190, v190, v189
    v_accvgpr_write_b32 a95, v190
    v_accvgpr_read_b32 v190, a96
    v_mul_f32 v190, v190, v189
    v_accvgpr_write_b32 a96, v190
    v_accvgpr_read_b32 v190, a97
    v_mul_f32 v190, v190, v189
    v_accvgpr_write_b32 a97, v190
    v_accvgpr_read_b32 v190, a98
    v_mul_f32 v190, v190, v189
    v_accvgpr_write_b32 a98, v190
    v_accvgpr_read_b32 v190, a99
    v_mul_f32 v190, v190, v189
    v_accvgpr_write_b32 a99, v190
    v_accvgpr_read_b32 v190, a100
    v_mul_f32 v190, v190, v189
    v_accvgpr_write_b32 a100, v190
    v_accvgpr_read_b32 v190, a101
    v_mul_f32 v190, v190, v189
    v_accvgpr_write_b32 a101, v190
    v_accvgpr_read_b32 v190, a102
    v_mul_f32 v190, v190, v189
    v_accvgpr_write_b32 a102, v190
    v_accvgpr_read_b32 v190, a103
    v_mul_f32 v190, v190, v189
    v_accvgpr_write_b32 a103, v190
    v_accvgpr_read_b32 v190, a104
    v_mul_f32 v190, v190, v189
    v_accvgpr_write_b32 a104, v190
    v_accvgpr_read_b32 v190, a105
    v_mul_f32 v190, v190, v189
    v_accvgpr_write_b32 a105, v190
    v_accvgpr_read_b32 v190, a106
    v_mul_f32 v190, v190, v189
    v_accvgpr_write_b32 a106, v190
    v_accvgpr_read_b32 v190, a107
    v_mul_f32 v190, v190, v189
    v_accvgpr_write_b32 a107, v190
    v_accvgpr_read_b32 v190, a108
    v_mul_f32 v190, v190, v189
    v_accvgpr_write_b32 a108, v190
    v_accvgpr_read_b32 v190, a109
    v_mul_f32 v190, v190, v189
    v_accvgpr_write_b32 a109, v190
    v_accvgpr_read_b32 v190, a110
    v_mul_f32 v190, v190, v189
    v_accvgpr_write_b32 a110, v190
    v_accvgpr_read_b32 v190, a111
    v_mul_f32 v190, v190, v189
    v_accvgpr_write_b32 a111, v190
    v_accvgpr_read_b32 v190, a112
    v_mul_f32 v190, v190, v189
    v_accvgpr_write_b32 a112, v190
    v_accvgpr_read_b32 v190, a113
    v_mul_f32 v190, v190, v189
    v_accvgpr_write_b32 a113, v190
    v_accvgpr_read_b32 v190, a114
    v_mul_f32 v190, v190, v189
    v_accvgpr_write_b32 a114, v190
    v_accvgpr_read_b32 v190, a115
    v_mul_f32 v190, v190, v189
    v_accvgpr_write_b32 a115, v190
    v_accvgpr_read_b32 v190, a116
    v_mul_f32 v190, v190, v189
    v_accvgpr_write_b32 a116, v190
    v_accvgpr_read_b32 v190, a117
    v_mul_f32 v190, v190, v189
    v_accvgpr_write_b32 a117, v190
    v_accvgpr_read_b32 v190, a118
    v_mul_f32 v190, v190, v189
    v_accvgpr_write_b32 a118, v190
    v_accvgpr_read_b32 v190, a119
    v_mul_f32 v190, v190, v189
    v_accvgpr_write_b32 a119, v190
    v_accvgpr_read_b32 v190, a120
    v_mul_f32 v190, v190, v189
    v_accvgpr_write_b32 a120, v190
    v_accvgpr_read_b32 v190, a121
    v_mul_f32 v190, v190, v189
    v_accvgpr_write_b32 a121, v190
    v_accvgpr_read_b32 v190, a122
    v_mul_f32 v190, v190, v189
    v_accvgpr_write_b32 a122, v190
    v_accvgpr_read_b32 v190, a123
    v_mul_f32 v190, v190, v189
    v_accvgpr_write_b32 a123, v190
    v_accvgpr_read_b32 v190, a124
    v_mul_f32 v190, v190, v189
    v_accvgpr_write_b32 a124, v190
    v_accvgpr_read_b32 v190, a125
    v_mul_f32 v190, v190, v189
    v_accvgpr_write_b32 a125, v190
    v_accvgpr_read_b32 v190, a126
    v_mul_f32 v190, v190, v189
    v_accvgpr_write_b32 a126, v190
    v_accvgpr_read_b32 v190, a127
    v_mul_f32 v190, v190, v189
    v_accvgpr_write_b32 a127, v190
    v_mul_f32 v185, v185, v189
    v_exp_f32 v187, v112
    v_exp_f32 v190, v113
    s_nop 0
    v_add_f32 v181, v187, v190
    v_cvt_pk_bf16_f32 v168, v187, v190
    v_exp_f32 v187, v114
    v_exp_f32 v190, v115
    v_add_f32 v181, v181, v187
    v_add_f32 v181, v181, v190
    v_cvt_pk_bf16_f32 v169, v187, v190
    v_exp_f32 v187, v116
    v_exp_f32 v190, v117
    v_add_f32 v181, v181, v187
    v_add_f32 v181, v181, v190
    v_cvt_pk_bf16_f32 v170, v187, v190
    v_exp_f32 v187, v118
    v_exp_f32 v190, v119
    v_add_f32 v181, v181, v187
    v_add_f32 v181, v181, v190
    v_cvt_pk_bf16_f32 v171, v187, v190
    v_exp_f32 v187, v120
    v_exp_f32 v190, v121
    v_add_f32 v181, v181, v187
    v_add_f32 v181, v181, v190
    v_cvt_pk_bf16_f32 v172, v187, v190
    v_exp_f32 v187, v122
    v_exp_f32 v190, v123
    v_add_f32 v181, v181, v187
    v_add_f32 v181, v181, v190
    v_cvt_pk_bf16_f32 v173, v187, v190
    v_exp_f32 v187, v124
    v_exp_f32 v190, v125
    v_add_f32 v181, v181, v187
    v_add_f32 v181, v181, v190
    v_cvt_pk_bf16_f32 v174, v187, v190
    v_exp_f32 v187, v126
    v_exp_f32 v190, v127
    v_add_f32 v181, v181, v187
    v_add_f32 v181, v181, v190
    v_cvt_pk_bf16_f32 v175, v187, v190
    s_nop 3
    s_setpc_b64 s[76:77]
L_k2_slowD1:
    s_nop 15
    s_nop 15
    v_max3_f32 v187, v96, v97, v98
    v_max3_f32 v187, v187, v99, v100
    v_max3_f32 v187, v187, v101, v102
    v_max3_f32 v187, v187, v103, v104
    v_max3_f32 v187, v187, v105, v106
    v_max3_f32 v187, v187, v107, v108
    v_max3_f32 v187, v187, v109, v110
    v_max_f32 v187, v187, v111
    v_mov_b32 v188, v187
    s_nop 1
    v_permlane32_swap_b32 v187, v188
    v_max_f32 v187, v187, v188
    v_max_f32 v189, 0, v187
    v_cndmask_b32 v188, v189, v187, s[74:75]
    v_exp_f32 v189, -v189
    v_sub_f32 v128, v128, v188
    v_sub_f32 v96, v96, v188
    v_sub_f32 v129, v129, v188
    v_sub_f32 v97, v97, v188
    v_sub_f32 v130, v130, v188
    v_sub_f32 v98, v98, v188
    v_sub_f32 v131, v131, v188
    v_sub_f32 v99, v99, v188
    v_sub_f32 v132, v132, v188
    v_sub_f32 v100, v100, v188
    v_sub_f32 v133, v133, v188
    v_sub_f32 v101, v101, v188
    v_sub_f32 v134, v134, v188
    v_sub_f32 v102, v102, v188
    v_sub_f32 v135, v135, v188
    v_sub_f32 v103, v103, v188
    v_sub_f32 v136, v136, v188
    v_sub_f32 v104, v104, v188
    v_sub_f32 v137, v137, v188
    v_sub_f32 v105, v105, v188
    v_sub_f32 v138, v138, v188
    v_sub_f32 v106, v106, v188
    v_sub_f32 v139, v139, v188
    v_sub_f32 v107, v107, v188
    v_sub_f32 v140, v140, v188
    v_sub_f32 v108, v108, v188
    v_sub_f32 v141, v141, v188
    v_sub_f32 v109, v109, v188
    v_sub_f32 v142, v142, v188
    v_sub_f32 v110, v110, v188
    v_sub_f32 v143, v143, v188
    v_sub_f32 v111, v111, v188
    v_mul_f32 v0, v0, v189
    v_mul_f32 v1, v1, v189
    v_mul_f32 v2, v2, v189
    v_mul_f32 v3, v3, v189
    v_mul_f32 v4, v4, v189
    v_mul_f32 v5, v5, v189
    v_mul_f32 v6, v6, v189
    v_mul_f32 v7, v7, v189
    v_mul_f32 v8, v8, v189
    v_mul_f32 v9, v9, v189
    v_mul_f32 v10, v10, v189
    v_mul_f32 v11, v11, v189
    v_mul_f32 v12, v12, v189
    v_mul_f32 v13, v13, v189
    v_mul_f32 v14, v14, v189
    v_mul_f32 v15, v15, v189
    v_mul_f32 v16, v16, v189
    v_mul_f32 v17, v17, v189
    v_mul_f32 v18, v18, v189
    v_mul_f32 v19, v19, v189
    v_mul_f32 v20, v20, v189
    v_mul_f32 v21, v21, v189
    v_mul_f32 v22, v22, v189
    v_mul_f32 v23, v23, v189
    v_mul_f32 v24, v24, v189
    v_mul_f32 v25, v25, v189
    v_mul_f32 v26, v26, v189
    v_mul_f32 v27, v27, v189
    v_mul_f32 v28, v28, v189
    v_mul_f32 v29, v29, v189
    v_mul_f32 v30, v30, v189
    v_mul_f32 v31, v31, v189
    v_mul_f32 v32, v32, v189
    v_mul_f32 v33, v33, v189
    v_mul_f32 v34, v34, v189
    v_mul_f32 v35, v35, v189
    v_mul_f32 v36, v36, v189
    v_mul_f32 v37, v37, v189
    v_mul_f32 v38, v38, v189
    v_mul_f32 v39, v39, v189
    v_mul_f32 v40, v40, v189
    v_mul_f32 v41, v41, v189
    v_mul_f32 v42, v42, v189
    v_mul_f32 v43, v43, v189
    v_mul_f32 v44, v44, v189
    v_mul_f32 v45, v45, v189
    v_mul_f32 v46, v46, v189
    v_mul_f32 v47, v47, v189
    v_mul_f32 v48, v48, v189
    v_mul_f32 v49, v49, v189
    v_mul_f32 v50, v50, v189
    v_mul_f32 v51, v51, v189
    v_mul_f32 v52, v52, v189
    v_mul_f32 v53, v53, v189
    v_mul_f32 v54, v54, v189
    v_mul_f32 v55, v55, v189
    v_mul_f32 v56, v56, v189
    v_mul_f32 v57, v57, v189
    v_mul_f32 v58, v58, v189
    v_mul_f32 v59, v59, v189
    v_mul_f32 v60, v60, v189
    v_mul_f32 v61, v61, v189
    v_mul_f32 v62, v62, v189
    v_mul_f32 v63, v63, v189
    v_mul_f32 v182, v182, v189
    v_exp_f32 v187, v96
    v_exp_f32 v190, v97
    s_nop 0
    v_add_f32 v180, v187, v190
    v_cvt_pk_bf16_f32 v160, v187, v190
    v_exp_f32 v187, v98
    v_exp_f32 v190, v99
    v_add_f32 v180, v180, v187
    v_add_f32 v180, v180, v190
    v_cvt_pk_bf16_f32 v161, v187, v190
    v_exp_f32 v187, v100
    v_exp_f32 v190, v101
    v_add_f32 v180, v180, v187
    v_add_f32 v180, v180, v190
    v_cvt_pk_bf16_f32 v162, v187, v190
    v_exp_f32 v187, v102
    v_exp_f32 v190, v103
    v_add_f32 v180, v180, v187
    v_add_f32 v180, v180, v190
    v_cvt_pk_bf16_f32 v163, v187, v190
    v_exp_f32 v187, v104
    v_exp_f32 v190, v105
    v_add_f32 v180, v180, v187
    v_add_f32 v180, v180, v190
    v_cvt_pk_bf16_f32 v164, v187, v190
    v_exp_f32 v187, v106
    v_exp_f32 v190, v107
    v_add_f32 v180, v180, v187
    v_add_f32 v180, v180, v190
    v_cvt_pk_bf16_f32 v165, v187, v190
    v_exp_f32 v187, v108
    v_exp_f32 v190, v109
    v_add_f32 v180, v180, v187
    v_add_f32 v180, v180, v190
    v_cvt_pk_bf16_f32 v166, v187, v190
    v_exp_f32 v187, v110
    v_exp_f32 v190, v111
    v_add_f32 v180, v180, v187
    v_add_f32 v180, v180, v190
    v_cvt_pk_bf16_f32 v167, v187, v190
    s_nop 3
    s_setpc_b64 s[76:77]
L_ka_codeend:
.section .rodata,"a"
.p2align 6
.amdhsa_kernel parallel_sum__compressed_kv_cla__moe_arch_mod__prompt_kernel
  .amdhsa_next_free_vgpr 512
  .amdhsa_next_free_sgpr 102
  .amdhsa_accum_offset 256
  .amdhsa_group_segment_fixed_size 0
  .amdhsa_kernarg_size 112
  .amdhsa_user_sgpr_count 2
  .amdhsa_user_sgpr_kernarg_segment_ptr 1
  .amdhsa_system_sgpr_workgroup_id_x 1
.end_amdhsa_kernel
```
